```python
import torch

def _softmax(x, axis=-1):
    return torch.softmax(x, dim=axis)
def _gelu(x):
    return torch.nn.functional.gelu(x, approximate="tanh")
def _silu(x):
    return torch.nn.functional.silu(x)
def _sigmoid(x):
    return torch.sigmoid(x)
def _layernorm(x, axis=-1, eps=1e-5):
    m = x.mean(dim=axis, keepdim=True)
    v = x.var(dim=axis, keepdim=True, unbiased=False)
    return (x - m) / torch.sqrt(v + eps)
def _scatter_add(tgt, idx, src, axis=0):
    return tgt.clone().index_add_(axis, idx, src)
def _segment_sum(src, seg, n):
    out = torch.zeros((n,) + src.shape[1:], dtype=src.dtype)
    return out.index_add_(0, seg, src)
def _pad(x, pw):
    flat = tuple(v for pair in reversed(pw) for v in pair)
    return torch.nn.functional.pad(x, flat)

kernel_name = 'parallel_sum__sliding_block__glu_gated_reglu__prompt'

def setup_inputs():

    _w = (lambda a: (lambda t: t.to(torch.bfloat16) if t.is_floating_point() else t)(torch.as_tensor(a)))
    def _A_setup():
        B, S, D = 1, 2048, 640
        return {
            "x": _w((lambda *s: torch.randn(*s, dtype=torch.bfloat16) * 0.05)(B, S, D)),
            "wqkv": _w((lambda *s: torch.randn(*s, dtype=torch.bfloat16) * 0.05)(D, 3 * D)),
            "wo": _w((lambda *s: torch.randn(*s, dtype=torch.bfloat16) * 0.05)(D, D)),
        }
    _A_in = _A_setup()

    def _B_setup():
        B, S, D, F = 1, 2048, 640, 1536
        return {
            "x": _w((lambda *s: torch.randn(*s, dtype=torch.bfloat16) * 0.05)(B, S, D)),
            "W_gate": _w((lambda *s: torch.randn(*s, dtype=torch.bfloat16) * 0.8)(D, F) * (2.0 / D) ** 0.5),
            "W_up": _w((lambda *s: torch.randn(*s, dtype=torch.bfloat16) * 0.8)(D, F) * (2.0 / D) ** 0.5),
            "W_down": _w((lambda *s: torch.randn(*s, dtype=torch.bfloat16) * 0.8)(F, D) * (1.0 / F) ** 0.5),
        }
    _B_in = _B_setup()

    return {
        "A_x": _A_in["x"],
        "A_wqkv": _A_in["wqkv"],
        "A_wo": _A_in["wo"],
        "B_x": _B_in["x"],
        "B_W_gate": _B_in["W_gate"],
        "B_W_up": _B_in["W_up"],
        "B_W_down": _B_in["W_down"],
    }

def reference(A_x, A_wqkv, A_wo, B_x, B_W_gate, B_W_up, B_W_down):
    def _A_ref(x, wqkv, wo):
        B, S, D = x.shape
        H = 32; Dh = D // H; W = 256
        qkv = (lambda x, *d: x.permute(*d))((x @ wqkv).reshape(B, S, 3, H, Dh), 2, 0, 3, 1, 4)
        q, k, v = qkv[0], qkv[1], qkv[2]
        scores = torch.einsum("bhqd,bhkd->bhqk", q, k) * (Dh ** -0.5)
        idx = torch.arange(S)
        mask = (idx[:, None] - idx[None, :] >= 0) & (idx[:, None] - idx[None, :] < W)
        scores = torch.where(mask[None, None], scores, -1e9)
        p = _softmax(scores, axis=-1)
        o = torch.einsum("bhqk,bhkd->bhqd", p, v)
        return (lambda x, *d: x.permute(*d))(o, 0, 2, 1, 3).reshape(B, S, D) @ wo

    def _B_ref(x, W_gate, W_up, W_down):
        gate = torch.einsum("bsd,df->bsf", x, W_gate)
        up = torch.einsum("bsd,df->bsf", x, W_up)
        gate = gate * (lambda x, dt: x.to(dt))(gate > 0, gate.dtype)
        h = gate * up
        return torch.einsum("bsf,fd->bsd", h, W_down)

    x = A_x
    xn = _layernorm(x, axis=-1)
    return x + _A_ref(xn, A_wqkv, A_wo) + _B_ref(xn, B_W_gate, B_W_up, B_W_down)
```

```asm
; @launch grid=(256,1,1) block=(256,1,1) lds=163840
.amdgcn_target "amdgcn-amd-amdhsa--gfx950"
.text
.globl parallel_sum__sliding_block__glu_gated_reglu__prompt_kernel
.p2align 8
.type parallel_sum__sliding_block__glu_gated_reglu__prompt_kernel,@function
parallel_sum__sliding_block__glu_gated_reglu__prompt_kernel:
  s_cmp_ge_u32 s2, 256
  s_cbranch_scc1 .Lend
  s_load_dwordx16 s[4:19], s[0:1], 0
  s_load_dwordx4 s[20:23], s[0:1], 64
  s_and_b32 s81, s2, 7
  s_lshr_b32 s82, s2, 3
  s_getpc_b64 s[24:25]
  s_lshl_b32 s26, s82, 11
  s_cmp_ge_u32 s81, 6
  s_cselect_b32 s27, .LV-parallel_sum__sliding_block__glu_gated_reglu__prompt_kernel, 0
  s_add_u32 s26, s26, s27
  s_add_u32 s24, s24, s26
  s_addc_u32 s25, s25, 0
  v_lshlrev_b32 v20, 3, v0
  v_mov_b32 v21, s25
  v_add_co_u32 v20, vcc, s24, v20
  v_lshrrev_b32 v1, 6, v0
  v_and_b32 v0, 63, v0
  v_addc_co_u32 v21, vcc, 0, v21, vcc
  v_readfirstlane_b32 s3, v1
  s_mov_b64 exec, 0x00010001
  s_mov_b32 exec_hi, 0x00010001
  global_load_dword v22, v[20:21], off
  s_mov_b64 exec, -1
  s_and_b32 s83, s82, 7
  s_lshr_b32 s84, s82, 3
  s_and_b32 s63, s81, 1
  s_lshl3_add_u32 s63, s63, s83
  s_lshr_b32 s64, s81, 1
  s_lshl2_add_u32 s64, s64, s84
  s_lshl1_add_u32 s85, s84, s83
  s_mul_i32 s85, s85, 5
  s_lshr_b32 s85, s85, 2
  s_sub_u32 s86, s85, 10
  s_min_u32 s85, s85, s86
  s_sub_u32 s60, 9, s85
  v_lshrrev_b32 v24, 5, v0
  v_and_b32 v25, 3, v0
  v_bfe_u32 v26, v0, 2, 3
  v_bfe_u32 v28, v0, 4, 1
  v_xor_b32 v28, v28, v25
  v_mul_u32_u24 v128, 1280, v26
  v_lshl_add_u32 v128, v24, 6, v128
  v_lshl_add_u32 v128, v28, 4, v128
  v_xor_b32 v129, 32, v128
  v_add_u32 v129, 9216, v129
  v_add_u32 v130, 18432, v128
  v_add_u32 v131, 18432, v129
  v_lshlrev_b32 v29, 6, v24
  v_lshl_add_u32 v29, v25, 4, v29
  v_lshl_add_u32 v30, s3, 4, v26
  s_movk_i32 s86, 3840
  v_mad_u32_u24 v1, v30, s86, v29
  v_add_u32 v2, 29696, v1
  s_lshl2_add_u32 s87, s63, s3
  s_mul_i32 s59, s87, 40960
  s_lshl_b32 s86, s85, 7
  s_add_u32 s59, s59, s86
  s_lshl_b32 s61, s3, 12
  s_add_u32 s62, s61, 98304
  s_mul_i32 s56, s85, 245760
  s_lshl_b32 s86, s64, 8
  s_add_u32 s56, s56, s86
  s_movk_i32 s74, 128
  s_mov_b32 s75, 245760
  s_cmp_eq_u32 s64, 15
  s_cselect_b32 s34, 0, 2457600
  s_mov_b32 s35, 0x20000
  s_mov_b32 s30, 2621440
  s_mov_b32 s31, 0x20000
  s_waitcnt lgkmcnt(0)
  s_mov_b32 s28, s4
  s_mov_b32 s29, s5
  s_mov_b32 s32, s6
  s_mov_b32 s33, s7
  s_add_u32 m0, s62, 0
  s_cmp_eq_u32 s60, 0
  s_cselect_b32 s77, -1152, s74
  buffer_load_dwordx4 v128, s[28:31], s59 offen offset:0 lds
  buffer_load_dwordx4 v129, s[28:31], s59 offen offset:1024 lds
  buffer_load_dwordx4 v130, s[28:31], s59 offen offset:2048 lds
  buffer_load_dwordx4 v131, s[28:31], s59 offen offset:3072 lds
  s_add_u32 s59, s59, s77
  s_add_u32 m0, s61, 0
  s_nop 0
  buffer_load_dwordx4 v1, s[32:35], s56 offen offset:0 lds
  buffer_load_dwordx4 v2, s[32:35], s56 offen offset:1024 lds
  s_add_u32 m0, s61, 1920
  s_cmp_eq_u32 s60, 0
  s_cselect_b32 s77, -2211840, s75
  buffer_load_dwordx4 v1, s[32:35], s56 offen offset:128 lds
  buffer_load_dwordx4 v2, s[32:35], s56 offen offset:1152 lds
  s_add_u32 s56, s56, s77
  s_mov_b32 s24, s22
  s_mov_b32 s25, s23
  s_mov_b32 s26, 22020096
  s_mov_b32 s27, 0x20000
  s_mov_b32 s52, s20
  s_mov_b32 s53, s21
  s_mov_b32 s54, 256
  s_mov_b32 s55, 0x20000
  s_mov_b32 s101, 1073741824
  v_lshlrev_b32 v14, 4, v0
  v_mov_b32 v148, 0x3f803f80
  v_mov_b32 v149, 0x3f803f80
  v_mov_b32 v150, 0x3f803f80
  v_mov_b32 v151, 0x3f803f80
  s_cmp_eq_u32 s64, 15
  s_cbranch_scc0 .Lnohdr
  s_mul_i32 s88, s87, 30720
  s_movk_i32 s89, 3072
  v_lshrrev_b32 v41, 4, v0
  v_and_b32 v42, 15, v0
  v_lshl_add_u32 v42, v42, 7, s88
  v_mad_u32_u24 v41, v41, s89, v42
  v_add_u32 v42, 12288, v41
  v_add_u32 v43, 24576, v41
  v_lshrrev_b32 v44, 3, v0
  v_and_b32 v45, 7, v0
  v_lshl_add_u32 v45, v45, 7, s88
  v_mad_u32_u24 v44, v44, s89, v45
  v_add_u32 v45, 24576, v44
  s_mov_b64 exec, -1
  global_load_dword v40, v44, s[12:13] offset:2048
  global_load_dword v40, v44, s[14:15] offset:2048
  s_mov_b64 exec, 0xffff
  global_load_dword v40, v45, s[12:13] offset:2048
  global_load_dword v40, v45, s[14:15] offset:2048
  s_mul_i32 s88, s87, 123392
  s_add_u32 s88, s88, 122880
  s_mov_b64 exec, 255
  buffer_store_dwordx4 v[148:151], v14, s[24:27], s88 offen sc1
  s_mov_b64 exec, -1
.Lnohdr:
  s_lshl2_add_u32 s88, s2, s3
  s_cmp_eq_u32 s88, 3
  s_cbranch_scc0 .Lnoz
  v_mov_b32 v32, 0
  v_mov_b32 v33, 0
  v_mov_b32 v34, 0
  v_mov_b32 v35, 0
  s_mov_b32 s88, 18104320
  s_mov_b32 s89, 18108416
  s_mov_b32 s90, 18112512
  buffer_store_dwordx4 v[32:35], v14, s[24:27], s88 offen offset:0 sc1
  buffer_store_dwordx4 v[32:35], v14, s[24:27], s88 offen offset:1024 sc1
  buffer_store_dwordx4 v[32:35], v14, s[24:27], s88 offen offset:2048 sc1
  buffer_store_dwordx4 v[32:35], v14, s[24:27], s88 offen offset:3072 sc1
  buffer_store_dwordx4 v[32:35], v14, s[24:27], s89 offen offset:0 sc1
  buffer_store_dwordx4 v[32:35], v14, s[24:27], s89 offen offset:1024 sc1
  buffer_store_dwordx4 v[32:35], v14, s[24:27], s89 offen offset:2048 sc1
  buffer_store_dwordx4 v[32:35], v14, s[24:27], s89 offen offset:3072 sc1
  buffer_store_dwordx4 v[32:35], v14, s[24:27], s90 offen offset:0 sc1
  buffer_store_dwordx4 v[32:35], v14, s[24:27], s90 offen offset:1024 sc1
  s_mov_b32 s101, 0
  s_nop 1
.Lnoz:
  s_movk_i32 s86, 3072
  v_mad_u32_u24 v154, v30, s86, v29
  s_xor_b32 s86, s64, 4
  s_lshl_b32 s86, s86, 7
  v_add_u32 v154, s86, v154
  v_and_b32 v27, 31, v0
  s_and_b32 s10, s81, 1
  s_lshl4_add_u32 s10, s10, s83
  s_and_b32 s11, s81, 2
  s_lshl2_add_u32 s10, s11, s10
  s_and_b32 s11, s81, 4
  s_add_u32 s11, s11, s84
  s_and_b32 s88, s3, 1
  s_lshl1_add_u32 s88, s82, s88
  s_lshr_b32 s89, s81, 1
  s_mul_i32 s90, s88, 49152
  s_lshl_b32 s91, s89, 9
  s_add_u32 s91, s91, s90
  s_lshl_b32 s89, s89, 8
  s_lshl1_add_u32 s89, s90, s89
  s_sub_u32 s89, s89, 3930112
  s_cmp_lt_u32 s88, 40
  s_cselect_b32 s89, s91, s89
  s_cselect_b32 s88, 2, 1
  v_lshrrev_b32 v153, s88, v0
  v_mul_u32_u24 v153, 3072, v153
  v_bfe_u32 v31, v0, 0, s88
  v_lshl_add_u32 v153, v31, 7, v153
  v_add_u32 v153, s89, v153
  s_mov_b32 s36, s12
  s_mov_b32 s37, s13
  s_mov_b32 s38, 1966080
  s_mov_b32 s39, 0x20000
  s_mov_b32 s40, s14
  s_mov_b32 s41, s15
  s_mov_b32 s42, 1966080
  s_mov_b32 s43, 0x20000
  s_cmp_lt_u32 s3, 2
  s_cselect_b32 s44, s12, s14
  s_cselect_b32 s45, s13, s15
  s_mov_b32 s46, 1966080
  s_mov_b32 s47, 0x20000
  s_lshl1_add_u32 s89, s10, s3
  s_lshr_b32 s90, s63, 1
  s_and_b32 s91, s63, 1
  s_lshl1_add_u32 s91, s91, s3
  s_add_u32 s91, s91, 62
  s_cmp_lt_u32 s3, 2
  s_cselect_b32 s88, s11, s90
  s_cselect_b32 s89, s89, s91
  s_cselect_b32 s92, 15, s64
  s_mul_i32 s78, s88, 68
  s_add_u32 s78, s78, s89
  s_mul_i32 s78, s78, 5120
  s_add_u32 s78, s78, 18874368
  s_sub_u32 s90, s89, 48
  s_mov_b32 s50, 819200
  s_cmp_lt_u32 s89, 48
  s_cselect_b32 s48, s16, s8
  s_cselect_b32 s49, s17, s9
  s_cselect_b32 s50, 1966080, s50
  s_cselect_b32 s89, s89, s90
  s_mul_i32 s89, s89, 40960
  s_mul_i32 s88, s88, 160
  s_add_u32 s76, s88, s89
  s_mov_b32 s51, 0x20000
  s_cmp_eq_u32 s92, 15
  s_cselect_b32 s50, s50, 0
  s_cselect_b32 s78, s78, 1073741824
  s_mov_b32 s16, s18
  s_mov_b32 s17, s19
  s_mov_b32 s18, 2621440
  s_mov_b32 s19, 0x20000
  s_mul_i32 s4, s85, 196608
  s_add_u32 s5, s4, 196608
  s_cmp_eq_u32 s60, 0
  s_cselect_b32 s5, 0, s5
  s_add_u32 s6, s5, 196608
  s_cmp_eq_u32 s60, 1
  s_cselect_b32 s6, 0, s6
  s_add_u32 s7, s6, 196608
  s_cmp_eq_u32 s60, 2
  s_cselect_b32 s7, 0, s7
  s_add_u32 s8, s7, 196608
  s_cmp_eq_u32 s60, 3
  s_cselect_b32 s8, 0, s8
  s_add_u32 s9, s8, 196608
  s_cmp_eq_u32 s60, 4
  s_cselect_b32 s9, 0, s9
  s_add_u32 s12, s9, 196608
  s_cmp_eq_u32 s60, 5
  s_cselect_b32 s12, 0, s12
  s_add_u32 s13, s12, 196608
  s_cmp_eq_u32 s60, 6
  s_cselect_b32 s13, 0, s13
  s_add_u32 s14, s13, 196608
  s_cmp_eq_u32 s60, 7
  s_cselect_b32 s14, 0, s14
  s_add_u32 s15, s14, 196608
  s_cmp_eq_u32 s60, 8
  s_cselect_b32 s15, 0, s15
  s_lshl2_add_u32 s86, s81, s84
  s_and_b32 s87, s84, 1
  s_mul_i32 s88, s86, 5
  s_lshr_b32 s88, s88, 1
  s_add_u32 s96, s88, s87
  s_xor_b32 s89, s87, 1
  s_lshl1_add_u32 s97, s89, s88
  s_mul_i32 s94, s86, 320
  s_lshl3_add_u32 s88, s83, s3
  s_mul_i32 s22, s88, 123392
  s_add_u32 s22, s22, 40960
  s_add_u32 s23, s22, 493568
  s_sub_u32 s20, s22, 987136
  s_cmp_eq_u32 s83, 0
  s_cselect_b32 s20, 1073741824, s20
  s_add_u32 s21, s20, 493568
  s_lshl2_add_u32 s88, s83, s3
  s_mul_i32 s57, s88, 246784
  s_mov_b32 s93, s83
  s_lshl1_add_u32 s91, s84, s83
  s_mul_i32 s88, s88, 278528
  s_add_u32 s88, s88, 8437760
  s_lshl_b32 s82, s96, 8
  s_add_u32 s82, s82, s88
  s_lshl_b32 s83, s97, 8
  s_add_u32 s83, s83, s88
  s_lshl3_add_u32 s83, s87, s83
  s_add_u32 s84, s82, 139264
  s_add_u32 s85, s83, 139264
  s_lshl_b32 s96, s96, 9
  s_lshl_b32 s97, s97, 9
  s_mov_b32 s92, s87
  s_and_b32 s86, s3, 1
  s_lshr_b32 s87, s3, 1
  s_xor_b32 s58, s64, 8
  s_xor_b32 s88, s64, 4
  s_lshl_b32 s88, s88, 1
  s_sub_u32 s58, s58, s88
  s_lshl_b32 s58, s58, 6
  s_add_u32 s58, s58, 2048
  s_mul_i32 s88, s87, 98304
  s_sub_u32 s58, s58, s88
  v_bfe_u32 v30, v0, 2, 2
  v_bfe_u32 v31, v0, 4, 1
  v_and_b32 v32, 1, v0
  v_bfe_u32 v33, v0, 1, 1
  v_lshlrev_b32 v34, 4, v32
  v_lshl_add_u32 v34, v33, 3, v34
  v_lshl_add_u32 v34, v30, 6, v34
  v_lshl_add_u32 v4, v24, 10, v34
  v_lshl_add_u32 v4, v31, 5, v4
  s_lshl_b32 s88, s87, 9
  s_lshl_b32 s89, s86, 12
  s_add_u32 s88, s88, s89
  v_add_u32 v4, s88, v4
  v_add_u32 v5, 65536, v4
  v_xor_b32 v6, 4096, v4
  v_add_u32 v7, 65536, v6
  v_bfe_u32 v35, v0, 3, 2
  v_and_b32 v36, 7, v0
  v_lshlrev_b32 v35, 10, v35
  v_lshl_add_u32 v35, v36, 6, v35
  s_lshl_b32 s88, s86, 13
  s_add_u32 s88, s88, 98304
  s_lshl_b32 s89, s86, 5
  v_add_u32 v37, s88, v35
  v_xor_b32 v36, v30, v24
  v_lshl_add_u32 v8, v36, 4, v37
  v_xor_b32 v8, s89, v8
  v_xor_b32 v9, 32, v8
  s_lshl_b32 s89, s87, 12
  s_add_u32 s88, s88, s89
  v_and_b32 v35, 2047, v35
  v_lshrrev_b32 v37, 4, v0
  v_xor_b32 v36, v37, v30
  v_lshl_add_u32 v35, v36, 4, v35
  v_add_u32 v152, s88, v35
  s_lshl1_add_u32 s88, s86, s87
  s_lshl_b32 s88, s88, 7
  s_add_u32 s88, s88, 160768
  v_and_b32 v35, 15, v0
  v_xor_b32 v38, 24, v35
  v_cmp_eq_u32 vcc, 0, v36
  s_nop 1
  v_cndmask_b32 v35, v38, v35, vcc
  v_lshl_add_u32 v35, v35, 2, s88
  v_and_b32 v38, 1, v36
  v_cmp_eq_u32 vcc, 0, v38
  v_mov_b32 v38, 162816
  s_nop 0
  v_cndmask_b32 v23, v38, v35, vcc
  s_lshl_b32 s88, s87, 9
  s_add_u32 s88, s88, 161792
  s_lshl_b32 s89, s86, 8
  s_add_u32 s89, s89, s88
  v_lshl_add_u32 v15, v27, 2, s89
  v_lshl_add_u32 v16, v27, 2, s88
  v_lshl_add_u32 v16, v24, 8, v16
  s_lshl_b32 s88, s86, 8
  s_add_u32 s88, s88, 160768
  v_lshl_add_u32 v19, v27, 2, s88
  v_lshl_add_u32 v18, v24, 4, s88
  v_mul_u32_u24 v232, 1280, v26
  v_add_u32 v232, v232, v29
  v_xor_b32 v233, 32, v232
  v_add_u32 v233, 9216, v233
  v_add_u32 v234, 18432, v232
  v_add_u32 v235, 18432, v233
  v_bfe_u32 v35, v0, 3, 2
  v_bfe_u32 v38, v0, 1, 2
  v_lshl_add_u32 v35, v35, 3, v38
  v_lshl_add_u32 v35, v24, 2, v35
  v_mul_u32_u24 v236, 1280, v35
  v_lshl_add_u32 v236, v32, 4, v236
  v_add_u32 v236, 128, v236
  s_min_u32 s88, s3, 2
  s_add_u32 s88, s88, 16
  s_add_u32 s90, s3, 7
  s_cmp_eq_u32 s64, 15
  s_cselect_b32 s88, s90, s88
  s_mul_i32 s88, s88, 5120
  s_add_u32 s90, s88, 4096
  v_lshlrev_b32 v35, 3, v25
  v_lshlrev_b32 v20, 1, v31
  v_xor_b32 v20, v20, v25
  v_lshlrev_b32 v20, 4, v20
  v_lshl_add_u32 v20, v37, 10, v20
  v_lshl_add_u32 v20, v30, 6, v20
  v_add_u32 v20, s88, v20
  v_add_u32 v21, 8, v20
  v_lshl_add_u32 v155, v37, 7, v35
  v_lshl_add_u32 v155, v30, 5, v155
  v_add_u32 v155, s90, v155
  v_lshlrev_b32 v35, 4, v25
  v_lshl_add_u32 v35, v31, 8, v35
  v_bfe_u32 v38, v0, 2, 1
  v_lshl_add_u32 v35, v38, 7, v35
  v_bfe_u32 v39, v0, 3, 1
  v_lshl_add_u32 v35, v39, 6, v35
  v_mul_u32_u24 v12, 10240, v24
  v_add_u32 v12, v12, v35
  v_mul_u32_u24 v13, 69632, v31
  v_lshl_add_u32 v13, v24, 8, v13
  v_and_b32 v36, 15, v0
  v_lshl_add_u32 v13, v36, 4, v13
  v_cmp_eq_u32 vcc, 1, v0
  v_mov_b32 v36, 1073741824
  s_nop 0
  v_cndmask_b32 v17, v36, 0, vcc
  v_xor_b32 v38, v38, v31
  v_or_b32 v38, v38, v25
  v_cmp_eq_u32 vcc, 0, v38
  s_nop 1
  v_cndmask_b32 v32, 0, v148, vcc
  v_cndmask_b32 v33, 0, v148, vcc
  v_cndmask_b32 v34, 0, v148, vcc
  v_cndmask_b32 v35, 0, v148, vcc
  v_mov_b32 v37, 0
  v_mov_b32 v39, 0
  s_lshl1_add_u32 s81, s63, s86
  s_lshl_b32 s88, s81, 1
  s_mul_i32 s65, s88, 123392
  s_mul_i32 s69, s88, 139264
  s_add_u32 s69, s69, 8388608
  s_lshl1_add_u32 s89, s64, s87
  s_xor_b32 s89, s89, 8
  s_lshl_b32 s81, s81, 5
  s_add_u32 s81, s81, s89
  s_lshl_b32 s81, s81, 2
  s_add_u32 s81, s81, 18106368
  s_xor_b32 s88, s89, 24
  s_lshl_b32 s88, s88, 9
  s_add_u32 s71, s69, s88
  s_add_u32 s71, s71, 32768
  s_add_u32 s72, s71, 139264
  s_lshl_b32 s88, s89, 10
  s_add_u32 s69, s69, s88
  s_add_u32 s70, s69, 139264
  s_lshl4_add_u32 s79, s63, s64
  s_lshl_b32 s79, s79, 2
  s_add_u32 s79, s79, 18105344
  s_lshl_b32 s80, s11, 5
  s_add_u32 s80, s80, s10
  s_lshl_b32 s80, s80, 2
  s_add_u32 s80, s80, 18104320
  s_cmp_eq_u32 s3, 0
  s_cselect_b32 s79, s79, 1073741824
  s_cselect_b32 s80, s80, 1073741824
  s_cmp_lt_u32 s64, 5
  s_cselect_b32 s73, 0x3ea52b5c, 1.0
  s_lshl2_add_u32 s86, s64, s87
  s_mov_b32 s95, 18104320
  s_mov_b32 s0, 0xaaaaaaaa
  s_mov_b32 s1, s0
  s_mov_b32 s88, 0xcccccccc
  s_mov_b32 s89, s88
  s_mul_i32 s63, s3, 5120
  s_add_u32 m0, s62, 16384
  s_cmp_eq_u32 s60, 1
  s_cselect_b32 s77, -1152, s74
  buffer_load_dwordx4 v128, s[28:31], s59 offen offset:0 lds
  buffer_load_dwordx4 v129, s[28:31], s59 offen offset:1024 lds
  buffer_load_dwordx4 v130, s[28:31], s59 offen offset:2048 lds
  buffer_load_dwordx4 v131, s[28:31], s59 offen offset:3072 lds
  s_add_u32 s59, s59, s77
  s_add_u32 m0, s61, 16384
  s_nop 0
  buffer_load_dwordx4 v1, s[32:35], s56 offen offset:0 lds
  buffer_load_dwordx4 v2, s[32:35], s56 offen offset:1024 lds
  s_add_u32 m0, s61, 18304
  s_cmp_eq_u32 s60, 1
  s_cselect_b32 s77, -2211840, s75
  buffer_load_dwordx4 v1, s[32:35], s56 offen offset:128 lds
  buffer_load_dwordx4 v2, s[32:35], s56 offen offset:1152 lds
  s_add_u32 s56, s56, s77
  s_sub_u32 s87, s64, 10
  s_cmp_lt_u32 s87, 5
  s_cbranch_scc1 .LV
  s_cmp_eq_u32 s64, 15
  s_cbranch_scc1 .LH
  s_lshl_b32 s87, s86, 11
  s_add_u32 s65, s65, s87
  s_cmp_eq_u32 s64, 15
  s_cselect_b32 s65, 1073741824, s65
  s_add_u32 s66, s65, 4096
  s_add_u32 s67, s65, 123392
  s_add_u32 s68, s66, 123392
  s_mul_i32 s64, s3, 3072
  s_add_u32 s64, s64, 65536
  s_add_u32 s87, s78, 4096
  s_waitcnt vmcnt(8)
  s_barrier
  ds_read_b64_tr_b16 v[40:41], v4 offset:0
  ds_read_b64_tr_b16 v[42:43], v4 offset:256
  ds_read_b128 a[0:3], v8 offset:0
  ds_read_b128 a[4:7], v8 offset:4096
  ds_read_b128 v[132:135], v152 offset:0
  ds_read_b64_tr_b16 v[44:45], v4 offset:2048
  ds_read_b64_tr_b16 v[46:47], v4 offset:2304
  ds_read_b128 a[8:11], v9 offset:0
  ds_read_b128 a[12:15], v9 offset:4096
  ds_read_b128 v[136:139], v152 offset:2048
  ds_read_b64_tr_b16 v[48:49], v6 offset:0
  ds_read_b64_tr_b16 v[50:51], v6 offset:256
  ds_read_b128 a[16:19], v8 offset:512
  ds_read_b128 a[20:23], v8 offset:4608
  ds_read_b128 v[140:143], v152 offset:512
  ds_read_b64_tr_b16 v[52:53], v6 offset:2048
  ds_read_b64_tr_b16 v[54:55], v6 offset:2304
  ds_read_b128 a[24:27], v9 offset:512
  ds_read_b128 a[28:31], v9 offset:4608
  ds_read_b128 v[144:147], v152 offset:2560
  s_waitcnt lgkmcnt(15)
  v_mfma_f32_32x32x16_bf16 v[64:79], v[40:43], a[0:3], 0
  ds_read_b64_tr_b16 v[56:57], v4 offset:8192
  ds_read_b64_tr_b16 v[58:59], v4 offset:8448
  s_cmp_eq_u32 s60, 2
  s_cselect_b32 s77, -1152, s74
  s_add_u32 m0, s62, 32768
  v_mfma_f32_32x32x16_bf16 v[96:111], v[40:43], a[4:7], 0
  buffer_load_dwordx4 v128, s[28:31], s59 offen offset:0 lds
  v_mfma_f32_16x16x32_bf16 v[24:27], v[32:35], v[40:43], 0
  v_mfma_f32_16x16x32_bf16 v[176:179], v[132:135], v[132:135], 0
  v_mfma_f32_16x16x32_bf16 v[184:187], v[148:151], v[132:135], 0
  s_waitcnt lgkmcnt(15)
  v_mfma_f32_32x32x16_bf16 v[80:95], v[44:47], a[0:3], 0
  ds_read_b64_tr_b16 v[60:61], v4 offset:10240
  ds_read_b64_tr_b16 v[62:63], v4 offset:10496
  buffer_load_dwordx4 v129, s[28:31], s59 offen offset:1024 lds
  v_mfma_f32_32x32x16_bf16 v[112:127], v[44:47], a[4:7], 0
  s_waitcnt lgkmcnt(14)
  buffer_load_dwordx4 v130, s[28:31], s59 offen offset:2048 lds
  v_mfma_f32_16x16x32_bf16 v[28:31], v[32:35], v[44:47], 0
  v_mfma_f32_16x16x32_bf16 v[180:183], v[136:139], v[136:139], 0
  v_mfma_f32_16x16x32_bf16 v[188:191], v[148:151], v[136:139], 0
  s_waitcnt lgkmcnt(12)
  v_mfma_f32_32x32x16_bf16 v[64:79], v[48:51], a[8:11], v[64:79]
  ds_read_b64_tr_b16 v[40:41], v6 offset:8192
  ds_read_b64_tr_b16 v[42:43], v6 offset:8448
  buffer_load_dwordx4 v131, s[28:31], s59 offen offset:3072 lds
  s_add_u32 s59, s59, s77
  v_mfma_f32_32x32x16_bf16 v[96:111], v[48:51], a[12:15], v[96:111]
  ds_read_b64_tr_b16 v[44:45], v6 offset:10240
  ds_read_b64_tr_b16 v[46:47], v6 offset:10496
  s_waitcnt lgkmcnt(13)
  s_add_u32 m0, s61, 32768
  v_mfma_f32_16x16x32_bf16 v[176:179], v[140:143], v[140:143], v[176:179]
  v_mfma_f32_16x16x32_bf16 v[184:187], v[148:151], v[140:143], v[184:187]
  s_waitcnt lgkmcnt(11)
  v_mfma_f32_32x32x16_bf16 v[80:95], v[52:55], a[8:11], v[80:95]
  buffer_load_dwordx4 v1, s[32:35], s56 offen offset:0 lds
  v_mfma_f32_32x32x16_bf16 v[112:127], v[52:55], a[12:15], v[112:127]
  s_waitcnt lgkmcnt(8)
  buffer_load_dwordx4 v2, s[32:35], s56 offen offset:1024 lds
  s_cmp_eq_u32 s60, 2
  s_cselect_b32 s77, -2211840, s75
  v_mfma_f32_16x16x32_bf16 v[180:183], v[144:147], v[144:147], v[180:183]
  s_add_u32 m0, s61, 34688
  v_mfma_f32_16x16x32_bf16 v[188:191], v[148:151], v[144:147], v[188:191]
  s_waitcnt lgkmcnt(4)
  v_mfma_f32_32x32x16_bf16 v[64:79], v[56:59], a[16:19], v[64:79]
  s_waitcnt vmcnt(6) lgkmcnt(0)
  buffer_store_dword v5, v37, s[52:55], s101 offen sc1
  s_barrier
  ds_read_b64_tr_b16 v[48:49], v4 offset:16384
  ds_read_b64_tr_b16 v[50:51], v4 offset:16640
  ds_read_b128 v[132:135], v152 offset:16384
  v_mfma_f32_32x32x16_bf16 v[96:111], v[56:59], a[20:23], v[96:111]
  ds_read_b128 a[32:35], v8 offset:16384
  ds_read_b128 a[36:39], v8 offset:20480
  buffer_load_dwordx4 v1, s[32:35], s56 offen offset:128 lds
  v_mfma_f32_16x16x32_bf16 v[24:27], v[32:35], v[56:59], v[24:27]
  v_mfma_f32_32x32x16_bf16 v[80:95], v[60:63], a[16:19], v[80:95]
  ds_read_b64_tr_b16 v[52:53], v4 offset:18432
  ds_read_b64_tr_b16 v[54:55], v4 offset:18688
  ds_read_b128 v[136:139], v152 offset:18432
  buffer_load_dwordx4 v2, s[32:35], s56 offen offset:1152 lds
  v_mfma_f32_32x32x16_bf16 v[112:127], v[60:63], a[20:23], v[112:127]
  ds_read_b128 a[40:43], v9 offset:16384
  ds_read_b128 a[44:47], v9 offset:20480
  s_add_u32 s56, s56, s77
  s_sub_u32 m0, s90, 4096
  v_mfma_f32_16x16x32_bf16 v[28:31], v[32:35], v[60:63], v[28:31]
  v_mfma_f32_32x32x16_bf16 v[64:79], v[40:43], a[24:27], v[64:79]
  ds_read_b64_tr_b16 v[56:57], v6 offset:16384
  ds_read_b64_tr_b16 v[58:59], v6 offset:16640
  ds_read_b128 v[140:143], v152 offset:16896
  buffer_load_dwordx4 v232, s[48:51], s76 offen offset:0 nt lds
  v_mfma_f32_32x32x16_bf16 v[96:111], v[40:43], a[28:31], v[96:111]
  ds_read_b128 a[48:51], v8 offset:16896
  ds_read_b128 a[52:55], v8 offset:20992
  s_waitcnt lgkmcnt(7)
  buffer_load_dwordx4 v233, s[48:51], s76 offen offset:1024 nt lds
  v_mfma_f32_16x16x32_bf16 v[176:179], v[132:135], v[132:135], v[176:179]
  v_mfma_f32_16x16x32_bf16 v[184:187], v[148:151], v[132:135], v[184:187]
  v_mfma_f32_32x32x16_bf16 v[80:95], v[44:47], a[24:27], v[80:95]
  ds_read_b64_tr_b16 v[60:61], v6 offset:18432
  ds_read_b64_tr_b16 v[62:63], v6 offset:18688
  ds_read_b128 v[144:147], v152 offset:18944
  buffer_load_dwordx4 v234, s[48:51], s76 offen offset:2048 nt lds
  v_mfma_f32_32x32x16_bf16 v[112:127], v[44:47], a[28:31], v[112:127]
  ds_read_b128 a[56:59], v9 offset:16896
  ds_read_b128 a[60:63], v9 offset:20992
  v_mfma_f32_16x16x32_bf16 v[180:183], v[136:139], v[136:139], v[180:183]
  v_mfma_f32_16x16x32_bf16 v[188:191], v[148:151], v[136:139], v[188:191]
  v_mfma_f32_32x32x16_bf16 v[64:79], v[48:51], a[32:35], v[64:79]
  ds_read_b64_tr_b16 v[40:41], v4 offset:24576
  ds_read_b64_tr_b16 v[42:43], v4 offset:24832
  buffer_load_dwordx4 v235, s[48:51], s76 offen offset:3072 nt lds
  s_mov_b32 m0, s90
  v_mfma_f32_32x32x16_bf16 v[96:111], v[48:51], a[36:39], v[96:111]
  buffer_load_dwordx4 v236, s[48:51], s76 offen nt lds
  s_cmp_eq_u32 s60, 3
  s_cselect_b32 s77, -1152, s74
  s_add_u32 m0, s62, 49152
  v_mfma_f32_16x16x32_bf16 v[24:27], v[32:35], v[48:51], v[24:27]
  v_mfma_f32_32x32x16_bf16 v[80:95], v[52:55], a[32:35], v[80:95]
  ds_read_b64_tr_b16 v[44:45], v4 offset:26624
  ds_read_b64_tr_b16 v[46:47], v4 offset:26880
  buffer_load_dwordx4 v128, s[28:31], s59 offen offset:0 lds
  v_mfma_f32_32x32x16_bf16 v[112:127], v[52:55], a[36:39], v[112:127]
  v_mfma_f32_16x16x32_bf16 v[28:31], v[32:35], v[52:55], v[28:31]
  s_waitcnt lgkmcnt(7)
  v_mfma_f32_32x32x16_bf16 v[64:79], v[56:59], a[40:43], v[64:79]
  ds_read_b64_tr_b16 v[48:49], v6 offset:24576
  ds_read_b64_tr_b16 v[50:51], v6 offset:24832
  buffer_load_dwordx4 v129, s[28:31], s59 offen offset:1024 lds
  v_mfma_f32_32x32x16_bf16 v[96:111], v[56:59], a[44:47], v[96:111]
  ds_read_b64_tr_b16 v[52:53], v6 offset:26624
  ds_read_b64_tr_b16 v[54:55], v6 offset:26880
  v_mfma_f32_16x16x32_bf16 v[176:179], v[140:143], v[140:143], v[176:179]
  v_mfma_f32_16x16x32_bf16 v[184:187], v[148:151], v[140:143], v[184:187]
  v_mfma_f32_32x32x16_bf16 v[80:95], v[60:63], a[40:43], v[80:95]
  buffer_load_dwordx4 v130, s[28:31], s59 offen offset:2048 lds
  v_mfma_f32_32x32x16_bf16 v[112:127], v[60:63], a[44:47], v[112:127]
  s_waitcnt lgkmcnt(10)
  buffer_load_dwordx4 v131, s[28:31], s59 offen offset:3072 lds
  s_add_u32 s59, s59, s77
  v_mfma_f32_16x16x32_bf16 v[180:183], v[144:147], v[144:147], v[180:183]
  s_add_u32 m0, s61, 49152
  v_mfma_f32_16x16x32_bf16 v[188:191], v[148:151], v[144:147], v[188:191]
  s_waitcnt lgkmcnt(4)
  v_mfma_f32_32x32x16_bf16 v[64:79], v[40:43], a[48:51], v[64:79]
  s_waitcnt vmcnt(9) lgkmcnt(0)
  s_barrier
  ds_read_b64_tr_b16 v[56:57], v4 offset:32768
  ds_read_b64_tr_b16 v[58:59], v4 offset:33024
  ds_read_b128 v[132:135], v152 offset:32768
  v_mfma_f32_32x32x16_bf16 v[96:111], v[40:43], a[52:55], v[96:111]
  ds_read_b128 a[64:67], v8 offset:32768
  ds_read_b128 a[68:71], v8 offset:36864
  buffer_load_dwordx4 v1, s[32:35], s56 offen offset:0 lds
  v_mfma_f32_16x16x32_bf16 v[24:27], v[32:35], v[40:43], v[24:27]
  v_mfma_f32_32x32x16_bf16 v[80:95], v[44:47], a[48:51], v[80:95]
  ds_read_b64_tr_b16 v[60:61], v4 offset:34816
  ds_read_b64_tr_b16 v[62:63], v4 offset:35072
  ds_read_b128 v[136:139], v152 offset:34816
  buffer_load_dwordx4 v2, s[32:35], s56 offen offset:1024 lds
  v_mfma_f32_32x32x16_bf16 v[112:127], v[44:47], a[52:55], v[112:127]
  ds_read_b128 a[72:75], v9 offset:32768
  ds_read_b128 a[76:79], v9 offset:36864
  s_cmp_eq_u32 s60, 3
  s_cselect_b32 s77, -2211840, s75
  s_add_u32 m0, s61, 51072
  v_mfma_f32_16x16x32_bf16 v[28:31], v[32:35], v[44:47], v[28:31]
  v_mfma_f32_32x32x16_bf16 v[64:79], v[48:51], a[56:59], v[64:79]
  ds_read_b64_tr_b16 v[40:41], v6 offset:32768
  ds_read_b64_tr_b16 v[42:43], v6 offset:33024
  ds_read_b128 v[140:143], v152 offset:33280
  buffer_load_dwordx4 v1, s[32:35], s56 offen offset:128 lds
  v_mfma_f32_32x32x16_bf16 v[96:111], v[48:51], a[60:63], v[96:111]
  ds_read_b128 a[80:83], v8 offset:33280
  ds_read_b128 a[84:87], v8 offset:37376
  s_waitcnt lgkmcnt(7)
  buffer_load_dwordx4 v2, s[32:35], s56 offen offset:1152 lds
  v_mfma_f32_16x16x32_bf16 v[176:179], v[132:135], v[132:135], v[176:179]
  s_add_u32 s56, s56, s77
  v_mfma_f32_16x16x32_bf16 v[184:187], v[148:151], v[132:135], v[184:187]
  v_mfma_f32_32x32x16_bf16 v[80:95], v[52:55], a[56:59], v[80:95]
  ds_read_b64_tr_b16 v[44:45], v6 offset:34816
  ds_read_b64_tr_b16 v[46:47], v6 offset:35072
  ds_read_b128 v[144:147], v152 offset:35328
  s_cmp_eq_u32 s60, 4
  s_cselect_b32 s77, -1152, s74
  s_add_u32 m0, s62, 0
  v_mfma_f32_32x32x16_bf16 v[112:127], v[52:55], a[60:63], v[112:127]
  ds_read_b128 a[88:91], v9 offset:33280
  ds_read_b128 a[92:95], v9 offset:37376
  buffer_load_dwordx4 v128, s[28:31], s59 offen offset:0 lds
  v_mfma_f32_16x16x32_bf16 v[180:183], v[136:139], v[136:139], v[180:183]
  v_mfma_f32_16x16x32_bf16 v[188:191], v[148:151], v[136:139], v[188:191]
  v_mfma_f32_32x32x16_bf16 v[64:79], v[56:59], a[64:67], v[64:79]
  ds_read_b64_tr_b16 v[48:49], v4 offset:40960
  ds_read_b64_tr_b16 v[50:51], v4 offset:41216
  buffer_load_dwordx4 v129, s[28:31], s59 offen offset:1024 lds
  s_waitcnt vmcnt(10)
  v_mfma_f32_32x32x16_bf16 v[96:111], v[56:59], a[68:71], v[96:111]
  ds_read_b64_tr_b16 v[156:157], v20 offset:0
  ds_read_b64_tr_b16 v[158:159], v20 offset:256
  ds_read_b64_tr_b16 v[160:161], v21 offset:0
  ds_read_b64_tr_b16 v[162:163], v21 offset:256
  ds_read_b64_tr_b16 v[164:165], v20 offset:512
  ds_read_b64_tr_b16 v[166:167], v20 offset:768
  v_mfma_f32_16x16x32_bf16 v[24:27], v[32:35], v[56:59], v[24:27]
  ds_read_b64_tr_b16 v[168:169], v21 offset:512
  v_mfma_f32_32x32x16_bf16 v[80:95], v[60:63], a[64:67], v[80:95]
  ds_read_b64_tr_b16 v[52:53], v4 offset:43008
  ds_read_b64_tr_b16 v[54:55], v4 offset:43264
  buffer_load_dwordx4 v130, s[28:31], s59 offen offset:2048 lds
  ds_read_b64_tr_b16 v[170:171], v21 offset:768
  v_mfma_f32_32x32x16_bf16 v[112:127], v[60:63], a[68:71], v[112:127]
  ds_read_b64_tr_b16 v[172:173], v155 offset:0
  ds_read_b64_tr_b16 v[174:175], v155 offset:512
  buffer_load_dwordx4 v131, s[28:31], s59 offen offset:3072 lds
  s_add_u32 s59, s59, s77
  v_mfma_f32_16x16x32_bf16 v[28:31], v[32:35], v[60:63], v[28:31]
  s_waitcnt lgkmcnt(15)
  v_mfma_f32_32x32x16_bf16 v[64:79], v[40:43], a[72:75], v[64:79]
  ds_read_b64_tr_b16 v[56:57], v6 offset:40960
  ds_read_b64_tr_b16 v[58:59], v6 offset:41216
  s_add_u32 m0, s61, 65536
  v_mfma_f32_32x32x16_bf16 v[96:111], v[40:43], a[76:79], v[96:111]
  ds_read_b64_tr_b16 v[60:61], v6 offset:43008
  ds_read_b64_tr_b16 v[62:63], v6 offset:43264
  buffer_load_dwordx4 v1, s[32:35], s56 offen offset:0 lds
  v_mfma_f32_16x16x32_bf16 v[176:179], v[140:143], v[140:143], v[176:179]
  v_mfma_f32_16x16x32_bf16 v[184:187], v[148:151], v[140:143], v[184:187]
  v_mfma_f32_32x32x16_bf16 v[80:95], v[44:47], a[72:75], v[80:95]
  buffer_load_dwordx4 v2, s[32:35], s56 offen offset:1024 lds
  s_cmp_eq_u32 s60, 4
  s_cselect_b32 s77, -2211840, s75
  s_waitcnt lgkmcnt(4)
  v_mfma_f32_32x32x16_bf16 v[112:127], v[44:47], a[76:79], v[112:127]
  buffer_store_dwordx4 v[156:159], v14, s[24:27], s78 offen offset:0 sc1
  buffer_store_dwordx4 v[160:163], v14, s[24:27], s78 offen offset:1024 sc1
  buffer_store_dwordx4 v[164:167], v14, s[24:27], s78 offen offset:2048 sc1
  buffer_store_dwordx4 v[168:171], v14, s[24:27], s78 offen offset:3072 sc1
  buffer_store_dwordx4 v[172:175], v14, s[24:27], s87 offen offset:0 sc1
  v_mfma_f32_16x16x32_bf16 v[180:183], v[144:147], v[144:147], v[180:183]
  s_add_u32 m0, s61, 67456
  v_mfma_f32_16x16x32_bf16 v[188:191], v[148:151], v[144:147], v[188:191]
  v_mfma_f32_32x32x16_bf16 v[64:79], v[48:51], a[80:83], v[64:79]
  s_waitcnt vmcnt(11) lgkmcnt(0)
  s_barrier
  ds_read_b64_tr_b16 v[40:41], v4 offset:49152
  ds_read_b64_tr_b16 v[42:43], v4 offset:49408
  ds_read_b128 v[132:135], v152 offset:49152
  v_mfma_f32_32x32x16_bf16 v[96:111], v[48:51], a[84:87], v[96:111]
  ds_read_b128 a[96:99], v8 offset:49152
  ds_read_b128 a[100:103], v8 offset:53248
  buffer_load_dwordx4 v1, s[32:35], s56 offen offset:128 lds
  v_mfma_f32_16x16x32_bf16 v[24:27], v[32:35], v[48:51], v[24:27]
  v_mfma_f32_32x32x16_bf16 v[80:95], v[52:55], a[80:83], v[80:95]
  ds_read_b64_tr_b16 v[44:45], v4 offset:51200
  ds_read_b64_tr_b16 v[46:47], v4 offset:51456
  ds_read_b128 v[136:139], v152 offset:51200
  buffer_load_dwordx4 v2, s[32:35], s56 offen offset:1152 lds
  v_mfma_f32_32x32x16_bf16 v[112:127], v[52:55], a[84:87], v[112:127]
  ds_read_b128 a[104:107], v9 offset:49152
  ds_read_b128 a[108:111], v9 offset:53248
  s_add_u32 s56, s56, s77
  s_cmp_eq_u32 s60, 5
  s_cselect_b32 s77, -1152, s74
  s_add_u32 m0, s62, 16384
  v_mfma_f32_16x16x32_bf16 v[28:31], v[32:35], v[52:55], v[28:31]
  v_mfma_f32_32x32x16_bf16 v[64:79], v[56:59], a[88:91], v[64:79]
  ds_read_b64_tr_b16 v[48:49], v6 offset:49152
  ds_read_b64_tr_b16 v[50:51], v6 offset:49408
  ds_read_b128 v[140:143], v152 offset:49664
  buffer_load_dwordx4 v128, s[28:31], s59 offen offset:0 lds
  v_mfma_f32_32x32x16_bf16 v[96:111], v[56:59], a[92:95], v[96:111]
  ds_read_b128 a[112:115], v8 offset:49664
  ds_read_b128 a[116:119], v8 offset:53760
  s_waitcnt lgkmcnt(7)
  buffer_load_dwordx4 v129, s[28:31], s59 offen offset:1024 lds
  v_mfma_f32_16x16x32_bf16 v[176:179], v[132:135], v[132:135], v[176:179]
  v_mfma_f32_16x16x32_bf16 v[184:187], v[148:151], v[132:135], v[184:187]
  v_mfma_f32_32x32x16_bf16 v[80:95], v[60:63], a[88:91], v[80:95]
  ds_read_b64_tr_b16 v[52:53], v6 offset:51200
  ds_read_b64_tr_b16 v[54:55], v6 offset:51456
  ds_read_b128 v[144:147], v152 offset:51712
  buffer_load_dwordx4 v130, s[28:31], s59 offen offset:2048 lds
  v_mfma_f32_32x32x16_bf16 v[112:127], v[60:63], a[92:95], v[112:127]
  ds_read_b128 a[120:123], v9 offset:49664
  ds_read_b128 a[124:127], v9 offset:53760
  v_mfma_f32_16x16x32_bf16 v[180:183], v[136:139], v[136:139], v[180:183]
  v_mfma_f32_16x16x32_bf16 v[188:191], v[148:151], v[136:139], v[188:191]
  v_mfma_f32_32x32x16_bf16 v[64:79], v[40:43], a[96:99], v[64:79]
  ds_read_b64_tr_b16 v[56:57], v4 offset:57344
  ds_read_b64_tr_b16 v[58:59], v4 offset:57600
  buffer_load_dwordx4 v131, s[28:31], s59 offen offset:3072 lds
  s_add_u32 s59, s59, s77
  v_mfma_f32_32x32x16_bf16 v[96:111], v[40:43], a[100:103], v[96:111]
  s_add_u32 m0, s61, 81920
  v_mfma_f32_16x16x32_bf16 v[24:27], v[32:35], v[40:43], v[24:27]
  v_mfma_f32_32x32x16_bf16 v[80:95], v[44:47], a[96:99], v[80:95]
  ds_read_b64_tr_b16 v[60:61], v4 offset:59392
  ds_read_b64_tr_b16 v[62:63], v4 offset:59648
  buffer_load_dwordx4 v1, s[32:35], s56 offen offset:0 lds
  v_mfma_f32_32x32x16_bf16 v[112:127], v[44:47], a[100:103], v[112:127]
  buffer_load_dwordx4 v2, s[32:35], s56 offen offset:1024 lds
  s_cmp_eq_u32 s60, 5
  s_cselect_b32 s77, -2211840, s75
  s_add_u32 m0, s61, 83840
  v_mfma_f32_16x16x32_bf16 v[28:31], v[32:35], v[44:47], v[28:31]
  s_waitcnt lgkmcnt(7)
  v_mfma_f32_32x32x16_bf16 v[64:79], v[48:51], a[104:107], v[64:79]
  ds_read_b64_tr_b16 v[40:41], v6 offset:57344
  ds_read_b64_tr_b16 v[42:43], v6 offset:57600
  buffer_load_dwordx4 v1, s[32:35], s56 offen offset:128 lds
  v_mfma_f32_32x32x16_bf16 v[96:111], v[48:51], a[108:111], v[96:111]
  ds_read_b64_tr_b16 v[44:45], v6 offset:59392
  ds_read_b64_tr_b16 v[46:47], v6 offset:59648
  v_mfma_f32_16x16x32_bf16 v[176:179], v[140:143], v[140:143], v[176:179]
  v_mfma_f32_16x16x32_bf16 v[184:187], v[148:151], v[140:143], v[184:187]
  v_mfma_f32_32x32x16_bf16 v[80:95], v[52:55], a[104:107], v[80:95]
  buffer_load_dwordx4 v2, s[32:35], s56 offen offset:1152 lds
  s_add_u32 s56, s56, s77
  s_cmp_eq_u32 s60, 6
  s_cselect_b32 s77, -1152, s74
  v_mfma_f32_32x32x16_bf16 v[112:127], v[52:55], a[108:111], v[112:127]
  s_waitcnt lgkmcnt(10)
  s_add_u32 m0, s62, 32768
  v_mfma_f32_16x16x32_bf16 v[180:183], v[144:147], v[144:147], v[180:183]
  v_mfma_f32_16x16x32_bf16 v[188:191], v[148:151], v[144:147], v[188:191]
  s_waitcnt lgkmcnt(4)
  v_mfma_f32_32x32x16_bf16 v[64:79], v[56:59], a[112:115], v[64:79]
  s_waitcnt vmcnt(8) lgkmcnt(0)
  s_barrier
  ds_read_b64_tr_b16 v[48:49], v5 offset:0
  ds_read_b64_tr_b16 v[50:51], v5 offset:256
  ds_read_b128 v[132:135], v152 offset:0
  v_mfma_f32_32x32x16_bf16 v[96:111], v[56:59], a[116:119], v[96:111]
  ds_read_b128 a[128:131], v8 offset:0
  ds_read_b128 a[132:135], v8 offset:4096
  buffer_load_dwordx4 v128, s[28:31], s59 offen offset:0 lds
  v_mfma_f32_16x16x32_bf16 v[24:27], v[32:35], v[56:59], v[24:27]
  v_mfma_f32_32x32x16_bf16 v[80:95], v[60:63], a[112:115], v[80:95]
  ds_read_b64_tr_b16 v[52:53], v5 offset:2048
  ds_read_b64_tr_b16 v[54:55], v5 offset:2304
  ds_read_b128 v[136:139], v152 offset:2048
  buffer_load_dwordx4 v129, s[28:31], s59 offen offset:1024 lds
  v_mfma_f32_32x32x16_bf16 v[112:127], v[60:63], a[116:119], v[112:127]
  ds_read_b128 a[136:139], v9 offset:0
  ds_read_b128 a[140:143], v9 offset:4096
  buffer_load_dwordx4 v130, s[28:31], s59 offen offset:2048 lds
  v_mfma_f32_16x16x32_bf16 v[28:31], v[32:35], v[60:63], v[28:31]
  v_mfma_f32_32x32x16_bf16 v[64:79], v[40:43], a[120:123], v[64:79]
  ds_read_b64_tr_b16 v[56:57], v7 offset:0
  ds_read_b64_tr_b16 v[58:59], v7 offset:256
  ds_read_b128 v[140:143], v152 offset:512
  buffer_load_dwordx4 v131, s[28:31], s59 offen offset:3072 lds
  v_mfma_f32_32x32x16_bf16 v[96:111], v[40:43], a[124:127], v[96:111]
  ds_read_b128 a[144:147], v8 offset:512
  ds_read_b128 a[148:151], v8 offset:4608
  s_waitcnt lgkmcnt(7)
  s_add_u32 s59, s59, s77
  s_add_u32 m0, s61, 0
  v_mfma_f32_16x16x32_bf16 v[176:179], v[132:135], v[132:135], v[176:179]
  v_mfma_f32_16x16x32_bf16 v[184:187], v[148:151], v[132:135], v[184:187]
  v_mfma_f32_32x32x16_bf16 v[80:95], v[44:47], a[120:123], v[80:95]
  ds_read_b64_tr_b16 v[60:61], v7 offset:2048
  ds_read_b64_tr_b16 v[62:63], v7 offset:2304
  ds_read_b128 v[144:147], v152 offset:2560
  buffer_load_dwordx4 v1, s[32:35], s56 offen offset:0 lds
  v_mfma_f32_32x32x16_bf16 v[112:127], v[44:47], a[124:127], v[112:127]
  ds_read_b128 a[152:155], v9 offset:512
  ds_read_b128 a[156:159], v9 offset:4608
  v_mfma_f32_16x16x32_bf16 v[180:183], v[136:139], v[136:139], v[180:183]
  v_mfma_f32_16x16x32_bf16 v[188:191], v[148:151], v[136:139], v[188:191]
  v_mfma_f32_32x32x16_bf16 v[64:79], v[48:51], a[128:131], v[64:79]
  ds_read_b64_tr_b16 v[40:41], v5 offset:8192
  ds_read_b64_tr_b16 v[42:43], v5 offset:8448
  buffer_load_dwordx4 v2, s[32:35], s56 offen offset:1024 lds
  v_mfma_f32_32x32x16_bf16 v[96:111], v[48:51], a[132:135], v[96:111]
  s_cmp_eq_u32 s60, 6
  s_cselect_b32 s77, -2211840, s75
  s_add_u32 m0, s61, 1920
  v_mfma_f32_16x16x32_bf16 v[24:27], v[32:35], v[48:51], v[24:27]
  v_mfma_f32_32x32x16_bf16 v[80:95], v[52:55], a[128:131], v[80:95]
  ds_read_b64_tr_b16 v[44:45], v5 offset:10240
  ds_read_b64_tr_b16 v[46:47], v5 offset:10496
  buffer_load_dwordx4 v1, s[32:35], s56 offen offset:128 lds
  v_mfma_f32_32x32x16_bf16 v[112:127], v[52:55], a[132:135], v[112:127]
  buffer_load_dwordx4 v2, s[32:35], s56 offen offset:1152 lds
  s_add_u32 s56, s56, s77
  s_cmp_eq_u32 s60, 7
  s_cselect_b32 s77, -1152, s74
  v_mfma_f32_16x16x32_bf16 v[28:31], v[32:35], v[52:55], v[28:31]
  s_add_u32 m0, s62, 49152
  s_waitcnt lgkmcnt(7)
  v_mfma_f32_32x32x16_bf16 v[64:79], v[56:59], a[136:139], v[64:79]
  ds_read_b64_tr_b16 v[48:49], v7 offset:8192
  ds_read_b64_tr_b16 v[50:51], v7 offset:8448
  buffer_load_dwordx4 v128, s[28:31], s59 offen offset:0 lds
  v_mfma_f32_32x32x16_bf16 v[96:111], v[56:59], a[140:143], v[96:111]
  ds_read_b64_tr_b16 v[52:53], v7 offset:10240
  ds_read_b64_tr_b16 v[54:55], v7 offset:10496
  v_mfma_f32_16x16x32_bf16 v[176:179], v[140:143], v[140:143], v[176:179]
  v_mfma_f32_16x16x32_bf16 v[184:187], v[148:151], v[140:143], v[184:187]
  v_mfma_f32_32x32x16_bf16 v[80:95], v[60:63], a[136:139], v[80:95]
  buffer_load_dwordx4 v129, s[28:31], s59 offen offset:1024 lds
  v_mfma_f32_32x32x16_bf16 v[112:127], v[60:63], a[140:143], v[112:127]
  s_waitcnt lgkmcnt(10)
  buffer_load_dwordx4 v130, s[28:31], s59 offen offset:2048 lds
  v_mfma_f32_16x16x32_bf16 v[180:183], v[144:147], v[144:147], v[180:183]
  v_mfma_f32_16x16x32_bf16 v[188:191], v[148:151], v[144:147], v[188:191]
  s_waitcnt lgkmcnt(4)
  v_mfma_f32_32x32x16_bf16 v[64:79], v[40:43], a[144:147], v[64:79]
  s_waitcnt vmcnt(11) lgkmcnt(0)
  s_barrier
  ds_read_b64_tr_b16 v[56:57], v5 offset:16384
  ds_read_b64_tr_b16 v[58:59], v5 offset:16640
  ds_read_b128 v[132:135], v152 offset:16384
  v_mfma_f32_32x32x16_bf16 v[96:111], v[40:43], a[148:151], v[96:111]
  ds_read_b128 a[160:163], v8 offset:16384
  ds_read_b128 a[164:167], v8 offset:20480
  buffer_load_dwordx4 v131, s[28:31], s59 offen offset:3072 lds
  s_add_u32 s59, s59, s77
  v_mfma_f32_16x16x32_bf16 v[24:27], v[32:35], v[40:43], v[24:27]
  s_add_u32 m0, s61, 16384
  v_mfma_f32_32x32x16_bf16 v[80:95], v[44:47], a[144:147], v[80:95]
  ds_read_b64_tr_b16 v[60:61], v5 offset:18432
  ds_read_b64_tr_b16 v[62:63], v5 offset:18688
  ds_read_b128 v[136:139], v152 offset:18432
  buffer_load_dwordx4 v1, s[32:35], s56 offen offset:0 lds
  v_mfma_f32_32x32x16_bf16 v[112:127], v[44:47], a[148:151], v[112:127]
  ds_read_b128 a[168:171], v9 offset:16384
  ds_read_b128 a[172:175], v9 offset:20480
  v_mfma_f32_16x16x32_bf16 v[28:31], v[32:35], v[44:47], v[28:31]
  v_mfma_f32_32x32x16_bf16 v[64:79], v[48:51], a[152:155], v[64:79]
  ds_read_b64_tr_b16 v[40:41], v7 offset:16384
  ds_read_b64_tr_b16 v[42:43], v7 offset:16640
  ds_read_b128 v[140:143], v152 offset:16896
  buffer_load_dwordx4 v2, s[32:35], s56 offen offset:1024 lds
  v_mfma_f32_32x32x16_bf16 v[96:111], v[48:51], a[156:159], v[96:111]
  ds_read_b128 a[176:179], v8 offset:16896
  ds_read_b128 a[180:183], v8 offset:20992
  s_waitcnt lgkmcnt(7)
  s_cmp_eq_u32 s60, 7
  s_cselect_b32 s77, -2211840, s75
  s_add_u32 m0, s61, 18304
  v_mfma_f32_16x16x32_bf16 v[176:179], v[132:135], v[132:135], v[176:179]
  v_mfma_f32_16x16x32_bf16 v[184:187], v[148:151], v[132:135], v[184:187]
  v_mfma_f32_32x32x16_bf16 v[80:95], v[52:55], a[152:155], v[80:95]
  ds_read_b64_tr_b16 v[44:45], v7 offset:18432
  ds_read_b64_tr_b16 v[46:47], v7 offset:18688
  ds_read_b128 v[144:147], v152 offset:18944
  buffer_load_dwordx4 v1, s[32:35], s56 offen offset:128 lds
  v_mfma_f32_32x32x16_bf16 v[112:127], v[52:55], a[156:159], v[112:127]
  ds_read_b128 a[184:187], v9 offset:16896
  ds_read_b128 a[188:191], v9 offset:20992
  buffer_load_dwordx4 v2, s[32:35], s56 offen offset:1152 lds
  s_add_u32 s56, s56, s77
  v_mfma_f32_16x16x32_bf16 v[180:183], v[136:139], v[136:139], v[180:183]
  v_mfma_f32_16x16x32_bf16 v[188:191], v[148:151], v[136:139], v[188:191]
  v_mfma_f32_32x32x16_bf16 v[64:79], v[56:59], a[160:163], v[64:79]
  ds_read_b64_tr_b16 v[48:49], v5 offset:24576
  ds_read_b64_tr_b16 v[50:51], v5 offset:24832
  s_cmp_eq_u32 s60, 8
  s_cselect_b32 s77, -1152, s74
  s_add_u32 m0, s62, 0
  v_mfma_f32_32x32x16_bf16 v[96:111], v[56:59], a[164:167], v[96:111]
  buffer_load_dwordx4 v128, s[28:31], s59 offen offset:0 lds
  v_mfma_f32_16x16x32_bf16 v[24:27], v[32:35], v[56:59], v[24:27]
  v_mfma_f32_32x32x16_bf16 v[80:95], v[60:63], a[160:163], v[80:95]
  ds_read_b64_tr_b16 v[52:53], v5 offset:26624
  ds_read_b64_tr_b16 v[54:55], v5 offset:26880
  buffer_load_dwordx4 v129, s[28:31], s59 offen offset:1024 lds
  v_mfma_f32_32x32x16_bf16 v[112:127], v[60:63], a[164:167], v[112:127]
  v_mfma_f32_16x16x32_bf16 v[28:31], v[32:35], v[60:63], v[28:31]
  s_waitcnt lgkmcnt(7)
  v_mfma_f32_32x32x16_bf16 v[64:79], v[40:43], a[168:171], v[64:79]
  ds_read_b64_tr_b16 v[56:57], v7 offset:24576
  ds_read_b64_tr_b16 v[58:59], v7 offset:24832
  buffer_load_dwordx4 v130, s[28:31], s59 offen offset:2048 lds
  v_mfma_f32_32x32x16_bf16 v[96:111], v[40:43], a[172:175], v[96:111]
  ds_read_b64_tr_b16 v[60:61], v7 offset:26624
  ds_read_b64_tr_b16 v[62:63], v7 offset:26880
  buffer_load_dwordx4 v131, s[28:31], s59 offen offset:3072 lds
  s_add_u32 s59, s59, s77
  v_mfma_f32_16x16x32_bf16 v[176:179], v[140:143], v[140:143], v[176:179]
  s_add_u32 m0, s61, 32768
  v_mfma_f32_16x16x32_bf16 v[184:187], v[148:151], v[140:143], v[184:187]
  v_mfma_f32_32x32x16_bf16 v[80:95], v[44:47], a[168:171], v[80:95]
  buffer_load_dwordx4 v1, s[32:35], s56 offen offset:0 lds
  v_mfma_f32_32x32x16_bf16 v[112:127], v[44:47], a[172:175], v[112:127]
  s_waitcnt lgkmcnt(10)
  v_mfma_f32_16x16x32_bf16 v[180:183], v[144:147], v[144:147], v[180:183]
  v_mfma_f32_16x16x32_bf16 v[188:191], v[148:151], v[144:147], v[188:191]
  s_waitcnt lgkmcnt(4)
  v_mfma_f32_32x32x16_bf16 v[64:79], v[48:51], a[176:179], v[64:79]
  s_waitcnt vmcnt(13) lgkmcnt(0)
  s_barrier
  ds_read_b64_tr_b16 v[40:41], v4 offset:0
  ds_read_b64_tr_b16 v[42:43], v4 offset:256
  ds_read_b128 v[132:135], v152 offset:32768
  v_mfma_f32_32x32x16_bf16 v[96:111], v[48:51], a[180:183], v[96:111]
  ds_read_b128 a[192:195], v8 offset:32768
  ds_read_b128 a[196:199], v8 offset:36864
  buffer_load_dwordx4 v2, s[32:35], s56 offen offset:1024 lds
  v_mfma_f32_16x16x32_bf16 v[24:27], v[32:35], v[48:51], v[24:27]
  v_mfma_f32_32x32x16_bf16 v[80:95], v[52:55], a[176:179], v[80:95]
  ds_read_b64_tr_b16 v[44:45], v4 offset:2048
  ds_read_b64_tr_b16 v[46:47], v4 offset:2304
  ds_read_b128 v[136:139], v152 offset:34816
  s_cmp_eq_u32 s60, 8
  s_cselect_b32 s77, -2211840, s75
  s_add_u32 m0, s61, 34688
  v_mfma_f32_32x32x16_bf16 v[112:127], v[52:55], a[180:183], v[112:127]
  ds_read_b128 a[200:203], v9 offset:32768
  ds_read_b128 a[204:207], v9 offset:36864
  buffer_load_dwordx4 v1, s[32:35], s56 offen offset:128 lds
  v_mfma_f32_16x16x32_bf16 v[28:31], v[32:35], v[52:55], v[28:31]
  v_mfma_f32_32x32x16_bf16 v[64:79], v[56:59], a[184:187], v[64:79]
  ds_read_b64_tr_b16 v[48:49], v6 offset:0
  ds_read_b64_tr_b16 v[50:51], v6 offset:256
  ds_read_b128 v[140:143], v152 offset:33280
  buffer_load_dwordx4 v2, s[32:35], s56 offen offset:1152 lds
  v_mfma_f32_32x32x16_bf16 v[96:111], v[56:59], a[188:191], v[96:111]
  ds_read_b128 a[208:211], v8 offset:33280
  ds_read_b128 a[212:215], v8 offset:37376
  s_waitcnt lgkmcnt(7)
  s_add_u32 s56, s56, s77
  s_add_u32 m0, s62, 16384
  v_mfma_f32_16x16x32_bf16 v[176:179], v[132:135], v[132:135], v[176:179]
  v_mfma_f32_16x16x32_bf16 v[184:187], v[148:151], v[132:135], v[184:187]
  v_mfma_f32_32x32x16_bf16 v[80:95], v[60:63], a[184:187], v[80:95]
  ds_read_b64_tr_b16 v[52:53], v6 offset:2048
  ds_read_b64_tr_b16 v[54:55], v6 offset:2304
  ds_read_b128 v[144:147], v152 offset:35328
  buffer_load_dwordx4 v128, s[28:31], s59 offen offset:0 lds
  v_mfma_f32_32x32x16_bf16 v[112:127], v[60:63], a[188:191], v[112:127]
  ds_read_b128 a[216:219], v9 offset:33280
  ds_read_b128 a[220:223], v9 offset:37376
  buffer_load_dwordx4 v129, s[28:31], s59 offen offset:1024 lds
  v_mfma_f32_16x16x32_bf16 v[180:183], v[136:139], v[136:139], v[180:183]
  v_mfma_f32_16x16x32_bf16 v[188:191], v[148:151], v[136:139], v[188:191]
  v_mfma_f32_32x32x16_bf16 v[64:79], v[40:43], a[192:195], v[64:79]
  ds_read_b64_tr_b16 v[56:57], v4 offset:8192
  ds_read_b64_tr_b16 v[58:59], v4 offset:8448
  buffer_load_dwordx4 v130, s[28:31], s59 offen offset:2048 lds
  v_mfma_f32_32x32x16_bf16 v[96:111], v[40:43], a[196:199], v[96:111]
  v_mfma_f32_16x16x32_bf16 v[24:27], v[32:35], v[40:43], v[24:27]
  v_mfma_f32_32x32x16_bf16 v[80:95], v[44:47], a[192:195], v[80:95]
  ds_read_b64_tr_b16 v[60:61], v4 offset:10240
  ds_read_b64_tr_b16 v[62:63], v4 offset:10496
  buffer_load_dwordx4 v131, s[28:31], s59 offen offset:3072 lds
  s_add_u32 m0, s61, 49152
  v_mfma_f32_32x32x16_bf16 v[112:127], v[44:47], a[196:199], v[112:127]
  v_mfma_f32_16x16x32_bf16 v[28:31], v[32:35], v[44:47], v[28:31]
  s_waitcnt lgkmcnt(7)
  v_mfma_f32_32x32x16_bf16 v[64:79], v[48:51], a[200:203], v[64:79]
  ds_read_b64_tr_b16 v[40:41], v6 offset:8192
  ds_read_b64_tr_b16 v[42:43], v6 offset:8448
  buffer_load_dwordx4 v1, s[32:35], s56 offen offset:0 lds
  v_mfma_f32_32x32x16_bf16 v[96:111], v[48:51], a[204:207], v[96:111]
  ds_read_b64_tr_b16 v[44:45], v6 offset:10240
  ds_read_b64_tr_b16 v[46:47], v6 offset:10496
  buffer_load_dwordx4 v2, s[32:35], s56 offen offset:1024 lds
  s_add_u32 m0, s61, 51072
  v_mfma_f32_16x16x32_bf16 v[176:179], v[140:143], v[140:143], v[176:179]
  v_mfma_f32_16x16x32_bf16 v[184:187], v[148:151], v[140:143], v[184:187]
  v_mfma_f32_32x32x16_bf16 v[80:95], v[52:55], a[200:203], v[80:95]
  buffer_load_dwordx4 v1, s[32:35], s56 offen offset:128 lds
  v_mfma_f32_32x32x16_bf16 v[112:127], v[52:55], a[204:207], v[112:127]
  s_waitcnt lgkmcnt(10)
  v_mfma_f32_16x16x32_bf16 v[180:183], v[144:147], v[144:147], v[180:183]
  v_mfma_f32_16x16x32_bf16 v[188:191], v[148:151], v[144:147], v[188:191]
  s_waitcnt lgkmcnt(4)
  v_mfma_f32_32x32x16_bf16 v[64:79], v[56:59], a[208:211], v[64:79]
  s_waitcnt vmcnt(15) lgkmcnt(0)
  s_barrier
  ds_read_b64_tr_b16 v[48:49], v4 offset:16384
  ds_read_b64_tr_b16 v[50:51], v4 offset:16640
  ds_read_b128 v[132:135], v152 offset:49152
  v_mfma_f32_32x32x16_bf16 v[96:111], v[56:59], a[212:215], v[96:111]
  ds_read_b128 a[224:227], v8 offset:49152
  ds_read_b128 a[228:231], v8 offset:53248
  buffer_load_dwordx4 v2, s[32:35], s56 offen offset:1152 lds
  v_mov_b32 v1, v154
  v_mfma_f32_16x16x32_bf16 v[24:27], v[32:35], v[56:59], v[24:27]
  v_add_u32 v2, 23552, v1
  v_mfma_f32_32x32x16_bf16 v[80:95], v[60:63], a[208:211], v[80:95]
  ds_read_b64_tr_b16 v[52:53], v4 offset:18432
  ds_read_b64_tr_b16 v[54:55], v4 offset:18688
  ds_read_b128 v[136:139], v152 offset:51200
  buffer_load_dword v10, v37, s[52:55], 0 offen offset:0 sc1
  v_mfma_f32_32x32x16_bf16 v[112:127], v[60:63], a[212:215], v[112:127]
  ds_read_b128 a[232:235], v9 offset:49152
  ds_read_b128 a[236:239], v9 offset:53248
  s_add_u32 m0, s61, 65536
  s_mul_i32 s32, s11, 348160
  s_add_u32 s32, s32, 18874368
  s_lshl3_add_u32 s59, s63, s32
  v_mfma_f32_16x16x32_bf16 v[28:31], v[32:35], v[60:63], v[28:31]
  s_lshl2_add_u32 s60, s63, s32
  v_mfma_f32_32x32x16_bf16 v[64:79], v[40:43], a[216:219], v[64:79]
  ds_read_b64_tr_b16 v[56:57], v6 offset:16384
  ds_read_b64_tr_b16 v[58:59], v6 offset:16640
  ds_read_b128 v[140:143], v152 offset:49664
  buffer_load_dwordx4 v1, s[36:39], s4 offen offset:0 lds
  v_mfma_f32_32x32x16_bf16 v[96:111], v[40:43], a[220:223], v[96:111]
  ds_read_b128 a[240:243], v8 offset:49664
  ds_read_b128 a[244:247], v8 offset:53760
  s_waitcnt lgkmcnt(7)
  buffer_load_dwordx4 v2, s[36:39], s4 offen offset:1024 lds
  v_mfma_f32_16x16x32_bf16 v[176:179], v[132:135], v[132:135], v[176:179]
  s_add_u32 s75, s60, s63
  v_mfma_f32_16x16x32_bf16 v[184:187], v[148:151], v[132:135], v[184:187]
  s_add_u32 s60, s60, 163840
  v_mfma_f32_32x32x16_bf16 v[80:95], v[44:47], a[216:219], v[80:95]
  ds_read_b64_tr_b16 v[60:61], v6 offset:18432
  ds_read_b64_tr_b16 v[62:63], v6 offset:18688
  ds_read_b128 v[144:147], v152 offset:51712
  s_add_u32 m0, s61, 67584
  s_add_u32 s75, s75, 245760
  s_add_u32 s74, s60, 10240
  v_mfma_f32_32x32x16_bf16 v[112:127], v[44:47], a[220:223], v[112:127]
  ds_read_b128 a[248:251], v9 offset:49664
  ds_read_b128 a[252:255], v9 offset:53760
  buffer_load_dwordx4 v1, s[40:43], s4 offen offset:0 lds
  s_lshl2_add_u32 s33, s93, s3
  v_mfma_f32_16x16x32_bf16 v[180:183], v[136:139], v[136:139], v[180:183]
  s_mul_i32 s33, s33, 10880
  v_mfma_f32_16x16x32_bf16 v[188:191], v[148:151], v[136:139], v[188:191]
  s_add_u32 s33, s33, s32
  v_mfma_f32_32x32x16_bf16 v[64:79], v[48:51], a[224:227], v[64:79]
  ds_read_b64_tr_b16 v[40:41], v4 offset:24576
  ds_read_b64_tr_b16 v[42:43], v4 offset:24832
  s_lshl_b32 s34, s11, 7
  s_lshr_b32 s35, s11, 2
  s_lshl_b32 s35, s35, 6
  s_and_b32 s62, s11, 3
  v_mfma_f32_32x32x16_bf16 v[96:111], v[48:51], a[228:231], v[96:111]
  buffer_load_dwordx4 v2, s[40:43], s4 offen offset:1024 lds
  s_lshl3_add_u32 s35, s62, s35
  s_add_u32 s35, s35, 928
  s_lshl2_add_u32 s62, s10, s3
  v_mfma_f32_16x16x32_bf16 v[24:27], v[32:35], v[48:51], v[24:27]
  s_mul_i32 s62, s62, 20480
  v_mfma_f32_32x32x16_bf16 v[80:95], v[52:55], a[224:227], v[80:95]
  ds_read_b64_tr_b16 v[44:45], v4 offset:26624
  ds_read_b64_tr_b16 v[46:47], v4 offset:26880
  s_add_u32 m0, s61, 81920
  s_mul_i32 s32, s11, 160
  s_add_u32 s62, s62, s32
  s_lshl_b32 s93, s93, 7
  v_mfma_f32_32x32x16_bf16 v[112:127], v[52:55], a[228:231], v[112:127]
  buffer_load_dwordx4 v1, s[36:39], s5 offen offset:0 lds
  s_sub_u32 s93, s93, 128
  v_mfma_f32_16x16x32_bf16 v[28:31], v[32:35], v[52:55], v[28:31]
  s_waitcnt lgkmcnt(7)
  v_mfma_f32_32x32x16_bf16 v[64:79], v[56:59], a[232:235], v[64:79]
  ds_read_b64_tr_b16 v[48:49], v6 offset:24576
  ds_read_b64_tr_b16 v[50:51], v6 offset:24832
  v_mfma_f32_32x32x16_bf16 v[96:111], v[56:59], a[236:239], v[96:111]
  ds_read_b64_tr_b16 v[52:53], v6 offset:26624
  ds_read_b64_tr_b16 v[54:55], v6 offset:26880
  buffer_load_dwordx4 v2, s[36:39], s5 offen offset:1024 lds
  v_mfma_f32_16x16x32_bf16 v[176:179], v[140:143], v[140:143], v[176:179]
  v_mfma_f32_16x16x32_bf16 v[184:187], v[148:151], v[140:143], v[184:187]
  v_mfma_f32_32x32x16_bf16 v[80:95], v[60:63], a[232:235], v[80:95]
  s_add_u32 m0, s61, 83968
  v_mfma_f32_32x32x16_bf16 v[112:127], v[60:63], a[236:239], v[112:127]
  s_waitcnt lgkmcnt(10)
  buffer_load_dwordx4 v1, s[40:43], s5 offen offset:0 lds
  v_mfma_f32_16x16x32_bf16 v[180:183], v[144:147], v[144:147], v[180:183]
  v_mfma_f32_16x16x32_bf16 v[188:191], v[148:151], v[144:147], v[188:191]
  s_waitcnt lgkmcnt(4)
  v_mfma_f32_32x32x16_bf16 v[64:79], v[40:43], a[240:243], v[64:79]
  s_waitcnt vmcnt(16) lgkmcnt(0)
  s_barrier
  ds_read_b64_tr_b16 v[56:57], v4 offset:32768
  ds_read_b64_tr_b16 v[58:59], v4 offset:33024
  ds_read_b128 v[132:135], v152 offset:0
  v_mfma_f32_32x32x16_bf16 v[96:111], v[40:43], a[244:247], v[96:111]
  ds_read_b128 v[192:195], v8 offset:0
  ds_read_b128 v[196:199], v8 offset:4096
  buffer_load_dwordx4 v2, s[40:43], s5 offen offset:1024 lds
  s_and_b32 s77, s3, 2
  v_mfma_f32_16x16x32_bf16 v[24:27], v[32:35], v[40:43], v[24:27]
  s_lshl_b32 s77, s77, 4
  v_mfma_f32_32x32x16_bf16 v[80:95], v[44:47], a[240:243], v[80:95]
  ds_read_b64_tr_b16 v[60:61], v4 offset:34816
  ds_read_b64_tr_b16 v[62:63], v4 offset:35072
  ds_read_b128 v[136:139], v152 offset:2048
  v_lshrrev_b32 v2, 5, v0
  v_mul_u32_u24 v2, 24512, v2
  v_xad_u32 v2, v1, s77, v2
  v_mfma_f32_32x32x16_bf16 v[112:127], v[44:47], a[244:247], v[112:127]
  ds_read_b128 v[200:203], v9 offset:0
  ds_read_b128 v[204:207], v9 offset:4096
  v_add_u32 v2, s58, v2
  s_add_u32 s77, s12, 97280
  s_add_u32 m0, s61, 131072
  v_mfma_f32_16x16x32_bf16 v[28:31], v[32:35], v[44:47], v[28:31]
  v_mfma_f32_32x32x16_bf16 v[64:79], v[48:51], a[248:251], v[64:79]
  ds_read_b64_tr_b16 v[40:41], v6 offset:32768
  ds_read_b64_tr_b16 v[42:43], v6 offset:33024
  ds_read_b128 v[140:143], v152 offset:512
  buffer_load_dwordx4 v2, s[44:47], s12 offen offset:0 lds
  v_mfma_f32_32x32x16_bf16 v[96:111], v[48:51], a[252:255], v[96:111]
  ds_read_b128 v[208:211], v8 offset:512
  ds_read_b128 v[212:215], v8 offset:4608
  s_waitcnt lgkmcnt(7)
  s_waitcnt vmcnt(9)
  v_cmp_eq_u32 vcc, 0, v10
  s_cbranch_vccnz .slow1
.back2:
  v_mfma_f32_16x16x32_bf16 v[176:179], v[132:135], v[132:135], v[176:179]
  v_mfma_f32_16x16x32_bf16 v[184:187], v[148:151], v[132:135], v[184:187]
  v_mfma_f32_32x32x16_bf16 v[80:95], v[52:55], a[248:251], v[80:95]
  ds_read_b64_tr_b16 v[44:45], v6 offset:34816
  ds_read_b64_tr_b16 v[46:47], v6 offset:35072
  ds_read_b128 v[144:147], v152 offset:2560
  buffer_load_dwordx4 v2, s[44:47], s77 offen offset:1024 lds
  v_mfma_f32_32x32x16_bf16 v[112:127], v[52:55], a[252:255], v[112:127]
  ds_read_b128 v[216:219], v9 offset:512
  ds_read_b128 v[220:223], v9 offset:4608
  s_add_u32 s77, s13, 97280
  v_mfma_f32_16x16x32_bf16 v[180:183], v[136:139], v[136:139], v[180:183]
  v_mfma_f32_16x16x32_bf16 v[188:191], v[148:151], v[136:139], v[188:191]
  v_mfma_f32_32x32x16_bf16 v[64:79], v[56:59], v[192:195], v[64:79]
  ds_read_b64_tr_b16 v[48:49], v4 offset:40960
  ds_read_b64_tr_b16 v[50:51], v4 offset:41216
  s_add_u32 m0, s61, 133120
  v_mfma_f32_32x32x16_bf16 v[96:111], v[56:59], v[196:199], v[96:111]
  v_mfma_f32_16x16x32_bf16 v[24:27], v[32:35], v[56:59], v[24:27]
  v_mfma_f32_32x32x16_bf16 v[80:95], v[60:63], v[192:195], v[80:95]
  ds_read_b64_tr_b16 v[52:53], v4 offset:43008
  ds_read_b64_tr_b16 v[54:55], v4 offset:43264
  buffer_load_dwordx4 v2, s[44:47], s13 offen offset:0 lds
  v_mfma_f32_32x32x16_bf16 v[112:127], v[60:63], v[196:199], v[112:127]
  v_mfma_f32_16x16x32_bf16 v[28:31], v[32:35], v[60:63], v[28:31]
  s_waitcnt lgkmcnt(7)
  v_mfma_f32_32x32x16_bf16 v[64:79], v[40:43], v[200:203], v[64:79]
  ds_read_b64_tr_b16 v[56:57], v6 offset:40960
  ds_read_b64_tr_b16 v[58:59], v6 offset:41216
  buffer_load_dwordx4 v2, s[44:47], s77 offen offset:1024 lds
  v_add_u32 v2, 23552, v1
  v_mfma_f32_32x32x16_bf16 v[96:111], v[40:43], v[204:207], v[96:111]
  ds_read_b64_tr_b16 v[60:61], v6 offset:43008
  ds_read_b64_tr_b16 v[62:63], v6 offset:43264
  v_mfma_f32_16x16x32_bf16 v[176:179], v[140:143], v[140:143], v[176:179]
  v_mfma_f32_16x16x32_bf16 v[184:187], v[148:151], v[140:143], v[184:187]
  v_mfma_f32_32x32x16_bf16 v[80:95], v[44:47], v[200:203], v[80:95]
  v_mfma_f32_32x32x16_bf16 v[112:127], v[44:47], v[204:207], v[112:127]
  s_waitcnt lgkmcnt(10)
  s_add_u32 m0, s61, 0
  v_mfma_f32_16x16x32_bf16 v[180:183], v[144:147], v[144:147], v[180:183]
  v_mfma_f32_16x16x32_bf16 v[188:191], v[148:151], v[144:147], v[188:191]
  s_waitcnt lgkmcnt(4)
  v_mfma_f32_32x32x16_bf16 v[64:79], v[48:51], v[208:211], v[64:79]
  s_waitcnt lgkmcnt(0)
  s_barrier
  ds_read_b64_tr_b16 v[40:41], v4 offset:49152
  ds_read_b64_tr_b16 v[42:43], v4 offset:49408
  ds_read_b128 v[132:135], v152 offset:16384
  v_mfma_f32_32x32x16_bf16 v[96:111], v[48:51], v[212:215], v[96:111]
  ds_read_b128 v[224:227], v8 offset:16384
  ds_read_b128 v[228:231], v8 offset:20480
  buffer_load_dwordx4 v1, s[36:39], s6 offen offset:0 lds
  v_mfma_f32_16x16x32_bf16 v[24:27], v[32:35], v[48:51], v[24:27]
  v_mfma_f32_32x32x16_bf16 v[80:95], v[52:55], v[208:211], v[80:95]
  ds_read_b64_tr_b16 v[44:45], v4 offset:51200
  ds_read_b64_tr_b16 v[46:47], v4 offset:51456
  ds_read_b128 v[136:139], v152 offset:18432
  buffer_load_dwordx4 v2, s[36:39], s6 offen offset:1024 lds
  v_mfma_f32_32x32x16_bf16 v[112:127], v[52:55], v[212:215], v[112:127]
  ds_read_b128 v[232:235], v9 offset:16384
  ds_read_b128 v[236:239], v9 offset:20480
  s_add_u32 m0, s61, 2048
  v_mfma_f32_16x16x32_bf16 v[28:31], v[32:35], v[52:55], v[28:31]
  v_mfma_f32_32x32x16_bf16 v[64:79], v[56:59], v[216:219], v[64:79]
  ds_read_b64_tr_b16 v[48:49], v6 offset:49152
  ds_read_b64_tr_b16 v[50:51], v6 offset:49408
  ds_read_b128 v[140:143], v152 offset:16896
  buffer_load_dwordx4 v1, s[40:43], s6 offen offset:0 lds
  v_mfma_f32_32x32x16_bf16 v[96:111], v[56:59], v[220:223], v[96:111]
  ds_read_b128 v[240:243], v8 offset:16896
  ds_read_b128 v[244:247], v8 offset:20992
  s_waitcnt lgkmcnt(7)
  buffer_load_dwordx4 v2, s[40:43], s6 offen offset:1024 lds
  v_mfma_f32_16x16x32_bf16 v[176:179], v[132:135], v[132:135], v[176:179]
  s_add_u32 m0, s61, 16384
  v_mfma_f32_16x16x32_bf16 v[184:187], v[148:151], v[132:135], v[184:187]
  v_mfma_f32_32x32x16_bf16 v[80:95], v[60:63], v[216:219], v[80:95]
  ds_read_b64_tr_b16 v[52:53], v6 offset:51200
  ds_read_b64_tr_b16 v[54:55], v6 offset:51456
  ds_read_b128 v[144:147], v152 offset:18944
  buffer_load_dwordx4 v1, s[36:39], s7 offen offset:0 lds
  v_mfma_f32_32x32x16_bf16 v[112:127], v[60:63], v[220:223], v[112:127]
  ds_read_b128 v[248:251], v9 offset:16896
  ds_read_b128 v[252:255], v9 offset:20992
  v_mfma_f32_16x16x32_bf16 v[180:183], v[136:139], v[136:139], v[180:183]
  v_mfma_f32_16x16x32_bf16 v[188:191], v[148:151], v[136:139], v[188:191]
  v_mfma_f32_32x32x16_bf16 v[64:79], v[40:43], v[224:227], v[64:79]
  ds_read_b64_tr_b16 v[56:57], v4 offset:57344
  ds_read_b64_tr_b16 v[58:59], v4 offset:57600
  buffer_load_dwordx4 v2, s[36:39], s7 offen offset:1024 lds
  s_add_u32 m0, s61, 18432
  v_mfma_f32_32x32x16_bf16 v[96:111], v[40:43], v[228:231], v[96:111]
  buffer_load_dwordx4 v1, s[40:43], s7 offen offset:0 lds
  v_mfma_f32_16x16x32_bf16 v[24:27], v[32:35], v[40:43], v[24:27]
  v_mfma_f32_32x32x16_bf16 v[80:95], v[44:47], v[224:227], v[80:95]
  ds_read_b64_tr_b16 v[60:61], v4 offset:59392
  ds_read_b64_tr_b16 v[62:63], v4 offset:59648
  buffer_load_dwordx4 v2, s[40:43], s7 offen offset:1024 lds
  s_and_b32 s77, s3, 2
  v_mfma_f32_32x32x16_bf16 v[112:127], v[44:47], v[228:231], v[112:127]
  s_lshl_b32 s77, s77, 4
  v_lshrrev_b32 v2, 5, v0
  v_mul_u32_u24 v2, 24512, v2
  v_xad_u32 v2, v1, s77, v2
  v_add_u32 v2, s58, v2
  s_add_u32 s77, s8, 97280
  v_mfma_f32_16x16x32_bf16 v[28:31], v[32:35], v[44:47], v[28:31]
  s_add_u32 m0, s61, 98304
  s_waitcnt lgkmcnt(7)
  v_mfma_f32_32x32x16_bf16 v[64:79], v[48:51], v[232:235], v[64:79]
  ds_read_b64_tr_b16 v[40:41], v6 offset:57344
  ds_read_b64_tr_b16 v[42:43], v6 offset:57600
  buffer_load_dwordx4 v2, s[44:47], s8 offen offset:0 lds
  v_mfma_f32_32x32x16_bf16 v[96:111], v[48:51], v[236:239], v[96:111]
  ds_read_b64_tr_b16 v[44:45], v6 offset:59392
  ds_read_b64_tr_b16 v[46:47], v6 offset:59648
  v_mfma_f32_16x16x32_bf16 v[176:179], v[140:143], v[140:143], v[176:179]
  v_mfma_f32_16x16x32_bf16 v[184:187], v[148:151], v[140:143], v[184:187]
  v_mfma_f32_32x32x16_bf16 v[80:95], v[52:55], v[232:235], v[80:95]
  v_mfma_f32_32x32x16_bf16 v[112:127], v[52:55], v[236:239], v[112:127]
  s_waitcnt lgkmcnt(10)
  buffer_load_dwordx4 v2, s[44:47], s77 offen offset:1024 lds
  s_add_u32 s77, s9, 97280
  v_mfma_f32_16x16x32_bf16 v[180:183], v[144:147], v[144:147], v[180:183]
  v_mfma_f32_16x16x32_bf16 v[188:191], v[148:151], v[144:147], v[188:191]
  s_waitcnt lgkmcnt(4)
  v_mfma_f32_32x32x16_bf16 v[64:79], v[56:59], v[240:243], v[64:79]
  s_waitcnt vmcnt(18) lgkmcnt(0)
  s_barrier
  ds_read_b64_tr_b16 v[48:49], v5 offset:0
  ds_read_b64_tr_b16 v[50:51], v5 offset:256
  v_mfma_f32_32x32x16_bf16 v[96:111], v[56:59], v[244:247], v[96:111]
  s_add_u32 m0, s61, 100352
  v_cndmask_b32 v180, v180, v181, s[0:1]
  v_cndmask_b32 v182, v182, v183, s[0:1]
  v_cndmask_b32 v176, v176, v177, s[0:1]
  v_cndmask_b32 v178, v178, v179, s[0:1]
  v_cndmask_b32 v180, v180, v182, s[88:89]
  v_mfma_f32_16x16x32_bf16 v[24:27], v[32:35], v[56:59], v[24:27]
  v_cndmask_b32 v176, v176, v178, s[88:89]
  v_mfma_f32_32x32x16_bf16 v[80:95], v[60:63], v[240:243], v[80:95]
  ds_read_b64_tr_b16 v[52:53], v5 offset:2048
  ds_read_b64_tr_b16 v[54:55], v5 offset:2304
  buffer_load_dwordx4 v2, s[44:47], s9 offen offset:0 lds
  v_mfma_f32_32x32x16_bf16 v[112:127], v[60:63], v[244:247], v[112:127]
  s_mov_b32 vcc_lo, 0x00f0000f
  s_mov_b32 vcc_hi, 0xf0000f00
  v_cndmask_b32_dpp v10, v188, v184, vcc row_ror:8 row_mask:0xf bank_mask:0xf
  v_cndmask_b32_dpp v11, v180, v176, vcc row_ror:8 row_mask:0xf bank_mask:0xf
  v_mul_f32 v10, 0xbacccccd, v10
  v_mul_f32 v11, 0x3acccccd, v11
  v_mfma_f32_16x16x32_bf16 v[28:31], v[32:35], v[60:63], v[28:31]
  v_fma_f32 v11, -v10, v10, v11
  v_mfma_f32_32x32x16_bf16 v[64:79], v[40:43], v[248:251], v[64:79]
  ds_read_b64_tr_b16 v[56:57], v7 offset:0
  ds_read_b64_tr_b16 v[58:59], v7 offset:256
  v_max_f32 v11, 0, v11
  v_cvt_pk_bf16_f32 v11, v11, v11
  v_lshlrev_b32 v11, 16, v11
  v_add_f32 v11, 0x3727c5ac, v11
  v_mfma_f32_32x32x16_bf16 v[96:111], v[40:43], v[252:255], v[96:111]
  v_cvt_pk_bf16_f32 v11, v11, v11
  v_lshlrev_b32 v11, 16, v11
  v_sqrt_f32 v11, v11
  v_cvt_pk_bf16_f32 v10, v10, v10
  v_cvt_pk_bf16_f32 v11, v11, v11
  v_mfma_f32_32x32x16_bf16 v[80:95], v[44:47], v[248:251], v[80:95]
  ds_read_b64_tr_b16 v[60:61], v7 offset:2048
  ds_read_b64_tr_b16 v[62:63], v7 offset:2304
  buffer_load_dwordx4 v2, s[44:47], s77 offen offset:1024 lds
  v_add_u32 v2, 23552, v1
  v_mfma_f32_32x32x16_bf16 v[112:127], v[44:47], v[252:255], v[112:127]
  v_lshlrev_b32 v11, 16, v11
  v_rcp_f32 v11, v11
  s_nop 0
  ds_write2_b32 v23, v10, v11 offset0:0 offset1:128
  v_mov_b32_dpp v32, v32 quad_perm:[3,0,1,2] row_mask:0xf bank_mask:0xf
  v_mov_b32_dpp v33, v33 quad_perm:[3,0,1,2] row_mask:0xf bank_mask:0xf
  v_mov_b32_dpp v34, v34 quad_perm:[3,0,1,2] row_mask:0xf bank_mask:0xf
  v_mov_b32_dpp v35, v35 quad_perm:[3,0,1,2] row_mask:0xf bank_mask:0xf
  s_waitcnt lgkmcnt(5)
  v_mfma_f32_32x32x16_bf16 v[128:143], v[48:51], a[0:3], 0
  ds_read_b64_tr_b16 v[40:41], v5 offset:8192
  ds_read_b64_tr_b16 v[42:43], v5 offset:8448
  s_add_u32 m0, s61, 32768
  v_cvt_pk_bf16_f32 v8, v24, v24
  v_cvt_pk_bf16_f32 v9, v28, v28
  v_lshlrev_b32 v8, 16, v8
  v_mfma_f32_32x32x16_bf16 v[160:175], v[48:51], a[4:7], 0
  v_lshlrev_b32 v9, 16, v9
  buffer_load_dwordx4 v1, s[36:39], s8 offen offset:0 lds
  v_sub_f32 v8, v24, v8
  v_sub_f32 v9, v28, v9
  v_mfma_f32_16x16x32_bf16 v[24:27], v[32:35], v[48:51], v[24:27]
  v_mfma_f32_32x32x16_bf16 v[144:159], v[52:55], a[0:3], 0
  ds_read_b64_tr_b16 v[44:45], v5 offset:10240
  ds_read_b64_tr_b16 v[46:47], v5 offset:10496
  v_mfma_f32_32x32x16_bf16 v[176:191], v[52:55], a[4:7], 0
  buffer_load_dwordx4 v2, s[36:39], s8 offen offset:1024 lds
  v_mfma_f32_16x16x32_bf16 v[28:31], v[32:35], v[52:55], v[28:31]
  s_add_u32 m0, s61, 34816
  s_waitcnt lgkmcnt(5)
  v_mfma_f32_32x32x16_bf16 v[128:143], v[56:59], a[8:11], v[128:143]
  ds_read_b64_tr_b16 v[48:49], v7 offset:8192
  ds_read_b64_tr_b16 v[50:51], v7 offset:8448
  buffer_load_dwordx4 v1, s[40:43], s8 offen offset:0 lds
  v_cvt_pk_bf16_f32 v8, v24, v8
  v_mfma_f32_32x32x16_bf16 v[160:175], v[56:59], a[12:15], v[160:175]
  ds_read_b64_tr_b16 v[52:53], v7 offset:10240
  ds_read_b64_tr_b16 v[54:55], v7 offset:10496
  v_cvt_pk_bf16_f32 v9, v28, v9
  ds_write2_b32 v15, v8, v9 offset0:0 offset1:32
  v_mfma_f32_32x32x16_bf16 v[144:159], v[60:63], a[8:11], v[144:159]
  v_mfma_f32_32x32x16_bf16 v[176:191], v[60:63], a[12:15], v[176:191]
  buffer_load_dwordx4 v2, s[40:43], s8 offen offset:1024 lds
  s_add_u32 m0, s61, 49152
  s_waitcnt lgkmcnt(5)
  v_mfma_f32_32x32x16_bf16 v[128:143], v[40:43], a[16:19], v[128:143]
  s_waitcnt vmcnt(20) lgkmcnt(0)
  s_barrier
  ds_read_b64_tr_b16 v[56:57], v5 offset:16384
  ds_read_b64_tr_b16 v[58:59], v5 offset:16640
  ds_read2_b32 v[8:9], v16 offset0:0 offset1:32
  ds_read2_b32 v[10:11], v16 offset0:32 offset1:0
  v_mfma_f32_32x32x16_bf16 v[160:175], v[40:43], a[20:23], v[160:175]
  buffer_load_dwordx4 v1, s[36:39], s9 offen offset:0 lds
  ds_read_b32 v36, v19
  ds_read_b32 v38, v19 offset:128
  ds_read2_b32 v[18:19], v19 offset0:128 offset1:160
  v_mfma_f32_16x16x32_bf16 v[24:27], v[32:35], v[40:43], v[24:27]
  v_mfma_f32_32x32x16_bf16 v[144:159], v[44:47], a[16:19], v[144:159]
  ds_read_b64_tr_b16 v[60:61], v5 offset:18432
  ds_read_b64_tr_b16 v[62:63], v5 offset:18688
  buffer_load_dwordx4 v2, s[36:39], s9 offen offset:1024 lds
  v_mfma_f32_32x32x16_bf16 v[176:191], v[44:47], a[20:23], v[176:191]
  s_add_u32 m0, s61, 51200
  buffer_store_dword v0, v17, s[24:27], s80 offen sc1
  v_mfma_f32_16x16x32_bf16 v[28:31], v[32:35], v[44:47], v[28:31]
  v_mfma_f32_32x32x16_bf16 v[128:143], v[48:51], a[24:27], v[128:143]
  ds_read_b64_tr_b16 v[40:41], v7 offset:16384
  ds_read_b64_tr_b16 v[42:43], v7 offset:16640
  buffer_load_dwordx4 v1, s[40:43], s9 offen offset:0 lds
  s_waitcnt lgkmcnt(5)
  v_mfma_f32_32x32x16_bf16 v[160:175], v[48:51], a[28:31], v[160:175]
  v_mfma_f32_32x32x8_bf16 v[96:111], v[8:9], v[38:39], v[96:111]
  buffer_load_dwordx4 v2, s[40:43], s9 offen offset:1024 lds
  v_mfma_f32_32x32x8_bf16 v[112:127], v[10:11], v[38:39], v[112:127]
  v_mfma_f32_32x32x8_bf16 v[64:79], v[8:9], v[36:37], v[64:79]
  v_mfma_f32_32x32x8_bf16 v[80:95], v[10:11], v[36:37], v[80:95]
  s_waitcnt lgkmcnt(4)
  v_mul_f32 v20, s73, v18
  v_mul_f32 v21, s73, v19
  v_mfma_f32_32x32x16_bf16 v[144:159], v[52:55], a[24:27], v[144:159]
  ds_read_b64_tr_b16 v[44:45], v7 offset:18432
  ds_read_b64_tr_b16 v[46:47], v7 offset:18688
  v_mfma_f32_32x32x16_bf16 v[176:191], v[52:55], a[28:31], v[176:191]
  s_waitcnt lgkmcnt(4)
  v_mfma_f32_32x32x16_bf16 v[128:143], v[56:59], a[32:35], v[128:143]
  ds_read_b64_tr_b16 v[48:49], v5 offset:24576
  ds_read_b64_tr_b16 v[50:51], v5 offset:24832
  v_mul_f32 v96, v96, v21
  v_mul_f32 v97, v97, v21
  v_mul_f32 v98, v98, v21
  v_mul_f32 v99, v99, v21
  v_mfma_f32_32x32x16_bf16 v[160:175], v[56:59], a[36:39], v[160:175]
  v_cvt_pk_bf16_f32 v96, v96, v97
  v_mul_f32 v100, v100, v21
  v_mul_f32 v101, v101, v21
  v_cvt_pk_bf16_f32 v97, v98, v99
  v_mul_f32 v102, v102, v21
  v_mul_f32 v103, v103, v21
  v_mfma_f32_16x16x32_bf16 v[24:27], v[32:35], v[56:59], v[24:27]
  v_cvt_pk_bf16_f32 v98, v100, v101
  v_mfma_f32_32x32x16_bf16 v[144:159], v[60:63], a[32:35], v[144:159]
  ds_read_b64_tr_b16 v[52:53], v5 offset:26624
  ds_read_b64_tr_b16 v[54:55], v5 offset:26880
  v_mul_f32 v104, v104, v21
  v_mul_f32 v105, v105, v21
  v_cvt_pk_bf16_f32 v99, v102, v103
  v_mul_f32 v106, v106, v21
  v_mfma_f32_32x32x16_bf16 v[176:191], v[60:63], a[36:39], v[176:191]
  buffer_store_dwordx4 v[96:99], v14, s[24:27], s67 offen offset:0 sc1
  v_mfma_f32_16x16x32_bf16 v[28:31], v[32:35], v[60:63], v[28:31]
  v_mul_f32 v107, v107, v21
  s_waitcnt lgkmcnt(4)
  v_mfma_f32_32x32x16_bf16 v[128:143], v[40:43], a[40:43], v[128:143]
  ds_read_b64_tr_b16 v[56:57], v7 offset:24576
  ds_read_b64_tr_b16 v[58:59], v7 offset:24832
  v_cvt_pk_bf16_f32 v100, v104, v105
  v_mul_f32 v108, v108, v21
  v_mul_f32 v109, v109, v21
  v_cvt_pk_bf16_f32 v101, v106, v107
  v_mfma_f32_32x32x16_bf16 v[160:175], v[40:43], a[44:47], v[160:175]
  ds_read_b64_tr_b16 v[60:61], v7 offset:26624
  ds_read_b64_tr_b16 v[62:63], v7 offset:26880
  v_mul_f32 v110, v110, v21
  v_mul_f32 v111, v111, v21
  v_cvt_pk_bf16_f32 v102, v108, v109
  v_cvt_pk_bf16_f32 v103, v110, v111
  v_mfma_f32_32x32x16_bf16 v[144:159], v[44:47], a[40:43], v[144:159]
  v_mul_f32 v112, v112, v21
  v_mul_f32 v113, v113, v21
  v_mul_f32 v114, v114, v21
  v_mul_f32 v115, v115, v21
  v_cvt_pk_bf16_f32 v112, v112, v113
  v_mul_f32 v116, v116, v21
  v_mfma_f32_32x32x16_bf16 v[176:191], v[44:47], a[44:47], v[176:191]
  buffer_store_dwordx4 v[100:103], v14, s[24:27], s67 offen offset:1024 sc1
  s_waitcnt lgkmcnt(4)
  v_mfma_f32_32x32x16_bf16 v[128:143], v[48:51], a[48:51], v[128:143]
  s_waitcnt vmcnt(19) lgkmcnt(0)
  s_barrier
  ds_read_b64_tr_b16 v[40:41], v4 offset:0
  ds_read_b64_tr_b16 v[42:43], v4 offset:256
  v_mul_f32 v117, v117, v21
  v_cvt_pk_bf16_f32 v113, v114, v115
  v_mfma_f32_32x32x16_bf16 v[160:175], v[48:51], a[52:55], v[160:175]
  v_mul_f32 v118, v118, v21
  v_mul_f32 v119, v119, v21
  v_cvt_pk_bf16_f32 v114, v116, v117
  v_mul_f32 v120, v120, v21
  v_mul_f32 v121, v121, v21
  v_cvt_pk_bf16_f32 v115, v118, v119
  v_mfma_f32_16x16x32_bf16 v[24:27], v[32:35], v[48:51], v[24:27]
  v_mul_f32 v122, v122, v21
  v_mfma_f32_32x32x16_bf16 v[144:159], v[52:55], a[48:51], v[144:159]
  ds_read_b64_tr_b16 v[44:45], v4 offset:2048
  ds_read_b64_tr_b16 v[46:47], v4 offset:2304
  v_mul_f32 v123, v123, v21
  v_cvt_pk_bf16_f32 v116, v120, v121
  v_mul_f32 v124, v124, v21
  v_mul_f32 v125, v125, v21
  v_mfma_f32_32x32x16_bf16 v[176:191], v[52:55], a[52:55], v[176:191]
  buffer_store_dwordx4 v[112:115], v14, s[24:27], s68 offen offset:0 sc1
  v_mfma_f32_16x16x32_bf16 v[28:31], v[32:35], v[52:55], v[28:31]
  v_cvt_pk_bf16_f32 v117, v122, v123
  v_mfma_f32_32x32x16_bf16 v[128:143], v[56:59], a[56:59], v[128:143]
  ds_read_b64_tr_b16 v[48:49], v6 offset:0
  ds_read_b64_tr_b16 v[50:51], v6 offset:256
  v_mul_f32 v126, v126, v21
  v_mul_f32 v127, v127, v21
  v_cvt_pk_bf16_f32 v118, v124, v125
  v_cvt_pk_bf16_f32 v119, v126, v127
  v_mfma_f32_32x32x16_bf16 v[160:175], v[56:59], a[60:63], v[160:175]
  v_mul_f32 v64, v64, v20
  v_mul_f32 v65, v65, v20
  v_mul_f32 v66, v66, v20
  v_mul_f32 v67, v67, v20
  v_cvt_pk_bf16_f32 v64, v64, v65
  v_mul_f32 v68, v68, v20
  v_mfma_f32_32x32x16_bf16 v[144:159], v[60:63], a[56:59], v[144:159]
  ds_read_b64_tr_b16 v[52:53], v6 offset:2048
  ds_read_b64_tr_b16 v[54:55], v6 offset:2304
  v_mul_f32 v69, v69, v20
  v_cvt_pk_bf16_f32 v65, v66, v67
  v_mul_f32 v70, v70, v20
  v_mul_f32 v71, v71, v20
  v_mfma_f32_32x32x16_bf16 v[176:191], v[60:63], a[60:63], v[176:191]
  buffer_store_dwordx4 v[116:119], v14, s[24:27], s68 offen offset:1024 sc1
  s_waitcnt lgkmcnt(4)
  v_mfma_f32_32x32x16_bf16 v[128:143], v[40:43], a[64:67], v[128:143]
  ds_read_b64_tr_b16 v[56:57], v4 offset:8192
  ds_read_b64_tr_b16 v[58:59], v4 offset:8448
  v_cvt_pk_bf16_f32 v66, v68, v69
  v_mul_f32 v72, v72, v20
  v_mul_f32 v73, v73, v20
  v_cvt_pk_bf16_f32 v67, v70, v71
  v_mfma_f32_32x32x16_bf16 v[160:175], v[40:43], a[68:71], v[160:175]
  v_mul_f32 v74, v74, v20
  v_mul_f32 v75, v75, v20
  v_cvt_pk_bf16_f32 v68, v72, v73
  v_mul_f32 v76, v76, v20
  v_mul_f32 v77, v77, v20
  v_cvt_pk_bf16_f32 v69, v74, v75
  v_mfma_f32_16x16x32_bf16 v[24:27], v[32:35], v[40:43], v[24:27]
  v_mul_f32 v78, v78, v20
  v_mfma_f32_32x32x16_bf16 v[144:159], v[44:47], a[64:67], v[144:159]
  ds_read_b64_tr_b16 v[60:61], v4 offset:10240
  ds_read_b64_tr_b16 v[62:63], v4 offset:10496
  v_mul_f32 v79, v79, v20
  v_cvt_pk_bf16_f32 v70, v76, v77
  v_cvt_pk_bf16_f32 v71, v78, v79
  v_mul_f32 v80, v80, v20
  v_mfma_f32_32x32x16_bf16 v[176:191], v[44:47], a[68:71], v[176:191]
  buffer_store_dwordx4 v[64:67], v14, s[24:27], s65 offen offset:0 sc1
  v_mfma_f32_16x16x32_bf16 v[28:31], v[32:35], v[44:47], v[28:31]
  v_mul_f32 v81, v81, v20
  s_waitcnt lgkmcnt(4)
  v_mfma_f32_32x32x16_bf16 v[128:143], v[48:51], a[72:75], v[128:143]
  ds_read_b64_tr_b16 v[40:41], v6 offset:8192
  ds_read_b64_tr_b16 v[42:43], v6 offset:8448
  v_mul_f32 v82, v82, v20
  v_mul_f32 v83, v83, v20
  v_cvt_pk_bf16_f32 v80, v80, v81
  v_mul_f32 v84, v84, v20
  v_mfma_f32_32x32x16_bf16 v[160:175], v[48:51], a[76:79], v[160:175]
  ds_read_b64_tr_b16 v[44:45], v6 offset:10240
  ds_read_b64_tr_b16 v[46:47], v6 offset:10496
  v_mul_f32 v85, v85, v20
  v_cvt_pk_bf16_f32 v81, v82, v83
  v_mul_f32 v86, v86, v20
  v_mul_f32 v87, v87, v20
  v_mfma_f32_32x32x16_bf16 v[144:159], v[52:55], a[72:75], v[144:159]
  v_cvt_pk_bf16_f32 v82, v84, v85
  v_mul_f32 v88, v88, v20
  v_mul_f32 v89, v89, v20
  v_cvt_pk_bf16_f32 v83, v86, v87
  v_mul_f32 v90, v90, v20
  v_mul_f32 v91, v91, v20
  v_mfma_f32_32x32x16_bf16 v[176:191], v[52:55], a[76:79], v[176:191]
  buffer_store_dwordx4 v[68:71], v14, s[24:27], s65 offen offset:1024 sc1
  s_waitcnt lgkmcnt(4)
  v_mfma_f32_32x32x16_bf16 v[128:143], v[56:59], a[80:83], v[128:143]
  s_waitcnt vmcnt(19) lgkmcnt(0)
  s_barrier
  ds_read_b64_tr_b16 v[48:49], v4 offset:16384
  ds_read_b64_tr_b16 v[50:51], v4 offset:16640
  s_add_u32 m0, s61, 0
  v_cvt_pk_bf16_f32 v84, v88, v89
  v_mfma_f32_32x32x16_bf16 v[160:175], v[56:59], a[84:87], v[160:175]
  buffer_load_dwordx4 v1, s[36:39], s12 offen offset:0 lds
  v_mul_f32 v92, v92, v20
  v_mul_f32 v93, v93, v20
  v_cvt_pk_bf16_f32 v85, v90, v91
  v_mfma_f32_16x16x32_bf16 v[24:27], v[32:35], v[56:59], v[24:27]
  v_mul_f32 v94, v94, v20
  v_mfma_f32_32x32x16_bf16 v[144:159], v[60:63], a[80:83], v[144:159]
  ds_read_b64_tr_b16 v[52:53], v4 offset:18432
  ds_read_b64_tr_b16 v[54:55], v4 offset:18688
  buffer_load_dwordx4 v2, s[36:39], s12 offen offset:1024 lds
  s_add_u32 m0, s61, 2048
  v_mfma_f32_32x32x16_bf16 v[176:191], v[60:63], a[84:87], v[176:191]
  buffer_load_dwordx4 v1, s[40:43], s12 offen offset:0 lds
  v_mul_f32 v95, v95, v20
  v_cvt_pk_bf16_f32 v86, v92, v93
  v_cvt_pk_bf16_f32 v87, v94, v95
  v_mfma_f32_16x16x32_bf16 v[28:31], v[32:35], v[60:63], v[28:31]
  v_mul_f32 v18, v18, v18
  v_mfma_f32_32x32x16_bf16 v[128:143], v[40:43], a[88:91], v[128:143]
  ds_read_b64_tr_b16 v[56:57], v6 offset:16384
  ds_read_b64_tr_b16 v[58:59], v6 offset:16640
  buffer_load_dwordx4 v2, s[40:43], s12 offen offset:1024 lds
  s_and_b32 s77, s3, 2
  v_mfma_f32_32x32x16_bf16 v[160:175], v[40:43], a[92:95], v[160:175]
  s_lshl_b32 s77, s77, 4
  v_lshrrev_b32 v2, 5, v0
  v_mul_u32_u24 v2, 24512, v2
  v_xad_u32 v2, v1, s77, v2
  v_add_u32 v2, s58, v2
  s_add_u32 s77, s14, 97280
  v_mfma_f32_32x32x16_bf16 v[144:159], v[44:47], a[88:91], v[144:159]
  ds_read_b64_tr_b16 v[60:61], v6 offset:18432
  ds_read_b64_tr_b16 v[62:63], v6 offset:18688
  s_add_u32 m0, s61, 114688
  v_mul_f32 v19, v19, v19
  v_lshl_add_u32 v93, v0, 2, s34
  v_and_b32 v72, 1, v0
  v_mfma_f32_32x32x16_bf16 v[176:191], v[44:47], a[92:95], v[176:191]
  buffer_load_dwordx4 v2, s[44:47], s14 offen offset:0 lds
  v_lshl_add_u32 v72, v72, 2, s35
  s_mov_b32 s0, -1
  s_waitcnt lgkmcnt(4)
  v_mfma_f32_32x32x16_bf16 v[128:143], v[48:51], a[96:99], v[128:143]
  ds_read_b64_tr_b16 v[40:41], v4 offset:24576
  ds_read_b64_tr_b16 v[42:43], v4 offset:24832
  s_mov_b32 s1, 0
  v_cndmask_b32 v93, v72, v93, s[0:1]
  v_lshlrev_b32 v79, 7, v0
  v_min_u32 v78, 20, v0
  v_mfma_f32_32x32x16_bf16 v[160:175], v[48:51], a[100:103], v[160:175]
  buffer_store_dwordx4 v[80:83], v14, s[24:27], s66 offen offset:0 sc1
  v_mfma_f32_16x16x32_bf16 v[24:27], v[32:35], v[48:51], v[24:27]
  v_lshlrev_b32 v78, 7, v78
  v_mfma_f32_32x32x16_bf16 v[144:159], v[52:55], a[96:99], v[144:159]
  ds_read_b64_tr_b16 v[44:45], v4 offset:26624
  ds_read_b64_tr_b16 v[46:47], v4 offset:26880
  buffer_load_dwordx4 v2, s[44:47], s77 offen offset:1024 lds
  s_add_u32 s77, s15, 97280
  v_mfma_f32_32x32x16_bf16 v[176:191], v[52:55], a[100:103], v[176:191]
  s_add_u32 s34, s33, 8192
  v_and_b32 v72, 1, v0
  v_mul_u32_u24 v72, 304, v72
  v_add_u32 v72, s94, v72
  v_lshrrev_b32 v72, 11, v72
  v_bfe_u32 v73, v0, 1, 2
  v_mfma_f32_16x16x32_bf16 v[28:31], v[32:35], v[52:55], v[28:31]
  v_mad_u32_u24 v72, v73, 5, v72
  s_waitcnt lgkmcnt(4)
  v_mfma_f32_32x32x16_bf16 v[128:143], v[56:59], a[104:107], v[128:143]
  ds_read_b64_tr_b16 v[48:49], v6 offset:24576
  ds_read_b64_tr_b16 v[50:51], v6 offset:24832
  s_add_u32 m0, s61, 116736
  v_min_u32 v72, 15, v72
  v_bfe_u32 v73, v0, 3, 2
  v_lshl_add_u32 v73, v73, 6, s93
  v_mfma_f32_32x32x16_bf16 v[160:175], v[56:59], a[108:111], v[160:175]
  ds_read_b64_tr_b16 v[52:53], v6 offset:26624
  ds_read_b64_tr_b16 v[54:55], v6 offset:26880
  v_max_i32 v73, 0, v73
  buffer_load_dwordx4 v2, s[44:47], s15 offen offset:0 lds
  v_mfma_f32_32x32x16_bf16 v[144:159], v[60:63], a[104:107], v[144:159]
  buffer_store_dwordx4 v[84:87], v14, s[24:27], s66 offen offset:1024 sc1
  v_mfma_f32_32x32x16_bf16 v[176:191], v[60:63], a[108:111], v[176:191]
  v_lshl_add_u32 v10, v72, 2, v73
  v_and_b32 v72, 31, v0
  v_lshrrev_b32 v73, 5, v0
  v_add_u32 v88, s96, v14
  v_lshlrev_b32 v21, 4, v72
  s_waitcnt lgkmcnt(4)
  v_mfma_f32_32x32x16_bf16 v[128:143], v[40:43], a[112:115], v[128:143]
  s_waitcnt vmcnt(20) lgkmcnt(0)
  s_barrier
  ds_read_b64_tr_b16 v[56:57], v4 offset:32768
  ds_read_b64_tr_b16 v[58:59], v4 offset:33024
  v_lshl_add_u32 v21, v73, 3, v21
  v_add_u32 v91, s97, v21
  v_mfma_f32_32x32x16_bf16 v[160:175], v[40:43], a[116:119], v[160:175]
  v_mov_b32 v74, 1073741824
  v_cmp_eq_u32 vcc, s92, v73
  s_add_u32 s76, s57, 123392
  s_sub_u32 s97, s97, 1024
  v_cndmask_b32 v91, v74, v91, vcc
  s_add_u32 s94, s94, 39936
  v_mfma_f32_16x16x32_bf16 v[24:27], v[32:35], v[40:43], v[24:27]
  v_lshl_add_u32 v74, v72, 4, s94
  v_mfma_f32_32x32x16_bf16 v[144:159], v[44:47], a[112:115], v[144:159]
  ds_read_b64_tr_b16 v[60:61], v4 offset:34816
  ds_read_b64_tr_b16 v[62:63], v4 offset:35072
  buffer_load_dwordx4 v2, s[44:47], s77 offen offset:1024 lds
  v_add_u32 v2, 23552, v1
  v_mfma_f32_32x32x16_bf16 v[176:191], v[44:47], a[116:119], v[176:191]
  v_add_u32 v75, 9920, v74
  v_add_u32 v76, s97, v14
  v_cmp_gt_u32 vcc, 20, v72
  s_sub_u32 s94, s94, 512
  v_add_u32 v77, s94, v14
  v_cndmask_b32 v74, v75, v74, vcc
  v_mfma_f32_16x16x32_bf16 v[28:31], v[32:35], v[44:47], v[28:31]
  s_add_u32 m0, s61, 16384
  v_mfma_f32_32x32x16_bf16 v[128:143], v[48:51], a[120:123], v[128:143]
  ds_read_b64_tr_b16 v[40:41], v6 offset:32768
  ds_read_b64_tr_b16 v[42:43], v6 offset:33024
  v_cndmask_b32 v89, v74, v76, s[0:1]
  v_add_u32 v74, 9920, v77
  v_add_u32 v75, 19712, v77
  v_add_u32 v76, 29632, v77
  v_mfma_f32_32x32x16_bf16 v[160:175], v[48:51], a[124:127], v[160:175]
  buffer_load_dwordx4 v1, s[36:39], s13 offen offset:0 lds
  v_mov_b32 v77, 79872
  v_mfma_f32_32x32x16_bf16 v[144:159], v[52:55], a[120:123], v[144:159]
  ds_read_b64_tr_b16 v[44:45], v6 offset:34816
  ds_read_b64_tr_b16 v[46:47], v6 offset:35072
  s_mov_b32 vcc_lo, 0xff
  s_mov_b32 vcc_hi, 0
  v_cndmask_b32 v77, v77, v74, vcc
  v_mfma_f32_32x32x16_bf16 v[176:191], v[52:55], a[124:127], v[176:191]
  buffer_load_dwordx4 v2, s[36:39], s13 offen offset:1024 lds
  s_waitcnt lgkmcnt(4)
  v_mfma_f32_32x32x16_bf16 v[128:143], v[56:59], a[128:131], v[128:143]
  ds_read_b64_tr_b16 v[48:49], v4 offset:40960
  ds_read_b64_tr_b16 v[50:51], v4 offset:41216
  s_add_u32 m0, s61, 18432
  s_mov_b32 vcc_lo, 0xffff0000
  s_mov_b32 vcc_hi, 15
  v_cndmask_b32 v77, v77, v75, vcc
  v_mfma_f32_32x32x16_bf16 v[160:175], v[56:59], a[132:135], v[160:175]
  buffer_load_dwordx4 v1, s[40:43], s13 offen offset:0 lds
  s_mov_b32 vcc_lo, 0
  s_mov_b32 vcc_hi, 0xfffff0
  v_cndmask_b32 v90, v77, v76, vcc
  v_mfma_f32_16x16x32_bf16 v[24:27], v[32:35], v[56:59], v[24:27]
  s_mul_i32 s32, s3, 6144
  v_mfma_f32_32x32x16_bf16 v[144:159], v[60:63], a[128:131], v[144:159]
  ds_read_b64_tr_b16 v[52:53], v4 offset:43008
  ds_read_b64_tr_b16 v[54:55], v4 offset:43264
  s_add_u32 s32, s32, 65536
  buffer_load_dwordx4 v2, s[40:43], s13 offen offset:1024 lds
  v_mfma_f32_32x32x16_bf16 v[176:191], v[60:63], a[132:135], v[176:191]
  s_and_b32 s77, s3, 2
  s_lshl_b32 s77, s77, 4
  v_lshrrev_b32 v2, 5, v0
  v_mul_u32_u24 v2, 24512, v2
  v_xad_u32 v2, v1, s77, v2
  v_add_u32 v2, s58, v2
  v_mfma_f32_16x16x32_bf16 v[28:31], v[32:35], v[60:63], v[28:31]
  s_add_u32 s77, s4, 97280
  s_waitcnt lgkmcnt(4)
  v_mfma_f32_32x32x16_bf16 v[128:143], v[40:43], a[136:139], v[128:143]
  ds_read_b64_tr_b16 v[56:57], v6 offset:40960
  ds_read_b64_tr_b16 v[58:59], v6 offset:41216
  s_add_u32 m0, s61, 65536
  v_add_u32 v20, s32, v14
  s_add_u32 s32, s32, 1024
  v_add_u32 v21, s32, v21
  v_mfma_f32_32x32x16_bf16 v[160:175], v[40:43], a[140:143], v[160:175]
  ds_read_b64_tr_b16 v[60:61], v6 offset:43008
  ds_read_b64_tr_b16 v[62:63], v6 offset:43264
  buffer_load_dwordx4 v2, s[44:47], s4 offen offset:0 lds
  v_mul_u32_u24 v74, 10240, v73
  v_mfma_f32_32x32x16_bf16 v[144:159], v[44:47], a[136:139], v[144:159]
  v_sub_u32 v74, v12, v74
  s_lshl_b32 s94, s92, 6
  v_add_u32 v75, s94, v74
  v_subrev_u32 v76, 320, v75
  v_min_u32 v75, v75, v76
  v_mul_u32_u24 v76, 320, v73
  v_mfma_f32_32x32x16_bf16 v[176:191], v[44:47], a[140:143], v[176:191]
  v_add_u32 v75, v75, v76
  v_mov_b32 v76, 640
  s_waitcnt lgkmcnt(4)
  v_mfma_f32_32x32x16_bf16 v[128:143], v[48:51], a[144:147], v[128:143]
  s_waitcnt vmcnt(6) lgkmcnt(0)
  s_barrier
  ds_read_b64_tr_b16 v[40:41], v4 offset:49152
  ds_read_b64_tr_b16 v[42:43], v4 offset:49408
  v_mfma_f32_32x32x16_bf16 v[160:175], v[48:51], a[148:151], v[160:175]
  buffer_load_dwordx4 v2, s[44:47], s77 offen offset:1024 lds
  s_add_u32 s77, s5, 97280
  v_mfma_f32_16x16x32_bf16 v[24:27], v[32:35], v[48:51], v[24:27]
  v_mfma_f32_32x32x16_bf16 v[144:159], v[52:55], a[144:147], v[144:159]
  ds_read_b64_tr_b16 v[44:45], v4 offset:51200
  ds_read_b64_tr_b16 v[46:47], v4 offset:51456
  buffer_store_dword v0, v17, s[24:27], s79 offen sc1
  v_mfma_f32_32x32x16_bf16 v[176:191], v[52:55], a[148:151], v[176:191]
  s_add_u32 m0, s61, 67584
  v_cmp_gt_u32 vcc, 320, v74
  s_add_u32 s32, s32, 512
  s_lshr_b32 s94, s3, 1
  v_cndmask_b32 v75, v76, v75, vcc
  v_add_u32 v22, s32, v75
  v_mfma_f32_16x16x32_bf16 v[28:31], v[32:35], v[52:55], v[28:31]
  v_and_b32 v8, 0x10df, v4
  v_mfma_f32_32x32x16_bf16 v[128:143], v[56:59], a[152:155], v[128:143]
  ds_read_b64_tr_b16 v[48:49], v6 offset:49152
  ds_read_b64_tr_b16 v[50:51], v6 offset:49408
  buffer_load_dwordx4 v2, s[44:47], s5 offen offset:0 lds
  v_lshl_add_u32 v8, v73, 9, v8
  v_mfma_f32_32x32x16_bf16 v[160:175], v[56:59], a[156:159], v[160:175]
  v_bfe_u32 v74, v0, 4, 1
  v_lshl_add_u32 v8, v74, 13, v8
  v_xor_b32 v74, s94, v74
  v_lshl_add_u32 v8, v74, 5, v8
  v_add_u32 v8, 65536, v8
  v_xor_b32 v9, 4096, v8
  v_mfma_f32_32x32x16_bf16 v[144:159], v[60:63], a[152:155], v[144:159]
  ds_read_b64_tr_b16 v[52:53], v6 offset:51200
  ds_read_b64_tr_b16 v[54:55], v6 offset:51456
  v_lshlrev_b32 v73, 2, v73
  v_sub_u32 v73, v72, v73
  v_mov_b32 v74, 0xf149f2ca
  v_mfma_f32_32x32x16_bf16 v[176:191], v[60:63], a[156:159], v[176:191]
  v_cmp_le_i32 vcc, 0, v73
  v_cmp_le_i32 s[0:1], 1, v73
  s_nop 0
  v_cndmask_b32 v96, v74, 0, vcc
  v_cndmask_b32 v97, v74, 0, s[0:1]
  s_waitcnt lgkmcnt(4)
  v_mfma_f32_32x32x16_bf16 v[128:143], v[40:43], a[160:163], v[128:143]
  ds_read_b64_tr_b16 v[56:57], v4 offset:57344
  ds_read_b64_tr_b16 v[58:59], v4 offset:57600
  buffer_load_dword v11, v93, s[24:27], s95 offen offset:0 sc1
  v_mfma_f32_32x32x16_bf16 v[160:175], v[40:43], a[164:167], v[160:175]
  buffer_load_dwordx4 v2, s[44:47], s77 offen offset:1024 lds
  v_add_u32 v2, 23552, v1
  v_mfma_f32_16x16x32_bf16 v[24:27], v[32:35], v[40:43], v[24:27]
  v_mfma_f32_32x32x16_bf16 v[144:159], v[44:47], a[160:163], v[144:159]
  ds_read_b64_tr_b16 v[60:61], v4 offset:59392
  ds_read_b64_tr_b16 v[62:63], v4 offset:59648
  s_add_u32 m0, s61, 32768
  v_mfma_f32_32x32x16_bf16 v[176:191], v[44:47], a[164:167], v[176:191]
  v_cmp_le_i32 vcc, 2, v73
  v_cmp_le_i32 s[0:1], 3, v73
  s_nop 0
  v_cndmask_b32 v98, v74, 0, vcc
  v_cndmask_b32 v99, v74, 0, s[0:1]
  v_mfma_f32_16x16x32_bf16 v[28:31], v[32:35], v[44:47], v[28:31]
  s_waitcnt lgkmcnt(4)
  v_mfma_f32_32x32x16_bf16 v[128:143], v[48:51], a[168:171], v[128:143]
  ds_read_b64_tr_b16 v[40:41], v6 offset:57344
  ds_read_b64_tr_b16 v[42:43], v6 offset:57600
  buffer_load_dwordx4 v1, s[36:39], s14 offen offset:0 lds
  v_mfma_f32_32x32x16_bf16 v[160:175], v[48:51], a[172:175], v[160:175]
  ds_read_b64_tr_b16 v[44:45], v6 offset:59392
  ds_read_b64_tr_b16 v[46:47], v6 offset:59648
  buffer_load_dwordx4 v2, s[36:39], s14 offen offset:1024 lds
  v_mfma_f32_32x32x16_bf16 v[144:159], v[52:55], a[168:171], v[144:159]
  s_add_u32 m0, s61, 34816
  v_cmp_le_i32 vcc, 8, v73
  v_cmp_le_i32 s[0:1], 9, v73
  s_nop 0
  v_cndmask_b32 v100, v74, 0, vcc
  v_cndmask_b32 v101, v74, 0, s[0:1]
  v_mfma_f32_32x32x16_bf16 v[176:191], v[52:55], a[172:175], v[176:191]
  v_cmp_le_i32 vcc, 10, v73
  v_cmp_le_i32 s[0:1], 11, v73
  s_nop 0
  v_cndmask_b32 v102, v74, 0, vcc
  v_cndmask_b32 v103, v74, 0, s[0:1]
  s_waitcnt lgkmcnt(4)
  v_mfma_f32_32x32x16_bf16 v[128:143], v[56:59], a[176:179], v[128:143]
  s_waitcnt lgkmcnt(0)
  s_barrier
  ds_read_b64_tr_b16 v[48:49], v4 offset:0
  ds_read_b64_tr_b16 v[50:51], v4 offset:256
  v_mfma_f32_32x32x16_bf16 v[160:175], v[56:59], a[180:183], v[160:175]
  buffer_load_dwordx4 v1, s[40:43], s14 offen offset:0 lds
  v_mfma_f32_16x16x32_bf16 v[24:27], v[32:35], v[56:59], v[24:27]
  v_mfma_f32_32x32x16_bf16 v[144:159], v[60:63], a[176:179], v[144:159]
  ds_read_b64_tr_b16 v[52:53], v4 offset:2048
  ds_read_b64_tr_b16 v[54:55], v4 offset:2304
  buffer_load_dwordx4 v2, s[40:43], s14 offen offset:1024 lds
  s_and_b32 s77, s3, 2
  v_mfma_f32_32x32x16_bf16 v[176:191], v[60:63], a[180:183], v[176:191]
  s_lshl_b32 s77, s77, 4
  v_lshrrev_b32 v2, 5, v0
  v_mul_u32_u24 v2, 24512, v2
  v_xad_u32 v2, v1, s77, v2
  v_add_u32 v2, s58, v2
  s_add_u32 s77, s6, 97280
  v_mfma_f32_16x16x32_bf16 v[28:31], v[32:35], v[60:63], v[28:31]
  s_add_u32 m0, s61, 81920
  v_mfma_f32_32x32x16_bf16 v[128:143], v[40:43], a[184:187], v[128:143]
  ds_read_b64_tr_b16 v[56:57], v6 offset:0
  ds_read_b64_tr_b16 v[58:59], v6 offset:256
  buffer_load_dwordx4 v2, s[44:47], s6 offen offset:0 lds
  v_mfma_f32_32x32x16_bf16 v[160:175], v[40:43], a[188:191], v[160:175]
  v_cmp_le_i32 vcc, 16, v73
  v_cmp_le_i32 s[0:1], 17, v73
  s_nop 0
  v_cndmask_b32 v104, v74, 0, vcc
  v_cndmask_b32 v105, v74, 0, s[0:1]
  v_mfma_f32_32x32x16_bf16 v[144:159], v[44:47], a[184:187], v[144:159]
  ds_read_b64_tr_b16 v[60:61], v6 offset:2048
  ds_read_b64_tr_b16 v[62:63], v6 offset:2304
  v_mfma_f32_32x32x16_bf16 v[176:191], v[44:47], a[188:191], v[176:191]
  buffer_load_dwordx4 v2, s[44:47], s77 offen offset:1024 lds
  s_add_u32 s77, s7, 97280
  s_waitcnt lgkmcnt(4)
  v_mfma_f32_32x32x16_bf16 v[128:143], v[48:51], a[192:195], v[128:143]
  ds_read_b64_tr_b16 v[40:41], v4 offset:8192
  ds_read_b64_tr_b16 v[42:43], v4 offset:8448
  v_mov_b32 v64, -1
  v_mov_b32 v65, -1
  v_mov_b32 v66, -1
  v_mov_b32 v67, -1
  v_mfma_f32_32x32x16_bf16 v[160:175], v[48:51], a[196:199], v[160:175]
  s_sub_u32 s65, s85, 8
  s_cmp_eq_u32 s92, 0
  s_cselect_b32 s65, s83, s65
  v_mfma_f32_16x16x32_bf16 v[24:27], v[32:35], v[48:51], v[24:27]
  s_add_u32 m0, s61, 83968
  v_mfma_f32_32x32x16_bf16 v[144:159], v[52:55], a[192:195], v[144:159]
  ds_read_b64_tr_b16 v[44:45], v4 offset:10240
  ds_read_b64_tr_b16 v[46:47], v4 offset:10496
  buffer_load_dwordx4 v2, s[44:47], s7 offen offset:0 lds
  v_mfma_f32_32x32x16_bf16 v[176:191], v[52:55], a[196:199], v[176:191]
  s_mov_b32 exec_hi, 0
  buffer_store_dwordx4 v[64:67], v13, s[24:27], s65 offen sc1
  s_mov_b32 exec_hi, -1
  v_mfma_f32_16x16x32_bf16 v[28:31], v[32:35], v[52:55], v[28:31]
  s_waitcnt lgkmcnt(4)
  v_mfma_f32_32x32x16_bf16 v[128:143], v[56:59], a[200:203], v[128:143]
  ds_read_b64_tr_b16 v[48:49], v6 offset:8192
  ds_read_b64_tr_b16 v[50:51], v6 offset:8448
  v_mfma_f32_32x32x16_bf16 v[160:175], v[56:59], a[204:207], v[160:175]
  ds_read_b64_tr_b16 v[52:53], v6 offset:10240
  ds_read_b64_tr_b16 v[54:55], v6 offset:10496
  v_mfma_f32_32x32x16_bf16 v[144:159], v[60:63], a[200:203], v[144:159]
  buffer_load_dwordx4 v2, s[44:47], s77 offen offset:1024 lds
  v_add_u32 v2, 23552, v1
  v_mfma_f32_32x32x16_bf16 v[176:191], v[60:63], a[204:207], v[176:191]
  buffer_store_dwordx4 v[64:67], v13, s[24:27], s82 offen sc1
  s_waitcnt lgkmcnt(4)
  v_mfma_f32_32x32x16_bf16 v[128:143], v[40:43], a[208:211], v[128:143]
  s_waitcnt vmcnt(16) lgkmcnt(0)
  s_barrier
  ds_read_b64_tr_b16 v[56:57], v4 offset:16384
  ds_read_b64_tr_b16 v[58:59], v4 offset:16640
  s_add_u32 m0, s61, 49152
  v_mfma_f32_32x32x16_bf16 v[160:175], v[40:43], a[212:215], v[160:175]
  v_cmp_le_i32 vcc, 18, v73
  v_cmp_le_i32 s[0:1], 19, v73
  s_nop 0
  v_cndmask_b32 v106, v74, 0, vcc
  v_cndmask_b32 v107, v74, 0, s[0:1]
  v_mfma_f32_16x16x32_bf16 v[24:27], v[32:35], v[40:43], v[24:27]
  v_mfma_f32_32x32x16_bf16 v[144:159], v[44:47], a[208:211], v[144:159]
  ds_read_b64_tr_b16 v[60:61], v4 offset:18432
  ds_read_b64_tr_b16 v[62:63], v4 offset:18688
  buffer_load_dwordx4 v1, s[36:39], s15 offen offset:0 lds
  v_mfma_f32_32x32x16_bf16 v[176:191], v[44:47], a[212:215], v[176:191]
  buffer_load_dwordx4 v2, s[36:39], s15 offen offset:1024 lds
  v_mfma_f32_16x16x32_bf16 v[28:31], v[32:35], v[44:47], v[28:31]
  s_add_u32 m0, s61, 51200
  v_mfma_f32_32x32x16_bf16 v[128:143], v[48:51], a[216:219], v[128:143]
  ds_read_b64_tr_b16 v[40:41], v6 offset:16384
  ds_read_b64_tr_b16 v[42:43], v6 offset:16640
  v_mfma_f32_32x32x16_bf16 v[160:175], v[48:51], a[220:223], v[160:175]
  buffer_load_dwordx4 v1, s[40:43], s15 offen offset:0 lds
  v_mfma_f32_32x32x16_bf16 v[144:159], v[52:55], a[216:219], v[144:159]
  ds_read_b64_tr_b16 v[44:45], v6 offset:18432
  ds_read_b64_tr_b16 v[46:47], v6 offset:18688
  v_mfma_f32_32x32x16_bf16 v[176:191], v[52:55], a[220:223], v[176:191]
  buffer_load_dwordx4 v2, s[40:43], s15 offen offset:1024 lds
  s_waitcnt lgkmcnt(4)
  v_mfma_f32_32x32x16_bf16 v[128:143], v[56:59], a[224:227], v[128:143]
  ds_read_b64_tr_b16 v[48:49], v4 offset:24576
  ds_read_b64_tr_b16 v[50:51], v4 offset:24832
  v_mfma_f32_32x32x16_bf16 v[160:175], v[56:59], a[228:231], v[160:175]
  buffer_store_dwordx4 v[64:67], v13, s[24:27], s84 offen sc1
  v_mfma_f32_16x16x32_bf16 v[24:27], v[32:35], v[56:59], v[24:27]
  v_mfma_f32_32x32x16_bf16 v[144:159], v[60:63], a[224:227], v[144:159]
  ds_read_b64_tr_b16 v[52:53], v4 offset:26624
  ds_read_b64_tr_b16 v[54:55], v4 offset:26880
  v_mfma_f32_32x32x16_bf16 v[176:191], v[60:63], a[228:231], v[176:191]
  v_cmp_le_i32 vcc, 24, v73
  v_cmp_le_i32 s[0:1], 25, v73
  s_nop 0
  v_cndmask_b32 v108, v74, 0, vcc
  v_cndmask_b32 v109, v74, 0, s[0:1]
  v_mfma_f32_16x16x32_bf16 v[28:31], v[32:35], v[60:63], v[28:31]
  s_waitcnt lgkmcnt(4)
  v_mfma_f32_32x32x16_bf16 v[128:143], v[40:43], a[232:235], v[128:143]
  ds_read_b64_tr_b16 v[56:57], v6 offset:24576
  ds_read_b64_tr_b16 v[58:59], v6 offset:24832
  s_waitcnt vmcnt(16)
  v_cmp_eq_u32 vcc, 0, v11
  s_cbranch_vccnz .slow4
.back5:
  v_mfma_f32_32x32x16_bf16 v[160:175], v[40:43], a[236:239], v[160:175]
  ds_read_b64_tr_b16 v[60:61], v6 offset:26624
  ds_read_b64_tr_b16 v[62:63], v6 offset:26880
  v_mfma_f32_32x32x16_bf16 v[144:159], v[44:47], a[232:235], v[144:159]
  v_cmp_le_i32 vcc, 26, v73
  v_cmp_le_i32 s[0:1], 27, v73
  s_nop 0
  v_cndmask_b32 v110, v74, 0, vcc
  v_cndmask_b32 v111, v74, 0, s[0:1]
  s_lshl2_add_u32 s94, s10, s3
  v_mfma_f32_32x32x16_bf16 v[176:191], v[44:47], a[236:239], v[176:191]
  s_lshl_b32 s94, s94, 5
  s_add_u32 s94, s94, 6144
  s_lshr_b32 s32, s10, 2
  s_lshl_b32 s32, s32, 1
  s_and_b32 s35, s10, 1
  s_waitcnt lgkmcnt(4)
  v_mfma_f32_32x32x16_bf16 v[128:143], v[48:51], a[240:243], v[128:143]
  s_waitcnt vmcnt(11) lgkmcnt(0)
  s_barrier
  ds_read_b64_tr_b16 v[40:41], v4 offset:32768
  ds_read_b64_tr_b16 v[42:43], v4 offset:33024
  s_add_u32 s56, s91, 0
  s_and_b32 s56, s56, 7
  v_mfma_f32_32x32x16_bf16 v[160:175], v[48:51], a[244:247], v[160:175]
  s_mul_i32 s56, s56, 5120
  s_add_u32 s56, s56, s59
  s_add_u32 m0, s63, 0
  s_add_u32 s32, s32, s35
  s_xor_b32 s35, s3, 1
  s_lshl2_add_u32 s32, s32, s35
  v_mfma_f32_16x16x32_bf16 v[24:27], v[32:35], v[48:51], v[24:27]
  s_lshl_b32 s32, s32, 5
  v_mfma_f32_32x32x16_bf16 v[144:159], v[52:55], a[240:243], v[144:159]
  ds_read_b64_tr_b16 v[44:45], v4 offset:34816
  ds_read_b64_tr_b16 v[46:47], v4 offset:35072
  buffer_load_dwordx4 v14, s[24:27], s56 offen offset:0 sc1 lds
  s_and_b32 s35, s10, 2
  v_mfma_f32_32x32x16_bf16 v[176:191], v[52:55], a[244:247], v[176:191]
  buffer_load_dwordx4 v14, s[24:27], s56 offen offset:1024 sc1 lds
  s_lshl1_add_u32 s32, s35, s32
  s_add_u32 s32, s32, 2048
  v_and_b32 v72, 7, v0
  v_mfma_f32_16x16x32_bf16 v[28:31], v[32:35], v[52:55], v[28:31]
  v_lshl_add_u32 v23, v72, 2, s94
  v_mfma_f32_32x32x16_bf16 v[128:143], v[56:59], a[248:251], v[128:143]
  ds_read_b64_tr_b16 v[48:49], v6 offset:32768
  ds_read_b64_tr_b16 v[50:51], v6 offset:33024
  buffer_load_dwordx4 v14, s[24:27], s56 offen offset:2048 sc1 lds
  v_and_b32 v72, 3, v0
  v_mfma_f32_32x32x16_bf16 v[160:175], v[56:59], a[252:255], v[160:175]
  v_lshl_add_u32 v72, v72, 3, s32
  v_bfe_u32 v73, v0, 2, 1
  v_lshl_add_u32 v72, v73, 11, v72
  s_mov_b32 vcc_lo, 0
  s_mov_b32 vcc_hi, -1
  v_cndmask_b32 v23, v23, v72, vcc
  v_mfma_f32_32x32x16_bf16 v[144:159], v[60:63], a[248:251], v[144:159]
  ds_read_b64_tr_b16 v[52:53], v6 offset:34816
  ds_read_b64_tr_b16 v[54:55], v6 offset:35072
  buffer_load_dwordx4 v14, s[24:27], s56 offen offset:3072 sc1 lds
  s_add_u32 s56, s56, 4096
  v_mfma_f32_32x32x16_bf16 v[176:191], v[60:63], a[252:255], v[176:191]
  s_add_u32 m0, s63, 4096
  s_sub_u32 s94, s94, 4096
  s_waitcnt lgkmcnt(4)
  v_mfma_f32_32x32x16_bf16 v[128:143], v[40:43], v[192:195], v[128:143]
  ds_read_b64_tr_b16 v[56:57], v4 offset:40960
  ds_read_b64_tr_b16 v[58:59], v4 offset:41216
  buffer_load_dwordx4 v14, s[24:27], s56 offen sc1 lds
  v_mfma_f32_32x32x16_bf16 v[160:175], v[40:43], v[196:199], v[160:175]
  v_mfma_f32_16x16x32_bf16 v[24:27], v[32:35], v[40:43], v[24:27]
  v_mfma_f32_32x32x16_bf16 v[144:159], v[44:47], v[192:195], v[144:159]
  ds_read_b64_tr_b16 v[60:61], v4 offset:43008
  ds_read_b64_tr_b16 v[62:63], v4 offset:43264
  v_mfma_f32_32x32x16_bf16 v[176:191], v[44:47], v[196:199], v[176:191]
  v_mfma_f32_16x16x32_bf16 v[28:31], v[32:35], v[44:47], v[28:31]
  s_waitcnt lgkmcnt(4)
  v_mfma_f32_32x32x16_bf16 v[128:143], v[48:51], v[200:203], v[128:143]
  ds_read_b64_tr_b16 v[40:41], v6 offset:40960
  ds_read_b64_tr_b16 v[42:43], v6 offset:41216
  v_mfma_f32_32x32x16_bf16 v[160:175], v[48:51], v[204:207], v[160:175]
  ds_read_b64_tr_b16 v[44:45], v6 offset:43008
  ds_read_b64_tr_b16 v[46:47], v6 offset:43264
  v_mfma_f32_32x32x16_bf16 v[144:159], v[52:55], v[200:203], v[144:159]
  v_mfma_f32_32x32x16_bf16 v[176:191], v[52:55], v[204:207], v[176:191]
  s_waitcnt lgkmcnt(4)
  v_mfma_f32_32x32x16_bf16 v[128:143], v[56:59], v[208:211], v[128:143]
  s_waitcnt vmcnt(6) lgkmcnt(0)
  s_barrier
  ds_read_b64_tr_b16 v[48:49], v4 offset:49152
  ds_read_b64_tr_b16 v[50:51], v4 offset:49408
  s_add_u32 s56, s91, 1
  s_and_b32 s56, s56, 7
  v_mfma_f32_32x32x16_bf16 v[160:175], v[56:59], v[212:215], v[160:175]
  s_mul_i32 s56, s56, 5120
  s_add_u32 s56, s56, s59
  s_add_u32 m0, s63, 20480
  v_mfma_f32_16x16x32_bf16 v[24:27], v[32:35], v[56:59], v[24:27]
  v_mfma_f32_32x32x16_bf16 v[144:159], v[60:63], v[208:211], v[144:159]
  ds_read_b64_tr_b16 v[52:53], v4 offset:51200
  ds_read_b64_tr_b16 v[54:55], v4 offset:51456
  buffer_load_dwordx4 v14, s[24:27], s56 offen offset:0 sc1 lds
  v_mfma_f32_32x32x16_bf16 v[176:191], v[60:63], v[212:215], v[176:191]
  buffer_load_dwordx4 v14, s[24:27], s56 offen offset:1024 sc1 lds
  v_mfma_f32_16x16x32_bf16 v[28:31], v[32:35], v[60:63], v[28:31]
  v_mfma_f32_32x32x16_bf16 v[128:143], v[40:43], v[216:219], v[128:143]
  ds_read_b64_tr_b16 v[56:57], v6 offset:49152
  ds_read_b64_tr_b16 v[58:59], v6 offset:49408
  buffer_load_dwordx4 v14, s[24:27], s56 offen offset:2048 sc1 lds
  v_mfma_f32_32x32x16_bf16 v[160:175], v[40:43], v[220:223], v[160:175]
  v_mfma_f32_32x32x16_bf16 v[144:159], v[44:47], v[216:219], v[144:159]
  ds_read_b64_tr_b16 v[60:61], v6 offset:51200
  ds_read_b64_tr_b16 v[62:63], v6 offset:51456
  buffer_load_dwordx4 v14, s[24:27], s56 offen offset:3072 sc1 lds
  s_add_u32 s56, s56, 4096
  v_mfma_f32_32x32x16_bf16 v[176:191], v[44:47], v[220:223], v[176:191]
  s_add_u32 m0, s63, 24576
  s_waitcnt lgkmcnt(4)
  v_mfma_f32_32x32x16_bf16 v[128:143], v[48:51], v[224:227], v[128:143]
  ds_read_b64_tr_b16 v[40:41], v4 offset:57344
  ds_read_b64_tr_b16 v[42:43], v4 offset:57600
  buffer_load_dwordx4 v14, s[24:27], s56 offen sc1 lds
  v_mfma_f32_32x32x16_bf16 v[160:175], v[48:51], v[228:231], v[160:175]
  v_mfma_f32_16x16x32_bf16 v[24:27], v[32:35], v[48:51], v[24:27]
  v_mfma_f32_32x32x16_bf16 v[144:159], v[52:55], v[224:227], v[144:159]
  ds_read_b64_tr_b16 v[44:45], v4 offset:59392
  ds_read_b64_tr_b16 v[46:47], v4 offset:59648
  v_mfma_f32_32x32x16_bf16 v[176:191], v[52:55], v[228:231], v[176:191]
  v_mfma_f32_16x16x32_bf16 v[28:31], v[32:35], v[52:55], v[28:31]
  s_waitcnt lgkmcnt(4)
  v_mfma_f32_32x32x16_bf16 v[128:143], v[56:59], v[232:235], v[128:143]
  ds_read_b64_tr_b16 v[48:49], v6 offset:57344
  ds_read_b64_tr_b16 v[50:51], v6 offset:57600
  v_mfma_f32_32x32x16_bf16 v[160:175], v[56:59], v[236:239], v[160:175]
  ds_read_b64_tr_b16 v[52:53], v6 offset:59392
  ds_read_b64_tr_b16 v[54:55], v6 offset:59648
  v_mfma_f32_32x32x16_bf16 v[144:159], v[60:63], v[232:235], v[144:159]
  v_mfma_f32_32x32x16_bf16 v[176:191], v[60:63], v[236:239], v[176:191]
  s_waitcnt lgkmcnt(4)
  v_mfma_f32_32x32x16_bf16 v[128:143], v[40:43], v[240:243], v[128:143]
  s_waitcnt lgkmcnt(0)
  s_barrier
  ds_read_b64_tr_b16 v[56:57], v8 offset:0
  ds_read_b64_tr_b16 v[58:59], v8 offset:256
  s_add_u32 s56, s91, 2
  s_and_b32 s56, s56, 7
  v_mfma_f32_32x32x16_bf16 v[160:175], v[40:43], v[244:247], v[160:175]
  s_mul_i32 s56, s56, 5120
  s_add_u32 s56, s56, s59
  s_add_u32 m0, s63, 40960
  v_mov_b32 v4, v88
  v_mov_b32 v5, v89
  v_mov_b32 v6, v90
  v_mfma_f32_16x16x32_bf16 v[24:27], v[32:35], v[40:43], v[24:27]
  v_mov_b32 v7, v91
  v_mfma_f32_32x32x16_bf16 v[144:159], v[44:47], v[240:243], v[144:159]
  ds_read_b64_tr_b16 v[60:61], v9 offset:0
  ds_read_b64_tr_b16 v[62:63], v9 offset:256
  buffer_load_dwordx4 v14, s[24:27], s56 offen offset:0 sc1 lds
  v_mfma_f32_32x32x16_bf16 v[176:191], v[44:47], v[244:247], v[176:191]
  buffer_load_dwordx4 v14, s[24:27], s56 offen offset:1024 sc1 lds
  v_mfma_f32_16x16x32_bf16 v[28:31], v[32:35], v[44:47], v[28:31]
  v_mfma_f32_32x32x16_bf16 v[128:143], v[48:51], v[248:251], v[128:143]
  ds_read_b64_tr_b16 v[40:41], v8 offset:1024
  ds_read_b64_tr_b16 v[42:43], v8 offset:1280
  buffer_load_dwordx4 v14, s[24:27], s56 offen offset:2048 sc1 lds
  v_mov_b32_dpp v32, v32 quad_perm:[3,0,1,2] row_mask:0xf bank_mask:0xf
  v_mfma_f32_32x32x16_bf16 v[160:175], v[48:51], v[252:255], v[160:175]
  v_mov_b32_dpp v33, v33 quad_perm:[3,0,1,2] row_mask:0xf bank_mask:0xf
  v_mov_b32_dpp v34, v34 quad_perm:[3,0,1,2] row_mask:0xf bank_mask:0xf
  v_mov_b32_dpp v35, v35 quad_perm:[3,0,1,2] row_mask:0xf bank_mask:0xf
  v_cvt_pk_bf16_f32 v124, v25, v25
  v_cvt_pk_bf16_f32 v125, v29, v29
  v_lshlrev_b32 v124, 16, v124
  v_mfma_f32_32x32x16_bf16 v[144:159], v[52:55], v[248:251], v[144:159]
  ds_read_b64_tr_b16 v[44:45], v9 offset:1024
  ds_read_b64_tr_b16 v[46:47], v9 offset:1280
  buffer_load_dwordx4 v14, s[24:27], s56 offen offset:3072 sc1 lds
  s_add_u32 s56, s56, 4096
  v_mfma_f32_32x32x16_bf16 v[176:191], v[52:55], v[252:255], v[176:191]
  s_add_u32 m0, s63, 45056
  v_lshlrev_b32 v125, 16, v125
  v_sub_f32 v124, v25, v124
  v_sub_f32 v125, v29, v125
  v_cvt_pk_bf16_f32 v124, v25, v124
  s_waitcnt lgkmcnt(4)
  v_mfma_f32_32x32x16_bf16 v[64:79], v[56:59], a[0:3], 0
  ds_read_b64_tr_b16 v[48:49], v8 offset:2048
  ds_read_b64_tr_b16 v[50:51], v8 offset:2304
  buffer_load_dwordx4 v14, s[24:27], s56 offen sc1 lds
  v_cvt_pk_bf16_f32 v125, v29, v125
  v_mfma_f32_32x32x16_bf16 v[80:95], v[56:59], a[4:7], 0
  ds_write2_b32 v15, v124, v125 offset0:0 offset1:32
  v_mfma_f32_16x16x32_bf16 v[24:27], v[32:35], v[56:59], v[24:27]
  v_mfma_f32_32x32x16_bf16 v[64:79], v[60:63], a[8:11], v[64:79]
  ds_read_b64_tr_b16 v[52:53], v9 offset:2048
  ds_read_b64_tr_b16 v[54:55], v9 offset:2304
  buffer_load_dword v11, v10, s[24:27], s95 offen offset:1024 sc1
  v_mfma_f32_32x32x16_bf16 v[80:95], v[60:63], a[12:15], v[80:95]
  buffer_load_dwordx4 a[0:3], v14, s[24:27], s74 offen offset:0 sc1
  s_waitcnt lgkmcnt(5)
  v_mfma_f32_32x32x16_bf16 v[64:79], v[40:43], a[16:19], v[64:79]
  ds_read_b64_tr_b16 v[56:57], v8 offset:3072
  ds_read_b64_tr_b16 v[58:59], v8 offset:3328
  buffer_load_dwordx4 a[4:7], v14, s[24:27], s74 offen offset:1024 sc1
  v_mfma_f32_32x32x16_bf16 v[80:95], v[40:43], a[20:23], v[80:95]
  ds_read_b64_tr_b16 v[60:61], v9 offset:3072
  ds_read_b64_tr_b16 v[62:63], v9 offset:3328
  v_mfma_f32_16x16x32_bf16 v[24:27], v[32:35], v[40:43], v[24:27]
  v_mfma_f32_32x32x16_bf16 v[64:79], v[44:47], a[24:27], v[64:79]
  buffer_load_dwordx4 a[8:11], v14, s[24:27], s74 offen offset:2048 sc1
  v_mfma_f32_32x32x16_bf16 v[80:95], v[44:47], a[28:31], v[80:95]
  s_waitcnt lgkmcnt(4)
  v_mfma_f32_32x32x16_bf16 v[64:79], v[48:51], a[32:35], v[64:79]
  s_waitcnt lgkmcnt(0)
  s_barrier
  ds_read_b64_tr_b16 v[40:41], v8 offset:16384
  ds_read_b64_tr_b16 v[42:43], v8 offset:16640
  ds_read2_b32 v[124:125], v16 offset0:0 offset1:32
  ds_read2_b32 v[126:127], v16 offset0:32 offset1:0
  v_mfma_f32_32x32x16_bf16 v[80:95], v[48:51], a[36:39], v[80:95]
  s_mul_i32 s33, s10, 278528
  s_lshl_b32 s32, s3, 13
  s_add_u32 s33, s33, s32
  s_add_u32 s33, s33, 8388608
  v_mfma_f32_16x16x32_bf16 v[24:27], v[32:35], v[48:51], v[24:27]
  v_mfma_f32_32x32x16_bf16 v[64:79], v[52:55], a[40:43], v[64:79]
  ds_read_b64_tr_b16 v[44:45], v9 offset:16384
  ds_read_b64_tr_b16 v[46:47], v9 offset:16640
  s_waitcnt lgkmcnt(2)
  buffer_load_dwordx4 a[12:15], v14, s[24:27], s74 offen offset:3072 sc1
  v_mfma_f32_32x32x16_bf16 v[80:95], v[52:55], a[44:47], v[80:95]
  s_add_u32 s74, s74, 4096
  buffer_load_dwordx4 a[16:19], v14, s[24:27], s74 offen offset:0 sc1
  v_mfma_f32_32x32x8_bf16 v[128:143], v[124:125], v[36:37], v[128:143]
  v_mfma_f32_32x32x8_bf16 v[144:159], v[126:127], v[36:37], v[144:159]
  buffer_load_dwordx4 a[20:23], v14, s[24:27], s74 offen offset:1024 sc1
  v_mfma_f32_32x32x8_bf16 v[160:175], v[124:125], v[38:39], v[160:175]
  v_mfma_f32_32x32x8_bf16 v[176:191], v[126:127], v[38:39], v[176:191]
  buffer_load_dwordx4 a[24:27], v14, s[24:27], s74 offen offset:2048 sc1
  v_mfma_f32_32x32x16_bf16 v[64:79], v[56:59], a[48:51], v[64:79]
  ds_read_b64_tr_b16 v[48:49], v8 offset:17408
  ds_read_b64_tr_b16 v[50:51], v8 offset:17664
  v_mfma_f32_32x32x16_bf16 v[80:95], v[56:59], a[52:55], v[80:95]
  buffer_load_dwordx4 a[28:31], v14, s[24:27], s74 offen offset:3072 sc1
  s_add_u32 s74, s74, 4096
  v_mfma_f32_16x16x32_bf16 v[24:27], v[32:35], v[56:59], v[24:27]
  v_max_f32 v128, 0, v128
  v_mfma_f32_32x32x16_bf16 v[64:79], v[60:63], a[56:59], v[64:79]
  ds_read_b64_tr_b16 v[52:53], v9 offset:17408
  ds_read_b64_tr_b16 v[54:55], v9 offset:17664
  v_max_f32 v129, 0, v129
  v_mul_f32 v144, v144, v18
  v_mul_f32 v145, v145, v18
  v_max_f32 v130, 0, v130
  v_mfma_f32_32x32x16_bf16 v[80:95], v[60:63], a[60:63], v[80:95]
  v_max_f32 v131, 0, v131
  v_mul_f32 v146, v146, v18
  v_mul_f32 v147, v147, v18
  v_mul_f32 v128, v128, v144
  v_mul_f32 v129, v129, v145
  s_waitcnt lgkmcnt(4)
  v_mfma_f32_32x32x16_bf16 v[64:79], v[40:43], a[64:67], v[64:79]
  ds_read_b64_tr_b16 v[56:57], v8 offset:18432
  ds_read_b64_tr_b16 v[58:59], v8 offset:18688
  v_cvt_pk_bf16_f32 v128, v128, v129
  v_max_f32 v132, 0, v132
  v_max_f32 v133, 0, v133
  v_mul_f32 v148, v148, v18
  v_mfma_f32_32x32x16_bf16 v[80:95], v[40:43], a[68:71], v[80:95]
  v_mul_f32 v149, v149, v18
  v_mul_f32 v130, v130, v146
  v_mul_f32 v131, v131, v147
  v_cvt_pk_bf16_f32 v129, v130, v131
  v_max_f32 v134, 0, v134
  v_max_f32 v135, 0, v135
  v_mfma_f32_16x16x32_bf16 v[24:27], v[32:35], v[40:43], v[24:27]
  v_mul_f32 v150, v150, v18
  v_mfma_f32_32x32x16_bf16 v[64:79], v[44:47], a[72:75], v[64:79]
  ds_read_b64_tr_b16 v[60:61], v9 offset:18432
  ds_read_b64_tr_b16 v[62:63], v9 offset:18688
  v_mul_f32 v151, v151, v18
  v_mul_f32 v132, v132, v148
  v_mul_f32 v133, v133, v149
  v_cvt_pk_bf16_f32 v130, v132, v133
  v_mfma_f32_32x32x16_bf16 v[80:95], v[44:47], a[76:79], v[80:95]
  v_max_f32 v136, 0, v136
  v_max_f32 v137, 0, v137
  v_mul_f32 v152, v152, v18
  v_mul_f32 v153, v153, v18
  v_mul_f32 v134, v134, v150
  s_waitcnt lgkmcnt(4)
  v_mfma_f32_32x32x16_bf16 v[64:79], v[48:51], a[80:83], v[64:79]
  ds_read_b64_tr_b16 v[40:41], v8 offset:19456
  ds_read_b64_tr_b16 v[42:43], v8 offset:19712
  v_mul_f32 v135, v135, v151
  v_cvt_pk_bf16_f32 v131, v134, v135
  v_max_f32 v138, 0, v138
  v_max_f32 v139, 0, v139
  v_mfma_f32_32x32x16_bf16 v[80:95], v[48:51], a[84:87], v[80:95]
  ds_read_b64_tr_b16 v[44:45], v9 offset:19456
  ds_read_b64_tr_b16 v[46:47], v9 offset:19712
  v_mul_f32 v154, v154, v18
  v_mul_f32 v155, v155, v18
  v_mul_f32 v136, v136, v152
  v_mul_f32 v137, v137, v153
  v_mfma_f32_16x16x32_bf16 v[24:27], v[32:35], v[48:51], v[24:27]
  v_cvt_pk_bf16_f32 v132, v136, v137
  v_mfma_f32_32x32x16_bf16 v[64:79], v[52:55], a[88:91], v[64:79]
  buffer_store_dwordx4 v[128:131], v13, s[24:27], s69 offen offset:0 sc1
  v_mfma_f32_32x32x16_bf16 v[80:95], v[52:55], a[92:95], v[80:95]
  v_max_f32 v140, 0, v140
  v_max_f32 v141, 0, v141
  v_mul_f32 v156, v156, v18
  v_mul_f32 v157, v157, v18
  v_mul_f32 v138, v138, v154
  s_waitcnt lgkmcnt(4)
  v_mfma_f32_32x32x16_bf16 v[64:79], v[56:59], a[96:99], v[64:79]
  s_waitcnt lgkmcnt(0)
  s_barrier
  ds_read_b64_tr_b16 v[48:49], v8 offset:32768
  ds_read_b64_tr_b16 v[50:51], v8 offset:33024
  v_mul_f32 v139, v139, v155
  v_cvt_pk_bf16_f32 v133, v138, v139
  v_mfma_f32_32x32x16_bf16 v[80:95], v[56:59], a[100:103], v[80:95]
  s_waitcnt vmcnt(9)
  v_cmp_eq_u32 vcc, 0, v11
  s_cbranch_vccnz .slow7
.back8:
  buffer_load_dwordx4 v[112:115], v4, s[24:27], s57 offen sc1
  v_mfma_f32_16x16x32_bf16 v[24:27], v[32:35], v[56:59], v[24:27]
  s_add_u32 m0, s64, 0
  v_mfma_f32_32x32x16_bf16 v[64:79], v[60:63], a[104:107], v[64:79]
  ds_read_b64_tr_b16 v[52:53], v9 offset:32768
  ds_read_b64_tr_b16 v[54:55], v9 offset:33024
  buffer_load_dwordx2 v[120:121], v7, s[24:27], s57 offen sc1
  v_max_f32 v142, 0, v142
  v_mfma_f32_32x32x16_bf16 v[80:95], v[60:63], a[108:111], v[80:95]
  buffer_load_dwordx4 v[116:119], v4, s[24:27], s76 offen sc1
  v_max_f32 v143, 0, v143
  v_mul_f32 v158, v158, v18
  v_mfma_f32_32x32x16_bf16 v[64:79], v[40:43], a[112:115], v[64:79]
  ds_read_b64_tr_b16 v[56:57], v8 offset:33792
  ds_read_b64_tr_b16 v[58:59], v8 offset:34048
  buffer_load_dwordx2 v[122:123], v7, s[24:27], s76 offen sc1
  v_mul_f32 v159, v159, v18
  v_mfma_f32_32x32x16_bf16 v[80:95], v[40:43], a[116:119], v[80:95]
  buffer_load_dwordx4 v4, s[24:27], s20 offen offset:0 sc1 lds
  v_mul_f32 v140, v140, v156
  v_mul_f32 v141, v141, v157
  v_cvt_pk_bf16_f32 v134, v140, v141
  v_mfma_f32_16x16x32_bf16 v[24:27], v[32:35], v[40:43], v[24:27]
  v_mul_f32 v142, v142, v158
  v_mfma_f32_32x32x16_bf16 v[64:79], v[44:47], a[120:123], v[64:79]
  ds_read_b64_tr_b16 v[60:61], v9 offset:33792
  ds_read_b64_tr_b16 v[62:63], v9 offset:34048
  v_mul_f32 v143, v143, v159
  v_cvt_pk_bf16_f32 v135, v142, v143
  v_max_f32 v160, 0, v160
  v_max_f32 v161, 0, v161
  v_mfma_f32_32x32x16_bf16 v[80:95], v[44:47], a[124:127], v[80:95]
  buffer_store_dwordx4 v[132:135], v13, s[24:27], s69 offen offset:512 sc1
  s_waitcnt lgkmcnt(4)
  v_mfma_f32_32x32x16_bf16 v[64:79], v[48:51], a[128:131], v[64:79]
  ds_read_b64_tr_b16 v[40:41], v8 offset:34816
  ds_read_b64_tr_b16 v[42:43], v8 offset:35072
  buffer_load_dwordx4 v5, s[24:27], s20 offen offset:1024 sc1 lds
  v_mul_f32 v176, v176, v19
  v_mfma_f32_32x32x16_bf16 v[80:95], v[48:51], a[132:135], v[80:95]
  buffer_load_dwordx4 v6, s[24:27], s20 offen offset:2048 sc1 lds
  s_add_u32 m0, s64, 12288
  v_mul_f32 v177, v177, v19
  v_max_f32 v162, 0, v162
  v_mfma_f32_16x16x32_bf16 v[24:27], v[32:35], v[48:51], v[24:27]
  v_max_f32 v163, 0, v163
  v_mfma_f32_32x32x16_bf16 v[64:79], v[52:55], a[136:139], v[64:79]
  ds_read_b64_tr_b16 v[44:45], v9 offset:34816
  ds_read_b64_tr_b16 v[46:47], v9 offset:35072
  buffer_load_dwordx4 v4, s[24:27], s21 offen offset:0 sc1 lds
  v_mul_f32 v178, v178, v19
  v_mfma_f32_32x32x16_bf16 v[80:95], v[52:55], a[140:143], v[80:95]
  v_mul_f32 v179, v179, v19
  v_mul_f32 v160, v160, v176
  v_mul_f32 v161, v161, v177
  v_cvt_pk_bf16_f32 v160, v160, v161
  v_max_f32 v164, 0, v164
  s_waitcnt lgkmcnt(4)
  v_mfma_f32_32x32x16_bf16 v[64:79], v[56:59], a[144:147], v[64:79]
  ds_read_b64_tr_b16 v[48:49], v8 offset:35840
  ds_read_b64_tr_b16 v[50:51], v8 offset:36096
  buffer_load_dwordx4 v5, s[24:27], s21 offen offset:1024 sc1 lds
  v_max_f32 v165, 0, v165
  v_mfma_f32_32x32x16_bf16 v[80:95], v[56:59], a[148:151], v[80:95]
  ds_read_b64_tr_b16 v[52:53], v9 offset:35840
  ds_read_b64_tr_b16 v[54:55], v9 offset:36096
  v_mul_f32 v180, v180, v19
  v_mul_f32 v181, v181, v19
  v_mul_f32 v162, v162, v178
  v_mul_f32 v163, v163, v179
  v_mfma_f32_16x16x32_bf16 v[24:27], v[32:35], v[56:59], v[24:27]
  v_cvt_pk_bf16_f32 v161, v162, v163
  v_mfma_f32_32x32x16_bf16 v[64:79], v[60:63], a[152:155], v[64:79]
  buffer_load_dwordx4 v6, s[24:27], s21 offen offset:2048 sc1 lds
  v_max_f32 v166, 0, v166
  v_max_f32 v167, 0, v167
  v_mul_f32 v182, v182, v19
  v_mfma_f32_32x32x16_bf16 v[80:95], v[60:63], a[156:159], v[80:95]
  v_mul_f32 v183, v183, v19
  v_mul_f32 v164, v164, v180
  v_mul_f32 v165, v165, v181
  v_cvt_pk_bf16_f32 v162, v164, v165
  v_max_f32 v168, 0, v168
  s_waitcnt lgkmcnt(4)
  v_mfma_f32_32x32x16_bf16 v[64:79], v[40:43], a[160:163], v[64:79]
  s_waitcnt lgkmcnt(0)
  v_add_u32 v8, 49152, v8
  v_add_u32 v9, 49152, v9
  s_barrier
  ds_read_b64_tr_b16 v[56:57], v8 offset:16384
  ds_read_b64_tr_b16 v[58:59], v8 offset:16640
  v_mfma_f32_32x32x16_bf16 v[80:95], v[40:43], a[164:167], v[80:95]
  s_add_u32 m0, s64, 24576
  v_max_f32 v169, 0, v169
  buffer_load_dwordx4 v4, s[24:27], s22 offen offset:0 sc1 lds
  v_mul_f32 v184, v184, v19
  v_mfma_f32_16x16x32_bf16 v[24:27], v[32:35], v[40:43], v[24:27]
  v_mul_f32 v185, v185, v19
  v_mfma_f32_32x32x16_bf16 v[64:79], v[44:47], a[168:171], v[64:79]
  ds_read_b64_tr_b16 v[60:61], v9 offset:16384
  ds_read_b64_tr_b16 v[62:63], v9 offset:16640
  buffer_load_dwordx4 v5, s[24:27], s22 offen offset:1024 sc1 lds
  v_mul_f32 v166, v166, v182
  v_mfma_f32_32x32x16_bf16 v[80:95], v[44:47], a[172:175], v[80:95]
  v_mul_f32 v167, v167, v183
  v_cvt_pk_bf16_f32 v163, v166, v167
  v_max_f32 v170, 0, v170
  v_max_f32 v171, 0, v171
  v_mul_f32 v186, v186, v19
  v_mfma_f32_32x32x16_bf16 v[64:79], v[48:51], a[176:179], v[64:79]
  ds_read_b64_tr_b16 v[40:41], v8 offset:17408
  ds_read_b64_tr_b16 v[42:43], v8 offset:17664
  buffer_load_dwordx4 v6, s[24:27], s22 offen offset:2048 sc1 lds
  s_add_u32 m0, s64, 36864
  v_mfma_f32_32x32x16_bf16 v[80:95], v[48:51], a[180:183], v[80:95]
  buffer_store_dwordx4 v[160:163], v13, s[24:27], s70 offen offset:0 sc1
  v_mfma_f32_16x16x32_bf16 v[24:27], v[32:35], v[48:51], v[24:27]
  v_mul_f32 v187, v187, v19
  v_mfma_f32_32x32x16_bf16 v[64:79], v[52:55], a[184:187], v[64:79]
  ds_read_b64_tr_b16 v[44:45], v9 offset:17408
  ds_read_b64_tr_b16 v[46:47], v9 offset:17664
  buffer_load_dwordx4 v4, s[24:27], s23 offen offset:0 sc1 lds
  v_mul_f32 v168, v168, v184
  v_mfma_f32_32x32x16_bf16 v[80:95], v[52:55], a[188:191], v[80:95]
  buffer_load_dwordx4 v5, s[24:27], s23 offen offset:1024 sc1 lds
  v_mul_f32 v169, v169, v185
  v_cvt_pk_bf16_f32 v164, v168, v169
  s_waitcnt lgkmcnt(4)
  v_mfma_f32_32x32x16_bf16 v[64:79], v[56:59], a[192:195], v[64:79]
  ds_read_b64_tr_b16 v[48:49], v8 offset:18432
  ds_read_b64_tr_b16 v[50:51], v8 offset:18688
  v_max_f32 v172, 0, v172
  v_max_f32 v173, 0, v173
  v_mul_f32 v188, v188, v19
  v_mul_f32 v189, v189, v19
  v_mfma_f32_32x32x16_bf16 v[80:95], v[56:59], a[196:199], v[80:95]
  v_mul_f32 v170, v170, v186
  buffer_load_dwordx4 v6, s[24:27], s23 offen offset:2048 sc1 lds
  v_mul_f32 v171, v171, v187
  v_cvt_pk_bf16_f32 v165, v170, v171
  v_mfma_f32_16x16x32_bf16 v[24:27], v[32:35], v[56:59], v[24:27]
  v_max_f32 v174, 0, v174
  v_mfma_f32_32x32x16_bf16 v[64:79], v[60:63], a[200:203], v[64:79]
  ds_read_b64_tr_b16 v[52:53], v9 offset:18432
  ds_read_b64_tr_b16 v[54:55], v9 offset:18688
  v_max_f32 v175, 0, v175
  v_mul_f32 v190, v190, v19
  v_mul_f32 v191, v191, v19
  v_mul_f32 v172, v172, v188
  v_mfma_f32_32x32x16_bf16 v[80:95], v[60:63], a[204:207], v[80:95]
  v_mul_f32 v173, v173, v189
  v_cvt_pk_bf16_f32 v166, v172, v173
  v_mul_f32 v174, v174, v190
  v_mul_f32 v175, v175, v191
  v_cvt_pk_bf16_f32 v167, v174, v175
  s_waitcnt lgkmcnt(4)
  v_mfma_f32_32x32x16_bf16 v[64:79], v[40:43], a[208:211], v[64:79]
  ds_read_b64_tr_b16 v[56:57], v8 offset:19456
  ds_read_b64_tr_b16 v[58:59], v8 offset:19712
  v_xor_b32 v144, 0xf149f2ca, v96
  v_xor_b32 v145, 0xf149f2ca, v97
  v_xor_b32 v146, 0xf149f2ca, v98
  v_xor_b32 v147, 0xf149f2ca, v99
  v_mfma_f32_32x32x16_bf16 v[80:95], v[40:43], a[212:215], v[80:95]
  ds_read_b64_tr_b16 v[60:61], v9 offset:19456
  ds_read_b64_tr_b16 v[62:63], v9 offset:19712
  v_xor_b32 v148, 0xf149f2ca, v100
  v_xor_b32 v149, 0xf149f2ca, v101
  v_xor_b32 v150, 0xf149f2ca, v102
  v_xor_b32 v151, 0xf149f2ca, v103
  v_mfma_f32_16x16x32_bf16 v[24:27], v[32:35], v[40:43], v[24:27]
  v_xor_b32 v152, 0xf149f2ca, v104
  v_mfma_f32_32x32x16_bf16 v[64:79], v[44:47], a[216:219], v[64:79]
  buffer_store_dwordx4 v[164:167], v13, s[24:27], s70 offen offset:512 sc1
  v_mfma_f32_32x32x16_bf16 v[80:95], v[44:47], a[220:223], v[80:95]
  v_xor_b32 v153, 0xf149f2ca, v105
  v_xor_b32 v154, 0xf149f2ca, v106
  v_xor_b32 v155, 0xf149f2ca, v107
  v_xor_b32 v156, 0xf149f2ca, v108
  v_xor_b32 v157, 0xf149f2ca, v109
  s_waitcnt lgkmcnt(4)
  v_mfma_f32_32x32x16_bf16 v[64:79], v[48:51], a[224:227], v[64:79]
  s_waitcnt lgkmcnt(0)
  s_barrier
  ds_read_b64_tr_b16 v[40:41], v8 offset:0
  ds_read_b64_tr_b16 v[42:43], v8 offset:256
  s_add_u32 s56, s91, 3
  s_and_b32 s56, s56, 7
  v_mfma_f32_32x32x16_bf16 v[80:95], v[48:51], a[228:231], v[80:95]
  s_mul_i32 s56, s56, 5120
  s_add_u32 s56, s56, s59
  s_add_u32 m0, s63, 140288
  buffer_load_dwordx4 a[32:35], v14, s[24:27], s74 offen offset:0 sc1
  v_mfma_f32_16x16x32_bf16 v[24:27], v[32:35], v[48:51], v[24:27]
  v_xor_b32 v158, 0xf149f2ca, v110
  v_mfma_f32_32x32x16_bf16 v[64:79], v[52:55], a[232:235], v[64:79]
  ds_read_b64_tr_b16 v[44:45], v9 offset:0
  ds_read_b64_tr_b16 v[46:47], v9 offset:256
  buffer_load_dwordx4 v14, s[24:27], s56 offen offset:0 sc1 lds
  v_xor_b32 v159, 0xf149f2ca, v111
  v_mfma_f32_32x32x16_bf16 v[80:95], v[52:55], a[236:239], v[80:95]
  buffer_load_dwordx4 v14, s[24:27], s56 offen offset:1024 sc1 lds
  v_and_b32 v127, 7, v0
  v_lshl_add_u32 v127, v127, 2, s94
  v_mfma_f32_32x32x16_bf16 v[64:79], v[56:59], a[240:243], v[64:79]
  ds_read_b64_tr_b16 v[48:49], v8 offset:1024
  ds_read_b64_tr_b16 v[50:51], v8 offset:1280
  s_xor_b32 s32, s81, 8
  s_sub_u32 s32, s32, s95
  v_writelane_b32 v127, s32, 63
  v_lshrrev_b32 v4, 4, v0
  v_mfma_f32_32x32x16_bf16 v[80:95], v[56:59], a[244:247], v[80:95]
  buffer_load_dwordx4 v14, s[24:27], s56 offen offset:2048 sc1 lds
  v_and_b32 v12, 15, v0
  v_mul_u32_u24 v12, 1280, v12
  v_lshl_add_u32 v12, v4, 3, v12
  v_mfma_f32_16x16x32_bf16 v[24:27], v[32:35], v[56:59], v[24:27]
  s_add_u32 s32, s3, 0
  v_mfma_f32_32x32x16_bf16 v[64:79], v[60:63], a[248:251], v[64:79]
  ds_read_b64_tr_b16 v[52:53], v9 offset:1024
  ds_read_b64_tr_b16 v[54:55], v9 offset:1280
  s_and_b32 s32, s32, 3
  s_mul_i32 s32, s32, 69632
  s_add_u32 s32, s33, s32
  v_add_u32 v4, s32, v14
  v_mfma_f32_32x32x16_bf16 v[80:95], v[60:63], a[252:255], v[80:95]
  buffer_load_dwordx4 v14, s[24:27], s56 offen offset:3072 sc1 lds
  s_add_u32 s56, s56, 4096
  s_add_u32 m0, s63, 144384
  s_waitcnt lgkmcnt(4)
  v_mfma_f32_32x32x16_bf16 v[64:79], v[40:43], v[192:195], v[64:79]
  ds_read_b64_tr_b16 v[56:57], v8 offset:2048
  ds_read_b64_tr_b16 v[58:59], v8 offset:2304
  s_add_u32 s32, s3, 1
  s_and_b32 s32, s32, 3
  s_mul_i32 s32, s32, 69632
  s_add_u32 s32, s33, s32
  v_mfma_f32_32x32x16_bf16 v[80:95], v[40:43], v[196:199], v[80:95]
  buffer_load_dwordx4 v14, s[24:27], s56 offen sc1 lds
  v_add_u32 v5, s32, v14
  s_add_u32 s32, s3, 2
  s_and_b32 s32, s32, 3
  v_mfma_f32_16x16x32_bf16 v[24:27], v[32:35], v[40:43], v[24:27]
  s_mul_i32 s32, s32, 69632
  v_mfma_f32_32x32x16_bf16 v[64:79], v[44:47], v[200:203], v[64:79]
  ds_read_b64_tr_b16 v[60:61], v9 offset:2048
  ds_read_b64_tr_b16 v[62:63], v9 offset:2304
  buffer_load_dwordx4 a[36:39], v14, s[24:27], s74 offen offset:1024 sc1
  s_mov_b32 s74, s75
  v_mfma_f32_32x32x16_bf16 v[80:95], v[44:47], v[204:207], v[80:95]
  s_add_u32 s32, s33, s32
  v_add_u32 v6, s32, v14
  s_add_u32 s32, s3, 3
  s_and_b32 s32, s32, 3
  s_mul_i32 s32, s32, 69632
  s_waitcnt lgkmcnt(4)
  v_mfma_f32_32x32x16_bf16 v[64:79], v[48:51], v[208:211], v[64:79]
  ds_read_b64_tr_b16 v[40:41], v8 offset:3072
  ds_read_b64_tr_b16 v[42:43], v8 offset:3328
  s_add_u32 s32, s33, s32
  buffer_load_dwordx4 a[40:43], v14, s[24:27], s74 offen offset:0 sc1
  v_mfma_f32_32x32x16_bf16 v[80:95], v[48:51], v[212:215], v[80:95]
  ds_read_b64_tr_b16 v[44:45], v9 offset:3072
  ds_read_b64_tr_b16 v[46:47], v9 offset:3328
  v_add_u32 v7, s32, v14
  v_add_u32 v1, s63, v14
  v_add_u32 v2, 119808, v1
  s_and_b32 s48, s91, 7
  v_mfma_f32_16x16x32_bf16 v[24:27], v[32:35], v[48:51], v[24:27]
  s_lshl_b32 s48, s48, 10
  v_mfma_f32_32x32x16_bf16 v[64:79], v[52:55], v[216:219], v[64:79]
  buffer_load_dwordx4 a[44:47], v14, s[24:27], s74 offen offset:1024 sc1
  s_lshl_b32 s49, s3, 12
  s_sub_u32 s49, 32768, s49
  s_mul_i32 s50, s3, 3072
  v_mfma_f32_32x32x16_bf16 v[80:95], v[52:55], v[220:223], v[80:95]
  s_sub_u32 s50, 49152, s50
  s_add_u32 s51, s50, 4096
  s_waitcnt lgkmcnt(4)
  v_mfma_f32_32x32x16_bf16 v[64:79], v[56:59], v[224:227], v[64:79]
  v_mfma_f32_32x32x16_bf16 v[80:95], v[56:59], v[228:231], v[80:95]
  buffer_load_dwordx4 a[48:51], v14, s[24:27], s74 offen offset:2048 sc1
  v_mfma_f32_16x16x32_bf16 v[24:27], v[32:35], v[56:59], v[24:27]
  v_mfma_f32_32x32x16_bf16 v[64:79], v[60:63], v[232:235], v[64:79]
  s_waitcnt vmcnt(10)
  buffer_store_dword v0, v17, s[24:27], s81 offen sc1
  v_mfma_f32_32x32x16_bf16 v[80:95], v[60:63], v[236:239], v[80:95]
  buffer_load_dwordx4 a[52:55], v14, s[24:27], s74 offen offset:3072 sc1
  s_add_u32 s74, s74, 4096
  s_waitcnt lgkmcnt(0)
  v_mfma_f32_32x32x16_bf16 v[64:79], v[40:43], v[240:243], v[64:79]
  buffer_load_dwordx4 a[56:59], v14, s[24:27], s74 offen offset:0 sc1
  v_mfma_f32_32x32x16_bf16 v[80:95], v[40:43], v[244:247], v[80:95]
  v_mfma_f32_16x16x32_bf16 v[24:27], v[32:35], v[40:43], v[24:27]
  v_mfma_f32_32x32x16_bf16 v[64:79], v[44:47], v[248:251], v[64:79]
  buffer_load_dwordx4 a[60:63], v14, s[24:27], s74 offen offset:1024 sc1
  v_mfma_f32_32x32x16_bf16 v[80:95], v[44:47], v[252:255], v[80:95]
  buffer_load_dwordx2 v[34:35], v12, s[28:31], s62 offen offset:128
  s_mov_b32 s90, 0x4e800000
  s_nop 2
  v_cvt_pk_bf16_f32 v10, v26, v26
  v_lshlrev_b32 v10, 16, v10
  ds_read_b128 a[252:255], v1 offset:24576
  v_sub_f32 v10, v26, v10
  v_cvt_pk_bf16_f32 v10, v26, v10
  ds_write2_b32 v15, v10, v10 offset0:0 offset1:32
  v_and_b32 v15, 24, v12
  v_add_u32 v15, v15, v12
  buffer_load_dwordx4 v[26:29], v15, s[28:31], s62 offen offset:0
  s_waitcnt lgkmcnt(0)
  s_barrier
  ds_read2_b32 v[10:11], v16 offset0:0 offset1:32
  s_add_u32 m0, s63, 119808
  s_add_u32 s56, s91, 4
  s_and_b32 s56, s56, 7
  s_mul_i32 s56, s56, 5120
  s_add_u32 s56, s56, s59
  ds_read_b128 v[176:179], v20 offset:0
  ds_read_b64 v[180:181], v21 offset:0
  ds_read_b128 v[182:185], v20 offset:3072
  ds_read_b64 v[186:187], v21 offset:3072
  ds_read_b128 v[224:227], v22 offset:0
  ds_read_b128 v[228:231], v22 offset:768
  ds_read_b128 v[232:235], v22 offset:3072
  ds_read_b128 v[236:239], v22 offset:3840
  s_waitcnt lgkmcnt(8)
  v_mfma_f32_32x32x8_bf16 v[64:79], v[10:11], v[36:37], v[64:79]
  v_mfma_f32_32x32x8_bf16 v[80:95], v[10:11], v[38:39], v[80:95]
  s_sub_u32 s77, s3, 1
  s_and_b32 s77, s77, 3
  s_mul_i32 s77, s77, 5120
  s_add_u32 s77, s77, 0
  v_add_u32 v8, s77, v14
  s_sub_u32 s77, s3, 2
  s_and_b32 s77, s77, 3
  s_mul_i32 s77, s77, 5120
  s_add_u32 s77, s77, 20480
  v_add_u32 v9, s77, v14
  s_sub_u32 s77, s3, 3
  s_and_b32 s77, s77, 3
  s_mul_i32 s77, s77, 5120
  s_add_u32 s77, s77, 40960
  v_add_u32 v10, s77, v14
  s_waitcnt lgkmcnt(0)
  v_mfma_f32_32x32x16_bf16 v[128:143], v[176:179], v[112:115], v[144:159]
  ds_read_b128 v[176:179], v20 offset:6144
  buffer_load_dwordx4 v[58:61], v15, s[28:31], s62 offen offset:64
  v_max_f32 v64, 0, v64
  v_max_f32 v65, 0, v65
  v_mfma_f32_32x32x8_bf16 v[128:143], v[180:181], v[120:121], v[128:143]
  ds_read_b64 v[180:181], v21 offset:6144
  v_mul_f32 v72, v72, v18
  v_mul_f32 v73, v73, v18
  v_max_f32 v66, 0, v66
  v_max_f32 v67, 0, v67
  v_mul_f32 v74, v74, v18
  v_mfma_f32_32x32x16_bf16 v[160:175], v[182:185], v[112:115], 0
  v_mul_f32 v75, v75, v18
  v_mul_f32 v64, v64, v72
  v_mul_f32 v65, v65, v73
  v_max_f32 v68, 0, v68
  v_cvt_pk_bf16_f32 v64, v64, v65
  v_max_f32 v69, 0, v69
  v_mfma_f32_32x32x8_bf16 v[160:175], v[186:187], v[120:121], v[160:175]
  v_mul_f32 v76, v76, v18
  v_mul_f32 v77, v77, v18
  v_mul_f32 v66, v66, v74
  v_mul_f32 v67, v67, v75
  v_max_f32 v70, 0, v70
  v_cvt_pk_bf16_f32 v65, v66, v67
  v_max_f32 v71, 0, v71
  v_mul_f32 v78, v78, v18
  v_mul_f32 v79, v79, v18
  v_mul_f32 v68, v68, v76
  v_mul_f32 v69, v69, v77
  v_mul_f32 v70, v70, v78
  v_cvt_pk_bf16_f32 v66, v68, v69
  v_mul_f32 v71, v71, v79
  v_max_f32 v80, 0, v80
  v_cvt_pk_bf16_f32 v67, v70, v71
  v_max_f32 v81, 0, v81
  buffer_store_dwordx4 v[64:67], v13, s[24:27], s71 offen sc1
  v_mul_f32 v88, v88, v19
  v_mul_f32 v89, v89, v19
  v_max_f32 v82, 0, v82
  v_max_f32 v83, 0, v83
  v_mul_f32 v90, v90, v19
  v_mul_f32 v91, v91, v19
  v_mul_f32 v80, v80, v88
  v_mul_f32 v81, v81, v89
  v_max_f32 v84, 0, v84
  v_cvt_pk_bf16_f32 v80, v80, v81
  v_max_f32 v85, 0, v85
  v_mul_f32 v92, v92, v19
  v_mul_f32 v93, v93, v19
  v_mul_f32 v82, v82, v90
  v_mul_f32 v83, v83, v91
  v_max_f32 v86, 0, v86
  v_cvt_pk_bf16_f32 v81, v82, v83
  ds_read_b128 v[72:75], v1 offset:2048
  ds_read_b128 v[76:79], v1 offset:3072
  ds_read_b128 v[68:71], v1 offset:1024
  ds_read_b128 v[64:67], v1 offset:0
  v_max_f32 v87, 0, v87
  v_mul_f32 v94, v94, v19
  v_mul_f32 v95, v95, v19
  v_mul_f32 v84, v84, v92
  v_mul_f32 v85, v85, v93
  v_mul_f32 v86, v86, v94
  v_cvt_pk_bf16_f32 v82, v84, v85
  v_mul_f32 v87, v87, v95
  v_exp_f32 v128, v128
  v_cvt_pk_bf16_f32 v83, v86, v87
  v_exp_f32 v129, v129
  buffer_store_dwordx4 v[80:83], v13, s[24:27], s72 offen sc1
  s_nop 1
  ds_read_b128 v[80:83], v1 offset:4096
  v_exp_f32 v130, v130
  v_exp_f32 v131, v131
  v_cvt_pk_bf16_f32 v40, v128, v129
  v_exp_f32 v132, v132
  v_exp_f32 v133, v133
  v_cvt_pk_bf16_f32 v41, v130, v131
  v_exp_f32 v134, v134
  v_exp_f32 v135, v135
  v_cvt_pk_bf16_f32 v42, v132, v133
  v_exp_f32 v136, v136
  v_exp_f32 v137, v137
  v_cvt_pk_bf16_f32 v43, v134, v135
  v_exp_f32 v138, v138
  s_nop 0
  v_mfma_f32_32x32x16_bf16 v[192:207], v[224:227], v[40:43], 0
  v_exp_f32 v139, v139
  v_cvt_pk_bf16_f32 v44, v136, v137
  v_exp_f32 v140, v140
  v_exp_f32 v141, v141
  v_cvt_pk_bf16_f32 v45, v138, v139
  v_exp_f32 v142, v142
  v_exp_f32 v143, v143
  v_cvt_pk_bf16_f32 v46, v140, v141
  v_cvt_pk_bf16_f32 v47, v142, v143
  v_mfma_f32_32x32x16_bf16 v[128:143], v[182:185], v[116:119], v[144:159]
  buffer_load_dwordx4 v14, s[24:27], s56 offen offset:0 sc1 lds
  ds_read_b128 v[144:147], v1 offset:20480
  ds_read_b128 v[148:151], v1 offset:21504
  ds_read_b128 v[152:155], v1 offset:22528
  v_mfma_f32_32x32x16_bf16 v[192:207], v[228:231], v[44:47], v[192:207]
  ds_read_b128 v[156:159], v1 offset:23552
  ds_read_b128 v[224:227], v22 offset:6144
  ds_read_b128 v[228:231], v22 offset:6912
  ds_read_b128 v[182:185], v20 offset:9216
  v_exp_f32 v160, v160
  v_mfma_f32_32x32x8_bf16 v[128:143], v[186:187], v[122:123], v[128:143]
  ds_read_b64 v[186:187], v21 offset:9216
  v_exp_f32 v161, v161
  v_exp_f32 v162, v162
  v_exp_f32 v163, v163
  buffer_load_dwordx4 v14, s[24:27], s56 offen offset:1024 sc1 lds
  v_cvt_pk_bf16_f32 v48, v160, v161
  v_exp_f32 v164, v164
  v_exp_f32 v165, v165
  v_cvt_pk_bf16_f32 v49, v162, v163
  v_exp_f32 v166, v166
  v_exp_f32 v167, v167
  v_cvt_pk_bf16_f32 v50, v164, v165
  v_exp_f32 v168, v168
  v_exp_f32 v169, v169
  v_cvt_pk_bf16_f32 v51, v166, v167
  v_exp_f32 v170, v170
  s_nop 0
  v_mfma_f32_32x32x16_bf16 v[192:207], v[232:235], v[48:51], v[192:207]
  buffer_load_dwordx4 v14, s[24:27], s56 offen offset:2048 sc1 lds
  v_exp_f32 v171, v171
  v_cvt_pk_bf16_f32 v52, v168, v169
  v_exp_f32 v172, v172
  v_exp_f32 v173, v173
  v_cvt_pk_bf16_f32 v53, v170, v171
  v_exp_f32 v174, v174
  v_exp_f32 v175, v175
  v_cvt_pk_bf16_f32 v54, v172, v173
  v_cvt_pk_bf16_f32 v55, v174, v175
  s_waitcnt lgkmcnt(0)
  v_mfma_f32_32x32x16_bf16 v[160:175], v[176:179], v[112:115], 0
  buffer_load_dwordx4 v14, s[24:27], s56 offen offset:3072 sc1 lds
  s_add_u32 m0, s63, 123904
  s_add_u32 s56, s56, 4096
  v_exp_f32 v128, v128
  v_mfma_f32_32x32x16_bf16 v[192:207], v[236:239], v[52:55], v[192:207]
  v_exp_f32 v129, v129
  v_exp_f32 v130, v130
  v_exp_f32 v131, v131
  v_mfma_f32_32x32x8_bf16 v[160:175], v[180:181], v[120:121], v[160:175]
  v_cvt_pk_bf16_f32 v40, v128, v129
  v_exp_f32 v132, v132
  v_exp_f32 v133, v133
  buffer_load_dwordx4 v14, s[24:27], s56 offen sc1 lds
  s_add_u32 m0, s63, 0
  s_add_u32 s56, s91, 5
  s_and_b32 s56, s56, 7
  s_mul_i32 s56, s56, 5120
  s_add_u32 s56, s56, s59
  v_cvt_pk_bf16_f32 v41, v130, v131
  v_exp_f32 v134, v134
  v_exp_f32 v135, v135
  v_cvt_pk_bf16_f32 v42, v132, v133
  v_exp_f32 v136, v136
  v_exp_f32 v137, v137
  v_cvt_pk_bf16_f32 v43, v134, v135
  v_exp_f32 v138, v138
  s_nop 0
  v_mfma_f32_32x32x16_bf16 v[208:223], v[232:235], v[40:43], 0
  buffer_load_dwordx4 v14, s[24:27], s56 offen offset:0 sc1 lds
  v_exp_f32 v139, v139
  v_cvt_pk_bf16_f32 v44, v136, v137
  v_exp_f32 v140, v140
  v_exp_f32 v141, v141
  v_cvt_pk_bf16_f32 v45, v138, v139
  v_exp_f32 v142, v142
  v_exp_f32 v143, v143
  v_cvt_pk_bf16_f32 v46, v140, v141
  v_cvt_pk_bf16_f32 v47, v142, v143
  v_mfma_f32_32x32x16_bf16 v[128:143], v[176:179], v[116:119], 0
  ds_read_b128 v[232:235], v22 offset:9216
  ds_read_b128 v[176:179], v20 offset:12288
  buffer_load_dwordx4 v14, s[24:27], s56 offen offset:1024 sc1 lds
  v_exp_f32 v160, v160
  v_mfma_f32_32x32x16_bf16 v[208:223], v[236:239], v[44:47], v[208:223]
  ds_read_b128 v[236:239], v22 offset:9984
  v_exp_f32 v161, v161
  v_exp_f32 v162, v162
  v_exp_f32 v163, v163
  v_mfma_f32_32x32x8_bf16 v[128:143], v[180:181], v[122:123], v[128:143]
  ds_read_b64 v[180:181], v21 offset:12288
  v_cvt_pk_bf16_f32 v48, v160, v161
  v_exp_f32 v164, v164
  v_exp_f32 v165, v165
  v_cvt_pk_bf16_f32 v49, v162, v163
  buffer_load_dwordx4 v14, s[24:27], s56 offen offset:2048 sc1 lds
  v_exp_f32 v166, v166
  v_exp_f32 v167, v167
  v_cvt_pk_bf16_f32 v50, v164, v165
  v_exp_f32 v168, v168
  v_exp_f32 v169, v169
  v_cvt_pk_bf16_f32 v51, v166, v167
  v_exp_f32 v170, v170
  s_nop 0
  v_mfma_f32_32x32x16_bf16 v[192:207], v[224:227], v[48:51], v[192:207]
  v_exp_f32 v171, v171
  v_cvt_pk_bf16_f32 v52, v168, v169
  v_exp_f32 v172, v172
  buffer_load_dwordx4 v14, s[24:27], s56 offen offset:3072 sc1 lds
  s_add_u32 m0, s63, 4096
  s_add_u32 s56, s56, 4096
  v_exp_f32 v173, v173
  v_cvt_pk_bf16_f32 v53, v170, v171
  v_exp_f32 v174, v174
  v_exp_f32 v175, v175
  v_cvt_pk_bf16_f32 v54, v172, v173
  v_cvt_pk_bf16_f32 v55, v174, v175
  v_mfma_f32_32x32x16_bf16 v[160:175], v[182:185], v[112:115], 0
  v_exp_f32 v128, v128
  v_exp_f32 v129, v129
  v_exp_f32 v130, v130
  v_mfma_f32_32x32x16_bf16 v[192:207], v[228:231], v[52:55], v[192:207]
  buffer_load_dwordx4 v14, s[24:27], s56 offen sc1 lds
  s_add_u32 m0, s63, 20480
  s_add_u32 s56, s91, 6
  s_and_b32 s56, s56, 7
  v_mfma_f32_32x32x8_bf16 v[160:175], v[186:187], v[120:121], v[160:175]
  s_mul_i32 s56, s56, 5120
  s_add_u32 s56, s56, s59
  v_exp_f32 v131, v131
  v_cvt_pk_bf16_f32 v40, v128, v129
  v_exp_f32 v132, v132
  v_exp_f32 v133, v133
  v_cvt_pk_bf16_f32 v41, v130, v131
  v_exp_f32 v134, v134
  buffer_load_dwordx4 v14, s[24:27], s56 offen offset:0 sc1 lds
  v_exp_f32 v135, v135
  v_cvt_pk_bf16_f32 v42, v132, v133
  v_exp_f32 v136, v136
  v_exp_f32 v137, v137
  v_cvt_pk_bf16_f32 v43, v134, v135
  v_exp_f32 v138, v138
  s_nop 0
  v_mfma_f32_32x32x16_bf16 v[208:223], v[224:227], v[40:43], v[208:223]
  v_exp_f32 v139, v139
  v_cvt_pk_bf16_f32 v44, v136, v137
  v_exp_f32 v140, v140
  v_exp_f32 v141, v141
  buffer_load_dwordx4 v14, s[24:27], s56 offen offset:1024 sc1 lds
  v_cvt_pk_bf16_f32 v45, v138, v139
  v_exp_f32 v142, v142
  v_exp_f32 v143, v143
  v_cvt_pk_bf16_f32 v46, v140, v141
  v_cvt_pk_bf16_f32 v47, v142, v143
  v_mfma_f32_32x32x16_bf16 v[128:143], v[182:185], v[116:119], 0
  ds_read_b128 v[224:227], v22 offset:12288
  ds_read_b128 v[182:185], v20 offset:15360
  v_exp_f32 v160, v160
  v_exp_f32 v161, v161
  v_mfma_f32_32x32x16_bf16 v[208:223], v[228:231], v[44:47], v[208:223]
  ds_read_b128 v[228:231], v22 offset:13056
  v_exp_f32 v162, v162
  buffer_load_dwordx4 v14, s[24:27], s56 offen offset:2048 sc1 lds
  v_mfma_f32_32x32x8_bf16 v[128:143], v[186:187], v[122:123], v[128:143]
  s_waitcnt vmcnt(13)
  s_add_u32 s81, s81, 4096
  s_xor_b32 s81, s81, 96
  buffer_store_dword v0, v17, s[24:27], s81 offen sc1
  ds_read_b64 v[186:187], v21 offset:15360
  v_exp_f32 v163, v163
  v_cvt_pk_bf16_f32 v48, v160, v161
  v_exp_f32 v164, v164
  v_exp_f32 v165, v165
  v_cvt_pk_bf16_f32 v49, v162, v163
  v_exp_f32 v166, v166
  v_exp_f32 v167, v167
  v_cvt_pk_bf16_f32 v50, v164, v165
  v_exp_f32 v168, v168
  buffer_load_dwordx4 v14, s[24:27], s56 offen offset:3072 sc1 lds
  s_add_u32 m0, s63, 24576
  s_add_u32 s56, s56, 4096
  v_exp_f32 v169, v169
  v_cvt_pk_bf16_f32 v51, v166, v167
  v_exp_f32 v170, v170
  s_waitcnt lgkmcnt(1)
  v_mfma_f32_32x32x16_bf16 v[192:207], v[232:235], v[48:51], v[192:207]
  v_exp_f32 v171, v171
  v_cvt_pk_bf16_f32 v52, v168, v169
  v_exp_f32 v172, v172
  v_exp_f32 v173, v173
  v_cvt_pk_bf16_f32 v53, v170, v171
  buffer_load_dword v188, v127, s[24:27], s95 offen offset:0 sc1
  buffer_load_dwordx4 v14, s[24:27], s56 offen sc1 lds
  v_exp_f32 v174, v174
  v_exp_f32 v175, v175
  v_cvt_pk_bf16_f32 v54, v172, v173
  v_cvt_pk_bf16_f32 v55, v174, v175
  v_mfma_f32_32x32x16_bf16 v[160:175], v[176:179], v[112:115], 0
  v_exp_f32 v128, v128
  v_exp_f32 v129, v129
  v_exp_f32 v130, v130
  v_mfma_f32_32x32x16_bf16 v[192:207], v[236:239], v[52:55], v[192:207]
  v_exp_f32 v131, v131
  v_cvt_pk_bf16_f32 v40, v128, v129
  buffer_load_dwordx4 a[64:67], v14, s[24:27], s74 offen offset:2048 sc1
  v_mfma_f32_32x32x8_bf16 v[160:175], v[180:181], v[120:121], v[160:175]
  v_exp_f32 v132, v132
  v_exp_f32 v133, v133
  v_cvt_pk_bf16_f32 v41, v130, v131
  v_exp_f32 v134, v134
  v_exp_f32 v135, v135
  v_cvt_pk_bf16_f32 v42, v132, v133
  v_exp_f32 v136, v136
  v_exp_f32 v137, v137
  v_cvt_pk_bf16_f32 v43, v134, v135
  v_exp_f32 v138, v138
  s_nop 0
  v_mfma_f32_32x32x16_bf16 v[208:223], v[232:235], v[40:43], v[208:223]
  buffer_load_dwordx4 a[68:71], v14, s[24:27], s74 offen offset:3072 sc1
  s_add_u32 s74, s74, 4096
  v_exp_f32 v139, v139
  v_cvt_pk_bf16_f32 v44, v136, v137
  v_exp_f32 v140, v140
  v_exp_f32 v141, v141
  v_cvt_pk_bf16_f32 v45, v138, v139
  v_exp_f32 v142, v142
  v_exp_f32 v143, v143
  v_cvt_pk_bf16_f32 v46, v140, v141
  v_cvt_pk_bf16_f32 v47, v142, v143
  v_mfma_f32_32x32x16_bf16 v[128:143], v[176:179], v[116:119], 0
  buffer_load_dwordx4 a[72:75], v14, s[24:27], s74 offen offset:0 sc1
  ds_read_b128 v[232:235], v22 offset:15360
  ds_read_b128 v[176:179], v20 offset:18432
  v_exp_f32 v160, v160
  v_mfma_f32_32x32x16_bf16 v[208:223], v[236:239], v[44:47], v[208:223]
  ds_read_b128 v[236:239], v22 offset:16128
  v_exp_f32 v161, v161
  v_exp_f32 v162, v162
  v_exp_f32 v163, v163
  v_mfma_f32_32x32x8_bf16 v[128:143], v[180:181], v[122:123], v[128:143]
  ds_read_b64 v[180:181], v21 offset:18432
  v_cvt_pk_bf16_f32 v48, v160, v161
  v_exp_f32 v164, v164
  v_exp_f32 v165, v165
  buffer_load_dwordx4 a[76:79], v14, s[24:27], s74 offen offset:1024 sc1
  v_cvt_pk_bf16_f32 v49, v162, v163
  v_exp_f32 v166, v166
  v_exp_f32 v167, v167
  v_cvt_pk_bf16_f32 v50, v164, v165
  v_exp_f32 v168, v168
  v_exp_f32 v169, v169
  v_cvt_pk_bf16_f32 v51, v166, v167
  v_exp_f32 v170, v170
  s_nop 0
  v_mfma_f32_32x32x16_bf16 v[192:207], v[224:227], v[48:51], v[192:207]
  v_exp_f32 v171, v171
  buffer_load_dwordx4 a[80:83], v14, s[24:27], s74 offen offset:2048 sc1
  v_cvt_pk_bf16_f32 v52, v168, v169
  v_exp_f32 v172, v172
  v_exp_f32 v173, v173
  v_cvt_pk_bf16_f32 v53, v170, v171
  v_exp_f32 v174, v174
  v_exp_f32 v175, v175
  v_cvt_pk_bf16_f32 v54, v172, v173
  v_cvt_pk_bf16_f32 v55, v174, v175
  v_mfma_f32_32x32x16_bf16 v[160:175], v[182:185], v[112:115], 0
  v_exp_f32 v128, v128
  v_exp_f32 v129, v129
  v_exp_f32 v130, v130
  v_mfma_f32_32x32x16_bf16 v[192:207], v[228:231], v[52:55], v[192:207]
  buffer_load_dwordx4 a[84:87], v14, s[24:27], s74 offen offset:3072 sc1
  s_add_u32 s74, s74, 4096
  v_exp_f32 v131, v131
  s_waitcnt lgkmcnt(0)
  v_mfma_f32_32x32x8_bf16 v[160:175], v[186:187], v[120:121], v[160:175]
  v_cvt_pk_bf16_f32 v40, v128, v129
  v_exp_f32 v132, v132
  v_exp_f32 v133, v133
  v_cvt_pk_bf16_f32 v41, v130, v131
  v_exp_f32 v134, v134
  v_exp_f32 v135, v135
  v_cvt_pk_bf16_f32 v42, v132, v133
  buffer_load_dwordx4 a[88:91], v14, s[24:27], s74 offen offset:0 sc1
  v_exp_f32 v136, v136
  v_exp_f32 v137, v137
  v_cvt_pk_bf16_f32 v43, v134, v135
  v_exp_f32 v138, v138
  s_nop 0
  v_mfma_f32_32x32x16_bf16 v[208:223], v[224:227], v[40:43], v[208:223]
  v_exp_f32 v139, v139
  v_cvt_pk_bf16_f32 v44, v136, v137
  v_exp_f32 v140, v140
  v_exp_f32 v141, v141
  v_cvt_pk_bf16_f32 v45, v138, v139
  v_exp_f32 v142, v142
  buffer_load_dwordx4 a[92:95], v14, s[24:27], s74 offen offset:1024 sc1
  v_exp_f32 v143, v143
  v_cvt_pk_bf16_f32 v46, v140, v141
  v_cvt_pk_bf16_f32 v47, v142, v143
  v_mfma_f32_32x32x16_bf16 v[128:143], v[182:185], v[116:119], 0
  ds_read_b128 v[224:227], v22 offset:18432
  ds_read_b128 v[182:185], v20 offset:21504
  v_exp_f32 v160, v160
  v_exp_f32 v161, v161
  v_mfma_f32_32x32x16_bf16 v[208:223], v[228:231], v[44:47], v[208:223]
  ds_read_b128 v[228:231], v22 offset:19200
  v_exp_f32 v162, v162
  v_exp_f32 v163, v163
  buffer_load_dwordx4 a[96:99], v14, s[24:27], s74 offen offset:2048 sc1
  v_mfma_f32_32x32x8_bf16 v[128:143], v[186:187], v[122:123], v[128:143]
  ds_read_b64 v[186:187], v21 offset:21504
  v_cvt_pk_bf16_f32 v48, v160, v161
  v_exp_f32 v164, v164
  v_exp_f32 v165, v165
  v_cvt_pk_bf16_f32 v49, v162, v163
  v_exp_f32 v166, v166
  v_exp_f32 v167, v167
  v_cvt_pk_bf16_f32 v50, v164, v165
  v_exp_f32 v168, v168
  v_exp_f32 v169, v169
  v_cvt_pk_bf16_f32 v51, v166, v167
  v_exp_f32 v170, v170
  s_nop 0
  v_mfma_f32_32x32x16_bf16 v[192:207], v[232:235], v[48:51], v[192:207]
  buffer_load_dwordx4 a[100:103], v14, s[24:27], s74 offen offset:3072 sc1
  s_add_u32 s74, s74, 4096
  v_exp_f32 v171, v171
  v_cvt_pk_bf16_f32 v52, v168, v169
  v_exp_f32 v172, v172
  v_exp_f32 v173, v173
  v_cvt_pk_bf16_f32 v53, v170, v171
  v_exp_f32 v174, v174
  v_exp_f32 v175, v175
  v_cvt_pk_bf16_f32 v54, v172, v173
  v_cvt_pk_bf16_f32 v55, v174, v175
  v_mfma_f32_32x32x16_bf16 v[160:175], v[176:179], v[112:115], 0
  buffer_load_dwordx4 a[104:107], v14, s[24:27], s74 offen offset:0 sc1
  v_exp_f32 v128, v128
  v_exp_f32 v129, v129
  v_mfma_f32_32x32x16_bf16 v[192:207], v[236:239], v[52:55], v[192:207]
  v_exp_f32 v130, v130
  v_exp_f32 v131, v131
  v_cvt_pk_bf16_f32 v40, v128, v129
  v_exp_f32 v132, v132
  v_mfma_f32_32x32x8_bf16 v[160:175], v[180:181], v[120:121], v[160:175]
  v_exp_f32 v133, v133
  v_cvt_pk_bf16_f32 v41, v130, v131
  buffer_load_dwordx4 a[108:111], v14, s[24:27], s74 offen offset:1024 sc1
  v_exp_f32 v134, v134
  v_exp_f32 v135, v135
  v_cvt_pk_bf16_f32 v42, v132, v133
  v_exp_f32 v136, v136
  v_exp_f32 v137, v137
  v_cvt_pk_bf16_f32 v43, v134, v135
  v_exp_f32 v138, v138
  s_nop 0
  v_mfma_f32_32x32x16_bf16 v[208:223], v[232:235], v[40:43], v[208:223]
  v_exp_f32 v139, v139
  v_cvt_pk_bf16_f32 v44, v136, v137
  v_exp_f32 v140, v140
  buffer_load_dwordx4 a[112:115], v14, s[24:27], s74 offen offset:2048 sc1
  v_exp_f32 v141, v141
  s_waitcnt vmcnt(14)
  v_cmp_eq_u32 vcc, 0, v188
  s_cbranch_vccnz .slow10
.back11:
  v_cvt_pk_bf16_f32 v45, v138, v139
  v_exp_f32 v142, v142
  v_exp_f32 v143, v143
  v_cvt_pk_bf16_f32 v46, v140, v141
  v_cvt_pk_bf16_f32 v47, v142, v143
  v_mfma_f32_32x32x16_bf16 v[128:143], v[176:179], v[116:119], 0
  ds_read_b128 v[232:235], v22 offset:21504
  ds_read_b128 v[176:179], v20 offset:24576
  buffer_load_dwordx4 a[140:143], v4, s[24:27], s48 offen offset:0 sc1
  v_lshlrev_b32 v24, 16, v26
  v_mfma_f32_32x32x16_bf16 v[208:223], v[236:239], v[44:47], v[208:223]
  ds_read_b128 v[236:239], v22 offset:22272
  v_and_b32 v25, 0xffff0000, v26
  v_lshlrev_b32 v26, 16, v27
  v_and_b32 v27, 0xffff0000, v27
  v_and_b32 v31, 0xffff0000, v29
  v_lshlrev_b32 v30, 16, v29
  v_mfma_f32_32x32x8_bf16 v[128:143], v[180:181], v[122:123], v[128:143]
  ds_read_b64 v[180:181], v21 offset:24576
  v_and_b32 v29, 0xffff0000, v28
  buffer_load_dwordx4 a[144:147], v5, s[24:27], s48 offen offset:0 sc1
  v_lshlrev_b32 v28, 16, v28
  v_lshlrev_b32 v56, 16, v58
  v_and_b32 v57, 0xffff0000, v58
  v_lshlrev_b32 v58, 16, v59
  v_and_b32 v59, 0xffff0000, v59
  v_and_b32 v63, 0xffff0000, v61
  v_lshlrev_b32 v62, 16, v61
  v_and_b32 v61, 0xffff0000, v60
  v_lshlrev_b32 v60, 16, v60
  v_lshlrev_b32 v32, 16, v34
  v_and_b32 v33, 0xffff0000, v34
  v_lshlrev_b32 v34, 16, v35
  v_and_b32 v35, 0xffff0000, v35
  v_exp_f32 v160, v160
  buffer_load_dwordx4 a[148:151], v6, s[24:27], s48 offen offset:0 sc1
  v_exp_f32 v161, v161
  v_exp_f32 v162, v162
  v_exp_f32 v163, v163
  v_cvt_pk_bf16_f32 v48, v160, v161
  v_exp_f32 v164, v164
  v_exp_f32 v165, v165
  v_cvt_pk_bf16_f32 v49, v162, v163
  v_exp_f32 v166, v166
  buffer_load_dwordx4 a[152:155], v7, s[24:27], s48 offen offset:0 sc1
  s_add_u32 s48, s48, 1024
  s_and_b32 s48, s48, 0x1fff
  v_exp_f32 v167, v167
  v_cvt_pk_bf16_f32 v50, v164, v165
  v_exp_f32 v168, v168
  v_exp_f32 v169, v169
  v_cvt_pk_bf16_f32 v51, v166, v167
  v_exp_f32 v170, v170
  s_waitcnt lgkmcnt(0)
  v_mfma_f32_32x32x16_bf16 v[192:207], v[224:227], v[48:51], v[192:207]
  buffer_load_dwordx4 a[156:159], v4, s[24:27], s48 offen offset:0 sc1
  v_exp_f32 v171, v171
  v_cvt_pk_bf16_f32 v52, v168, v169
  v_exp_f32 v172, v172
  v_exp_f32 v173, v173
  v_cvt_pk_bf16_f32 v53, v170, v171
  v_exp_f32 v174, v174
  v_exp_f32 v175, v175
  buffer_load_dwordx4 a[160:163], v5, s[24:27], s48 offen offset:0 sc1
  v_cvt_pk_bf16_f32 v54, v172, v173
  v_cvt_pk_bf16_f32 v55, v174, v175
  v_mfma_f32_32x32x16_bf16 v[160:175], v[182:185], v[112:115], 0
  v_exp_f32 v128, v128
  v_exp_f32 v129, v129
  v_exp_f32 v130, v130
  v_mfma_f32_32x32x16_bf16 v[192:207], v[228:231], v[52:55], v[192:207]
  v_exp_f32 v131, v131
  buffer_load_dwordx4 a[164:167], v6, s[24:27], s48 offen offset:0 sc1
  v_cvt_pk_bf16_f32 v40, v128, v129
  v_mfma_f32_32x32x8_bf16 v[160:175], v[186:187], v[120:121], v[160:175]
  v_exp_f32 v132, v132
  v_exp_f32 v133, v133
  v_cvt_pk_bf16_f32 v41, v130, v131
  v_exp_f32 v134, v134
  v_exp_f32 v135, v135
  v_cvt_pk_bf16_f32 v42, v132, v133
  buffer_load_dwordx4 a[168:171], v7, s[24:27], s48 offen offset:0 sc1
  s_add_u32 s48, s48, 1024
  s_and_b32 s48, s48, 0x1fff
  v_exp_f32 v136, v136
  v_exp_f32 v137, v137
  v_cvt_pk_bf16_f32 v43, v134, v135
  v_exp_f32 v138, v138
  s_nop 0
  v_mfma_f32_32x32x16_bf16 v[208:223], v[224:227], v[40:43], v[208:223]
  v_exp_f32 v139, v139
  buffer_load_dwordx4 a[172:175], v4, s[24:27], s48 offen offset:0 sc1
  v_cvt_pk_bf16_f32 v44, v136, v137
  v_exp_f32 v140, v140
  v_exp_f32 v141, v141
  v_cvt_pk_bf16_f32 v45, v138, v139
  v_exp_f32 v142, v142
  v_exp_f32 v143, v143
  v_cvt_pk_bf16_f32 v46, v140, v141
  v_cvt_pk_bf16_f32 v47, v142, v143
  v_mfma_f32_32x32x16_bf16 v[128:143], v[182:185], v[116:119], 0
  buffer_load_dwordx4 a[176:179], v5, s[24:27], s48 offen offset:0 sc1
  ds_read_b128 v[224:227], v22 offset:24576
  ds_read_b128 v[182:185], v20 offset:27648
  v_exp_f32 v160, v160
  v_mfma_f32_32x32x16_bf16 v[208:223], v[228:231], v[44:47], v[208:223]
  ds_read_b128 v[228:231], v22 offset:25344
  v_exp_f32 v161, v161
  v_exp_f32 v162, v162
  v_exp_f32 v163, v163
  v_mfma_f32_32x32x8_bf16 v[128:143], v[186:187], v[122:123], v[128:143]
  buffer_load_dwordx4 a[180:183], v6, s[24:27], s48 offen offset:0 sc1
  ds_read_b64 v[186:187], v21 offset:27648
  v_cvt_pk_bf16_f32 v48, v160, v161
  v_exp_f32 v164, v164
  v_exp_f32 v165, v165
  v_cvt_pk_bf16_f32 v49, v162, v163
  v_exp_f32 v166, v166
  v_exp_f32 v167, v167
  v_cvt_pk_bf16_f32 v50, v164, v165
  buffer_load_dwordx4 a[184:187], v7, s[24:27], s48 offen offset:0 sc1
  s_add_u32 s48, s48, 1024
  s_and_b32 s48, s48, 0x1fff
  v_exp_f32 v168, v168
  v_exp_f32 v169, v169
  v_cvt_pk_bf16_f32 v51, v166, v167
  v_exp_f32 v170, v170
  s_nop 0
  v_mfma_f32_32x32x16_bf16 v[192:207], v[232:235], v[48:51], v[192:207]
  v_exp_f32 v171, v171
  buffer_load_dwordx4 a[188:191], v4, s[24:27], s48 offen offset:0 sc1
  v_cvt_pk_bf16_f32 v52, v168, v169
  v_exp_f32 v172, v172
  v_exp_f32 v173, v173
  v_cvt_pk_bf16_f32 v53, v170, v171
  v_exp_f32 v174, v174
  v_exp_f32 v175, v175
  v_cvt_pk_bf16_f32 v54, v172, v173
  v_cvt_pk_bf16_f32 v55, v174, v175
  v_mfma_f32_32x32x16_bf16 v[160:175], v[176:179], v[112:115], v[96:111]
  buffer_load_dwordx4 a[192:195], v5, s[24:27], s48 offen offset:0 sc1
  v_exp_f32 v128, v128
  v_exp_f32 v129, v129
  v_mfma_f32_32x32x16_bf16 v[192:207], v[236:239], v[52:55], v[192:207]
  v_exp_f32 v130, v130
  v_exp_f32 v131, v131
  v_cvt_pk_bf16_f32 v40, v128, v129
  v_exp_f32 v132, v132
  v_mfma_f32_32x32x8_bf16 v[160:175], v[180:181], v[120:121], v[160:175]
  buffer_load_dwordx4 a[196:199], v6, s[24:27], s48 offen offset:0 sc1
  v_exp_f32 v133, v133
  v_cvt_pk_bf16_f32 v41, v130, v131
  v_exp_f32 v134, v134
  v_exp_f32 v135, v135
  v_cvt_pk_bf16_f32 v42, v132, v133
  v_exp_f32 v136, v136
  v_exp_f32 v137, v137
  buffer_load_dwordx4 a[200:203], v7, s[24:27], s48 offen offset:0 sc1
  s_add_u32 s48, s48, 1024
  s_and_b32 s48, s48, 0x1fff
  v_cvt_pk_bf16_f32 v43, v134, v135
  v_exp_f32 v138, v138
  s_nop 0
  v_mfma_f32_32x32x16_bf16 v[208:223], v[232:235], v[40:43], v[208:223]
  v_exp_f32 v139, v139
  v_cvt_pk_bf16_f32 v44, v136, v137
  v_exp_f32 v140, v140
  v_exp_f32 v141, v141
  buffer_load_dwordx4 a[204:207], v4, s[24:27], s48 offen offset:0 sc1
  v_cvt_pk_bf16_f32 v45, v138, v139
  v_exp_f32 v142, v142
  v_exp_f32 v143, v143
  v_cvt_pk_bf16_f32 v46, v140, v141
  v_cvt_pk_bf16_f32 v47, v142, v143
  v_mfma_f32_32x32x16_bf16 v[128:143], v[176:179], v[116:119], 0
  ds_read_b128 v[232:235], v22 offset:27648
  v_exp_f32 v160, v160
  buffer_load_dwordx4 a[208:211], v5, s[24:27], s48 offen offset:0 sc1
  v_mfma_f32_32x32x16_bf16 v[208:223], v[236:239], v[44:47], v[208:223]
  ds_read_b128 v[236:239], v22 offset:28416
  v_exp_f32 v161, v161
  v_exp_f32 v162, v162
  v_exp_f32 v163, v163
  v_mfma_f32_32x32x8_bf16 v[128:143], v[180:181], v[122:123], v[128:143]
  v_cvt_pk_bf16_f32 v48, v160, v161
  v_exp_f32 v164, v164
  buffer_load_dwordx4 a[212:215], v6, s[24:27], s48 offen offset:0 sc1
  v_exp_f32 v165, v165
  v_cvt_pk_bf16_f32 v49, v162, v163
  v_exp_f32 v166, v166
  v_exp_f32 v167, v167
  v_cvt_pk_bf16_f32 v50, v164, v165
  v_exp_f32 v168, v168
  v_exp_f32 v169, v169
  v_cvt_pk_bf16_f32 v51, v166, v167
  v_exp_f32 v170, v170
  s_waitcnt lgkmcnt(1)
  v_mfma_f32_32x32x16_bf16 v[192:207], v[224:227], v[48:51], v[192:207]
  buffer_load_dwordx4 a[216:219], v7, s[24:27], s48 offen offset:0 sc1
  s_add_u32 s48, s48, 1024
  s_and_b32 s48, s48, 0x1fff
  v_exp_f32 v171, v171
  v_cvt_pk_bf16_f32 v52, v168, v169
  v_exp_f32 v172, v172
  v_exp_f32 v173, v173
  v_cvt_pk_bf16_f32 v53, v170, v171
  buffer_load_dwordx4 a[220:223], v4, s[24:27], s48 offen offset:0 sc1
  v_exp_f32 v174, v174
  v_exp_f32 v175, v175
  v_cvt_pk_bf16_f32 v54, v172, v173
  v_cvt_pk_bf16_f32 v55, v174, v175
  v_mfma_f32_32x32x16_bf16 v[160:175], v[182:185], v[116:119], v[96:111]
  v_exp_f32 v128, v128
  v_exp_f32 v129, v129
  v_exp_f32 v130, v130
  v_mfma_f32_32x32x16_bf16 v[192:207], v[228:231], v[52:55], v[192:207]
  buffer_load_dwordx4 a[224:227], v5, s[24:27], s48 offen offset:0 sc1
  v_exp_f32 v131, v131
  v_cvt_pk_bf16_f32 v40, v128, v129
  v_mfma_f32_32x32x8_bf16 v[160:175], v[186:187], v[122:123], v[160:175]
  v_exp_f32 v132, v132
  s_nop 6
  v_rcp_f32 v205, v204
  buffer_load_dwordx4 a[228:231], v6, s[24:27], s48 offen offset:0 sc1
  v_max_f32 v204, v204, v205
  v_mul_f32 v192, v192, v205
  v_cmp_nge_f32 s[86:87], s90, v204
  v_mul_f32 v193, v193, v205
  v_mul_f32 v194, v194, v205
  v_mul_f32 v195, v195, v205
  v_cvt_pk_bf16_f32 v192, v192, v193
  v_mul_f32 v196, v196, v205
  v_mul_f32 v197, v197, v205
  v_cvt_pk_bf16_f32 v193, v194, v195
  v_mul_f32 v198, v198, v205
  v_mul_f32 v199, v199, v205
  buffer_load_dword v188, v23, s[24:27], s95 offen offset:0 sc1
  v_cvt_pk_bf16_f32 v194, v196, v197
  v_mul_f32 v200, v200, v205
  buffer_load_dwordx4 a[232:235], v7, s[24:27], s48 offen offset:0 sc1
  s_add_u32 s48, s48, 1024
  s_and_b32 s48, s48, 0x1fff
  v_mul_f32 v201, v201, v205
  v_cvt_pk_bf16_f32 v195, v198, v199
  v_mul_f32 v202, v202, v205
  v_mul_f32 v203, v203, v205
  v_cvt_pk_bf16_f32 v196, v200, v201
  v_cvt_pk_bf16_f32 v197, v202, v203
  s_cmp_lg_u64 s[86:87], 0
  s_cselect_b32 s96, 1073741824, s82
  s_cselect_b32 s97, 1073741824, s83
  buffer_store_dwordx4 v[192:195], v13, s[24:27], s96 offen sc1
  s_mov_b32 exec_hi, 0
  buffer_store_dwordx2 v[196:197], v13, s[24:27], s97 offen sc1
  s_mov_b32 exec_hi, -1
  v_exp_f32 v133, v133
  v_cvt_pk_bf16_f32 v41, v130, v131
  v_exp_f32 v134, v134
  v_exp_f32 v135, v135
  v_cvt_pk_bf16_f32 v42, v132, v133
  v_exp_f32 v136, v136
  v_exp_f32 v137, v137
  v_cvt_pk_bf16_f32 v43, v134, v135
  v_exp_f32 v138, v138
  s_nop 0
  v_mfma_f32_32x32x16_bf16 v[208:223], v[224:227], v[40:43], v[208:223]
  v_exp_f32 v139, v139
  v_cvt_pk_bf16_f32 v44, v136, v137
  v_exp_f32 v140, v140
  v_exp_f32 v141, v141
  v_cvt_pk_bf16_f32 v45, v138, v139
  v_exp_f32 v142, v142
  v_exp_f32 v143, v143
  v_cvt_pk_bf16_f32 v46, v140, v141
  v_cvt_pk_bf16_f32 v47, v142, v143
  v_exp_f32 v160, v160
  s_nop 0
  v_mfma_f32_32x32x16_bf16 v[208:223], v[228:231], v[44:47], v[208:223]
  v_exp_f32 v161, v161
  buffer_load_dwordx4 a[236:239], v4, s[24:27], s48 offen offset:0 sc1
  v_exp_f32 v162, v162
  v_exp_f32 v163, v163
  v_cvt_pk_bf16_f32 v48, v160, v161
  v_exp_f32 v164, v164
  v_exp_f32 v165, v165
  v_cvt_pk_bf16_f32 v49, v162, v163
  v_exp_f32 v166, v166
  v_exp_f32 v167, v167
  buffer_load_dwordx4 a[240:243], v5, s[24:27], s48 offen offset:0 sc1
  v_cvt_pk_bf16_f32 v50, v164, v165
  v_exp_f32 v168, v168
  v_exp_f32 v169, v169
  v_cvt_pk_bf16_f32 v51, v166, v167
  v_exp_f32 v170, v170
  s_nop 0
  v_mfma_f32_32x32x16_bf16 v[208:223], v[232:235], v[48:51], v[208:223]
  v_exp_f32 v171, v171
  v_cvt_pk_bf16_f32 v52, v168, v169
  buffer_load_dwordx4 a[244:247], v6, s[24:27], s48 offen offset:0 sc1
  v_exp_f32 v172, v172
  v_exp_f32 v173, v173
  v_cvt_pk_bf16_f32 v53, v170, v171
  v_exp_f32 v174, v174
  v_exp_f32 v175, v175
  v_cvt_pk_bf16_f32 v54, v172, v173
  v_cvt_pk_bf16_f32 v55, v174, v175
  s_waitcnt lgkmcnt(0)
  s_nop 0
  v_mfma_f32_32x32x16_bf16 v[208:223], v[236:239], v[52:55], v[208:223]
  buffer_load_dwordx4 a[248:251], v7, s[24:27], s48 offen offset:0 sc1
  s_add_u32 s48, s48, 1024
  s_and_b32 s48, s48, 0x1fff
  s_nop 7
  s_nop 0
  v_rcp_f32 v221, v220
  s_nop 0
  v_max_f32 v220, v220, v221
  v_cmp_nge_f32 s[88:89], s90, v220
  buffer_load_dwordx4 v[240:243], v4, s[24:27], s48 offen offset:0 sc1
  s_or_b64 vcc, s[86:87], s[88:89]
  s_cbranch_vccnz .fb13
.fbb14:
  v_mul_f32 v208, v208, v221
  v_mul_f32 v209, v209, v221
  v_mul_f32 v210, v210, v221
  v_mul_f32 v211, v211, v221
  v_mul_f32 v212, v212, v221
  v_mul_f32 v213, v213, v221
  v_mul_f32 v214, v214, v221
  v_mul_f32 v215, v215, v221
  v_mul_f32 v216, v216, v221
  v_mul_f32 v217, v217, v221
  v_mul_f32 v218, v218, v221
  v_mul_f32 v219, v219, v221
  v_cvt_pk_bf16_f32 v208, v208, v209
  v_cvt_pk_bf16_f32 v209, v210, v211
  v_cvt_pk_bf16_f32 v210, v212, v213
  v_cvt_pk_bf16_f32 v211, v214, v215
  v_cvt_pk_bf16_f32 v212, v216, v217
  v_cvt_pk_bf16_f32 v213, v218, v219
  buffer_store_dwordx4 v[208:211], v13, s[24:27], s84 offen sc1
  s_mov_b32 exec_hi, 0
  buffer_store_dwordx2 v[212:213], v13, s[24:27], s85 offen sc1
  s_mov_b32 exec_hi, -1
  s_waitcnt vmcnt(30)
  v_mfma_f32_16x16x32_bf16 v[24:27], v[64:67], a[140:143], v[24:27]
  ds_read_b128 v[128:131], v2 offset:20480
  v_mfma_f32_16x16x32_bf16 v[84:87], v[64:67], a[144:147], 0
  ds_read_b128 v[132:135], v2 offset:21504
  v_mfma_f32_16x16x32_bf16 v[28:31], v[68:71], a[140:143], v[28:31]
  ds_read_b128 v[136:139], v2 offset:22528
  v_mfma_f32_16x16x32_bf16 v[88:91], v[68:71], a[144:147], 0
  ds_read_b128 v[140:143], v2 offset:23552
  v_mfma_f32_16x16x32_bf16 v[56:59], v[72:75], a[140:143], v[56:59]
  ds_read_b128 v[160:163], v2 offset:24576
  v_mfma_f32_16x16x32_bf16 v[92:95], v[72:75], a[144:147], 0
  buffer_load_dwordx4 v[244:247], v5, s[24:27], s48 offen offset:0 sc1
  v_mfma_f32_16x16x32_bf16 v[60:63], v[76:79], a[140:143], v[60:63]
  v_mfma_f32_16x16x32_bf16 v[32:35], v[80:83], a[140:143], v[32:35]
  v_mfma_f32_16x16x32_bf16 v[104:107], v[64:67], a[148:151], 0
  v_mfma_f32_16x16x32_bf16 v[40:43], v[64:67], a[152:155], 0
  buffer_load_dwordx4 v[248:251], v6, s[24:27], s48 offen offset:0 sc1
  v_mfma_f32_16x16x32_bf16 v[108:111], v[68:71], a[148:151], 0
  ds_read_b128 v[64:67], v1 offset:40960
  v_mfma_f32_16x16x32_bf16 v[44:47], v[68:71], a[152:155], 0
  ds_read_b128 v[68:71], v1 offset:41984
  v_mfma_f32_16x16x32_bf16 v[112:115], v[72:75], a[148:151], 0
  v_mfma_f32_16x16x32_bf16 v[48:51], v[72:75], a[152:155], 0
  buffer_load_dwordx4 v[252:255], v7, s[24:27], s48 offen offset:0 sc1
  v_mfma_f32_16x16x32_bf16 v[96:99], v[76:79], a[144:147], 0
  ds_read_b128 v[72:75], v1 offset:43008
  v_mfma_f32_16x16x32_bf16 v[116:119], v[76:79], a[148:151], 0
  v_mfma_f32_16x16x32_bf16 v[52:55], v[76:79], a[152:155], 0
  ds_read_b128 v[76:79], v1 offset:44032
  v_mfma_f32_16x16x32_bf16 v[100:103], v[80:83], a[144:147], 0
  buffer_load_dwordx4 a[116:119], v14, s[24:27], s74 offen offset:3072 sc1
  v_mfma_f32_16x16x32_bf16 v[120:123], v[80:83], a[148:151], 0
  s_add_u32 s74, s74, 4096
  v_mfma_f32_16x16x32_bf16 v[36:39], v[80:83], a[152:155], 0
  ds_read_b128 v[80:83], v1 offset:45056
  s_waitcnt vmcnt(30)
  v_mfma_f32_16x16x32_bf16 v[24:27], v[144:147], a[156:159], v[24:27]
  v_mfma_f32_16x16x32_bf16 v[84:87], v[144:147], a[160:163], v[84:87]
  v_mfma_f32_16x16x32_bf16 v[104:107], v[144:147], a[164:167], v[104:107]
  buffer_load_dwordx4 a[120:123], v14, s[24:27], s74 offen offset:0 sc1
  v_mfma_f32_16x16x32_bf16 v[40:43], v[144:147], a[168:171], v[40:43]
  v_mfma_f32_16x16x32_bf16 v[28:31], v[148:151], a[156:159], v[28:31]
  v_mfma_f32_16x16x32_bf16 v[88:91], v[148:151], a[160:163], v[88:91]
  v_mfma_f32_16x16x32_bf16 v[108:111], v[148:151], a[164:167], v[108:111]
  v_mfma_f32_16x16x32_bf16 v[44:47], v[148:151], a[168:171], v[44:47]
  s_waitcnt lgkmcnt(0)
  s_add_u32 m0, s63, 40960
  v_mfma_f32_16x16x32_bf16 v[56:59], v[152:155], a[156:159], v[56:59]
  s_waitcnt vmcnt(15)
  v_cmp_eq_u32 vcc, 0, v188
  s_cbranch_vccnz .slow15
.back16:
  v_mfma_f32_16x16x32_bf16 v[92:95], v[152:155], a[160:163], v[92:95]
  s_add_u32 s56, s91, 7
  v_mfma_f32_16x16x32_bf16 v[112:115], v[152:155], a[164:167], v[112:115]
  s_and_b32 s56, s56, 7
  v_mfma_f32_16x16x32_bf16 v[48:51], v[152:155], a[168:171], v[48:51]
  s_mul_i32 s56, s56, 5120
  v_mfma_f32_16x16x32_bf16 v[60:63], v[156:159], a[156:159], v[60:63]
  s_add_u32 s56, s56, s59
  v_mfma_f32_16x16x32_bf16 v[96:99], v[156:159], a[160:163], v[96:99]
  buffer_load_dwordx4 v14, s[24:27], s56 offen offset:0 sc1 lds
  v_mfma_f32_16x16x32_bf16 v[116:119], v[156:159], a[164:167], v[116:119]
  buffer_load_dwordx4 v14, s[24:27], s56 offen offset:1024 sc1 lds
  v_mfma_f32_16x16x32_bf16 v[52:55], v[156:159], a[168:171], v[52:55]
  buffer_load_dwordx4 v14, s[24:27], s56 offen offset:2048 sc1 lds
  v_mfma_f32_16x16x32_bf16 v[32:35], a[252:255], a[156:159], v[32:35]
  v_mfma_f32_16x16x32_bf16 v[100:103], a[252:255], a[160:163], v[100:103]
  v_mfma_f32_16x16x32_bf16 v[120:123], a[252:255], a[164:167], v[120:123]
  buffer_load_dwordx4 v14, s[24:27], s56 offen offset:3072 sc1 lds
  v_mfma_f32_16x16x32_bf16 v[36:39], a[252:255], a[168:171], v[36:39]
  s_add_u32 m0, s63, 45056
  v_mfma_f32_16x16x32_bf16 v[24:27], v[64:67], a[172:175], v[24:27]
  s_add_u32 s56, s56, 4096
  v_mfma_f32_16x16x32_bf16 v[84:87], v[64:67], a[176:179], v[84:87]
  v_mfma_f32_16x16x32_bf16 v[104:107], v[64:67], a[180:183], v[104:107]
  buffer_load_dwordx4 v14, s[24:27], s56 offen sc1 lds
  v_mfma_f32_16x16x32_bf16 v[40:43], v[64:67], a[184:187], v[40:43]
  s_add_u32 m0, s63, 140288
  v_mfma_f32_16x16x32_bf16 v[28:31], v[68:71], a[172:175], v[28:31]
  s_mov_b32 s56, s60
  v_mfma_f32_16x16x32_bf16 v[88:91], v[68:71], a[176:179], v[88:91]
  ds_read_b128 v[64:67], v2 offset:0
  v_mfma_f32_16x16x32_bf16 v[108:111], v[68:71], a[180:183], v[108:111]
  buffer_load_dwordx4 v14, s[24:27], s56 offen offset:0 sc1 lds
  v_mfma_f32_16x16x32_bf16 v[44:47], v[68:71], a[184:187], v[44:47]
  ds_read_b128 v[68:71], v2 offset:1024
  v_mfma_f32_16x16x32_bf16 v[56:59], v[72:75], a[172:175], v[56:59]
  v_mfma_f32_16x16x32_bf16 v[92:95], v[72:75], a[176:179], v[92:95]
  v_mfma_f32_16x16x32_bf16 v[112:115], v[72:75], a[180:183], v[112:115]
  buffer_load_dwordx4 v14, s[24:27], s56 offen offset:1024 sc1 lds
  v_mfma_f32_16x16x32_bf16 v[48:51], v[72:75], a[184:187], v[48:51]
  ds_read_b128 v[72:75], v2 offset:2048
  v_mfma_f32_16x16x32_bf16 v[60:63], v[76:79], a[172:175], v[60:63]
  v_mfma_f32_16x16x32_bf16 v[96:99], v[76:79], a[176:179], v[96:99]
  v_mfma_f32_16x16x32_bf16 v[116:119], v[76:79], a[180:183], v[116:119]
  buffer_load_dwordx4 v14, s[24:27], s56 offen offset:2048 sc1 lds
  v_mfma_f32_16x16x32_bf16 v[52:55], v[76:79], a[184:187], v[52:55]
  ds_read_b128 v[76:79], v2 offset:3072
  v_mfma_f32_16x16x32_bf16 v[32:35], v[80:83], a[172:175], v[32:35]
  v_mfma_f32_16x16x32_bf16 v[100:103], v[80:83], a[176:179], v[100:103]
  v_mfma_f32_16x16x32_bf16 v[120:123], v[80:83], a[180:183], v[120:123]
  buffer_load_dwordx4 v14, s[24:27], s56 offen offset:3072 sc1 lds
  v_mfma_f32_16x16x32_bf16 v[36:39], v[80:83], a[184:187], v[36:39]
  s_add_u32 m0, s63, 144384
  v_mfma_f32_16x16x32_bf16 v[24:27], v[128:131], a[188:191], v[24:27]
  s_add_u32 s56, s56, 4096
  v_mfma_f32_16x16x32_bf16 v[84:87], v[128:131], a[192:195], v[84:87]
  ds_read_b128 v[80:83], v2 offset:4096
  buffer_load_dwordx4 v14, s[24:27], s56 offen sc1 lds
  v_mfma_f32_16x16x32_bf16 v[104:107], v[128:131], a[196:199], v[104:107]
  v_mfma_f32_16x16x32_bf16 v[40:43], v[128:131], a[200:203], v[40:43]
  ds_read_b128 v[128:131], v1 offset:0
  v_mfma_f32_16x16x32_bf16 v[28:31], v[132:135], a[188:191], v[28:31]
  v_mfma_f32_16x16x32_bf16 v[88:91], v[132:135], a[192:195], v[88:91]
  buffer_load_dwordx4 v[144:147], v4, s[24:27], s49 offen offset:0 sc1
  v_mfma_f32_16x16x32_bf16 v[108:111], v[132:135], a[196:199], v[108:111]
  v_mfma_f32_16x16x32_bf16 v[44:47], v[132:135], a[200:203], v[44:47]
  ds_read_b128 v[132:135], v1 offset:1024
  v_mfma_f32_16x16x32_bf16 v[56:59], v[136:139], a[188:191], v[56:59]
  v_mfma_f32_16x16x32_bf16 v[92:95], v[136:139], a[192:195], v[92:95]
  buffer_load_dwordx4 v[148:151], v5, s[24:27], s49 offen offset:0 sc1
  v_mfma_f32_16x16x32_bf16 v[112:115], v[136:139], a[196:199], v[112:115]
  s_waitcnt lgkmcnt(2)
  s_add_u32 m0, s63, 119808
  v_mfma_f32_16x16x32_bf16 v[48:51], v[136:139], a[200:203], v[48:51]
  s_add_u32 s56, s56, 1024
  v_mfma_f32_16x16x32_bf16 v[60:63], v[140:143], a[188:191], v[60:63]
  ds_read_b128 v[136:139], v1 offset:2048
  v_mfma_f32_16x16x32_bf16 v[96:99], v[140:143], a[192:195], v[96:99]
  buffer_load_dwordx4 v[152:155], v6, s[24:27], s49 offen offset:0 sc1
  v_mfma_f32_16x16x32_bf16 v[116:119], v[140:143], a[196:199], v[116:119]
  v_mfma_f32_16x16x32_bf16 v[52:55], v[140:143], a[200:203], v[52:55]
  ds_read_b128 v[140:143], v1 offset:3072
  v_mfma_f32_16x16x32_bf16 v[32:35], v[160:163], a[188:191], v[32:35]
  v_mfma_f32_16x16x32_bf16 v[100:103], v[160:163], a[192:195], v[100:103]
  buffer_load_dwordx4 v[156:159], v7, s[24:27], s49 offen offset:0 sc1
  v_mfma_f32_16x16x32_bf16 v[120:123], v[160:163], a[196:199], v[120:123]
  v_mfma_f32_16x16x32_bf16 v[36:39], v[160:163], a[200:203], v[36:39]
  ds_read_b128 v[160:163], v1 offset:4096
  v_mfma_f32_16x16x32_bf16 v[24:27], v[64:67], a[204:207], v[24:27]
  v_mfma_f32_16x16x32_bf16 v[84:87], v[64:67], a[208:211], v[84:87]
  buffer_load_dwordx4 v14, s[24:27], s56 offen offset:0 sc1 lds
  v_mfma_f32_16x16x32_bf16 v[104:107], v[64:67], a[212:215], v[104:107]
  v_mfma_f32_16x16x32_bf16 v[40:43], v[64:67], a[216:219], v[40:43]
  ds_read_b128 v[64:67], v1 offset:20480
  v_mfma_f32_16x16x32_bf16 v[28:31], v[68:71], a[204:207], v[28:31]
  v_mfma_f32_16x16x32_bf16 v[88:91], v[68:71], a[208:211], v[88:91]
  buffer_load_dwordx4 v14, s[24:27], s56 offen offset:1024 sc1 lds
  v_mfma_f32_16x16x32_bf16 v[108:111], v[68:71], a[212:215], v[108:111]
  v_mfma_f32_16x16x32_bf16 v[44:47], v[68:71], a[216:219], v[44:47]
  ds_read_b128 v[68:71], v1 offset:21504
  v_mfma_f32_16x16x32_bf16 v[56:59], v[72:75], a[204:207], v[56:59]
  v_mfma_f32_16x16x32_bf16 v[92:95], v[72:75], a[208:211], v[92:95]
  buffer_load_dwordx4 v14, s[24:27], s56 offen offset:2048 sc1 lds
  v_mfma_f32_16x16x32_bf16 v[112:115], v[72:75], a[212:215], v[112:115]
  v_mfma_f32_16x16x32_bf16 v[48:51], v[72:75], a[216:219], v[48:51]
  ds_read_b128 v[72:75], v1 offset:22528
  v_mfma_f32_16x16x32_bf16 v[60:63], v[76:79], a[204:207], v[60:63]
  buffer_load_dwordx4 v14, s[24:27], s56 offen offset:3072 sc1 lds
  v_mfma_f32_16x16x32_bf16 v[96:99], v[76:79], a[208:211], v[96:99]
  s_add_u32 m0, s63, 123904
  v_mfma_f32_16x16x32_bf16 v[116:119], v[76:79], a[212:215], v[116:119]
  s_add_u32 s56, s56, 4096
  v_mfma_f32_16x16x32_bf16 v[52:55], v[76:79], a[216:219], v[52:55]
  ds_read_b128 v[76:79], v1 offset:23552
  v_mfma_f32_16x16x32_bf16 v[32:35], v[80:83], a[204:207], v[32:35]
  buffer_load_dwordx4 v14, s[24:27], s56 offen sc1 lds
  v_mfma_f32_16x16x32_bf16 v[100:103], v[80:83], a[208:211], v[100:103]
  v_mfma_f32_16x16x32_bf16 v[120:123], v[80:83], a[212:215], v[120:123]
  v_mfma_f32_16x16x32_bf16 v[36:39], v[80:83], a[216:219], v[36:39]
  ds_read_b128 v[80:83], v1 offset:24576
  s_waitcnt vmcnt(33) lgkmcnt(2)
  v_mfma_f32_16x16x32_bf16 v[24:27], v[128:131], a[220:223], v[24:27]
  buffer_load_dwordx4 v[192:195], v4, s[24:27], s49 offen offset:1024 sc1
  v_mfma_f32_16x16x32_bf16 v[84:87], v[128:131], a[224:227], v[84:87]
  v_mfma_f32_16x16x32_bf16 v[104:107], v[128:131], a[228:231], v[104:107]
  v_mfma_f32_16x16x32_bf16 v[40:43], v[128:131], a[232:235], v[40:43]
  v_mfma_f32_16x16x32_bf16 v[28:31], v[132:135], a[220:223], v[28:31]
  buffer_load_dwordx4 v[196:199], v5, s[24:27], s49 offen offset:1024 sc1
  v_mfma_f32_16x16x32_bf16 v[88:91], v[132:135], a[224:227], v[88:91]
  v_mfma_f32_16x16x32_bf16 v[108:111], v[132:135], a[228:231], v[108:111]
  v_mfma_f32_16x16x32_bf16 v[44:47], v[132:135], a[232:235], v[44:47]
  buffer_load_dwordx4 v[200:203], v6, s[24:27], s49 offen offset:1024 sc1
  v_mfma_f32_16x16x32_bf16 v[56:59], v[136:139], a[220:223], v[56:59]
  v_mfma_f32_16x16x32_bf16 v[92:95], v[136:139], a[224:227], v[92:95]
  v_mfma_f32_16x16x32_bf16 v[112:115], v[136:139], a[228:231], v[112:115]
  v_mfma_f32_16x16x32_bf16 v[48:51], v[136:139], a[232:235], v[48:51]
  buffer_load_dwordx4 v[204:207], v7, s[24:27], s49 offen offset:1024 sc1
  v_mfma_f32_16x16x32_bf16 v[60:63], v[140:143], a[220:223], v[60:63]
  v_mfma_f32_16x16x32_bf16 v[96:99], v[140:143], a[224:227], v[96:99]
  v_mfma_f32_16x16x32_bf16 v[116:119], v[140:143], a[228:231], v[116:119]
  s_waitcnt vmcnt(18)
  ds_read_b128 v[128:131], v1 offset:40960
  v_mfma_f32_16x16x32_bf16 v[52:55], v[140:143], a[232:235], v[52:55]
  buffer_load_dwordx4 v[208:211], v4, s[24:27], s49 offen offset:2048 sc1
  v_mfma_f32_16x16x32_bf16 v[32:35], v[160:163], a[220:223], v[32:35]
  ds_read_b128 v[132:135], v1 offset:41984
  v_mfma_f32_16x16x32_bf16 v[100:103], v[160:163], a[224:227], v[100:103]
  ds_read_b128 v[136:139], v1 offset:43008
  v_mfma_f32_16x16x32_bf16 v[120:123], v[160:163], a[228:231], v[120:123]
  ds_read_b128 v[140:143], v1 offset:44032
  buffer_load_dwordx4 v[212:215], v5, s[24:27], s49 offen offset:2048 sc1
  v_mfma_f32_16x16x32_bf16 v[36:39], v[160:163], a[232:235], v[36:39]
  ds_read_b128 v[160:163], v1 offset:45056
  v_mfma_f32_16x16x32_bf16 v[24:27], v[64:67], a[236:239], v[24:27]
  v_mfma_f32_16x16x32_bf16 v[84:87], v[64:67], a[240:243], v[84:87]
  v_mfma_f32_16x16x32_bf16 v[104:107], v[64:67], a[244:247], v[104:107]
  buffer_load_dwordx4 v[216:219], v6, s[24:27], s49 offen offset:2048 sc1
  v_mfma_f32_16x16x32_bf16 v[40:43], v[64:67], a[248:251], v[40:43]
  v_mfma_f32_16x16x32_bf16 v[28:31], v[68:71], a[236:239], v[28:31]
  v_mfma_f32_16x16x32_bf16 v[88:91], v[68:71], a[240:243], v[88:91]
  v_mfma_f32_16x16x32_bf16 v[108:111], v[68:71], a[244:247], v[108:111]
  buffer_load_dwordx4 v[220:223], v7, s[24:27], s49 offen offset:2048 sc1
  v_mfma_f32_16x16x32_bf16 v[44:47], v[68:71], a[248:251], v[44:47]
  v_mfma_f32_16x16x32_bf16 v[56:59], v[72:75], a[236:239], v[56:59]
  v_mfma_f32_16x16x32_bf16 v[92:95], v[72:75], a[240:243], v[92:95]
  v_mfma_f32_16x16x32_bf16 v[112:115], v[72:75], a[244:247], v[112:115]
  buffer_load_dwordx4 v[224:227], v4, s[24:27], s49 offen offset:3072 sc1
  v_mfma_f32_16x16x32_bf16 v[48:51], v[72:75], a[248:251], v[48:51]
  s_waitcnt lgkmcnt(0)
  v_mfma_f32_16x16x32_bf16 v[60:63], v[76:79], a[236:239], v[60:63]
  v_mfma_f32_16x16x32_bf16 v[96:99], v[76:79], a[240:243], v[96:99]
  s_waitcnt vmcnt(18)
  ds_read_b128 v[64:67], v2 offset:20480
  v_mfma_f32_16x16x32_bf16 v[116:119], v[76:79], a[244:247], v[116:119]
  buffer_load_dwordx4 v[228:231], v5, s[24:27], s49 offen offset:3072 sc1
  v_mfma_f32_16x16x32_bf16 v[52:55], v[76:79], a[248:251], v[52:55]
  ds_read_b128 v[68:71], v2 offset:21504
  v_mfma_f32_16x16x32_bf16 v[32:35], v[80:83], a[236:239], v[32:35]
  ds_read_b128 v[72:75], v2 offset:22528
  v_mfma_f32_16x16x32_bf16 v[100:103], v[80:83], a[240:243], v[100:103]
  ds_read_b128 v[76:79], v2 offset:23552
  buffer_load_dwordx4 v[232:235], v6, s[24:27], s49 offen offset:3072 sc1
  v_mfma_f32_16x16x32_bf16 v[120:123], v[80:83], a[244:247], v[120:123]
  v_mfma_f32_16x16x32_bf16 v[36:39], v[80:83], a[248:251], v[36:39]
  ds_read_b128 v[80:83], v2 offset:24576
  v_mfma_f32_16x16x32_bf16 v[24:27], v[128:131], v[240:243], v[24:27]
  v_mfma_f32_16x16x32_bf16 v[84:87], v[128:131], v[244:247], v[84:87]
  buffer_load_dwordx4 v[236:239], v7, s[24:27], s49 offen offset:3072 sc1
  v_mfma_f32_16x16x32_bf16 v[104:107], v[128:131], v[248:251], v[104:107]
  v_mfma_f32_16x16x32_bf16 v[40:43], v[128:131], v[252:255], v[40:43]
  v_mfma_f32_16x16x32_bf16 v[28:31], v[132:135], v[240:243], v[28:31]
  v_mfma_f32_16x16x32_bf16 v[88:91], v[132:135], v[244:247], v[88:91]
  buffer_load_dwordx4 a[124:127], v14, s[24:27], s74 offen offset:1024 sc1
  v_mfma_f32_16x16x32_bf16 v[108:111], v[132:135], v[248:251], v[108:111]
  v_mfma_f32_16x16x32_bf16 v[44:47], v[132:135], v[252:255], v[44:47]
  v_mfma_f32_16x16x32_bf16 v[56:59], v[136:139], v[240:243], v[56:59]
  v_mfma_f32_16x16x32_bf16 v[92:95], v[136:139], v[244:247], v[92:95]
  v_mfma_f32_16x16x32_bf16 v[112:115], v[136:139], v[248:251], v[112:115]
  buffer_load_dwordx4 a[128:131], v14, s[24:27], s74 offen offset:2048 sc1
  v_mfma_f32_16x16x32_bf16 v[48:51], v[136:139], v[252:255], v[48:51]
  v_mfma_f32_16x16x32_bf16 v[60:63], v[140:143], v[240:243], v[60:63]
  v_mfma_f32_16x16x32_bf16 v[96:99], v[140:143], v[244:247], v[96:99]
  v_mfma_f32_16x16x32_bf16 v[116:119], v[140:143], v[248:251], v[116:119]
  v_mfma_f32_16x16x32_bf16 v[52:55], v[140:143], v[252:255], v[52:55]
  buffer_load_dwordx4 a[132:135], v14, s[24:27], s74 offen offset:3072 sc1
  v_mfma_f32_16x16x32_bf16 v[32:35], v[160:163], v[240:243], v[32:35]
  s_add_u32 s74, s74, 4096
  v_mfma_f32_16x16x32_bf16 v[100:103], v[160:163], v[244:247], v[100:103]
  v_mfma_f32_16x16x32_bf16 v[120:123], v[160:163], v[248:251], v[120:123]
  v_mfma_f32_16x16x32_bf16 v[36:39], v[160:163], v[252:255], v[36:39]
  s_waitcnt vmcnt(20) lgkmcnt(0)
  v_mfma_f32_16x16x32_bf16 v[24:27], v[64:67], v[144:147], v[24:27]
  buffer_load_dwordx4 a[136:139], v14, s[24:27], s74 offen offset:0 sc1
  v_mfma_f32_16x16x32_bf16 v[84:87], v[64:67], v[148:151], v[84:87]
  v_mfma_f32_16x16x32_bf16 v[104:107], v[64:67], v[152:155], v[104:107]
  v_mfma_f32_16x16x32_bf16 v[40:43], v[64:67], v[156:159], v[40:43]
  v_mfma_f32_16x16x32_bf16 v[28:31], v[68:71], v[144:147], v[28:31]
  v_mfma_f32_16x16x32_bf16 v[88:91], v[68:71], v[148:151], v[88:91]
  buffer_load_dwordx4 a[140:143], v5, s[24:27], s50 offen offset:0 sc1
  v_mfma_f32_16x16x32_bf16 v[108:111], v[68:71], v[152:155], v[108:111]
  v_mfma_f32_16x16x32_bf16 v[44:47], v[68:71], v[156:159], v[44:47]
  s_waitcnt vmcnt(17)
  ds_read_b128 v[128:131], v2 offset:0
  v_mfma_f32_16x16x32_bf16 v[56:59], v[72:75], v[144:147], v[56:59]
  ds_read_b128 v[132:135], v2 offset:1024
  v_mfma_f32_16x16x32_bf16 v[92:95], v[72:75], v[148:151], v[92:95]
  buffer_load_dwordx4 a[144:147], v5, s[24:27], s50 offen offset:1024 sc1
  v_mfma_f32_16x16x32_bf16 v[112:115], v[72:75], v[152:155], v[112:115]
  ds_read_b128 v[136:139], v2 offset:2048
  v_mfma_f32_16x16x32_bf16 v[48:51], v[72:75], v[156:159], v[48:51]
  ds_read_b128 v[140:143], v2 offset:3072
  v_mfma_f32_16x16x32_bf16 v[60:63], v[76:79], v[144:147], v[60:63]
  ds_read_b128 v[160:163], v2 offset:4096
  v_mfma_f32_16x16x32_bf16 v[96:99], v[76:79], v[148:151], v[96:99]
  buffer_load_dwordx4 a[148:151], v5, s[24:27], s50 offen offset:2048 sc1
  v_mfma_f32_16x16x32_bf16 v[116:119], v[76:79], v[152:155], v[116:119]
  v_mfma_f32_16x16x32_bf16 v[52:55], v[76:79], v[156:159], v[52:55]
  v_mfma_f32_16x16x32_bf16 v[32:35], v[80:83], v[144:147], v[32:35]
  v_mfma_f32_16x16x32_bf16 v[100:103], v[80:83], v[148:151], v[100:103]
  buffer_load_dwordx4 a[152:155], v5, s[24:27], s50 offen offset:3072 sc1
  v_mfma_f32_16x16x32_bf16 v[120:123], v[80:83], v[152:155], v[120:123]
  v_mfma_f32_16x16x32_bf16 v[36:39], v[80:83], v[156:159], v[36:39]
  buffer_load_dwordx4 a[156:159], v5, s[24:27], s51 offen offset:0 sc1
  s_waitcnt vmcnt(17) lgkmcnt(0)
  v_mfma_f32_16x16x32_bf16 v[24:27], v[128:131], v[192:195], v[24:27]
  v_mfma_f32_16x16x32_bf16 v[84:87], v[128:131], v[196:199], v[84:87]
  buffer_load_dwordx4 a[160:163], v6, s[24:27], s50 offen offset:0 sc1
  v_mfma_f32_16x16x32_bf16 v[104:107], v[128:131], v[200:203], v[104:107]
  v_mfma_f32_16x16x32_bf16 v[40:43], v[128:131], v[204:207], v[40:43]
  v_mfma_f32_16x16x32_bf16 v[28:31], v[132:135], v[192:195], v[28:31]
  v_mfma_f32_16x16x32_bf16 v[88:91], v[132:135], v[196:199], v[88:91]
  buffer_load_dwordx4 a[164:167], v6, s[24:27], s50 offen offset:1024 sc1
  v_mfma_f32_16x16x32_bf16 v[108:111], v[132:135], v[200:203], v[108:111]
  v_mfma_f32_16x16x32_bf16 v[44:47], v[132:135], v[204:207], v[44:47]
  v_mfma_f32_16x16x32_bf16 v[56:59], v[136:139], v[192:195], v[56:59]
  v_mfma_f32_16x16x32_bf16 v[92:95], v[136:139], v[196:199], v[92:95]
  buffer_load_dwordx4 a[168:171], v6, s[24:27], s50 offen offset:2048 sc1
  v_mfma_f32_16x16x32_bf16 v[112:115], v[136:139], v[200:203], v[112:115]
  v_mfma_f32_16x16x32_bf16 v[48:51], v[136:139], v[204:207], v[48:51]
  v_mfma_f32_16x16x32_bf16 v[60:63], v[140:143], v[192:195], v[60:63]
  v_mfma_f32_16x16x32_bf16 v[96:99], v[140:143], v[196:199], v[96:99]
  buffer_load_dwordx4 a[172:175], v6, s[24:27], s50 offen offset:3072 sc1
  v_mfma_f32_16x16x32_bf16 v[116:119], v[140:143], v[200:203], v[116:119]
  v_mfma_f32_16x16x32_bf16 v[52:55], v[140:143], v[204:207], v[52:55]
  v_mfma_f32_16x16x32_bf16 v[32:35], v[160:163], v[192:195], v[32:35]
  v_mfma_f32_16x16x32_bf16 v[100:103], v[160:163], v[196:199], v[100:103]
  buffer_load_dwordx4 a[176:179], v6, s[24:27], s51 offen offset:0 sc1
  v_mfma_f32_16x16x32_bf16 v[120:123], v[160:163], v[200:203], v[120:123]
  v_mfma_f32_16x16x32_bf16 v[36:39], v[160:163], v[204:207], v[36:39]
  s_waitcnt vmcnt(18)
  v_mfma_f32_16x16x32_bf16 v[24:27], a[0:3], v[208:211], v[24:27]
  buffer_load_dwordx4 a[180:183], v7, s[24:27], s50 offen offset:0 sc1
  v_mfma_f32_16x16x32_bf16 v[84:87], a[0:3], v[212:215], v[84:87]
  v_mfma_f32_16x16x32_bf16 v[104:107], a[0:3], v[216:219], v[104:107]
  v_mfma_f32_16x16x32_bf16 v[40:43], a[0:3], v[220:223], v[40:43]
  v_mfma_f32_16x16x32_bf16 v[28:31], a[4:7], v[208:211], v[28:31]
  buffer_load_dwordx4 a[184:187], v7, s[24:27], s50 offen offset:1024 sc1
  v_mfma_f32_16x16x32_bf16 v[88:91], a[4:7], v[212:215], v[88:91]
  v_mfma_f32_16x16x32_bf16 v[108:111], a[4:7], v[216:219], v[108:111]
  v_mfma_f32_16x16x32_bf16 v[44:47], a[4:7], v[220:223], v[44:47]
  v_mfma_f32_16x16x32_bf16 v[56:59], a[8:11], v[208:211], v[56:59]
  buffer_load_dwordx4 a[188:191], v7, s[24:27], s50 offen offset:2048 sc1
  v_mfma_f32_16x16x32_bf16 v[92:95], a[8:11], v[212:215], v[92:95]
  v_mfma_f32_16x16x32_bf16 v[112:115], a[8:11], v[216:219], v[112:115]
  v_mfma_f32_16x16x32_bf16 v[48:51], a[8:11], v[220:223], v[48:51]
  v_mfma_f32_16x16x32_bf16 v[60:63], a[12:15], v[208:211], v[60:63]
  buffer_load_dwordx4 a[192:195], v7, s[24:27], s50 offen offset:3072 sc1
  v_mfma_f32_16x16x32_bf16 v[96:99], a[12:15], v[212:215], v[96:99]
  v_mfma_f32_16x16x32_bf16 v[116:119], a[12:15], v[216:219], v[116:119]
  v_mfma_f32_16x16x32_bf16 v[52:55], a[12:15], v[220:223], v[52:55]
  v_mfma_f32_16x16x32_bf16 v[32:35], a[16:19], v[208:211], v[32:35]
  buffer_load_dwordx4 a[196:199], v7, s[24:27], s51 offen offset:0 sc1
  v_mfma_f32_16x16x32_bf16 v[100:103], a[16:19], v[212:215], v[100:103]
  v_mfma_f32_16x16x32_bf16 v[120:123], a[16:19], v[216:219], v[120:123]
  v_mfma_f32_16x16x32_bf16 v[36:39], a[16:19], v[220:223], v[36:39]
  s_waitcnt vmcnt(19)
  v_mfma_f32_16x16x32_bf16 v[24:27], a[20:23], v[224:227], v[24:27]
  buffer_load_dwordx4 a[200:203], v4, s[24:27], s50 offen offset:0 sc1
  v_mfma_f32_16x16x32_bf16 v[84:87], a[20:23], v[228:231], v[84:87]
  v_mfma_f32_16x16x32_bf16 v[104:107], a[20:23], v[232:235], v[104:107]
  v_mfma_f32_16x16x32_bf16 v[40:43], a[20:23], v[236:239], v[40:43]
  buffer_load_dwordx4 a[204:207], v4, s[24:27], s50 offen offset:1024 sc1
  v_mfma_f32_16x16x32_bf16 v[28:31], a[24:27], v[224:227], v[28:31]
  v_mfma_f32_16x16x32_bf16 v[88:91], a[24:27], v[228:231], v[88:91]
  v_mfma_f32_16x16x32_bf16 v[108:111], a[24:27], v[232:235], v[108:111]
  v_mfma_f32_16x16x32_bf16 v[44:47], a[24:27], v[236:239], v[44:47]
  buffer_load_dwordx4 a[208:211], v4, s[24:27], s50 offen offset:2048 sc1
  v_mfma_f32_16x16x32_bf16 v[56:59], a[28:31], v[224:227], v[56:59]
  v_mfma_f32_16x16x32_bf16 v[92:95], a[28:31], v[228:231], v[92:95]
  v_mfma_f32_16x16x32_bf16 v[112:115], a[28:31], v[232:235], v[112:115]
  v_mfma_f32_16x16x32_bf16 v[48:51], a[28:31], v[236:239], v[48:51]
  buffer_load_dwordx4 a[212:215], v4, s[24:27], s50 offen offset:3072 sc1
  v_mfma_f32_16x16x32_bf16 v[60:63], a[32:35], v[224:227], v[60:63]
  v_mfma_f32_16x16x32_bf16 v[96:99], a[32:35], v[228:231], v[96:99]
  v_mfma_f32_16x16x32_bf16 v[116:119], a[32:35], v[232:235], v[116:119]
  v_mfma_f32_16x16x32_bf16 v[52:55], a[32:35], v[236:239], v[52:55]
  buffer_load_dwordx4 a[216:219], v4, s[24:27], s51 offen offset:0 sc1
  v_mfma_f32_16x16x32_bf16 v[32:35], a[36:39], v[224:227], v[32:35]
  v_mfma_f32_16x16x32_bf16 v[100:103], a[36:39], v[228:231], v[100:103]
  v_mfma_f32_16x16x32_bf16 v[120:123], a[36:39], v[232:235], v[120:123]
  v_mfma_f32_16x16x32_bf16 v[36:39], a[36:39], v[236:239], v[36:39]
  s_waitcnt vmcnt(15)
  v_mfma_f32_16x16x32_bf16 v[64:67], a[40:43], a[140:143], v[84:87]
  v_mfma_f32_16x16x32_bf16 v[68:71], a[44:47], a[140:143], v[88:91]
  v_mfma_f32_16x16x32_bf16 v[72:75], a[48:51], a[140:143], v[92:95]
  v_mfma_f32_16x16x32_bf16 v[76:79], a[52:55], a[140:143], v[96:99]
  v_mfma_f32_16x16x32_bf16 v[80:83], a[56:59], a[140:143], v[100:103]
  v_mfma_f32_16x16x32_bf16 v[64:67], a[60:63], a[144:147], v[64:67]
  v_mfma_f32_16x16x32_bf16 v[68:71], a[64:67], a[144:147], v[68:71]
  v_mfma_f32_16x16x32_bf16 v[72:75], a[68:71], a[144:147], v[72:75]
  v_mfma_f32_16x16x32_bf16 v[76:79], a[72:75], a[144:147], v[76:79]
  v_mfma_f32_16x16x32_bf16 v[80:83], a[76:79], a[144:147], v[80:83]
  v_mfma_f32_16x16x32_bf16 v[64:67], a[80:83], a[148:151], v[64:67]
  v_mfma_f32_16x16x32_bf16 v[68:71], a[84:87], a[148:151], v[68:71]
  v_mfma_f32_16x16x32_bf16 v[72:75], a[88:91], a[148:151], v[72:75]
  v_mfma_f32_16x16x32_bf16 v[76:79], a[92:95], a[148:151], v[76:79]
  v_mfma_f32_16x16x32_bf16 v[80:83], a[96:99], a[148:151], v[80:83]
  v_mfma_f32_16x16x32_bf16 v[64:67], a[100:103], a[152:155], v[64:67]
  v_mfma_f32_16x16x32_bf16 v[68:71], a[104:107], a[152:155], v[68:71]
  v_mfma_f32_16x16x32_bf16 v[72:75], a[108:111], a[152:155], v[72:75]
  v_mfma_f32_16x16x32_bf16 v[76:79], a[112:115], a[152:155], v[76:79]
  v_mfma_f32_16x16x32_bf16 v[80:83], a[116:119], a[152:155], v[80:83]
  v_mfma_f32_16x16x32_bf16 v[64:67], a[120:123], a[156:159], v[64:67]
  v_mfma_f32_16x16x32_bf16 v[68:71], a[124:127], a[156:159], v[68:71]
  v_mfma_f32_16x16x32_bf16 v[72:75], a[128:131], a[156:159], v[72:75]
  v_mfma_f32_16x16x32_bf16 v[76:79], a[132:135], a[156:159], v[76:79]
  v_mfma_f32_16x16x32_bf16 v[80:83], a[136:139], a[156:159], v[80:83]
  s_waitcnt vmcnt(10)
  v_mfma_f32_16x16x32_bf16 v[128:131], a[40:43], a[160:163], v[104:107]
  s_nop 1
  v_cmp_u_f32 vcc, v64, v64
  s_cbranch_vccnz .oc18
.ocb19:
  v_mfma_f32_16x16x32_bf16 v[132:135], a[44:47], a[160:163], v[108:111]
  ds_write_b128 v1, v[64:67] offset:0
  v_mfma_f32_16x16x32_bf16 v[136:139], a[48:51], a[160:163], v[112:115]
  ds_write_b128 v1, v[68:71] offset:1024
  v_mfma_f32_16x16x32_bf16 v[140:143], a[52:55], a[160:163], v[116:119]
  ds_write_b128 v1, v[72:75] offset:2048
  v_mfma_f32_16x16x32_bf16 v[160:163], a[56:59], a[160:163], v[120:123]
  ds_write_b128 v1, v[76:79] offset:3072
  v_mfma_f32_16x16x32_bf16 v[128:131], a[60:63], a[164:167], v[128:131]
  ds_write_b128 v1, v[80:83] offset:4096
  v_mfma_f32_16x16x32_bf16 v[132:135], a[64:67], a[164:167], v[132:135]
  v_mfma_f32_16x16x32_bf16 v[136:139], a[68:71], a[164:167], v[136:139]
  v_mfma_f32_16x16x32_bf16 v[140:143], a[72:75], a[164:167], v[140:143]
  v_mfma_f32_16x16x32_bf16 v[160:163], a[76:79], a[164:167], v[160:163]
  v_mfma_f32_16x16x32_bf16 v[128:131], a[80:83], a[168:171], v[128:131]
  v_mfma_f32_16x16x32_bf16 v[132:135], a[84:87], a[168:171], v[132:135]
  v_mfma_f32_16x16x32_bf16 v[136:139], a[88:91], a[168:171], v[136:139]
  v_mfma_f32_16x16x32_bf16 v[140:143], a[92:95], a[168:171], v[140:143]
  v_mfma_f32_16x16x32_bf16 v[160:163], a[96:99], a[168:171], v[160:163]
  v_mfma_f32_16x16x32_bf16 v[128:131], a[100:103], a[172:175], v[128:131]
  v_mfma_f32_16x16x32_bf16 v[132:135], a[104:107], a[172:175], v[132:135]
  v_mfma_f32_16x16x32_bf16 v[136:139], a[108:111], a[172:175], v[136:139]
  v_mfma_f32_16x16x32_bf16 v[140:143], a[112:115], a[172:175], v[140:143]
  v_mfma_f32_16x16x32_bf16 v[160:163], a[116:119], a[172:175], v[160:163]
  v_mfma_f32_16x16x32_bf16 v[128:131], a[120:123], a[176:179], v[128:131]
  v_mfma_f32_16x16x32_bf16 v[132:135], a[124:127], a[176:179], v[132:135]
  v_mfma_f32_16x16x32_bf16 v[136:139], a[128:131], a[176:179], v[136:139]
  v_mfma_f32_16x16x32_bf16 v[140:143], a[132:135], a[176:179], v[140:143]
  v_mfma_f32_16x16x32_bf16 v[160:163], a[136:139], a[176:179], v[160:163]
  s_waitcnt vmcnt(5)
  v_mfma_f32_16x16x32_bf16 v[84:87], a[40:43], a[180:183], v[40:43]
  s_nop 1
  v_cmp_u_f32 vcc, v128, v128
  s_cbranch_vccnz .oc20
.ocb21:
  v_mfma_f32_16x16x32_bf16 v[88:91], a[44:47], a[180:183], v[44:47]
  ds_write_b128 v1, v[128:131] offset:20480
  v_mfma_f32_16x16x32_bf16 v[92:95], a[48:51], a[180:183], v[48:51]
  ds_write_b128 v1, v[132:135] offset:21504
  v_mfma_f32_16x16x32_bf16 v[96:99], a[52:55], a[180:183], v[52:55]
  ds_write_b128 v1, v[136:139] offset:22528
  v_mfma_f32_16x16x32_bf16 v[100:103], a[56:59], a[180:183], v[36:39]
  ds_write_b128 v1, v[140:143] offset:23552
  v_mfma_f32_16x16x32_bf16 v[84:87], a[60:63], a[184:187], v[84:87]
  ds_write_b128 v1, v[160:163] offset:24576
  v_mfma_f32_16x16x32_bf16 v[88:91], a[64:67], a[184:187], v[88:91]
  v_mfma_f32_16x16x32_bf16 v[92:95], a[68:71], a[184:187], v[92:95]
  v_mfma_f32_16x16x32_bf16 v[96:99], a[72:75], a[184:187], v[96:99]
  v_mfma_f32_16x16x32_bf16 v[100:103], a[76:79], a[184:187], v[100:103]
  v_mfma_f32_16x16x32_bf16 v[84:87], a[80:83], a[188:191], v[84:87]
  v_mfma_f32_16x16x32_bf16 v[88:91], a[84:87], a[188:191], v[88:91]
  v_mfma_f32_16x16x32_bf16 v[92:95], a[88:91], a[188:191], v[92:95]
  v_mfma_f32_16x16x32_bf16 v[96:99], a[92:95], a[188:191], v[96:99]
  v_mfma_f32_16x16x32_bf16 v[100:103], a[96:99], a[188:191], v[100:103]
  v_mfma_f32_16x16x32_bf16 v[84:87], a[100:103], a[192:195], v[84:87]
  v_mfma_f32_16x16x32_bf16 v[88:91], a[104:107], a[192:195], v[88:91]
  v_mfma_f32_16x16x32_bf16 v[92:95], a[108:111], a[192:195], v[92:95]
  v_mfma_f32_16x16x32_bf16 v[96:99], a[112:115], a[192:195], v[96:99]
  v_mfma_f32_16x16x32_bf16 v[100:103], a[116:119], a[192:195], v[100:103]
  v_mfma_f32_16x16x32_bf16 v[84:87], a[120:123], a[196:199], v[84:87]
  v_mfma_f32_16x16x32_bf16 v[88:91], a[124:127], a[196:199], v[88:91]
  v_mfma_f32_16x16x32_bf16 v[92:95], a[128:131], a[196:199], v[92:95]
  v_mfma_f32_16x16x32_bf16 v[96:99], a[132:135], a[196:199], v[96:99]
  v_mfma_f32_16x16x32_bf16 v[100:103], a[136:139], a[196:199], v[100:103]
  s_waitcnt vmcnt(0)
  v_mfma_f32_16x16x32_bf16 v[104:107], a[40:43], a[200:203], v[24:27]
  s_nop 1
  v_cmp_u_f32 vcc, v84, v84
  s_cbranch_vccnz .oc22
.ocb23:
  v_mfma_f32_16x16x32_bf16 v[108:111], a[44:47], a[200:203], v[28:31]
  ds_write_b128 v1, v[84:87] offset:40960
  v_mfma_f32_16x16x32_bf16 v[112:115], a[48:51], a[200:203], v[56:59]
  ds_write_b128 v1, v[88:91] offset:41984
  v_mfma_f32_16x16x32_bf16 v[116:119], a[52:55], a[200:203], v[60:63]
  ds_write_b128 v1, v[92:95] offset:43008
  v_mfma_f32_16x16x32_bf16 v[120:123], a[56:59], a[200:203], v[32:35]
  ds_write_b128 v1, v[96:99] offset:44032
  v_mfma_f32_16x16x32_bf16 v[104:107], a[60:63], a[204:207], v[104:107]
  ds_write_b128 v1, v[100:103] offset:45056
  v_mfma_f32_16x16x32_bf16 v[108:111], a[64:67], a[204:207], v[108:111]
  v_mfma_f32_16x16x32_bf16 v[112:115], a[68:71], a[204:207], v[112:115]
  v_mfma_f32_16x16x32_bf16 v[116:119], a[72:75], a[204:207], v[116:119]
  v_mfma_f32_16x16x32_bf16 v[120:123], a[76:79], a[204:207], v[120:123]
  v_mfma_f32_16x16x32_bf16 v[104:107], a[80:83], a[208:211], v[104:107]
  v_mfma_f32_16x16x32_bf16 v[108:111], a[84:87], a[208:211], v[108:111]
  s_waitcnt lgkmcnt(0)
  s_barrier
  v_mfma_f32_16x16x32_bf16 v[112:115], a[88:91], a[208:211], v[112:115]
  ds_read_b128 v[192:195], v8 offset:0
  v_mfma_f32_16x16x32_bf16 v[116:119], a[92:95], a[208:211], v[116:119]
  ds_read_b128 v[196:199], v9 offset:0
  v_mfma_f32_16x16x32_bf16 v[120:123], a[96:99], a[208:211], v[120:123]
  ds_read_b128 v[200:203], v10 offset:0
  v_mfma_f32_16x16x32_bf16 v[104:107], a[100:103], a[212:215], v[104:107]
  ds_read_b128 v[204:207], v8 offset:1024
  v_mfma_f32_16x16x32_bf16 v[108:111], a[104:107], a[212:215], v[108:111]
  ds_read_b128 v[208:211], v9 offset:1024
  v_mfma_f32_16x16x32_bf16 v[112:115], a[108:111], a[212:215], v[112:115]
  ds_read_b128 v[212:215], v10 offset:1024
  v_mfma_f32_16x16x32_bf16 v[116:119], a[112:115], a[212:215], v[116:119]
  ds_read_b128 v[216:219], v8 offset:2048
  v_mfma_f32_16x16x32_bf16 v[120:123], a[116:119], a[212:215], v[120:123]
  ds_read_b128 v[220:223], v9 offset:2048
  v_mfma_f32_16x16x32_bf16 v[104:107], a[120:123], a[216:219], v[104:107]
  ds_read_b128 v[224:227], v10 offset:2048
  v_mfma_f32_16x16x32_bf16 v[108:111], a[124:127], a[216:219], v[108:111]
  ds_read_b128 v[228:231], v8 offset:3072
  v_mfma_f32_16x16x32_bf16 v[112:115], a[128:131], a[216:219], v[112:115]
  ds_read_b128 v[232:235], v9 offset:3072
  v_mfma_f32_16x16x32_bf16 v[116:119], a[132:135], a[216:219], v[116:119]
  ds_read_b128 v[236:239], v10 offset:3072
  v_mfma_f32_16x16x32_bf16 v[120:123], a[136:139], a[216:219], v[120:123]
  ds_read_b128 v[240:243], v8 offset:4096
  ds_read_b128 v[244:247], v9 offset:4096
  ds_read_b128 v[248:251], v10 offset:4096
  s_waitcnt lgkmcnt(10)
  v_add_f32 v192, v192, v196
  v_add_f32 v193, v193, v197
  v_cmp_u_f32 vcc, v104, v104
  s_cbranch_vccnz .oc24
.ocb25:
  v_add_f32 v194, v194, v198
  v_add_f32 v195, v195, v199
  v_add_f32 v192, v192, v200
  v_add_f32 v193, v193, v201
  v_add_f32 v194, v194, v202
  v_add_f32 v195, v195, v203
  v_add_f32 v204, v204, v208
  v_add_f32 v205, v205, v209
  v_add_f32 v206, v206, v210
  v_add_f32 v207, v207, v211
  s_waitcnt lgkmcnt(6)
  v_add_f32 v204, v204, v212
  v_add_f32 v205, v205, v213
  v_add_f32 v206, v206, v214
  v_add_f32 v207, v207, v215
  v_add_f32 v216, v216, v220
  v_add_f32 v217, v217, v221
  v_add_f32 v218, v218, v222
  v_add_f32 v219, v219, v223
  v_add_f32 v216, v216, v224
  v_add_f32 v217, v217, v225
  v_add_f32 v218, v218, v226
  v_add_f32 v219, v219, v227
  s_waitcnt lgkmcnt(3)
  v_add_f32 v228, v228, v232
  v_add_f32 v229, v229, v233
  v_add_f32 v230, v230, v234
  v_add_f32 v231, v231, v235
  v_add_f32 v228, v228, v236
  v_add_f32 v229, v229, v237
  v_add_f32 v230, v230, v238
  v_add_f32 v231, v231, v239
  s_waitcnt lgkmcnt(0)
  v_add_f32 v240, v240, v244
  v_add_f32 v241, v241, v245
  v_add_f32 v242, v242, v246
  v_add_f32 v243, v243, v247
  v_add_f32 v240, v240, v248
  v_add_f32 v241, v241, v249
  v_add_f32 v242, v242, v250
  v_add_f32 v243, v243, v251
  v_add_f32 v104, v104, v192
  v_add_f32 v105, v105, v193
  v_add_f32 v106, v106, v194
  v_add_f32 v107, v107, v195
  v_cvt_pk_bf16_f32 v104, v104, v105
  v_cvt_pk_bf16_f32 v105, v106, v107
  v_add_f32 v108, v108, v204
  v_add_f32 v109, v109, v205
  v_add_f32 v110, v110, v206
  v_add_f32 v111, v111, v207
  v_cvt_pk_bf16_f32 v106, v108, v109
  v_cvt_pk_bf16_f32 v107, v110, v111
  v_add_f32 v112, v112, v216
  buffer_store_dwordx4 v[104:107], v15, s[16:19], s62 offen offset:0
  v_add_f32 v113, v113, v217
  v_add_f32 v114, v114, v218
  v_add_f32 v115, v115, v219
  v_cvt_pk_bf16_f32 v112, v112, v113
  v_cvt_pk_bf16_f32 v113, v114, v115
  v_add_f32 v116, v116, v228
  v_add_f32 v117, v117, v229
  v_add_f32 v118, v118, v230
  v_add_f32 v119, v119, v231
  v_cvt_pk_bf16_f32 v114, v116, v117
  v_cvt_pk_bf16_f32 v115, v118, v119
  v_add_f32 v120, v120, v240
  buffer_store_dwordx4 v[112:115], v15, s[16:19], s62 offen offset:64
  v_add_f32 v121, v121, v241
  v_add_f32 v122, v122, v242
  v_add_f32 v123, v123, v243
  v_cvt_pk_bf16_f32 v120, v120, v121
  v_cvt_pk_bf16_f32 v121, v122, v123
  buffer_store_dwordx2 v[120:121], v12, s[16:19], s62 offen offset:128
  s_endpgm
.LV:
  s_lshl_b32 s87, s86, 9
  s_add_u32 s65, s65, s87
  s_add_u32 s65, s65, 61440
  s_add_u32 s66, s65, 20480
  s_add_u32 s67, s65, 123392
  s_add_u32 s68, s66, 123392
  s_mul_i32 s64, s3, 3072
  s_add_u32 s64, s64, 65536
  s_add_u32 s87, s78, 4096
  s_waitcnt vmcnt(8)
  s_barrier
  ds_read_b64_tr_b16 v[40:41], v4 offset:0
  ds_read_b64_tr_b16 v[42:43], v4 offset:256
  ds_read_b128 a[0:3], v8 offset:0
  ds_read_b128 a[4:7], v8 offset:4096
  ds_read_b128 v[132:135], v152 offset:0
  ds_read_b64_tr_b16 v[44:45], v4 offset:2048
  ds_read_b64_tr_b16 v[46:47], v4 offset:2304
  ds_read_b128 a[8:11], v9 offset:0
  ds_read_b128 a[12:15], v9 offset:4096
  ds_read_b128 v[136:139], v152 offset:2048
  ds_read_b64_tr_b16 v[48:49], v6 offset:0
  ds_read_b64_tr_b16 v[50:51], v6 offset:256
  ds_read_b128 a[16:19], v8 offset:512
  ds_read_b128 a[20:23], v8 offset:4608
  ds_read_b128 v[140:143], v152 offset:512
  ds_read_b64_tr_b16 v[52:53], v6 offset:2048
  ds_read_b64_tr_b16 v[54:55], v6 offset:2304
  ds_read_b128 a[24:27], v9 offset:512
  ds_read_b128 a[28:31], v9 offset:4608
  ds_read_b128 v[144:147], v152 offset:2560
  s_waitcnt lgkmcnt(15)
  v_mfma_f32_32x32x16_bf16 v[64:79], a[0:3], v[40:43], 0
  ds_read_b64_tr_b16 v[56:57], v4 offset:8192
  ds_read_b64_tr_b16 v[58:59], v4 offset:8448
  s_cmp_eq_u32 s60, 2
  s_cselect_b32 s77, -1152, s74
  s_add_u32 m0, s62, 32768
  v_mfma_f32_32x32x16_bf16 v[96:111], a[4:7], v[40:43], 0
  buffer_load_dwordx4 v128, s[28:31], s59 offen offset:0 lds
  v_mfma_f32_16x16x32_bf16 v[24:27], v[32:35], v[40:43], 0
  v_mfma_f32_16x16x32_bf16 v[176:179], v[132:135], v[132:135], 0
  v_mfma_f32_16x16x32_bf16 v[184:187], v[148:151], v[132:135], 0
  s_waitcnt lgkmcnt(15)
  v_mfma_f32_32x32x16_bf16 v[80:95], a[0:3], v[44:47], 0
  ds_read_b64_tr_b16 v[60:61], v4 offset:10240
  ds_read_b64_tr_b16 v[62:63], v4 offset:10496
  buffer_load_dwordx4 v129, s[28:31], s59 offen offset:1024 lds
  v_mfma_f32_32x32x16_bf16 v[112:127], a[4:7], v[44:47], 0
  s_waitcnt lgkmcnt(14)
  buffer_load_dwordx4 v130, s[28:31], s59 offen offset:2048 lds
  v_mfma_f32_16x16x32_bf16 v[28:31], v[32:35], v[44:47], 0
  v_mfma_f32_16x16x32_bf16 v[180:183], v[136:139], v[136:139], 0
  v_mfma_f32_16x16x32_bf16 v[188:191], v[148:151], v[136:139], 0
  s_waitcnt lgkmcnt(12)
  v_mfma_f32_32x32x16_bf16 v[64:79], a[8:11], v[48:51], v[64:79]
  ds_read_b64_tr_b16 v[40:41], v6 offset:8192
  ds_read_b64_tr_b16 v[42:43], v6 offset:8448
  buffer_load_dwordx4 v131, s[28:31], s59 offen offset:3072 lds
  s_add_u32 s59, s59, s77
  v_mfma_f32_32x32x16_bf16 v[96:111], a[12:15], v[48:51], v[96:111]
  ds_read_b64_tr_b16 v[44:45], v6 offset:10240
  ds_read_b64_tr_b16 v[46:47], v6 offset:10496
  s_waitcnt lgkmcnt(13)
  s_add_u32 m0, s61, 32768
  v_mfma_f32_16x16x32_bf16 v[176:179], v[140:143], v[140:143], v[176:179]
  v_mfma_f32_16x16x32_bf16 v[184:187], v[148:151], v[140:143], v[184:187]
  s_waitcnt lgkmcnt(11)
  v_mfma_f32_32x32x16_bf16 v[80:95], a[8:11], v[52:55], v[80:95]
  buffer_load_dwordx4 v1, s[32:35], s56 offen offset:0 lds
  v_mfma_f32_32x32x16_bf16 v[112:127], a[12:15], v[52:55], v[112:127]
  s_waitcnt lgkmcnt(8)
  buffer_load_dwordx4 v2, s[32:35], s56 offen offset:1024 lds
  s_cmp_eq_u32 s60, 2
  s_cselect_b32 s77, -2211840, s75
  v_mfma_f32_16x16x32_bf16 v[180:183], v[144:147], v[144:147], v[180:183]
  s_add_u32 m0, s61, 34688
  v_mfma_f32_16x16x32_bf16 v[188:191], v[148:151], v[144:147], v[188:191]
  s_waitcnt lgkmcnt(4)
  v_mfma_f32_32x32x16_bf16 v[64:79], a[16:19], v[56:59], v[64:79]
  s_waitcnt vmcnt(6) lgkmcnt(0)
  buffer_store_dword v5, v37, s[52:55], s101 offen sc1
  s_barrier
  ds_read_b64_tr_b16 v[48:49], v4 offset:16384
  ds_read_b64_tr_b16 v[50:51], v4 offset:16640
  ds_read_b128 v[132:135], v152 offset:16384
  v_mfma_f32_32x32x16_bf16 v[96:111], a[20:23], v[56:59], v[96:111]
  ds_read_b128 a[32:35], v8 offset:16384
  ds_read_b128 a[36:39], v8 offset:20480
  buffer_load_dwordx4 v1, s[32:35], s56 offen offset:128 lds
  v_mfma_f32_16x16x32_bf16 v[24:27], v[32:35], v[56:59], v[24:27]
  v_mfma_f32_32x32x16_bf16 v[80:95], a[16:19], v[60:63], v[80:95]
  ds_read_b64_tr_b16 v[52:53], v4 offset:18432
  ds_read_b64_tr_b16 v[54:55], v4 offset:18688
  ds_read_b128 v[136:139], v152 offset:18432
  buffer_load_dwordx4 v2, s[32:35], s56 offen offset:1152 lds
  v_mfma_f32_32x32x16_bf16 v[112:127], a[20:23], v[60:63], v[112:127]
  ds_read_b128 a[40:43], v9 offset:16384
  ds_read_b128 a[44:47], v9 offset:20480
  s_add_u32 s56, s56, s77
  s_sub_u32 m0, s90, 4096
  v_mfma_f32_16x16x32_bf16 v[28:31], v[32:35], v[60:63], v[28:31]
  v_mfma_f32_32x32x16_bf16 v[64:79], a[24:27], v[40:43], v[64:79]
  ds_read_b64_tr_b16 v[56:57], v6 offset:16384
  ds_read_b64_tr_b16 v[58:59], v6 offset:16640
  ds_read_b128 v[140:143], v152 offset:16896
  buffer_load_dwordx4 v232, s[48:51], s76 offen offset:0 nt lds
  v_mfma_f32_32x32x16_bf16 v[96:111], a[28:31], v[40:43], v[96:111]
  ds_read_b128 a[48:51], v8 offset:16896
  ds_read_b128 a[52:55], v8 offset:20992
  s_waitcnt lgkmcnt(7)
  buffer_load_dwordx4 v233, s[48:51], s76 offen offset:1024 nt lds
  v_mfma_f32_16x16x32_bf16 v[176:179], v[132:135], v[132:135], v[176:179]
  v_mfma_f32_16x16x32_bf16 v[184:187], v[148:151], v[132:135], v[184:187]
  v_mfma_f32_32x32x16_bf16 v[80:95], a[24:27], v[44:47], v[80:95]
  ds_read_b64_tr_b16 v[60:61], v6 offset:18432
  ds_read_b64_tr_b16 v[62:63], v6 offset:18688
  ds_read_b128 v[144:147], v152 offset:18944
  buffer_load_dwordx4 v234, s[48:51], s76 offen offset:2048 nt lds
  v_mfma_f32_32x32x16_bf16 v[112:127], a[28:31], v[44:47], v[112:127]
  ds_read_b128 a[56:59], v9 offset:16896
  ds_read_b128 a[60:63], v9 offset:20992
  v_mfma_f32_16x16x32_bf16 v[180:183], v[136:139], v[136:139], v[180:183]
  v_mfma_f32_16x16x32_bf16 v[188:191], v[148:151], v[136:139], v[188:191]
  v_mfma_f32_32x32x16_bf16 v[64:79], a[32:35], v[48:51], v[64:79]
  ds_read_b64_tr_b16 v[40:41], v4 offset:24576
  ds_read_b64_tr_b16 v[42:43], v4 offset:24832
  buffer_load_dwordx4 v235, s[48:51], s76 offen offset:3072 nt lds
  s_mov_b32 m0, s90
  v_mfma_f32_32x32x16_bf16 v[96:111], a[36:39], v[48:51], v[96:111]
  buffer_load_dwordx4 v236, s[48:51], s76 offen nt lds
  s_cmp_eq_u32 s60, 3
  s_cselect_b32 s77, -1152, s74
  s_add_u32 m0, s62, 49152
  v_mfma_f32_16x16x32_bf16 v[24:27], v[32:35], v[48:51], v[24:27]
  v_mfma_f32_32x32x16_bf16 v[80:95], a[32:35], v[52:55], v[80:95]
  ds_read_b64_tr_b16 v[44:45], v4 offset:26624
  ds_read_b64_tr_b16 v[46:47], v4 offset:26880
  buffer_load_dwordx4 v128, s[28:31], s59 offen offset:0 lds
  v_mfma_f32_32x32x16_bf16 v[112:127], a[36:39], v[52:55], v[112:127]
  v_mfma_f32_16x16x32_bf16 v[28:31], v[32:35], v[52:55], v[28:31]
  s_waitcnt lgkmcnt(7)
  v_mfma_f32_32x32x16_bf16 v[64:79], a[40:43], v[56:59], v[64:79]
  ds_read_b64_tr_b16 v[48:49], v6 offset:24576
  ds_read_b64_tr_b16 v[50:51], v6 offset:24832
  buffer_load_dwordx4 v129, s[28:31], s59 offen offset:1024 lds
  v_mfma_f32_32x32x16_bf16 v[96:111], a[44:47], v[56:59], v[96:111]
  ds_read_b64_tr_b16 v[52:53], v6 offset:26624
  ds_read_b64_tr_b16 v[54:55], v6 offset:26880
  v_mfma_f32_16x16x32_bf16 v[176:179], v[140:143], v[140:143], v[176:179]
  v_mfma_f32_16x16x32_bf16 v[184:187], v[148:151], v[140:143], v[184:187]
  v_mfma_f32_32x32x16_bf16 v[80:95], a[40:43], v[60:63], v[80:95]
  buffer_load_dwordx4 v130, s[28:31], s59 offen offset:2048 lds
  v_mfma_f32_32x32x16_bf16 v[112:127], a[44:47], v[60:63], v[112:127]
  s_waitcnt lgkmcnt(10)
  buffer_load_dwordx4 v131, s[28:31], s59 offen offset:3072 lds
  s_add_u32 s59, s59, s77
  v_mfma_f32_16x16x32_bf16 v[180:183], v[144:147], v[144:147], v[180:183]
  s_add_u32 m0, s61, 49152
  v_mfma_f32_16x16x32_bf16 v[188:191], v[148:151], v[144:147], v[188:191]
  s_waitcnt lgkmcnt(4)
  v_mfma_f32_32x32x16_bf16 v[64:79], a[48:51], v[40:43], v[64:79]
  s_waitcnt vmcnt(9) lgkmcnt(0)
  s_barrier
  ds_read_b64_tr_b16 v[56:57], v4 offset:32768
  ds_read_b64_tr_b16 v[58:59], v4 offset:33024
  ds_read_b128 v[132:135], v152 offset:32768
  v_mfma_f32_32x32x16_bf16 v[96:111], a[52:55], v[40:43], v[96:111]
  ds_read_b128 a[64:67], v8 offset:32768
  ds_read_b128 a[68:71], v8 offset:36864
  buffer_load_dwordx4 v1, s[32:35], s56 offen offset:0 lds
  v_mfma_f32_16x16x32_bf16 v[24:27], v[32:35], v[40:43], v[24:27]
  v_mfma_f32_32x32x16_bf16 v[80:95], a[48:51], v[44:47], v[80:95]
  ds_read_b64_tr_b16 v[60:61], v4 offset:34816
  ds_read_b64_tr_b16 v[62:63], v4 offset:35072
  ds_read_b128 v[136:139], v152 offset:34816
  buffer_load_dwordx4 v2, s[32:35], s56 offen offset:1024 lds
  v_mfma_f32_32x32x16_bf16 v[112:127], a[52:55], v[44:47], v[112:127]
  ds_read_b128 a[72:75], v9 offset:32768
  ds_read_b128 a[76:79], v9 offset:36864
  s_cmp_eq_u32 s60, 3
  s_cselect_b32 s77, -2211840, s75
  s_add_u32 m0, s61, 51072
  v_mfma_f32_16x16x32_bf16 v[28:31], v[32:35], v[44:47], v[28:31]
  v_mfma_f32_32x32x16_bf16 v[64:79], a[56:59], v[48:51], v[64:79]
  ds_read_b64_tr_b16 v[40:41], v6 offset:32768
  ds_read_b64_tr_b16 v[42:43], v6 offset:33024
  ds_read_b128 v[140:143], v152 offset:33280
  buffer_load_dwordx4 v1, s[32:35], s56 offen offset:128 lds
  v_mfma_f32_32x32x16_bf16 v[96:111], a[60:63], v[48:51], v[96:111]
  ds_read_b128 a[80:83], v8 offset:33280
  ds_read_b128 a[84:87], v8 offset:37376
  s_waitcnt lgkmcnt(7)
  buffer_load_dwordx4 v2, s[32:35], s56 offen offset:1152 lds
  v_mfma_f32_16x16x32_bf16 v[176:179], v[132:135], v[132:135], v[176:179]
  s_add_u32 s56, s56, s77
  v_mfma_f32_16x16x32_bf16 v[184:187], v[148:151], v[132:135], v[184:187]
  v_mfma_f32_32x32x16_bf16 v[80:95], a[56:59], v[52:55], v[80:95]
  ds_read_b64_tr_b16 v[44:45], v6 offset:34816
  ds_read_b64_tr_b16 v[46:47], v6 offset:35072
  ds_read_b128 v[144:147], v152 offset:35328
  s_cmp_eq_u32 s60, 4
  s_cselect_b32 s77, -1152, s74
  s_add_u32 m0, s62, 0
  v_mfma_f32_32x32x16_bf16 v[112:127], a[60:63], v[52:55], v[112:127]
  ds_read_b128 a[88:91], v9 offset:33280
  ds_read_b128 a[92:95], v9 offset:37376
  buffer_load_dwordx4 v128, s[28:31], s59 offen offset:0 lds
  v_mfma_f32_16x16x32_bf16 v[180:183], v[136:139], v[136:139], v[180:183]
  v_mfma_f32_16x16x32_bf16 v[188:191], v[148:151], v[136:139], v[188:191]
  v_mfma_f32_32x32x16_bf16 v[64:79], a[64:67], v[56:59], v[64:79]
  ds_read_b64_tr_b16 v[48:49], v4 offset:40960
  ds_read_b64_tr_b16 v[50:51], v4 offset:41216
  buffer_load_dwordx4 v129, s[28:31], s59 offen offset:1024 lds
  s_waitcnt vmcnt(10)
  v_mfma_f32_32x32x16_bf16 v[96:111], a[68:71], v[56:59], v[96:111]
  ds_read_b64_tr_b16 v[156:157], v20 offset:0
  ds_read_b64_tr_b16 v[158:159], v20 offset:256
  ds_read_b64_tr_b16 v[160:161], v21 offset:0
  ds_read_b64_tr_b16 v[162:163], v21 offset:256
  ds_read_b64_tr_b16 v[164:165], v20 offset:512
  ds_read_b64_tr_b16 v[166:167], v20 offset:768
  v_mfma_f32_16x16x32_bf16 v[24:27], v[32:35], v[56:59], v[24:27]
  ds_read_b64_tr_b16 v[168:169], v21 offset:512
  v_mfma_f32_32x32x16_bf16 v[80:95], a[64:67], v[60:63], v[80:95]
  ds_read_b64_tr_b16 v[52:53], v4 offset:43008
  ds_read_b64_tr_b16 v[54:55], v4 offset:43264
  buffer_load_dwordx4 v130, s[28:31], s59 offen offset:2048 lds
  ds_read_b64_tr_b16 v[170:171], v21 offset:768
  v_mfma_f32_32x32x16_bf16 v[112:127], a[68:71], v[60:63], v[112:127]
  ds_read_b64_tr_b16 v[172:173], v155 offset:0
  ds_read_b64_tr_b16 v[174:175], v155 offset:512
  buffer_load_dwordx4 v131, s[28:31], s59 offen offset:3072 lds
  s_add_u32 s59, s59, s77
  v_mfma_f32_16x16x32_bf16 v[28:31], v[32:35], v[60:63], v[28:31]
  s_waitcnt lgkmcnt(15)
  v_mfma_f32_32x32x16_bf16 v[64:79], a[72:75], v[40:43], v[64:79]
  ds_read_b64_tr_b16 v[56:57], v6 offset:40960
  ds_read_b64_tr_b16 v[58:59], v6 offset:41216
  s_add_u32 m0, s61, 65536
  v_mfma_f32_32x32x16_bf16 v[96:111], a[76:79], v[40:43], v[96:111]
  ds_read_b64_tr_b16 v[60:61], v6 offset:43008
  ds_read_b64_tr_b16 v[62:63], v6 offset:43264
  buffer_load_dwordx4 v1, s[32:35], s56 offen offset:0 lds
  v_mfma_f32_16x16x32_bf16 v[176:179], v[140:143], v[140:143], v[176:179]
  v_mfma_f32_16x16x32_bf16 v[184:187], v[148:151], v[140:143], v[184:187]
  v_mfma_f32_32x32x16_bf16 v[80:95], a[72:75], v[44:47], v[80:95]
  buffer_load_dwordx4 v2, s[32:35], s56 offen offset:1024 lds
  s_cmp_eq_u32 s60, 4
  s_cselect_b32 s77, -2211840, s75
  s_waitcnt lgkmcnt(4)
  v_mfma_f32_32x32x16_bf16 v[112:127], a[76:79], v[44:47], v[112:127]
  buffer_store_dwordx4 v[156:159], v14, s[24:27], s78 offen offset:0 sc1
  buffer_store_dwordx4 v[160:163], v14, s[24:27], s78 offen offset:1024 sc1
  buffer_store_dwordx4 v[164:167], v14, s[24:27], s78 offen offset:2048 sc1
  buffer_store_dwordx4 v[168:171], v14, s[24:27], s78 offen offset:3072 sc1
  buffer_store_dwordx4 v[172:175], v14, s[24:27], s87 offen offset:0 sc1
  v_mfma_f32_16x16x32_bf16 v[180:183], v[144:147], v[144:147], v[180:183]
  s_add_u32 m0, s61, 67456
  v_mfma_f32_16x16x32_bf16 v[188:191], v[148:151], v[144:147], v[188:191]
  v_mfma_f32_32x32x16_bf16 v[64:79], a[80:83], v[48:51], v[64:79]
  s_waitcnt vmcnt(11) lgkmcnt(0)
  s_barrier
  ds_read_b64_tr_b16 v[40:41], v4 offset:49152
  ds_read_b64_tr_b16 v[42:43], v4 offset:49408
  ds_read_b128 v[132:135], v152 offset:49152
  v_mfma_f32_32x32x16_bf16 v[96:111], a[84:87], v[48:51], v[96:111]
  ds_read_b128 a[96:99], v8 offset:49152
  ds_read_b128 a[100:103], v8 offset:53248
  buffer_load_dwordx4 v1, s[32:35], s56 offen offset:128 lds
  v_mfma_f32_16x16x32_bf16 v[24:27], v[32:35], v[48:51], v[24:27]
  v_mfma_f32_32x32x16_bf16 v[80:95], a[80:83], v[52:55], v[80:95]
  ds_read_b64_tr_b16 v[44:45], v4 offset:51200
  ds_read_b64_tr_b16 v[46:47], v4 offset:51456
  ds_read_b128 v[136:139], v152 offset:51200
  buffer_load_dwordx4 v2, s[32:35], s56 offen offset:1152 lds
  v_mfma_f32_32x32x16_bf16 v[112:127], a[84:87], v[52:55], v[112:127]
  ds_read_b128 a[104:107], v9 offset:49152
  ds_read_b128 a[108:111], v9 offset:53248
  s_add_u32 s56, s56, s77
  s_cmp_eq_u32 s60, 5
  s_cselect_b32 s77, -1152, s74
  s_add_u32 m0, s62, 16384
  v_mfma_f32_16x16x32_bf16 v[28:31], v[32:35], v[52:55], v[28:31]
  v_mfma_f32_32x32x16_bf16 v[64:79], a[88:91], v[56:59], v[64:79]
  ds_read_b64_tr_b16 v[48:49], v6 offset:49152
  ds_read_b64_tr_b16 v[50:51], v6 offset:49408
  ds_read_b128 v[140:143], v152 offset:49664
  buffer_load_dwordx4 v128, s[28:31], s59 offen offset:0 lds
  v_mfma_f32_32x32x16_bf16 v[96:111], a[92:95], v[56:59], v[96:111]
  ds_read_b128 a[112:115], v8 offset:49664
  ds_read_b128 a[116:119], v8 offset:53760
  s_waitcnt lgkmcnt(7)
  buffer_load_dwordx4 v129, s[28:31], s59 offen offset:1024 lds
  v_mfma_f32_16x16x32_bf16 v[176:179], v[132:135], v[132:135], v[176:179]
  v_mfma_f32_16x16x32_bf16 v[184:187], v[148:151], v[132:135], v[184:187]
  v_mfma_f32_32x32x16_bf16 v[80:95], a[88:91], v[60:63], v[80:95]
  ds_read_b64_tr_b16 v[52:53], v6 offset:51200
  ds_read_b64_tr_b16 v[54:55], v6 offset:51456
  ds_read_b128 v[144:147], v152 offset:51712
  buffer_load_dwordx4 v130, s[28:31], s59 offen offset:2048 lds
  v_mfma_f32_32x32x16_bf16 v[112:127], a[92:95], v[60:63], v[112:127]
  ds_read_b128 a[120:123], v9 offset:49664
  ds_read_b128 a[124:127], v9 offset:53760
  v_mfma_f32_16x16x32_bf16 v[180:183], v[136:139], v[136:139], v[180:183]
  v_mfma_f32_16x16x32_bf16 v[188:191], v[148:151], v[136:139], v[188:191]
  v_mfma_f32_32x32x16_bf16 v[64:79], a[96:99], v[40:43], v[64:79]
  ds_read_b64_tr_b16 v[56:57], v4 offset:57344
  ds_read_b64_tr_b16 v[58:59], v4 offset:57600
  buffer_load_dwordx4 v131, s[28:31], s59 offen offset:3072 lds
  s_add_u32 s59, s59, s77
  v_mfma_f32_32x32x16_bf16 v[96:111], a[100:103], v[40:43], v[96:111]
  s_add_u32 m0, s61, 81920
  v_mfma_f32_16x16x32_bf16 v[24:27], v[32:35], v[40:43], v[24:27]
  v_mfma_f32_32x32x16_bf16 v[80:95], a[96:99], v[44:47], v[80:95]
  ds_read_b64_tr_b16 v[60:61], v4 offset:59392
  ds_read_b64_tr_b16 v[62:63], v4 offset:59648
  buffer_load_dwordx4 v1, s[32:35], s56 offen offset:0 lds
  v_mfma_f32_32x32x16_bf16 v[112:127], a[100:103], v[44:47], v[112:127]
  buffer_load_dwordx4 v2, s[32:35], s56 offen offset:1024 lds
  s_cmp_eq_u32 s60, 5
  s_cselect_b32 s77, -2211840, s75
  s_add_u32 m0, s61, 83840
  v_mfma_f32_16x16x32_bf16 v[28:31], v[32:35], v[44:47], v[28:31]
  s_waitcnt lgkmcnt(7)
  v_mfma_f32_32x32x16_bf16 v[64:79], a[104:107], v[48:51], v[64:79]
  ds_read_b64_tr_b16 v[40:41], v6 offset:57344
  ds_read_b64_tr_b16 v[42:43], v6 offset:57600
  buffer_load_dwordx4 v1, s[32:35], s56 offen offset:128 lds
  v_mfma_f32_32x32x16_bf16 v[96:111], a[108:111], v[48:51], v[96:111]
  ds_read_b64_tr_b16 v[44:45], v6 offset:59392
  ds_read_b64_tr_b16 v[46:47], v6 offset:59648
  v_mfma_f32_16x16x32_bf16 v[176:179], v[140:143], v[140:143], v[176:179]
  v_mfma_f32_16x16x32_bf16 v[184:187], v[148:151], v[140:143], v[184:187]
  v_mfma_f32_32x32x16_bf16 v[80:95], a[104:107], v[52:55], v[80:95]
  buffer_load_dwordx4 v2, s[32:35], s56 offen offset:1152 lds
  s_add_u32 s56, s56, s77
  s_cmp_eq_u32 s60, 6
  s_cselect_b32 s77, -1152, s74
  v_mfma_f32_32x32x16_bf16 v[112:127], a[108:111], v[52:55], v[112:127]
  s_waitcnt lgkmcnt(10)
  s_add_u32 m0, s62, 32768
  v_mfma_f32_16x16x32_bf16 v[180:183], v[144:147], v[144:147], v[180:183]
  v_mfma_f32_16x16x32_bf16 v[188:191], v[148:151], v[144:147], v[188:191]
  s_waitcnt lgkmcnt(4)
  v_mfma_f32_32x32x16_bf16 v[64:79], a[112:115], v[56:59], v[64:79]
  s_waitcnt vmcnt(8) lgkmcnt(0)
  s_barrier
  ds_read_b64_tr_b16 v[48:49], v5 offset:0
  ds_read_b64_tr_b16 v[50:51], v5 offset:256
  ds_read_b128 v[132:135], v152 offset:0
  v_mfma_f32_32x32x16_bf16 v[96:111], a[116:119], v[56:59], v[96:111]
  ds_read_b128 a[128:131], v8 offset:0
  ds_read_b128 a[132:135], v8 offset:4096
  buffer_load_dwordx4 v128, s[28:31], s59 offen offset:0 lds
  v_mfma_f32_16x16x32_bf16 v[24:27], v[32:35], v[56:59], v[24:27]
  v_mfma_f32_32x32x16_bf16 v[80:95], a[112:115], v[60:63], v[80:95]
  ds_read_b64_tr_b16 v[52:53], v5 offset:2048
  ds_read_b64_tr_b16 v[54:55], v5 offset:2304
  ds_read_b128 v[136:139], v152 offset:2048
  buffer_load_dwordx4 v129, s[28:31], s59 offen offset:1024 lds
  v_mfma_f32_32x32x16_bf16 v[112:127], a[116:119], v[60:63], v[112:127]
  ds_read_b128 a[136:139], v9 offset:0
  ds_read_b128 a[140:143], v9 offset:4096
  buffer_load_dwordx4 v130, s[28:31], s59 offen offset:2048 lds
  v_mfma_f32_16x16x32_bf16 v[28:31], v[32:35], v[60:63], v[28:31]
  v_mfma_f32_32x32x16_bf16 v[64:79], a[120:123], v[40:43], v[64:79]
  ds_read_b64_tr_b16 v[56:57], v7 offset:0
  ds_read_b64_tr_b16 v[58:59], v7 offset:256
  ds_read_b128 v[140:143], v152 offset:512
  buffer_load_dwordx4 v131, s[28:31], s59 offen offset:3072 lds
  v_mfma_f32_32x32x16_bf16 v[96:111], a[124:127], v[40:43], v[96:111]
  ds_read_b128 a[144:147], v8 offset:512
  ds_read_b128 a[148:151], v8 offset:4608
  s_waitcnt lgkmcnt(7)
  s_add_u32 s59, s59, s77
  s_add_u32 m0, s61, 0
  v_mfma_f32_16x16x32_bf16 v[176:179], v[132:135], v[132:135], v[176:179]
  v_mfma_f32_16x16x32_bf16 v[184:187], v[148:151], v[132:135], v[184:187]
  v_mfma_f32_32x32x16_bf16 v[80:95], a[120:123], v[44:47], v[80:95]
  ds_read_b64_tr_b16 v[60:61], v7 offset:2048
  ds_read_b64_tr_b16 v[62:63], v7 offset:2304
  ds_read_b128 v[144:147], v152 offset:2560
  buffer_load_dwordx4 v1, s[32:35], s56 offen offset:0 lds
  v_mfma_f32_32x32x16_bf16 v[112:127], a[124:127], v[44:47], v[112:127]
  ds_read_b128 a[152:155], v9 offset:512
  ds_read_b128 a[156:159], v9 offset:4608
  v_mfma_f32_16x16x32_bf16 v[180:183], v[136:139], v[136:139], v[180:183]
  v_mfma_f32_16x16x32_bf16 v[188:191], v[148:151], v[136:139], v[188:191]
  v_mfma_f32_32x32x16_bf16 v[64:79], a[128:131], v[48:51], v[64:79]
  ds_read_b64_tr_b16 v[40:41], v5 offset:8192
  ds_read_b64_tr_b16 v[42:43], v5 offset:8448
  buffer_load_dwordx4 v2, s[32:35], s56 offen offset:1024 lds
  v_mfma_f32_32x32x16_bf16 v[96:111], a[132:135], v[48:51], v[96:111]
  s_cmp_eq_u32 s60, 6
  s_cselect_b32 s77, -2211840, s75
  s_add_u32 m0, s61, 1920
  v_mfma_f32_16x16x32_bf16 v[24:27], v[32:35], v[48:51], v[24:27]
  v_mfma_f32_32x32x16_bf16 v[80:95], a[128:131], v[52:55], v[80:95]
  ds_read_b64_tr_b16 v[44:45], v5 offset:10240
  ds_read_b64_tr_b16 v[46:47], v5 offset:10496
  buffer_load_dwordx4 v1, s[32:35], s56 offen offset:128 lds
  v_mfma_f32_32x32x16_bf16 v[112:127], a[132:135], v[52:55], v[112:127]
  buffer_load_dwordx4 v2, s[32:35], s56 offen offset:1152 lds
  s_add_u32 s56, s56, s77
  s_cmp_eq_u32 s60, 7
  s_cselect_b32 s77, -1152, s74
  v_mfma_f32_16x16x32_bf16 v[28:31], v[32:35], v[52:55], v[28:31]
  s_add_u32 m0, s62, 49152
  s_waitcnt lgkmcnt(7)
  v_mfma_f32_32x32x16_bf16 v[64:79], a[136:139], v[56:59], v[64:79]
  ds_read_b64_tr_b16 v[48:49], v7 offset:8192
  ds_read_b64_tr_b16 v[50:51], v7 offset:8448
  buffer_load_dwordx4 v128, s[28:31], s59 offen offset:0 lds
  v_mfma_f32_32x32x16_bf16 v[96:111], a[140:143], v[56:59], v[96:111]
  ds_read_b64_tr_b16 v[52:53], v7 offset:10240
  ds_read_b64_tr_b16 v[54:55], v7 offset:10496
  v_mfma_f32_16x16x32_bf16 v[176:179], v[140:143], v[140:143], v[176:179]
  v_mfma_f32_16x16x32_bf16 v[184:187], v[148:151], v[140:143], v[184:187]
  v_mfma_f32_32x32x16_bf16 v[80:95], a[136:139], v[60:63], v[80:95]
  buffer_load_dwordx4 v129, s[28:31], s59 offen offset:1024 lds
  v_mfma_f32_32x32x16_bf16 v[112:127], a[140:143], v[60:63], v[112:127]
  s_waitcnt lgkmcnt(10)
  buffer_load_dwordx4 v130, s[28:31], s59 offen offset:2048 lds
  v_mfma_f32_16x16x32_bf16 v[180:183], v[144:147], v[144:147], v[180:183]
  v_mfma_f32_16x16x32_bf16 v[188:191], v[148:151], v[144:147], v[188:191]
  s_waitcnt lgkmcnt(4)
  v_mfma_f32_32x32x16_bf16 v[64:79], a[144:147], v[40:43], v[64:79]
  s_waitcnt vmcnt(11) lgkmcnt(0)
  s_barrier
  ds_read_b64_tr_b16 v[56:57], v5 offset:16384
  ds_read_b64_tr_b16 v[58:59], v5 offset:16640
  ds_read_b128 v[132:135], v152 offset:16384
  v_mfma_f32_32x32x16_bf16 v[96:111], a[148:151], v[40:43], v[96:111]
  ds_read_b128 a[160:163], v8 offset:16384
  ds_read_b128 a[164:167], v8 offset:20480
  buffer_load_dwordx4 v131, s[28:31], s59 offen offset:3072 lds
  s_add_u32 s59, s59, s77
  v_mfma_f32_16x16x32_bf16 v[24:27], v[32:35], v[40:43], v[24:27]
  s_add_u32 m0, s61, 16384
  v_mfma_f32_32x32x16_bf16 v[80:95], a[144:147], v[44:47], v[80:95]
  ds_read_b64_tr_b16 v[60:61], v5 offset:18432
  ds_read_b64_tr_b16 v[62:63], v5 offset:18688
  ds_read_b128 v[136:139], v152 offset:18432
  buffer_load_dwordx4 v1, s[32:35], s56 offen offset:0 lds
  v_mfma_f32_32x32x16_bf16 v[112:127], a[148:151], v[44:47], v[112:127]
  ds_read_b128 a[168:171], v9 offset:16384
  ds_read_b128 a[172:175], v9 offset:20480
  v_mfma_f32_16x16x32_bf16 v[28:31], v[32:35], v[44:47], v[28:31]
  v_mfma_f32_32x32x16_bf16 v[64:79], a[152:155], v[48:51], v[64:79]
  ds_read_b64_tr_b16 v[40:41], v7 offset:16384
  ds_read_b64_tr_b16 v[42:43], v7 offset:16640
  ds_read_b128 v[140:143], v152 offset:16896
  buffer_load_dwordx4 v2, s[32:35], s56 offen offset:1024 lds
  v_mfma_f32_32x32x16_bf16 v[96:111], a[156:159], v[48:51], v[96:111]
  ds_read_b128 a[176:179], v8 offset:16896
  ds_read_b128 a[180:183], v8 offset:20992
  s_waitcnt lgkmcnt(7)
  s_cmp_eq_u32 s60, 7
  s_cselect_b32 s77, -2211840, s75
  s_add_u32 m0, s61, 18304
  v_mfma_f32_16x16x32_bf16 v[176:179], v[132:135], v[132:135], v[176:179]
  v_mfma_f32_16x16x32_bf16 v[184:187], v[148:151], v[132:135], v[184:187]
  v_mfma_f32_32x32x16_bf16 v[80:95], a[152:155], v[52:55], v[80:95]
  ds_read_b64_tr_b16 v[44:45], v7 offset:18432
  ds_read_b64_tr_b16 v[46:47], v7 offset:18688
  ds_read_b128 v[144:147], v152 offset:18944
  buffer_load_dwordx4 v1, s[32:35], s56 offen offset:128 lds
  v_mfma_f32_32x32x16_bf16 v[112:127], a[156:159], v[52:55], v[112:127]
  ds_read_b128 a[184:187], v9 offset:16896
  ds_read_b128 a[188:191], v9 offset:20992
  buffer_load_dwordx4 v2, s[32:35], s56 offen offset:1152 lds
  s_add_u32 s56, s56, s77
  v_mfma_f32_16x16x32_bf16 v[180:183], v[136:139], v[136:139], v[180:183]
  v_mfma_f32_16x16x32_bf16 v[188:191], v[148:151], v[136:139], v[188:191]
  v_mfma_f32_32x32x16_bf16 v[64:79], a[160:163], v[56:59], v[64:79]
  ds_read_b64_tr_b16 v[48:49], v5 offset:24576
  ds_read_b64_tr_b16 v[50:51], v5 offset:24832
  s_cmp_eq_u32 s60, 8
  s_cselect_b32 s77, -1152, s74
  s_add_u32 m0, s62, 0
  v_mfma_f32_32x32x16_bf16 v[96:111], a[164:167], v[56:59], v[96:111]
  buffer_load_dwordx4 v128, s[28:31], s59 offen offset:0 lds
  v_mfma_f32_16x16x32_bf16 v[24:27], v[32:35], v[56:59], v[24:27]
  v_mfma_f32_32x32x16_bf16 v[80:95], a[160:163], v[60:63], v[80:95]
  ds_read_b64_tr_b16 v[52:53], v5 offset:26624
  ds_read_b64_tr_b16 v[54:55], v5 offset:26880
  buffer_load_dwordx4 v129, s[28:31], s59 offen offset:1024 lds
  v_mfma_f32_32x32x16_bf16 v[112:127], a[164:167], v[60:63], v[112:127]
  v_mfma_f32_16x16x32_bf16 v[28:31], v[32:35], v[60:63], v[28:31]
  s_waitcnt lgkmcnt(7)
  v_mfma_f32_32x32x16_bf16 v[64:79], a[168:171], v[40:43], v[64:79]
  ds_read_b64_tr_b16 v[56:57], v7 offset:24576
  ds_read_b64_tr_b16 v[58:59], v7 offset:24832
  buffer_load_dwordx4 v130, s[28:31], s59 offen offset:2048 lds
  v_mfma_f32_32x32x16_bf16 v[96:111], a[172:175], v[40:43], v[96:111]
  ds_read_b64_tr_b16 v[60:61], v7 offset:26624
  ds_read_b64_tr_b16 v[62:63], v7 offset:26880
  buffer_load_dwordx4 v131, s[28:31], s59 offen offset:3072 lds
  s_add_u32 s59, s59, s77
  v_mfma_f32_16x16x32_bf16 v[176:179], v[140:143], v[140:143], v[176:179]
  s_add_u32 m0, s61, 32768
  v_mfma_f32_16x16x32_bf16 v[184:187], v[148:151], v[140:143], v[184:187]
  v_mfma_f32_32x32x16_bf16 v[80:95], a[168:171], v[44:47], v[80:95]
  buffer_load_dwordx4 v1, s[32:35], s56 offen offset:0 lds
  v_mfma_f32_32x32x16_bf16 v[112:127], a[172:175], v[44:47], v[112:127]
  s_waitcnt lgkmcnt(10)
  v_mfma_f32_16x16x32_bf16 v[180:183], v[144:147], v[144:147], v[180:183]
  v_mfma_f32_16x16x32_bf16 v[188:191], v[148:151], v[144:147], v[188:191]
  s_waitcnt lgkmcnt(4)
  v_mfma_f32_32x32x16_bf16 v[64:79], a[176:179], v[48:51], v[64:79]
  s_waitcnt vmcnt(13) lgkmcnt(0)
  s_barrier
  ds_read_b64_tr_b16 v[40:41], v4 offset:0
  ds_read_b64_tr_b16 v[42:43], v4 offset:256
  ds_read_b128 v[132:135], v152 offset:32768
  v_mfma_f32_32x32x16_bf16 v[96:111], a[180:183], v[48:51], v[96:111]
  ds_read_b128 a[192:195], v8 offset:32768
  ds_read_b128 a[196:199], v8 offset:36864
  buffer_load_dwordx4 v2, s[32:35], s56 offen offset:1024 lds
  v_mfma_f32_16x16x32_bf16 v[24:27], v[32:35], v[48:51], v[24:27]
  v_mfma_f32_32x32x16_bf16 v[80:95], a[176:179], v[52:55], v[80:95]
  ds_read_b64_tr_b16 v[44:45], v4 offset:2048
  ds_read_b64_tr_b16 v[46:47], v4 offset:2304
  ds_read_b128 v[136:139], v152 offset:34816
  s_cmp_eq_u32 s60, 8
  s_cselect_b32 s77, -2211840, s75
  s_add_u32 m0, s61, 34688
  v_mfma_f32_32x32x16_bf16 v[112:127], a[180:183], v[52:55], v[112:127]
  ds_read_b128 a[200:203], v9 offset:32768
  ds_read_b128 a[204:207], v9 offset:36864
  buffer_load_dwordx4 v1, s[32:35], s56 offen offset:128 lds
  v_mfma_f32_16x16x32_bf16 v[28:31], v[32:35], v[52:55], v[28:31]
  v_mfma_f32_32x32x16_bf16 v[64:79], a[184:187], v[56:59], v[64:79]
  ds_read_b64_tr_b16 v[48:49], v6 offset:0
  ds_read_b64_tr_b16 v[50:51], v6 offset:256
  ds_read_b128 v[140:143], v152 offset:33280
  buffer_load_dwordx4 v2, s[32:35], s56 offen offset:1152 lds
  v_mfma_f32_32x32x16_bf16 v[96:111], a[188:191], v[56:59], v[96:111]
  ds_read_b128 a[208:211], v8 offset:33280
  ds_read_b128 a[212:215], v8 offset:37376
  s_waitcnt lgkmcnt(7)
  s_add_u32 s56, s56, s77
  s_add_u32 m0, s62, 16384
  v_mfma_f32_16x16x32_bf16 v[176:179], v[132:135], v[132:135], v[176:179]
  v_mfma_f32_16x16x32_bf16 v[184:187], v[148:151], v[132:135], v[184:187]
  v_mfma_f32_32x32x16_bf16 v[80:95], a[184:187], v[60:63], v[80:95]
  ds_read_b64_tr_b16 v[52:53], v6 offset:2048
  ds_read_b64_tr_b16 v[54:55], v6 offset:2304
  ds_read_b128 v[144:147], v152 offset:35328
  buffer_load_dwordx4 v128, s[28:31], s59 offen offset:0 lds
  v_mfma_f32_32x32x16_bf16 v[112:127], a[188:191], v[60:63], v[112:127]
  ds_read_b128 a[216:219], v9 offset:33280
  ds_read_b128 a[220:223], v9 offset:37376
  buffer_load_dwordx4 v129, s[28:31], s59 offen offset:1024 lds
  v_mfma_f32_16x16x32_bf16 v[180:183], v[136:139], v[136:139], v[180:183]
  v_mfma_f32_16x16x32_bf16 v[188:191], v[148:151], v[136:139], v[188:191]
  v_mfma_f32_32x32x16_bf16 v[64:79], a[192:195], v[40:43], v[64:79]
  ds_read_b64_tr_b16 v[56:57], v4 offset:8192
  ds_read_b64_tr_b16 v[58:59], v4 offset:8448
  buffer_load_dwordx4 v130, s[28:31], s59 offen offset:2048 lds
  v_mfma_f32_32x32x16_bf16 v[96:111], a[196:199], v[40:43], v[96:111]
  v_mfma_f32_16x16x32_bf16 v[24:27], v[32:35], v[40:43], v[24:27]
  v_mfma_f32_32x32x16_bf16 v[80:95], a[192:195], v[44:47], v[80:95]
  ds_read_b64_tr_b16 v[60:61], v4 offset:10240
  ds_read_b64_tr_b16 v[62:63], v4 offset:10496
  buffer_load_dwordx4 v131, s[28:31], s59 offen offset:3072 lds
  s_add_u32 m0, s61, 49152
  v_mfma_f32_32x32x16_bf16 v[112:127], a[196:199], v[44:47], v[112:127]
  v_mfma_f32_16x16x32_bf16 v[28:31], v[32:35], v[44:47], v[28:31]
  s_waitcnt lgkmcnt(7)
  v_mfma_f32_32x32x16_bf16 v[64:79], a[200:203], v[48:51], v[64:79]
  ds_read_b64_tr_b16 v[40:41], v6 offset:8192
  ds_read_b64_tr_b16 v[42:43], v6 offset:8448
  buffer_load_dwordx4 v1, s[32:35], s56 offen offset:0 lds
  v_mfma_f32_32x32x16_bf16 v[96:111], a[204:207], v[48:51], v[96:111]
  ds_read_b64_tr_b16 v[44:45], v6 offset:10240
  ds_read_b64_tr_b16 v[46:47], v6 offset:10496
  buffer_load_dwordx4 v2, s[32:35], s56 offen offset:1024 lds
  s_add_u32 m0, s61, 51072
  v_mfma_f32_16x16x32_bf16 v[176:179], v[140:143], v[140:143], v[176:179]
  v_mfma_f32_16x16x32_bf16 v[184:187], v[148:151], v[140:143], v[184:187]
  v_mfma_f32_32x32x16_bf16 v[80:95], a[200:203], v[52:55], v[80:95]
  buffer_load_dwordx4 v1, s[32:35], s56 offen offset:128 lds
  v_mfma_f32_32x32x16_bf16 v[112:127], a[204:207], v[52:55], v[112:127]
  s_waitcnt lgkmcnt(10)
  v_mfma_f32_16x16x32_bf16 v[180:183], v[144:147], v[144:147], v[180:183]
  v_mfma_f32_16x16x32_bf16 v[188:191], v[148:151], v[144:147], v[188:191]
  s_waitcnt lgkmcnt(4)
  v_mfma_f32_32x32x16_bf16 v[64:79], a[208:211], v[56:59], v[64:79]
  s_waitcnt vmcnt(15) lgkmcnt(0)
  s_barrier
  ds_read_b64_tr_b16 v[48:49], v4 offset:16384
  ds_read_b64_tr_b16 v[50:51], v4 offset:16640
  ds_read_b128 v[132:135], v152 offset:49152
  v_mfma_f32_32x32x16_bf16 v[96:111], a[212:215], v[56:59], v[96:111]
  ds_read_b128 a[224:227], v8 offset:49152
  ds_read_b128 a[228:231], v8 offset:53248
  buffer_load_dwordx4 v2, s[32:35], s56 offen offset:1152 lds
  v_mov_b32 v1, v154
  v_mfma_f32_16x16x32_bf16 v[24:27], v[32:35], v[56:59], v[24:27]
  v_add_u32 v2, 23552, v1
  v_mfma_f32_32x32x16_bf16 v[80:95], a[208:211], v[60:63], v[80:95]
  ds_read_b64_tr_b16 v[52:53], v4 offset:18432
  ds_read_b64_tr_b16 v[54:55], v4 offset:18688
  ds_read_b128 v[136:139], v152 offset:51200
  buffer_load_dword v10, v37, s[52:55], 0 offen offset:0 sc1
  v_mfma_f32_32x32x16_bf16 v[112:127], a[212:215], v[60:63], v[112:127]
  ds_read_b128 a[232:235], v9 offset:49152
  ds_read_b128 a[236:239], v9 offset:53248
  s_add_u32 m0, s61, 65536
  s_mul_i32 s32, s11, 348160
  s_add_u32 s32, s32, 18874368
  s_lshl3_add_u32 s59, s63, s32
  v_mfma_f32_16x16x32_bf16 v[28:31], v[32:35], v[60:63], v[28:31]
  s_lshl2_add_u32 s60, s63, s32
  v_mfma_f32_32x32x16_bf16 v[64:79], a[216:219], v[40:43], v[64:79]
  ds_read_b64_tr_b16 v[56:57], v6 offset:16384
  ds_read_b64_tr_b16 v[58:59], v6 offset:16640
  ds_read_b128 v[140:143], v152 offset:49664
  buffer_load_dwordx4 v1, s[36:39], s4 offen offset:0 lds
  v_mfma_f32_32x32x16_bf16 v[96:111], a[220:223], v[40:43], v[96:111]
  ds_read_b128 a[240:243], v8 offset:49664
  ds_read_b128 a[244:247], v8 offset:53760
  s_waitcnt lgkmcnt(7)
  buffer_load_dwordx4 v2, s[36:39], s4 offen offset:1024 lds
  v_mfma_f32_16x16x32_bf16 v[176:179], v[132:135], v[132:135], v[176:179]
  s_add_u32 s75, s60, s63
  v_mfma_f32_16x16x32_bf16 v[184:187], v[148:151], v[132:135], v[184:187]
  s_add_u32 s60, s60, 163840
  v_mfma_f32_32x32x16_bf16 v[80:95], a[216:219], v[44:47], v[80:95]
  ds_read_b64_tr_b16 v[60:61], v6 offset:18432
  ds_read_b64_tr_b16 v[62:63], v6 offset:18688
  ds_read_b128 v[144:147], v152 offset:51712
  s_add_u32 m0, s61, 67584
  s_add_u32 s75, s75, 245760
  s_add_u32 s74, s60, 10240
  v_mfma_f32_32x32x16_bf16 v[112:127], a[220:223], v[44:47], v[112:127]
  ds_read_b128 a[248:251], v9 offset:49664
  ds_read_b128 a[252:255], v9 offset:53760
  buffer_load_dwordx4 v1, s[40:43], s4 offen offset:0 lds
  s_lshl2_add_u32 s33, s93, s3
  v_mfma_f32_16x16x32_bf16 v[180:183], v[136:139], v[136:139], v[180:183]
  s_mul_i32 s33, s33, 10880
  v_mfma_f32_16x16x32_bf16 v[188:191], v[148:151], v[136:139], v[188:191]
  s_add_u32 s33, s33, s32
  v_mfma_f32_32x32x16_bf16 v[64:79], a[224:227], v[48:51], v[64:79]
  ds_read_b64_tr_b16 v[40:41], v4 offset:24576
  ds_read_b64_tr_b16 v[42:43], v4 offset:24832
  s_lshl_b32 s34, s11, 7
  s_lshr_b32 s35, s11, 2
  s_lshl_b32 s35, s35, 6
  s_and_b32 s62, s11, 3
  v_mfma_f32_32x32x16_bf16 v[96:111], a[228:231], v[48:51], v[96:111]
  buffer_load_dwordx4 v2, s[40:43], s4 offen offset:1024 lds
  s_lshl3_add_u32 s35, s62, s35
  s_add_u32 s35, s35, 928
  s_lshl2_add_u32 s62, s10, s3
  v_mfma_f32_16x16x32_bf16 v[24:27], v[32:35], v[48:51], v[24:27]
  s_mul_i32 s62, s62, 20480
  v_mfma_f32_32x32x16_bf16 v[80:95], a[224:227], v[52:55], v[80:95]
  ds_read_b64_tr_b16 v[44:45], v4 offset:26624
  ds_read_b64_tr_b16 v[46:47], v4 offset:26880
  s_add_u32 m0, s61, 81920
  s_mul_i32 s32, s11, 160
  s_add_u32 s62, s62, s32
  s_lshl_b32 s93, s93, 7
  v_mfma_f32_32x32x16_bf16 v[112:127], a[228:231], v[52:55], v[112:127]
  buffer_load_dwordx4 v1, s[36:39], s5 offen offset:0 lds
  s_sub_u32 s93, s93, 128
  v_mfma_f32_16x16x32_bf16 v[28:31], v[32:35], v[52:55], v[28:31]
  s_waitcnt lgkmcnt(7)
  v_mfma_f32_32x32x16_bf16 v[64:79], a[232:235], v[56:59], v[64:79]
  ds_read_b64_tr_b16 v[48:49], v6 offset:24576
  ds_read_b64_tr_b16 v[50:51], v6 offset:24832
  v_mfma_f32_32x32x16_bf16 v[96:111], a[236:239], v[56:59], v[96:111]
  ds_read_b64_tr_b16 v[52:53], v6 offset:26624
  ds_read_b64_tr_b16 v[54:55], v6 offset:26880
  buffer_load_dwordx4 v2, s[36:39], s5 offen offset:1024 lds
  v_mfma_f32_16x16x32_bf16 v[176:179], v[140:143], v[140:143], v[176:179]
  v_mfma_f32_16x16x32_bf16 v[184:187], v[148:151], v[140:143], v[184:187]
  v_mfma_f32_32x32x16_bf16 v[80:95], a[232:235], v[60:63], v[80:95]
  s_add_u32 m0, s61, 83968
  v_mfma_f32_32x32x16_bf16 v[112:127], a[236:239], v[60:63], v[112:127]
  s_waitcnt lgkmcnt(10)
  buffer_load_dwordx4 v1, s[40:43], s5 offen offset:0 lds
  v_mfma_f32_16x16x32_bf16 v[180:183], v[144:147], v[144:147], v[180:183]
  v_mfma_f32_16x16x32_bf16 v[188:191], v[148:151], v[144:147], v[188:191]
  s_waitcnt lgkmcnt(4)
  v_mfma_f32_32x32x16_bf16 v[64:79], a[240:243], v[40:43], v[64:79]
  s_waitcnt vmcnt(16) lgkmcnt(0)
  s_barrier
  ds_read_b64_tr_b16 v[56:57], v4 offset:32768
  ds_read_b64_tr_b16 v[58:59], v4 offset:33024
  ds_read_b128 v[132:135], v152 offset:0
  v_mfma_f32_32x32x16_bf16 v[96:111], a[244:247], v[40:43], v[96:111]
  ds_read_b128 v[192:195], v8 offset:0
  ds_read_b128 v[196:199], v8 offset:4096
  buffer_load_dwordx4 v2, s[40:43], s5 offen offset:1024 lds
  s_and_b32 s77, s3, 2
  v_mfma_f32_16x16x32_bf16 v[24:27], v[32:35], v[40:43], v[24:27]
  s_lshl_b32 s77, s77, 4
  v_mfma_f32_32x32x16_bf16 v[80:95], a[240:243], v[44:47], v[80:95]
  ds_read_b64_tr_b16 v[60:61], v4 offset:34816
  ds_read_b64_tr_b16 v[62:63], v4 offset:35072
  ds_read_b128 v[136:139], v152 offset:2048
  v_lshrrev_b32 v2, 5, v0
  v_mul_u32_u24 v2, 24512, v2
  v_xad_u32 v2, v1, s77, v2
  v_mfma_f32_32x32x16_bf16 v[112:127], a[244:247], v[44:47], v[112:127]
  ds_read_b128 v[200:203], v9 offset:0
  ds_read_b128 v[204:207], v9 offset:4096
  v_add_u32 v2, s58, v2
  s_add_u32 s77, s12, 97280
  s_add_u32 m0, s61, 131072
  v_mfma_f32_16x16x32_bf16 v[28:31], v[32:35], v[44:47], v[28:31]
  v_mfma_f32_32x32x16_bf16 v[64:79], a[248:251], v[48:51], v[64:79]
  ds_read_b64_tr_b16 v[40:41], v6 offset:32768
  ds_read_b64_tr_b16 v[42:43], v6 offset:33024
  ds_read_b128 v[140:143], v152 offset:512
  buffer_load_dwordx4 v2, s[44:47], s12 offen offset:0 lds
  v_mfma_f32_32x32x16_bf16 v[96:111], a[252:255], v[48:51], v[96:111]
  ds_read_b128 v[208:211], v8 offset:512
  ds_read_b128 v[212:215], v8 offset:4608
  s_waitcnt lgkmcnt(7)
  s_waitcnt vmcnt(9)
  v_cmp_eq_u32 vcc, 0, v10
  s_cbranch_vccnz .slow26
.back27:
  v_mfma_f32_16x16x32_bf16 v[176:179], v[132:135], v[132:135], v[176:179]
  v_mfma_f32_16x16x32_bf16 v[184:187], v[148:151], v[132:135], v[184:187]
  v_mfma_f32_32x32x16_bf16 v[80:95], a[248:251], v[52:55], v[80:95]
  ds_read_b64_tr_b16 v[44:45], v6 offset:34816
  ds_read_b64_tr_b16 v[46:47], v6 offset:35072
  ds_read_b128 v[144:147], v152 offset:2560
  buffer_load_dwordx4 v2, s[44:47], s77 offen offset:1024 lds
  v_mfma_f32_32x32x16_bf16 v[112:127], a[252:255], v[52:55], v[112:127]
  ds_read_b128 v[216:219], v9 offset:512
  ds_read_b128 v[220:223], v9 offset:4608
  s_add_u32 s77, s13, 97280
  v_mfma_f32_16x16x32_bf16 v[180:183], v[136:139], v[136:139], v[180:183]
  v_mfma_f32_16x16x32_bf16 v[188:191], v[148:151], v[136:139], v[188:191]
  v_mfma_f32_32x32x16_bf16 v[64:79], v[192:195], v[56:59], v[64:79]
  ds_read_b64_tr_b16 v[48:49], v4 offset:40960
  ds_read_b64_tr_b16 v[50:51], v4 offset:41216
  s_add_u32 m0, s61, 133120
  v_mfma_f32_32x32x16_bf16 v[96:111], v[196:199], v[56:59], v[96:111]
  v_mfma_f32_16x16x32_bf16 v[24:27], v[32:35], v[56:59], v[24:27]
  v_mfma_f32_32x32x16_bf16 v[80:95], v[192:195], v[60:63], v[80:95]
  ds_read_b64_tr_b16 v[52:53], v4 offset:43008
  ds_read_b64_tr_b16 v[54:55], v4 offset:43264
  buffer_load_dwordx4 v2, s[44:47], s13 offen offset:0 lds
  v_mfma_f32_32x32x16_bf16 v[112:127], v[196:199], v[60:63], v[112:127]
  v_mfma_f32_16x16x32_bf16 v[28:31], v[32:35], v[60:63], v[28:31]
  s_waitcnt lgkmcnt(7)
  v_mfma_f32_32x32x16_bf16 v[64:79], v[200:203], v[40:43], v[64:79]
  ds_read_b64_tr_b16 v[56:57], v6 offset:40960
  ds_read_b64_tr_b16 v[58:59], v6 offset:41216
  buffer_load_dwordx4 v2, s[44:47], s77 offen offset:1024 lds
  v_add_u32 v2, 23552, v1
  v_mfma_f32_32x32x16_bf16 v[96:111], v[204:207], v[40:43], v[96:111]
  ds_read_b64_tr_b16 v[60:61], v6 offset:43008
  ds_read_b64_tr_b16 v[62:63], v6 offset:43264
  v_mfma_f32_16x16x32_bf16 v[176:179], v[140:143], v[140:143], v[176:179]
  v_mfma_f32_16x16x32_bf16 v[184:187], v[148:151], v[140:143], v[184:187]
  v_mfma_f32_32x32x16_bf16 v[80:95], v[200:203], v[44:47], v[80:95]
  v_mfma_f32_32x32x16_bf16 v[112:127], v[204:207], v[44:47], v[112:127]
  s_waitcnt lgkmcnt(10)
  s_add_u32 m0, s61, 0
  v_mfma_f32_16x16x32_bf16 v[180:183], v[144:147], v[144:147], v[180:183]
  v_mfma_f32_16x16x32_bf16 v[188:191], v[148:151], v[144:147], v[188:191]
  s_waitcnt lgkmcnt(4)
  v_mfma_f32_32x32x16_bf16 v[64:79], v[208:211], v[48:51], v[64:79]
  s_waitcnt lgkmcnt(0)
  s_barrier
  ds_read_b64_tr_b16 v[40:41], v4 offset:49152
  ds_read_b64_tr_b16 v[42:43], v4 offset:49408
  ds_read_b128 v[132:135], v152 offset:16384
  v_mfma_f32_32x32x16_bf16 v[96:111], v[212:215], v[48:51], v[96:111]
  ds_read_b128 v[224:227], v8 offset:16384
  ds_read_b128 v[228:231], v8 offset:20480
  buffer_load_dwordx4 v1, s[36:39], s6 offen offset:0 lds
  v_mfma_f32_16x16x32_bf16 v[24:27], v[32:35], v[48:51], v[24:27]
  v_mfma_f32_32x32x16_bf16 v[80:95], v[208:211], v[52:55], v[80:95]
  ds_read_b64_tr_b16 v[44:45], v4 offset:51200
  ds_read_b64_tr_b16 v[46:47], v4 offset:51456
  ds_read_b128 v[136:139], v152 offset:18432
  buffer_load_dwordx4 v2, s[36:39], s6 offen offset:1024 lds
  v_mfma_f32_32x32x16_bf16 v[112:127], v[212:215], v[52:55], v[112:127]
  ds_read_b128 v[232:235], v9 offset:16384
  ds_read_b128 v[236:239], v9 offset:20480
  s_add_u32 m0, s61, 2048
  v_mfma_f32_16x16x32_bf16 v[28:31], v[32:35], v[52:55], v[28:31]
  v_mfma_f32_32x32x16_bf16 v[64:79], v[216:219], v[56:59], v[64:79]
  ds_read_b64_tr_b16 v[48:49], v6 offset:49152
  ds_read_b64_tr_b16 v[50:51], v6 offset:49408
  ds_read_b128 v[140:143], v152 offset:16896
  buffer_load_dwordx4 v1, s[40:43], s6 offen offset:0 lds
  v_mfma_f32_32x32x16_bf16 v[96:111], v[220:223], v[56:59], v[96:111]
  ds_read_b128 v[240:243], v8 offset:16896
  ds_read_b128 v[244:247], v8 offset:20992
  s_waitcnt lgkmcnt(7)
  buffer_load_dwordx4 v2, s[40:43], s6 offen offset:1024 lds
  v_mfma_f32_16x16x32_bf16 v[176:179], v[132:135], v[132:135], v[176:179]
  s_add_u32 m0, s61, 16384
  v_mfma_f32_16x16x32_bf16 v[184:187], v[148:151], v[132:135], v[184:187]
  v_mfma_f32_32x32x16_bf16 v[80:95], v[216:219], v[60:63], v[80:95]
  ds_read_b64_tr_b16 v[52:53], v6 offset:51200
  ds_read_b64_tr_b16 v[54:55], v6 offset:51456
  ds_read_b128 v[144:147], v152 offset:18944
  buffer_load_dwordx4 v1, s[36:39], s7 offen offset:0 lds
  v_mfma_f32_32x32x16_bf16 v[112:127], v[220:223], v[60:63], v[112:127]
  ds_read_b128 v[248:251], v9 offset:16896
  ds_read_b128 v[252:255], v9 offset:20992
  v_mfma_f32_16x16x32_bf16 v[180:183], v[136:139], v[136:139], v[180:183]
  v_mfma_f32_16x16x32_bf16 v[188:191], v[148:151], v[136:139], v[188:191]
  v_mfma_f32_32x32x16_bf16 v[64:79], v[224:227], v[40:43], v[64:79]
  ds_read_b64_tr_b16 v[56:57], v4 offset:57344
  ds_read_b64_tr_b16 v[58:59], v4 offset:57600
  buffer_load_dwordx4 v2, s[36:39], s7 offen offset:1024 lds
  s_add_u32 m0, s61, 18432
  v_mfma_f32_32x32x16_bf16 v[96:111], v[228:231], v[40:43], v[96:111]
  buffer_load_dwordx4 v1, s[40:43], s7 offen offset:0 lds
  v_mfma_f32_16x16x32_bf16 v[24:27], v[32:35], v[40:43], v[24:27]
  v_mfma_f32_32x32x16_bf16 v[80:95], v[224:227], v[44:47], v[80:95]
  ds_read_b64_tr_b16 v[60:61], v4 offset:59392
  ds_read_b64_tr_b16 v[62:63], v4 offset:59648
  buffer_load_dwordx4 v2, s[40:43], s7 offen offset:1024 lds
  s_and_b32 s77, s3, 2
  v_mfma_f32_32x32x16_bf16 v[112:127], v[228:231], v[44:47], v[112:127]
  s_lshl_b32 s77, s77, 4
  v_lshrrev_b32 v2, 5, v0
  v_mul_u32_u24 v2, 24512, v2
  v_xad_u32 v2, v1, s77, v2
  v_add_u32 v2, s58, v2
  s_add_u32 s77, s8, 97280
  v_mfma_f32_16x16x32_bf16 v[28:31], v[32:35], v[44:47], v[28:31]
  s_add_u32 m0, s61, 98304
  s_waitcnt lgkmcnt(7)
  v_mfma_f32_32x32x16_bf16 v[64:79], v[232:235], v[48:51], v[64:79]
  ds_read_b64_tr_b16 v[40:41], v6 offset:57344
  ds_read_b64_tr_b16 v[42:43], v6 offset:57600
  buffer_load_dwordx4 v2, s[44:47], s8 offen offset:0 lds
  v_mfma_f32_32x32x16_bf16 v[96:111], v[236:239], v[48:51], v[96:111]
  ds_read_b64_tr_b16 v[44:45], v6 offset:59392
  ds_read_b64_tr_b16 v[46:47], v6 offset:59648
  v_mfma_f32_16x16x32_bf16 v[176:179], v[140:143], v[140:143], v[176:179]
  v_mfma_f32_16x16x32_bf16 v[184:187], v[148:151], v[140:143], v[184:187]
  v_mfma_f32_32x32x16_bf16 v[80:95], v[232:235], v[52:55], v[80:95]
  v_mfma_f32_32x32x16_bf16 v[112:127], v[236:239], v[52:55], v[112:127]
  s_waitcnt lgkmcnt(10)
  buffer_load_dwordx4 v2, s[44:47], s77 offen offset:1024 lds
  s_add_u32 s77, s9, 97280
  v_mfma_f32_16x16x32_bf16 v[180:183], v[144:147], v[144:147], v[180:183]
  v_mfma_f32_16x16x32_bf16 v[188:191], v[148:151], v[144:147], v[188:191]
  s_waitcnt lgkmcnt(4)
  v_mfma_f32_32x32x16_bf16 v[64:79], v[240:243], v[56:59], v[64:79]
  s_waitcnt vmcnt(18) lgkmcnt(0)
  s_barrier
  ds_read_b64_tr_b16 v[48:49], v5 offset:0
  ds_read_b64_tr_b16 v[50:51], v5 offset:256
  v_mfma_f32_32x32x16_bf16 v[96:111], v[244:247], v[56:59], v[96:111]
  s_add_u32 m0, s61, 100352
  v_cndmask_b32 v180, v180, v181, s[0:1]
  v_cndmask_b32 v182, v182, v183, s[0:1]
  v_cndmask_b32 v176, v176, v177, s[0:1]
  v_cndmask_b32 v178, v178, v179, s[0:1]
  v_cndmask_b32 v180, v180, v182, s[88:89]
  v_mfma_f32_16x16x32_bf16 v[24:27], v[32:35], v[56:59], v[24:27]
  v_cndmask_b32 v176, v176, v178, s[88:89]
  v_mfma_f32_32x32x16_bf16 v[80:95], v[240:243], v[60:63], v[80:95]
  ds_read_b64_tr_b16 v[52:53], v5 offset:2048
  ds_read_b64_tr_b16 v[54:55], v5 offset:2304
  buffer_load_dwordx4 v2, s[44:47], s9 offen offset:0 lds
  v_mfma_f32_32x32x16_bf16 v[112:127], v[244:247], v[60:63], v[112:127]
  s_mov_b32 vcc_lo, 0x00f0000f
  s_mov_b32 vcc_hi, 0xf0000f00
  v_cndmask_b32_dpp v10, v188, v184, vcc row_ror:8 row_mask:0xf bank_mask:0xf
  v_cndmask_b32_dpp v11, v180, v176, vcc row_ror:8 row_mask:0xf bank_mask:0xf
  v_mul_f32 v10, 0xbacccccd, v10
  v_mul_f32 v11, 0x3acccccd, v11
  v_mfma_f32_16x16x32_bf16 v[28:31], v[32:35], v[60:63], v[28:31]
  v_fma_f32 v11, -v10, v10, v11
  v_mfma_f32_32x32x16_bf16 v[64:79], v[248:251], v[40:43], v[64:79]
  ds_read_b64_tr_b16 v[56:57], v7 offset:0
  ds_read_b64_tr_b16 v[58:59], v7 offset:256
  v_max_f32 v11, 0, v11
  v_cvt_pk_bf16_f32 v11, v11, v11
  v_lshlrev_b32 v11, 16, v11
  v_add_f32 v11, 0x3727c5ac, v11
  v_mfma_f32_32x32x16_bf16 v[96:111], v[252:255], v[40:43], v[96:111]
  v_cvt_pk_bf16_f32 v11, v11, v11
  v_lshlrev_b32 v11, 16, v11
  v_sqrt_f32 v11, v11
  v_cvt_pk_bf16_f32 v10, v10, v10
  v_cvt_pk_bf16_f32 v11, v11, v11
  v_mfma_f32_32x32x16_bf16 v[80:95], v[248:251], v[44:47], v[80:95]
  ds_read_b64_tr_b16 v[60:61], v7 offset:2048
  ds_read_b64_tr_b16 v[62:63], v7 offset:2304
  buffer_load_dwordx4 v2, s[44:47], s77 offen offset:1024 lds
  v_add_u32 v2, 23552, v1
  v_mfma_f32_32x32x16_bf16 v[112:127], v[252:255], v[44:47], v[112:127]
  v_lshlrev_b32 v11, 16, v11
  v_rcp_f32 v11, v11
  s_nop 0
  ds_write2_b32 v23, v10, v11 offset0:0 offset1:128
  v_mov_b32_dpp v32, v32 quad_perm:[3,0,1,2] row_mask:0xf bank_mask:0xf
  v_mov_b32_dpp v33, v33 quad_perm:[3,0,1,2] row_mask:0xf bank_mask:0xf
  v_mov_b32_dpp v34, v34 quad_perm:[3,0,1,2] row_mask:0xf bank_mask:0xf
  v_mov_b32_dpp v35, v35 quad_perm:[3,0,1,2] row_mask:0xf bank_mask:0xf
  s_waitcnt lgkmcnt(5)
  v_mfma_f32_32x32x16_bf16 v[128:143], v[48:51], a[0:3], 0
  ds_read_b64_tr_b16 v[40:41], v5 offset:8192
  ds_read_b64_tr_b16 v[42:43], v5 offset:8448
  s_add_u32 m0, s61, 32768
  v_cvt_pk_bf16_f32 v8, v24, v24
  v_cvt_pk_bf16_f32 v9, v28, v28
  v_lshlrev_b32 v8, 16, v8
  v_mfma_f32_32x32x16_bf16 v[160:175], v[48:51], a[4:7], 0
  v_lshlrev_b32 v9, 16, v9
  buffer_load_dwordx4 v1, s[36:39], s8 offen offset:0 lds
  v_sub_f32 v8, v24, v8
  v_sub_f32 v9, v28, v9
  v_mfma_f32_16x16x32_bf16 v[24:27], v[32:35], v[48:51], v[24:27]
  v_mfma_f32_32x32x16_bf16 v[144:159], v[52:55], a[0:3], 0
  ds_read_b64_tr_b16 v[44:45], v5 offset:10240
  ds_read_b64_tr_b16 v[46:47], v5 offset:10496
  v_mfma_f32_32x32x16_bf16 v[176:191], v[52:55], a[4:7], 0
  buffer_load_dwordx4 v2, s[36:39], s8 offen offset:1024 lds
  v_mfma_f32_16x16x32_bf16 v[28:31], v[32:35], v[52:55], v[28:31]
  s_add_u32 m0, s61, 34816
  s_waitcnt lgkmcnt(5)
  v_mfma_f32_32x32x16_bf16 v[128:143], v[56:59], a[8:11], v[128:143]
  ds_read_b64_tr_b16 v[48:49], v7 offset:8192
  ds_read_b64_tr_b16 v[50:51], v7 offset:8448
  buffer_load_dwordx4 v1, s[40:43], s8 offen offset:0 lds
  v_cvt_pk_bf16_f32 v8, v24, v8
  v_mfma_f32_32x32x16_bf16 v[160:175], v[56:59], a[12:15], v[160:175]
  ds_read_b64_tr_b16 v[52:53], v7 offset:10240
  ds_read_b64_tr_b16 v[54:55], v7 offset:10496
  v_cvt_pk_bf16_f32 v9, v28, v9
  ds_write2_b32 v15, v8, v9 offset0:0 offset1:32
  v_mfma_f32_32x32x16_bf16 v[144:159], v[60:63], a[8:11], v[144:159]
  v_mfma_f32_32x32x16_bf16 v[176:191], v[60:63], a[12:15], v[176:191]
  buffer_load_dwordx4 v2, s[40:43], s8 offen offset:1024 lds
  s_add_u32 m0, s61, 49152
  s_waitcnt lgkmcnt(5)
  v_mfma_f32_32x32x16_bf16 v[128:143], v[40:43], a[16:19], v[128:143]
  s_waitcnt vmcnt(20) lgkmcnt(0)
  s_barrier
  ds_read_b64_tr_b16 v[56:57], v5 offset:16384
  ds_read_b64_tr_b16 v[58:59], v5 offset:16640
  ds_read2_b32 v[8:9], v16 offset0:0 offset1:32
  ds_read2_b32 v[10:11], v16 offset0:32 offset1:0
  v_mfma_f32_32x32x16_bf16 v[160:175], v[40:43], a[20:23], v[160:175]
  buffer_load_dwordx4 v1, s[36:39], s9 offen offset:0 lds
  ds_read_b32 v36, v19
  ds_read_b32 v38, v19 offset:128
  ds_read_b128 v[20:23], v18 offset:640
  v_mfma_f32_16x16x32_bf16 v[24:27], v[32:35], v[40:43], v[24:27]
  v_mfma_f32_32x32x16_bf16 v[144:159], v[44:47], a[16:19], v[144:159]
  ds_read_b64_tr_b16 v[60:61], v5 offset:18432
  ds_read_b64_tr_b16 v[62:63], v5 offset:18688
  buffer_load_dwordx4 v2, s[36:39], s9 offen offset:1024 lds
  v_mfma_f32_32x32x16_bf16 v[176:191], v[44:47], a[20:23], v[176:191]
  s_add_u32 m0, s61, 51200
  buffer_store_dword v0, v17, s[24:27], s80 offen sc1
  v_mfma_f32_16x16x32_bf16 v[28:31], v[32:35], v[44:47], v[28:31]
  v_mfma_f32_32x32x16_bf16 v[128:143], v[48:51], a[24:27], v[128:143]
  ds_read_b64_tr_b16 v[40:41], v7 offset:16384
  ds_read_b64_tr_b16 v[42:43], v7 offset:16640
  buffer_load_dwordx4 v1, s[40:43], s9 offen offset:0 lds
  s_waitcnt lgkmcnt(5)
  v_mfma_f32_32x32x16_bf16 v[160:175], v[48:51], a[28:31], v[160:175]
  v_mfma_f32_32x32x8_bf16 v[96:111], v[38:39], v[8:9], v[96:111]
  buffer_load_dwordx4 v2, s[40:43], s9 offen offset:1024 lds
  v_mfma_f32_32x32x8_bf16 v[112:127], v[38:39], v[10:11], v[112:127]
  v_mfma_f32_32x32x8_bf16 v[64:79], v[36:37], v[8:9], v[64:79]
  v_mfma_f32_32x32x8_bf16 v[80:95], v[36:37], v[10:11], v[80:95]
  ds_read_b128 v[8:11], v18 offset:672
  s_waitcnt lgkmcnt(5)
  v_mfma_f32_32x32x16_bf16 v[144:159], v[52:55], a[24:27], v[144:159]
  ds_read_b64_tr_b16 v[44:45], v7 offset:18432
  ds_read_b64_tr_b16 v[46:47], v7 offset:18688
  v_mfma_f32_32x32x16_bf16 v[176:191], v[52:55], a[28:31], v[176:191]
  s_waitcnt lgkmcnt(5)
  v_mfma_f32_32x32x16_bf16 v[128:143], v[56:59], a[32:35], v[128:143]
  ds_read_b64_tr_b16 v[48:49], v5 offset:24576
  ds_read_b64_tr_b16 v[50:51], v5 offset:24832
  v_mul_f32 v96, v96, v20
  v_mul_f32 v97, v97, v21
  v_mul_f32 v98, v98, v22
  v_mul_f32 v99, v99, v23
  v_mfma_f32_32x32x16_bf16 v[160:175], v[56:59], a[36:39], v[160:175]
  v_mul_f32 v112, v112, v20
  v_mul_f32 v113, v113, v21
  v_mul_f32 v114, v114, v22
  v_mul_f32 v115, v115, v23
  ds_read_b128 v[20:23], v18 offset:704
  v_cvt_pk_bf16_f32 v96, v96, v97
  v_mfma_f32_16x16x32_bf16 v[24:27], v[32:35], v[56:59], v[24:27]
  v_cvt_pk_bf16_f32 v97, v98, v99
  v_mfma_f32_32x32x16_bf16 v[144:159], v[60:63], a[32:35], v[144:159]
  ds_read_b64_tr_b16 v[52:53], v5 offset:26624
  ds_read_b64_tr_b16 v[54:55], v5 offset:26880
  v_cvt_pk_bf16_f32 v112, v112, v113
  v_cvt_pk_bf16_f32 v113, v114, v115
  s_waitcnt lgkmcnt(7)
  v_mul_f32 v100, v100, v8
  v_mfma_f32_32x32x16_bf16 v[176:191], v[60:63], a[36:39], v[176:191]
  v_mul_f32 v101, v101, v9
  v_mul_f32 v102, v102, v10
  v_mul_f32 v103, v103, v11
  v_mul_f32 v116, v116, v8
  v_mul_f32 v117, v117, v9
  v_mul_f32 v118, v118, v10
  v_mfma_f32_16x16x32_bf16 v[28:31], v[32:35], v[60:63], v[28:31]
  v_mul_f32 v119, v119, v11
  s_waitcnt lgkmcnt(5)
  v_mfma_f32_32x32x16_bf16 v[128:143], v[40:43], a[40:43], v[128:143]
  ds_read_b64_tr_b16 v[56:57], v7 offset:24576
  ds_read_b64_tr_b16 v[58:59], v7 offset:24832
  ds_read_b128 v[8:11], v18 offset:736
  v_cvt_pk_bf16_f32 v98, v100, v101
  v_cvt_pk_bf16_f32 v99, v102, v103
  v_cvt_pk_bf16_f32 v114, v116, v117
  v_mfma_f32_32x32x16_bf16 v[160:175], v[40:43], a[44:47], v[160:175]
  ds_read_b64_tr_b16 v[60:61], v7 offset:26624
  ds_read_b64_tr_b16 v[62:63], v7 offset:26880
  v_cvt_pk_bf16_f32 v115, v118, v119
  s_waitcnt lgkmcnt(7)
  v_mul_f32 v104, v104, v20
  v_mul_f32 v105, v105, v21
  v_mfma_f32_32x32x16_bf16 v[144:159], v[44:47], a[40:43], v[144:159]
  buffer_store_dwordx4 v[96:99], v12, s[24:27], s67 offen offset:0 sc1
  v_mfma_f32_32x32x16_bf16 v[176:191], v[44:47], a[44:47], v[176:191]
  v_mul_f32 v106, v106, v22
  v_mul_f32 v107, v107, v23
  v_mul_f32 v120, v120, v20
  v_mul_f32 v121, v121, v21
  v_mul_f32 v122, v122, v22
  s_waitcnt lgkmcnt(5)
  v_mfma_f32_32x32x16_bf16 v[128:143], v[48:51], a[48:51], v[128:143]
  s_waitcnt vmcnt(18) lgkmcnt(0)
  s_barrier
  ds_read_b64_tr_b16 v[40:41], v4 offset:0
  ds_read_b64_tr_b16 v[42:43], v4 offset:256
  v_mul_f32 v123, v123, v23
  ds_read_b128 v[20:23], v18 offset:512
  v_mfma_f32_32x32x16_bf16 v[160:175], v[48:51], a[52:55], v[160:175]
  v_cvt_pk_bf16_f32 v100, v104, v105
  v_cvt_pk_bf16_f32 v101, v106, v107
  v_cvt_pk_bf16_f32 v116, v120, v121
  v_cvt_pk_bf16_f32 v117, v122, v123
  v_mul_f32 v108, v108, v8
  v_mul_f32 v109, v109, v9
  v_mfma_f32_16x16x32_bf16 v[24:27], v[32:35], v[48:51], v[24:27]
  v_mul_f32 v110, v110, v10
  v_mfma_f32_32x32x16_bf16 v[144:159], v[52:55], a[48:51], v[144:159]
  ds_read_b64_tr_b16 v[44:45], v4 offset:2048
  ds_read_b64_tr_b16 v[46:47], v4 offset:2304
  v_mul_f32 v111, v111, v11
  v_mul_f32 v124, v124, v8
  v_mul_f32 v125, v125, v9
  v_mul_f32 v126, v126, v10
  v_mfma_f32_32x32x16_bf16 v[176:191], v[52:55], a[52:55], v[176:191]
  buffer_store_dwordx4 v[112:115], v12, s[24:27], s67 offen offset:1024 sc1
  v_mfma_f32_16x16x32_bf16 v[28:31], v[32:35], v[52:55], v[28:31]
  v_mul_f32 v127, v127, v11
  v_mfma_f32_32x32x16_bf16 v[128:143], v[56:59], a[56:59], v[128:143]
  ds_read_b64_tr_b16 v[48:49], v6 offset:0
  ds_read_b64_tr_b16 v[50:51], v6 offset:256
  ds_read_b128 v[8:11], v18 offset:544
  v_cvt_pk_bf16_f32 v102, v108, v109
  v_cvt_pk_bf16_f32 v103, v110, v111
  v_cvt_pk_bf16_f32 v118, v124, v125
  v_mfma_f32_32x32x16_bf16 v[160:175], v[56:59], a[60:63], v[160:175]
  v_cvt_pk_bf16_f32 v119, v126, v127
  s_waitcnt lgkmcnt(5)
  v_mul_f32 v64, v64, v20
  v_mul_f32 v65, v65, v21
  v_mul_f32 v66, v66, v22
  v_mul_f32 v67, v67, v23
  v_mfma_f32_32x32x16_bf16 v[144:159], v[60:63], a[56:59], v[144:159]
  ds_read_b64_tr_b16 v[52:53], v6 offset:2048
  ds_read_b64_tr_b16 v[54:55], v6 offset:2304
  v_mul_f32 v80, v80, v20
  v_mul_f32 v81, v81, v21
  v_mul_f32 v82, v82, v22
  v_mul_f32 v83, v83, v23
  v_mfma_f32_32x32x16_bf16 v[176:191], v[60:63], a[60:63], v[176:191]
  buffer_store_dwordx4 v[100:103], v12, s[24:27], s68 offen offset:0 sc1
  s_waitcnt lgkmcnt(5)
  v_mfma_f32_32x32x16_bf16 v[128:143], v[40:43], a[64:67], v[128:143]
  ds_read_b64_tr_b16 v[56:57], v4 offset:8192
  ds_read_b64_tr_b16 v[58:59], v4 offset:8448
  ds_read_b128 v[20:23], v18 offset:576
  v_cvt_pk_bf16_f32 v64, v64, v65
  v_cvt_pk_bf16_f32 v65, v66, v67
  v_cvt_pk_bf16_f32 v80, v80, v81
  v_mfma_f32_32x32x16_bf16 v[160:175], v[40:43], a[68:71], v[160:175]
  v_cvt_pk_bf16_f32 v81, v82, v83
  s_waitcnt lgkmcnt(5)
  v_mul_f32 v68, v68, v8
  v_mul_f32 v69, v69, v9
  v_mul_f32 v70, v70, v10
  v_mul_f32 v71, v71, v11
  v_mfma_f32_16x16x32_bf16 v[24:27], v[32:35], v[40:43], v[24:27]
  v_mul_f32 v84, v84, v8
  v_mfma_f32_32x32x16_bf16 v[144:159], v[44:47], a[64:67], v[144:159]
  ds_read_b64_tr_b16 v[60:61], v4 offset:10240
  ds_read_b64_tr_b16 v[62:63], v4 offset:10496
  v_mul_f32 v85, v85, v9
  v_mul_f32 v86, v86, v10
  v_mul_f32 v87, v87, v11
  ds_read_b128 v[8:11], v18 offset:608
  v_mfma_f32_32x32x16_bf16 v[176:191], v[44:47], a[68:71], v[176:191]
  buffer_store_dwordx4 v[116:119], v12, s[24:27], s68 offen offset:1024 sc1
  v_mfma_f32_16x16x32_bf16 v[28:31], v[32:35], v[44:47], v[28:31]
  v_cvt_pk_bf16_f32 v66, v68, v69
  s_waitcnt lgkmcnt(6)
  v_mfma_f32_32x32x16_bf16 v[128:143], v[48:51], a[72:75], v[128:143]
  ds_read_b64_tr_b16 v[40:41], v6 offset:8192
  ds_read_b64_tr_b16 v[42:43], v6 offset:8448
  v_cvt_pk_bf16_f32 v67, v70, v71
  v_cvt_pk_bf16_f32 v82, v84, v85
  v_cvt_pk_bf16_f32 v83, v86, v87
  s_waitcnt lgkmcnt(5)
  v_mfma_f32_32x32x16_bf16 v[160:175], v[48:51], a[76:79], v[160:175]
  ds_read_b64_tr_b16 v[44:45], v6 offset:10240
  ds_read_b64_tr_b16 v[46:47], v6 offset:10496
  v_mul_f32 v72, v72, v20
  v_mul_f32 v73, v73, v21
  v_mul_f32 v74, v74, v22
  v_mul_f32 v75, v75, v23
  v_mfma_f32_32x32x16_bf16 v[144:159], v[52:55], a[72:75], v[144:159]
  v_mul_f32 v88, v88, v20
  v_mul_f32 v89, v89, v21
  v_mul_f32 v90, v90, v22
  v_mul_f32 v91, v91, v23
  ds_read2_b32 v[18:19], v19 offset0:128 offset1:160
  v_cvt_pk_bf16_f32 v68, v72, v73
  v_mfma_f32_32x32x16_bf16 v[176:191], v[52:55], a[76:79], v[176:191]
  buffer_store_dwordx4 v[64:67], v12, s[24:27], s65 offen offset:0 sc1
  s_waitcnt lgkmcnt(6)
  v_mfma_f32_32x32x16_bf16 v[128:143], v[56:59], a[80:83], v[128:143]
  s_waitcnt vmcnt(18) lgkmcnt(1)
  s_barrier
  ds_read_b64_tr_b16 v[48:49], v4 offset:16384
  ds_read_b64_tr_b16 v[50:51], v4 offset:16640
  s_add_u32 m0, s61, 0
  v_cvt_pk_bf16_f32 v69, v74, v75
  v_mfma_f32_32x32x16_bf16 v[160:175], v[56:59], a[84:87], v[160:175]
  buffer_load_dwordx4 v1, s[36:39], s12 offen offset:0 lds
  v_cvt_pk_bf16_f32 v84, v88, v89
  v_cvt_pk_bf16_f32 v85, v90, v91
  v_mul_f32 v76, v76, v8
  v_mfma_f32_16x16x32_bf16 v[24:27], v[32:35], v[56:59], v[24:27]
  v_mul_f32 v77, v77, v9
  v_mfma_f32_32x32x16_bf16 v[144:159], v[60:63], a[80:83], v[144:159]
  ds_read_b64_tr_b16 v[52:53], v4 offset:18432
  ds_read_b64_tr_b16 v[54:55], v4 offset:18688
  buffer_load_dwordx4 v2, s[36:39], s12 offen offset:1024 lds
  s_add_u32 m0, s61, 2048
  v_mfma_f32_32x32x16_bf16 v[176:191], v[60:63], a[84:87], v[176:191]
  buffer_load_dwordx4 v1, s[40:43], s12 offen offset:0 lds
  v_mul_f32 v78, v78, v10
  v_mul_f32 v79, v79, v11
  v_mul_f32 v92, v92, v8
  v_mfma_f32_16x16x32_bf16 v[28:31], v[32:35], v[60:63], v[28:31]
  v_mul_f32 v93, v93, v9
  v_mfma_f32_32x32x16_bf16 v[128:143], v[40:43], a[88:91], v[128:143]
  ds_read_b64_tr_b16 v[56:57], v6 offset:16384
  ds_read_b64_tr_b16 v[58:59], v6 offset:16640
  buffer_load_dwordx4 v2, s[40:43], s12 offen offset:1024 lds
  s_and_b32 s77, s3, 2
  v_mfma_f32_32x32x16_bf16 v[160:175], v[40:43], a[92:95], v[160:175]
  s_lshl_b32 s77, s77, 4
  v_lshrrev_b32 v2, 5, v0
  v_mul_u32_u24 v2, 24512, v2
  v_xad_u32 v2, v1, s77, v2
  v_add_u32 v2, s58, v2
  s_add_u32 s77, s14, 97280
  v_mfma_f32_32x32x16_bf16 v[144:159], v[44:47], a[88:91], v[144:159]
  ds_read_b64_tr_b16 v[60:61], v6 offset:18432
  ds_read_b64_tr_b16 v[62:63], v6 offset:18688
  s_add_u32 m0, s61, 114688
  v_mul_f32 v94, v94, v10
  v_mul_f32 v95, v95, v11
  v_cvt_pk_bf16_f32 v70, v76, v77
  v_mfma_f32_32x32x16_bf16 v[176:191], v[44:47], a[92:95], v[176:191]
  buffer_load_dwordx4 v2, s[44:47], s14 offen offset:0 lds
  v_cvt_pk_bf16_f32 v71, v78, v79
  v_cvt_pk_bf16_f32 v86, v92, v93
  s_waitcnt lgkmcnt(4)
  v_mfma_f32_32x32x16_bf16 v[128:143], v[48:51], a[96:99], v[128:143]
  ds_read_b64_tr_b16 v[40:41], v4 offset:24576
  ds_read_b64_tr_b16 v[42:43], v4 offset:24832
  v_cvt_pk_bf16_f32 v87, v94, v95
  v_mul_f32 v18, v18, v18
  v_mul_f32 v19, v19, v19
  v_lshl_add_u32 v93, v0, 2, s34
  v_mfma_f32_32x32x16_bf16 v[160:175], v[48:51], a[100:103], v[160:175]
  buffer_store_dwordx4 v[80:83], v12, s[24:27], s65 offen offset:1024 sc1
  v_mfma_f32_16x16x32_bf16 v[24:27], v[32:35], v[48:51], v[24:27]
  v_and_b32 v72, 1, v0
  v_mfma_f32_32x32x16_bf16 v[144:159], v[52:55], a[96:99], v[144:159]
  ds_read_b64_tr_b16 v[44:45], v4 offset:26624
  ds_read_b64_tr_b16 v[46:47], v4 offset:26880
  buffer_load_dwordx4 v2, s[44:47], s77 offen offset:1024 lds
  s_add_u32 s77, s15, 97280
  v_mfma_f32_32x32x16_bf16 v[176:191], v[52:55], a[100:103], v[176:191]
  v_lshl_add_u32 v72, v72, 2, s35
  s_mov_b32 s0, -1
  s_mov_b32 s1, 0
  v_cndmask_b32 v93, v72, v93, s[0:1]
  v_lshlrev_b32 v79, 7, v0
  v_min_u32 v78, 20, v0
  v_mfma_f32_16x16x32_bf16 v[28:31], v[32:35], v[52:55], v[28:31]
  v_lshlrev_b32 v78, 7, v78
  s_waitcnt lgkmcnt(4)
  v_mfma_f32_32x32x16_bf16 v[128:143], v[56:59], a[104:107], v[128:143]
  ds_read_b64_tr_b16 v[48:49], v6 offset:24576
  ds_read_b64_tr_b16 v[50:51], v6 offset:24832
  s_add_u32 m0, s61, 116736
  s_add_u32 s34, s33, 8192
  v_and_b32 v72, 1, v0
  v_mul_u32_u24 v72, 304, v72
  v_mfma_f32_32x32x16_bf16 v[160:175], v[56:59], a[108:111], v[160:175]
  ds_read_b64_tr_b16 v[52:53], v6 offset:26624
  ds_read_b64_tr_b16 v[54:55], v6 offset:26880
  v_add_u32 v72, s94, v72
  buffer_load_dwordx4 v2, s[44:47], s15 offen offset:0 lds
  v_mfma_f32_32x32x16_bf16 v[144:159], v[60:63], a[104:107], v[144:159]
  buffer_store_dwordx4 v[68:71], v12, s[24:27], s66 offen offset:0 sc1
  v_mfma_f32_32x32x16_bf16 v[176:191], v[60:63], a[108:111], v[176:191]
  v_lshrrev_b32 v72, 11, v72
  v_bfe_u32 v73, v0, 1, 2
  v_mad_u32_u24 v72, v73, 5, v72
  v_min_u32 v72, 15, v72
  v_bfe_u32 v73, v0, 3, 2
  s_waitcnt lgkmcnt(4)
  v_mfma_f32_32x32x16_bf16 v[128:143], v[40:43], a[112:115], v[128:143]
  s_waitcnt vmcnt(19) lgkmcnt(0)
  s_barrier
  ds_read_b64_tr_b16 v[56:57], v4 offset:32768
  ds_read_b64_tr_b16 v[58:59], v4 offset:33024
  v_lshl_add_u32 v73, v73, 6, s93
  v_max_i32 v73, 0, v73
  v_mfma_f32_32x32x16_bf16 v[160:175], v[40:43], a[116:119], v[160:175]
  v_lshl_add_u32 v10, v72, 2, v73
  v_and_b32 v72, 31, v0
  v_lshrrev_b32 v73, 5, v0
  buffer_load_dwordx4 v2, s[44:47], s77 offen offset:1024 lds
  v_mfma_f32_16x16x32_bf16 v[24:27], v[32:35], v[40:43], v[24:27]
  v_add_u32 v2, 23552, v1
  v_mfma_f32_32x32x16_bf16 v[144:159], v[44:47], a[112:115], v[144:159]
  ds_read_b64_tr_b16 v[60:61], v4 offset:34816
  ds_read_b64_tr_b16 v[62:63], v4 offset:35072
  v_add_u32 v88, s96, v14
  v_lshlrev_b32 v21, 4, v72
  v_lshl_add_u32 v21, v73, 3, v21
  v_add_u32 v91, s97, v21
  v_mfma_f32_32x32x16_bf16 v[176:191], v[44:47], a[116:119], v[176:191]
  buffer_store_dwordx4 v[84:87], v12, s[24:27], s66 offen offset:1024 sc1
  v_mfma_f32_16x16x32_bf16 v[28:31], v[32:35], v[44:47], v[28:31]
  s_add_u32 m0, s61, 16384
  v_mfma_f32_32x32x16_bf16 v[128:143], v[48:51], a[120:123], v[128:143]
  ds_read_b64_tr_b16 v[40:41], v6 offset:32768
  ds_read_b64_tr_b16 v[42:43], v6 offset:33024
  v_mov_b32 v74, 1073741824
  buffer_load_dwordx4 v1, s[36:39], s13 offen offset:0 lds
  v_mfma_f32_32x32x16_bf16 v[160:175], v[48:51], a[124:127], v[160:175]
  v_cmp_eq_u32 vcc, s92, v73
  s_add_u32 s76, s57, 123392
  s_sub_u32 s97, s97, 1024
  v_cndmask_b32 v91, v74, v91, vcc
  s_add_u32 s94, s94, 39936
  v_lshl_add_u32 v74, v72, 4, s94
  v_mfma_f32_32x32x16_bf16 v[144:159], v[52:55], a[120:123], v[144:159]
  ds_read_b64_tr_b16 v[44:45], v6 offset:34816
  ds_read_b64_tr_b16 v[46:47], v6 offset:35072
  v_add_u32 v75, 9920, v74
  v_add_u32 v76, s97, v14
  v_mfma_f32_32x32x16_bf16 v[176:191], v[52:55], a[124:127], v[176:191]
  buffer_load_dwordx4 v2, s[36:39], s13 offen offset:1024 lds
  s_add_u32 m0, s61, 18432
  s_waitcnt lgkmcnt(4)
  v_mfma_f32_32x32x16_bf16 v[128:143], v[56:59], a[128:131], v[128:143]
  ds_read_b64_tr_b16 v[48:49], v4 offset:40960
  ds_read_b64_tr_b16 v[50:51], v4 offset:41216
  v_cmp_gt_u32 vcc, 20, v72
  s_sub_u32 s94, s94, 512
  v_add_u32 v77, s94, v14
  v_cndmask_b32 v74, v75, v74, vcc
  v_mfma_f32_32x32x16_bf16 v[160:175], v[56:59], a[132:135], v[160:175]
  buffer_load_dwordx4 v1, s[40:43], s13 offen offset:0 lds
  v_cndmask_b32 v89, v74, v76, s[0:1]
  v_add_u32 v74, 9920, v77
  v_add_u32 v75, 19712, v77
  v_mfma_f32_16x16x32_bf16 v[24:27], v[32:35], v[56:59], v[24:27]
  v_add_u32 v76, 29632, v77
  v_mfma_f32_32x32x16_bf16 v[144:159], v[60:63], a[128:131], v[144:159]
  ds_read_b64_tr_b16 v[52:53], v4 offset:43008
  ds_read_b64_tr_b16 v[54:55], v4 offset:43264
  buffer_load_dwordx4 v2, s[40:43], s13 offen offset:1024 lds
  s_and_b32 s77, s3, 2
  v_mfma_f32_32x32x16_bf16 v[176:191], v[60:63], a[132:135], v[176:191]
  s_lshl_b32 s77, s77, 4
  v_lshrrev_b32 v2, 5, v0
  v_mul_u32_u24 v2, 24512, v2
  v_xad_u32 v2, v1, s77, v2
  v_add_u32 v2, s58, v2
  s_add_u32 s77, s4, 97280
  v_mfma_f32_16x16x32_bf16 v[28:31], v[32:35], v[60:63], v[28:31]
  s_add_u32 m0, s61, 65536
  s_waitcnt lgkmcnt(4)
  v_mfma_f32_32x32x16_bf16 v[128:143], v[40:43], a[136:139], v[128:143]
  ds_read_b64_tr_b16 v[56:57], v6 offset:40960
  ds_read_b64_tr_b16 v[58:59], v6 offset:41216
  buffer_load_dwordx4 v2, s[44:47], s4 offen offset:0 lds
  v_mov_b32 v77, 79872
  v_mfma_f32_32x32x16_bf16 v[160:175], v[40:43], a[140:143], v[160:175]
  ds_read_b64_tr_b16 v[60:61], v6 offset:43008
  ds_read_b64_tr_b16 v[62:63], v6 offset:43264
  s_mov_b32 vcc_lo, 0xff
  s_mov_b32 vcc_hi, 0
  v_cndmask_b32 v77, v77, v74, vcc
  v_mfma_f32_32x32x16_bf16 v[144:159], v[44:47], a[136:139], v[144:159]
  s_mov_b32 vcc_lo, 0xffff0000
  s_mov_b32 vcc_hi, 15
  v_cndmask_b32 v77, v77, v75, vcc
  s_mov_b32 vcc_lo, 0
  s_mov_b32 vcc_hi, 0xfffff0
  v_cndmask_b32 v90, v77, v76, vcc
  v_mfma_f32_32x32x16_bf16 v[176:191], v[44:47], a[140:143], v[176:191]
  s_mul_i32 s32, s3, 6144
  s_add_u32 s32, s32, 65536
  v_add_u32 v20, s32, v14
  s_add_u32 s32, s32, 1024
  v_add_u32 v21, s32, v21
  s_waitcnt lgkmcnt(4)
  v_mfma_f32_32x32x16_bf16 v[128:143], v[48:51], a[144:147], v[128:143]
  s_waitcnt vmcnt(21) lgkmcnt(0)
  s_barrier
  ds_read_b64_tr_b16 v[40:41], v4 offset:49152
  ds_read_b64_tr_b16 v[42:43], v4 offset:49408
  v_mul_u32_u24 v74, 10240, v73
  v_sub_u32 v74, v12, v74
  v_mfma_f32_32x32x16_bf16 v[160:175], v[48:51], a[148:151], v[160:175]
  buffer_load_dwordx4 v2, s[44:47], s77 offen offset:1024 lds
  s_add_u32 s77, s5, 97280
  s_lshl_b32 s94, s92, 6
  v_add_u32 v75, s94, v74
  v_mfma_f32_16x16x32_bf16 v[24:27], v[32:35], v[48:51], v[24:27]
  v_subrev_u32 v76, 320, v75
  v_mfma_f32_32x32x16_bf16 v[144:159], v[52:55], a[144:147], v[144:159]
  ds_read_b64_tr_b16 v[44:45], v4 offset:51200
  ds_read_b64_tr_b16 v[46:47], v4 offset:51456
  v_min_u32 v75, v75, v76
  s_add_u32 m0, s61, 67584
  v_mul_u32_u24 v76, 320, v73
  v_add_u32 v75, v75, v76
  v_mfma_f32_32x32x16_bf16 v[176:191], v[52:55], a[148:151], v[176:191]
  v_mov_b32 v76, 640
  v_cmp_gt_u32 vcc, 320, v74
  s_add_u32 s32, s32, 512
  s_lshr_b32 s94, s3, 1
  v_cndmask_b32 v75, v76, v75, vcc
  v_add_u32 v22, s32, v75
  v_mfma_f32_16x16x32_bf16 v[28:31], v[32:35], v[52:55], v[28:31]
  v_and_b32 v8, 0x10df, v4
  v_mfma_f32_32x32x16_bf16 v[128:143], v[56:59], a[152:155], v[128:143]
  ds_read_b64_tr_b16 v[48:49], v6 offset:49152
  ds_read_b64_tr_b16 v[50:51], v6 offset:49408
  buffer_load_dwordx4 v2, s[44:47], s5 offen offset:0 lds
  v_lshl_add_u32 v8, v73, 9, v8
  v_mfma_f32_32x32x16_bf16 v[160:175], v[56:59], a[156:159], v[160:175]
  v_bfe_u32 v74, v0, 4, 1
  v_lshl_add_u32 v8, v74, 13, v8
  v_xor_b32 v74, s94, v74
  v_lshl_add_u32 v8, v74, 5, v8
  v_add_u32 v8, 65536, v8
  v_xor_b32 v9, 4096, v8
  v_mfma_f32_32x32x16_bf16 v[144:159], v[60:63], a[152:155], v[144:159]
  ds_read_b64_tr_b16 v[52:53], v6 offset:51200
  ds_read_b64_tr_b16 v[54:55], v6 offset:51456
  v_lshlrev_b32 v73, 2, v73
  v_sub_u32 v73, v72, v73
  v_mov_b32 v74, 0xf149f2ca
  v_mfma_f32_32x32x16_bf16 v[176:191], v[60:63], a[156:159], v[176:191]
  v_cmp_le_i32 vcc, 0, v73
  v_cmp_le_i32 s[0:1], 1, v73
  s_nop 0
  v_cndmask_b32 v96, v74, 0, vcc
  v_cndmask_b32 v97, v74, 0, s[0:1]
  s_waitcnt lgkmcnt(4)
  v_mfma_f32_32x32x16_bf16 v[128:143], v[40:43], a[160:163], v[128:143]
  ds_read_b64_tr_b16 v[56:57], v4 offset:57344
  ds_read_b64_tr_b16 v[58:59], v4 offset:57600
  buffer_load_dword v11, v93, s[24:27], s95 offen offset:0 sc1
  v_mfma_f32_32x32x16_bf16 v[160:175], v[40:43], a[164:167], v[160:175]
  buffer_load_dwordx4 v2, s[44:47], s77 offen offset:1024 lds
  v_add_u32 v2, 23552, v1
  v_mfma_f32_16x16x32_bf16 v[24:27], v[32:35], v[40:43], v[24:27]
  v_mfma_f32_32x32x16_bf16 v[144:159], v[44:47], a[160:163], v[144:159]
  ds_read_b64_tr_b16 v[60:61], v4 offset:59392
  ds_read_b64_tr_b16 v[62:63], v4 offset:59648
  s_add_u32 m0, s61, 32768
  v_mfma_f32_32x32x16_bf16 v[176:191], v[44:47], a[164:167], v[176:191]
  v_cmp_le_i32 vcc, 2, v73
  v_cmp_le_i32 s[0:1], 3, v73
  s_nop 0
  v_cndmask_b32 v98, v74, 0, vcc
  v_cndmask_b32 v99, v74, 0, s[0:1]
  v_mfma_f32_16x16x32_bf16 v[28:31], v[32:35], v[44:47], v[28:31]
  s_waitcnt lgkmcnt(4)
  v_mfma_f32_32x32x16_bf16 v[128:143], v[48:51], a[168:171], v[128:143]
  ds_read_b64_tr_b16 v[40:41], v6 offset:57344
  ds_read_b64_tr_b16 v[42:43], v6 offset:57600
  buffer_load_dwordx4 v1, s[36:39], s14 offen offset:0 lds
  v_mfma_f32_32x32x16_bf16 v[160:175], v[48:51], a[172:175], v[160:175]
  ds_read_b64_tr_b16 v[44:45], v6 offset:59392
  ds_read_b64_tr_b16 v[46:47], v6 offset:59648
  buffer_load_dwordx4 v2, s[36:39], s14 offen offset:1024 lds
  v_mfma_f32_32x32x16_bf16 v[144:159], v[52:55], a[168:171], v[144:159]
  s_add_u32 m0, s61, 34816
  v_cmp_le_i32 vcc, 8, v73
  v_cmp_le_i32 s[0:1], 9, v73
  s_nop 0
  v_cndmask_b32 v100, v74, 0, vcc
  v_cndmask_b32 v101, v74, 0, s[0:1]
  v_mfma_f32_32x32x16_bf16 v[176:191], v[52:55], a[172:175], v[176:191]
  buffer_load_dwordx4 v1, s[40:43], s14 offen offset:0 lds
  s_waitcnt lgkmcnt(4)
  v_mfma_f32_32x32x16_bf16 v[128:143], v[56:59], a[176:179], v[128:143]
  s_waitcnt vmcnt(12) lgkmcnt(0)
  s_barrier
  ds_read_b64_tr_b16 v[48:49], v4 offset:0
  ds_read_b64_tr_b16 v[50:51], v4 offset:256
  v_mfma_f32_32x32x16_bf16 v[160:175], v[56:59], a[180:183], v[160:175]
  buffer_store_dword v0, v17, s[24:27], s79 offen sc1
  v_mfma_f32_16x16x32_bf16 v[24:27], v[32:35], v[56:59], v[24:27]
  v_mfma_f32_32x32x16_bf16 v[144:159], v[60:63], a[176:179], v[144:159]
  ds_read_b64_tr_b16 v[52:53], v4 offset:2048
  ds_read_b64_tr_b16 v[54:55], v4 offset:2304
  buffer_load_dwordx4 v2, s[40:43], s14 offen offset:1024 lds
  s_and_b32 s77, s3, 2
  v_mfma_f32_32x32x16_bf16 v[176:191], v[60:63], a[180:183], v[176:191]
  s_lshl_b32 s77, s77, 4
  v_lshrrev_b32 v2, 5, v0
  v_mul_u32_u24 v2, 24512, v2
  v_xad_u32 v2, v1, s77, v2
  v_add_u32 v2, s58, v2
  s_add_u32 s77, s6, 97280
  v_mfma_f32_16x16x32_bf16 v[28:31], v[32:35], v[60:63], v[28:31]
  s_add_u32 m0, s61, 81920
  v_mfma_f32_32x32x16_bf16 v[128:143], v[40:43], a[184:187], v[128:143]
  ds_read_b64_tr_b16 v[56:57], v6 offset:0
  ds_read_b64_tr_b16 v[58:59], v6 offset:256
  buffer_load_dwordx4 v2, s[44:47], s6 offen offset:0 lds
  v_mfma_f32_32x32x16_bf16 v[160:175], v[40:43], a[188:191], v[160:175]
  v_cmp_le_i32 vcc, 10, v73
  v_cmp_le_i32 s[0:1], 11, v73
  s_nop 0
  v_cndmask_b32 v102, v74, 0, vcc
  v_cndmask_b32 v103, v74, 0, s[0:1]
  v_mfma_f32_32x32x16_bf16 v[144:159], v[44:47], a[184:187], v[144:159]
  ds_read_b64_tr_b16 v[60:61], v6 offset:2048
  ds_read_b64_tr_b16 v[62:63], v6 offset:2304
  v_mfma_f32_32x32x16_bf16 v[176:191], v[44:47], a[188:191], v[176:191]
  buffer_load_dwordx4 v2, s[44:47], s77 offen offset:1024 lds
  s_add_u32 s77, s7, 97280
  s_waitcnt lgkmcnt(4)
  v_mfma_f32_32x32x16_bf16 v[128:143], v[48:51], a[192:195], v[128:143]
  ds_read_b64_tr_b16 v[40:41], v4 offset:8192
  ds_read_b64_tr_b16 v[42:43], v4 offset:8448
  v_mov_b32 v64, -1
  v_mov_b32 v65, -1
  v_mov_b32 v66, -1
  v_mov_b32 v67, -1
  v_mfma_f32_32x32x16_bf16 v[160:175], v[48:51], a[196:199], v[160:175]
  s_sub_u32 s65, s85, 8
  s_cmp_eq_u32 s92, 0
  s_cselect_b32 s65, s83, s65
  s_add_u32 m0, s61, 83968
  v_mfma_f32_16x16x32_bf16 v[24:27], v[32:35], v[48:51], v[24:27]
  v_mfma_f32_32x32x16_bf16 v[144:159], v[52:55], a[192:195], v[144:159]
  ds_read_b64_tr_b16 v[44:45], v4 offset:10240
  ds_read_b64_tr_b16 v[46:47], v4 offset:10496
  buffer_load_dwordx4 v2, s[44:47], s7 offen offset:0 lds
  v_mfma_f32_32x32x16_bf16 v[176:191], v[52:55], a[196:199], v[176:191]
  s_mov_b32 exec_hi, 0
  buffer_store_dwordx4 v[64:67], v13, s[24:27], s65 offen sc1
  s_mov_b32 exec_hi, -1
  v_mfma_f32_16x16x32_bf16 v[28:31], v[32:35], v[52:55], v[28:31]
  s_waitcnt lgkmcnt(4)
  v_mfma_f32_32x32x16_bf16 v[128:143], v[56:59], a[200:203], v[128:143]
  ds_read_b64_tr_b16 v[48:49], v6 offset:8192
  ds_read_b64_tr_b16 v[50:51], v6 offset:8448
  v_mfma_f32_32x32x16_bf16 v[160:175], v[56:59], a[204:207], v[160:175]
  ds_read_b64_tr_b16 v[52:53], v6 offset:10240
  ds_read_b64_tr_b16 v[54:55], v6 offset:10496
  v_mfma_f32_32x32x16_bf16 v[144:159], v[60:63], a[200:203], v[144:159]
  buffer_load_dwordx4 v2, s[44:47], s77 offen offset:1024 lds
  v_add_u32 v2, 23552, v1
  v_mfma_f32_32x32x16_bf16 v[176:191], v[60:63], a[204:207], v[176:191]
  buffer_store_dwordx4 v[64:67], v13, s[24:27], s82 offen sc1
  s_waitcnt lgkmcnt(4)
  v_mfma_f32_32x32x16_bf16 v[128:143], v[40:43], a[208:211], v[128:143]
  s_waitcnt vmcnt(16) lgkmcnt(0)
  s_barrier
  ds_read_b64_tr_b16 v[56:57], v4 offset:16384
  ds_read_b64_tr_b16 v[58:59], v4 offset:16640
  s_add_u32 m0, s61, 49152
  v_mfma_f32_32x32x16_bf16 v[160:175], v[40:43], a[212:215], v[160:175]
  v_cmp_le_i32 vcc, 16, v73
  v_cmp_le_i32 s[0:1], 17, v73
  s_nop 0
  v_cndmask_b32 v104, v74, 0, vcc
  v_cndmask_b32 v105, v74, 0, s[0:1]
  v_mfma_f32_16x16x32_bf16 v[24:27], v[32:35], v[40:43], v[24:27]
  v_mfma_f32_32x32x16_bf16 v[144:159], v[44:47], a[208:211], v[144:159]
  ds_read_b64_tr_b16 v[60:61], v4 offset:18432
  ds_read_b64_tr_b16 v[62:63], v4 offset:18688
  buffer_load_dwordx4 v1, s[36:39], s15 offen offset:0 lds
  v_mfma_f32_32x32x16_bf16 v[176:191], v[44:47], a[212:215], v[176:191]
  buffer_load_dwordx4 v2, s[36:39], s15 offen offset:1024 lds
  v_mfma_f32_16x16x32_bf16 v[28:31], v[32:35], v[44:47], v[28:31]
  s_add_u32 m0, s61, 51200
  v_mfma_f32_32x32x16_bf16 v[128:143], v[48:51], a[216:219], v[128:143]
  ds_read_b64_tr_b16 v[40:41], v6 offset:16384
  ds_read_b64_tr_b16 v[42:43], v6 offset:16640
  v_mfma_f32_32x32x16_bf16 v[160:175], v[48:51], a[220:223], v[160:175]
  buffer_load_dwordx4 v1, s[40:43], s15 offen offset:0 lds
  v_mfma_f32_32x32x16_bf16 v[144:159], v[52:55], a[216:219], v[144:159]
  ds_read_b64_tr_b16 v[44:45], v6 offset:18432
  ds_read_b64_tr_b16 v[46:47], v6 offset:18688
  v_mfma_f32_32x32x16_bf16 v[176:191], v[52:55], a[220:223], v[176:191]
  buffer_load_dwordx4 v2, s[40:43], s15 offen offset:1024 lds
  s_waitcnt lgkmcnt(4)
  v_mfma_f32_32x32x16_bf16 v[128:143], v[56:59], a[224:227], v[128:143]
  ds_read_b64_tr_b16 v[48:49], v4 offset:24576
  ds_read_b64_tr_b16 v[50:51], v4 offset:24832
  v_mfma_f32_32x32x16_bf16 v[160:175], v[56:59], a[228:231], v[160:175]
  buffer_store_dwordx4 v[64:67], v13, s[24:27], s84 offen sc1
  v_mfma_f32_16x16x32_bf16 v[24:27], v[32:35], v[56:59], v[24:27]
  v_mfma_f32_32x32x16_bf16 v[144:159], v[60:63], a[224:227], v[144:159]
  ds_read_b64_tr_b16 v[52:53], v4 offset:26624
  ds_read_b64_tr_b16 v[54:55], v4 offset:26880
  v_mfma_f32_32x32x16_bf16 v[176:191], v[60:63], a[228:231], v[176:191]
  v_cmp_le_i32 vcc, 18, v73
  v_cmp_le_i32 s[0:1], 19, v73
  s_nop 0
  v_cndmask_b32 v106, v74, 0, vcc
  v_cndmask_b32 v107, v74, 0, s[0:1]
  v_mfma_f32_16x16x32_bf16 v[28:31], v[32:35], v[60:63], v[28:31]
  s_waitcnt lgkmcnt(4)
  v_mfma_f32_32x32x16_bf16 v[128:143], v[40:43], a[232:235], v[128:143]
  ds_read_b64_tr_b16 v[56:57], v6 offset:24576
  ds_read_b64_tr_b16 v[58:59], v6 offset:24832
  s_waitcnt vmcnt(17)
  v_cmp_eq_u32 vcc, 0, v11
  s_cbranch_vccnz .slow29
.back30:
  v_mfma_f32_32x32x16_bf16 v[160:175], v[40:43], a[236:239], v[160:175]
  ds_read_b64_tr_b16 v[60:61], v6 offset:26624
  ds_read_b64_tr_b16 v[62:63], v6 offset:26880
  v_mfma_f32_32x32x16_bf16 v[144:159], v[44:47], a[232:235], v[144:159]
  v_cmp_le_i32 vcc, 24, v73
  v_cmp_le_i32 s[0:1], 25, v73
  s_nop 0
  v_cndmask_b32 v108, v74, 0, vcc
  v_cndmask_b32 v109, v74, 0, s[0:1]
  v_mfma_f32_32x32x16_bf16 v[176:191], v[44:47], a[236:239], v[176:191]
  v_cmp_le_i32 vcc, 26, v73
  v_cmp_le_i32 s[0:1], 27, v73
  s_nop 0
  v_cndmask_b32 v110, v74, 0, vcc
  v_cndmask_b32 v111, v74, 0, s[0:1]
  s_waitcnt lgkmcnt(4)
  v_mfma_f32_32x32x16_bf16 v[128:143], v[48:51], a[240:243], v[128:143]
  s_waitcnt vmcnt(11) lgkmcnt(0)
  s_barrier
  ds_read_b64_tr_b16 v[40:41], v4 offset:32768
  ds_read_b64_tr_b16 v[42:43], v4 offset:33024
  s_add_u32 s56, s91, 0
  s_and_b32 s56, s56, 7
  v_mfma_f32_32x32x16_bf16 v[160:175], v[48:51], a[244:247], v[160:175]
  s_mul_i32 s56, s56, 5120
  s_add_u32 s56, s56, s59
  s_add_u32 m0, s63, 0
  s_lshl2_add_u32 s94, s10, s3
  s_lshl_b32 s94, s94, 5
  s_add_u32 s94, s94, 6144
  v_mfma_f32_16x16x32_bf16 v[24:27], v[32:35], v[48:51], v[24:27]
  s_lshr_b32 s32, s10, 2
  v_mfma_f32_32x32x16_bf16 v[144:159], v[52:55], a[240:243], v[144:159]
  ds_read_b64_tr_b16 v[44:45], v4 offset:34816
  ds_read_b64_tr_b16 v[46:47], v4 offset:35072
  buffer_load_dwordx4 v14, s[24:27], s56 offen offset:0 sc1 lds
  s_lshl_b32 s32, s32, 1
  v_mfma_f32_32x32x16_bf16 v[176:191], v[52:55], a[244:247], v[176:191]
  buffer_load_dwordx4 v14, s[24:27], s56 offen offset:1024 sc1 lds
  s_and_b32 s35, s10, 1
  s_add_u32 s32, s32, s35
  s_xor_b32 s35, s3, 1
  v_mfma_f32_16x16x32_bf16 v[28:31], v[32:35], v[52:55], v[28:31]
  s_lshl2_add_u32 s32, s32, s35
  v_mfma_f32_32x32x16_bf16 v[128:143], v[56:59], a[248:251], v[128:143]
  ds_read_b64_tr_b16 v[48:49], v6 offset:32768
  ds_read_b64_tr_b16 v[50:51], v6 offset:33024
  buffer_load_dwordx4 v14, s[24:27], s56 offen offset:2048 sc1 lds
  s_lshl_b32 s32, s32, 5
  v_mfma_f32_32x32x16_bf16 v[160:175], v[56:59], a[252:255], v[160:175]
  s_and_b32 s35, s10, 2
  s_lshl1_add_u32 s32, s35, s32
  s_add_u32 s32, s32, 2048
  v_and_b32 v72, 7, v0
  v_lshl_add_u32 v23, v72, 2, s94
  v_and_b32 v72, 3, v0
  v_mfma_f32_32x32x16_bf16 v[144:159], v[60:63], a[248:251], v[144:159]
  ds_read_b64_tr_b16 v[52:53], v6 offset:34816
  ds_read_b64_tr_b16 v[54:55], v6 offset:35072
  buffer_load_dwordx4 v14, s[24:27], s56 offen offset:3072 sc1 lds
  s_add_u32 s56, s56, 4096
  v_mfma_f32_32x32x16_bf16 v[176:191], v[60:63], a[252:255], v[176:191]
  s_add_u32 m0, s63, 4096
  v_lshl_add_u32 v72, v72, 3, s32
  v_bfe_u32 v73, v0, 2, 1
  v_lshl_add_u32 v72, v73, 11, v72
  s_waitcnt lgkmcnt(4)
  v_mfma_f32_32x32x16_bf16 v[128:143], v[40:43], v[192:195], v[128:143]
  ds_read_b64_tr_b16 v[56:57], v4 offset:40960
  ds_read_b64_tr_b16 v[58:59], v4 offset:41216
  buffer_load_dwordx4 v14, s[24:27], s56 offen sc1 lds
  v_mfma_f32_32x32x16_bf16 v[160:175], v[40:43], v[196:199], v[160:175]
  s_mov_b32 vcc_lo, 0
  s_mov_b32 vcc_hi, -1
  v_cndmask_b32 v23, v23, v72, vcc
  s_sub_u32 s94, s94, 4096
  v_mfma_f32_16x16x32_bf16 v[24:27], v[32:35], v[40:43], v[24:27]
  v_mfma_f32_32x32x16_bf16 v[144:159], v[44:47], v[192:195], v[144:159]
  ds_read_b64_tr_b16 v[60:61], v4 offset:43008
  ds_read_b64_tr_b16 v[62:63], v4 offset:43264
  v_mfma_f32_32x32x16_bf16 v[176:191], v[44:47], v[196:199], v[176:191]
  v_mfma_f32_16x16x32_bf16 v[28:31], v[32:35], v[44:47], v[28:31]
  s_waitcnt lgkmcnt(4)
  v_mfma_f32_32x32x16_bf16 v[128:143], v[48:51], v[200:203], v[128:143]
  ds_read_b64_tr_b16 v[40:41], v6 offset:40960
  ds_read_b64_tr_b16 v[42:43], v6 offset:41216
  v_mfma_f32_32x32x16_bf16 v[160:175], v[48:51], v[204:207], v[160:175]
  ds_read_b64_tr_b16 v[44:45], v6 offset:43008
  ds_read_b64_tr_b16 v[46:47], v6 offset:43264
  v_mfma_f32_32x32x16_bf16 v[144:159], v[52:55], v[200:203], v[144:159]
  v_mfma_f32_32x32x16_bf16 v[176:191], v[52:55], v[204:207], v[176:191]
  s_waitcnt lgkmcnt(4)
  v_mfma_f32_32x32x16_bf16 v[128:143], v[56:59], v[208:211], v[128:143]
  s_waitcnt vmcnt(6) lgkmcnt(0)
  s_barrier
  ds_read_b64_tr_b16 v[48:49], v4 offset:49152
  ds_read_b64_tr_b16 v[50:51], v4 offset:49408
  s_add_u32 s56, s91, 1
  s_and_b32 s56, s56, 7
  v_mfma_f32_32x32x16_bf16 v[160:175], v[56:59], v[212:215], v[160:175]
  s_mul_i32 s56, s56, 5120
  s_add_u32 s56, s56, s59
  s_add_u32 m0, s63, 20480
  v_mfma_f32_16x16x32_bf16 v[24:27], v[32:35], v[56:59], v[24:27]
  v_mfma_f32_32x32x16_bf16 v[144:159], v[60:63], v[208:211], v[144:159]
  ds_read_b64_tr_b16 v[52:53], v4 offset:51200
  ds_read_b64_tr_b16 v[54:55], v4 offset:51456
  buffer_load_dwordx4 v14, s[24:27], s56 offen offset:0 sc1 lds
  v_mfma_f32_32x32x16_bf16 v[176:191], v[60:63], v[212:215], v[176:191]
  buffer_load_dwordx4 v14, s[24:27], s56 offen offset:1024 sc1 lds
  v_mfma_f32_16x16x32_bf16 v[28:31], v[32:35], v[60:63], v[28:31]
  v_mfma_f32_32x32x16_bf16 v[128:143], v[40:43], v[216:219], v[128:143]
  ds_read_b64_tr_b16 v[56:57], v6 offset:49152
  ds_read_b64_tr_b16 v[58:59], v6 offset:49408
  buffer_load_dwordx4 v14, s[24:27], s56 offen offset:2048 sc1 lds
  v_mfma_f32_32x32x16_bf16 v[160:175], v[40:43], v[220:223], v[160:175]
  v_mfma_f32_32x32x16_bf16 v[144:159], v[44:47], v[216:219], v[144:159]
  ds_read_b64_tr_b16 v[60:61], v6 offset:51200
  ds_read_b64_tr_b16 v[62:63], v6 offset:51456
  buffer_load_dwordx4 v14, s[24:27], s56 offen offset:3072 sc1 lds
  s_add_u32 s56, s56, 4096
  v_mfma_f32_32x32x16_bf16 v[176:191], v[44:47], v[220:223], v[176:191]
  s_add_u32 m0, s63, 24576
  s_waitcnt lgkmcnt(4)
  v_mfma_f32_32x32x16_bf16 v[128:143], v[48:51], v[224:227], v[128:143]
  ds_read_b64_tr_b16 v[40:41], v4 offset:57344
  ds_read_b64_tr_b16 v[42:43], v4 offset:57600
  buffer_load_dwordx4 v14, s[24:27], s56 offen sc1 lds
  v_mfma_f32_32x32x16_bf16 v[160:175], v[48:51], v[228:231], v[160:175]
  v_mfma_f32_16x16x32_bf16 v[24:27], v[32:35], v[48:51], v[24:27]
  v_mfma_f32_32x32x16_bf16 v[144:159], v[52:55], v[224:227], v[144:159]
  ds_read_b64_tr_b16 v[44:45], v4 offset:59392
  ds_read_b64_tr_b16 v[46:47], v4 offset:59648
  v_mfma_f32_32x32x16_bf16 v[176:191], v[52:55], v[228:231], v[176:191]
  v_mfma_f32_16x16x32_bf16 v[28:31], v[32:35], v[52:55], v[28:31]
  s_waitcnt lgkmcnt(4)
  v_mfma_f32_32x32x16_bf16 v[128:143], v[56:59], v[232:235], v[128:143]
  ds_read_b64_tr_b16 v[48:49], v6 offset:57344
  ds_read_b64_tr_b16 v[50:51], v6 offset:57600
  v_mfma_f32_32x32x16_bf16 v[160:175], v[56:59], v[236:239], v[160:175]
  ds_read_b64_tr_b16 v[52:53], v6 offset:59392
  ds_read_b64_tr_b16 v[54:55], v6 offset:59648
  v_mfma_f32_32x32x16_bf16 v[144:159], v[60:63], v[232:235], v[144:159]
  v_mfma_f32_32x32x16_bf16 v[176:191], v[60:63], v[236:239], v[176:191]
  s_waitcnt lgkmcnt(4)
  v_mfma_f32_32x32x16_bf16 v[128:143], v[40:43], v[240:243], v[128:143]
  s_waitcnt lgkmcnt(0)
  s_barrier
  ds_read_b64_tr_b16 v[56:57], v8 offset:0
  ds_read_b64_tr_b16 v[58:59], v8 offset:256
  s_add_u32 s56, s91, 2
  s_and_b32 s56, s56, 7
  v_mfma_f32_32x32x16_bf16 v[160:175], v[40:43], v[244:247], v[160:175]
  s_mul_i32 s56, s56, 5120
  s_add_u32 s56, s56, s59
  s_add_u32 m0, s63, 40960
  v_mov_b32 v4, v88
  v_mov_b32 v5, v89
  v_mov_b32 v6, v90
  v_mfma_f32_16x16x32_bf16 v[24:27], v[32:35], v[40:43], v[24:27]
  v_mov_b32 v7, v91
  v_mfma_f32_32x32x16_bf16 v[144:159], v[44:47], v[240:243], v[144:159]
  ds_read_b64_tr_b16 v[60:61], v9 offset:0
  ds_read_b64_tr_b16 v[62:63], v9 offset:256
  buffer_load_dwordx4 v14, s[24:27], s56 offen offset:0 sc1 lds
  v_mfma_f32_32x32x16_bf16 v[176:191], v[44:47], v[244:247], v[176:191]
  buffer_load_dwordx4 v14, s[24:27], s56 offen offset:1024 sc1 lds
  v_mfma_f32_16x16x32_bf16 v[28:31], v[32:35], v[44:47], v[28:31]
  v_mfma_f32_32x32x16_bf16 v[128:143], v[48:51], v[248:251], v[128:143]
  ds_read_b64_tr_b16 v[40:41], v8 offset:1024
  ds_read_b64_tr_b16 v[42:43], v8 offset:1280
  buffer_load_dwordx4 v14, s[24:27], s56 offen offset:2048 sc1 lds
  v_mov_b32_dpp v32, v32 quad_perm:[3,0,1,2] row_mask:0xf bank_mask:0xf
  v_mfma_f32_32x32x16_bf16 v[160:175], v[48:51], v[252:255], v[160:175]
  v_mov_b32_dpp v33, v33 quad_perm:[3,0,1,2] row_mask:0xf bank_mask:0xf
  v_mov_b32_dpp v34, v34 quad_perm:[3,0,1,2] row_mask:0xf bank_mask:0xf
  v_mov_b32_dpp v35, v35 quad_perm:[3,0,1,2] row_mask:0xf bank_mask:0xf
  v_cvt_pk_bf16_f32 v124, v25, v25
  v_cvt_pk_bf16_f32 v125, v29, v29
  v_lshlrev_b32 v124, 16, v124
  v_mfma_f32_32x32x16_bf16 v[144:159], v[52:55], v[248:251], v[144:159]
  ds_read_b64_tr_b16 v[44:45], v9 offset:1024
  ds_read_b64_tr_b16 v[46:47], v9 offset:1280
  buffer_load_dwordx4 v14, s[24:27], s56 offen offset:3072 sc1 lds
  s_add_u32 s56, s56, 4096
  v_mfma_f32_32x32x16_bf16 v[176:191], v[52:55], v[252:255], v[176:191]
  s_add_u32 m0, s63, 45056
  v_lshlrev_b32 v125, 16, v125
  v_sub_f32 v124, v25, v124
  v_sub_f32 v125, v29, v125
  v_cvt_pk_bf16_f32 v124, v25, v124
  s_waitcnt lgkmcnt(4)
  v_mfma_f32_32x32x16_bf16 v[64:79], v[56:59], a[0:3], 0
  ds_read_b64_tr_b16 v[48:49], v8 offset:2048
  ds_read_b64_tr_b16 v[50:51], v8 offset:2304
  buffer_load_dwordx4 v14, s[24:27], s56 offen sc1 lds
  v_cvt_pk_bf16_f32 v125, v29, v125
  v_mfma_f32_32x32x16_bf16 v[80:95], v[56:59], a[4:7], 0
  ds_write2_b32 v15, v124, v125 offset0:0 offset1:32
  v_mfma_f32_16x16x32_bf16 v[24:27], v[32:35], v[56:59], v[24:27]
  v_mfma_f32_32x32x16_bf16 v[64:79], v[60:63], a[8:11], v[64:79]
  ds_read_b64_tr_b16 v[52:53], v9 offset:2048
  ds_read_b64_tr_b16 v[54:55], v9 offset:2304
  buffer_load_dword v11, v10, s[24:27], s95 offen offset:1024 sc1
  v_mfma_f32_32x32x16_bf16 v[80:95], v[60:63], a[12:15], v[80:95]
  buffer_load_dwordx4 a[0:3], v14, s[24:27], s74 offen offset:0 sc1
  s_waitcnt lgkmcnt(5)
  v_mfma_f32_32x32x16_bf16 v[64:79], v[40:43], a[16:19], v[64:79]
  ds_read_b64_tr_b16 v[56:57], v8 offset:3072
  ds_read_b64_tr_b16 v[58:59], v8 offset:3328
  buffer_load_dwordx4 a[4:7], v14, s[24:27], s74 offen offset:1024 sc1
  v_mfma_f32_32x32x16_bf16 v[80:95], v[40:43], a[20:23], v[80:95]
  ds_read_b64_tr_b16 v[60:61], v9 offset:3072
  ds_read_b64_tr_b16 v[62:63], v9 offset:3328
  v_mfma_f32_16x16x32_bf16 v[24:27], v[32:35], v[40:43], v[24:27]
  v_mfma_f32_32x32x16_bf16 v[64:79], v[44:47], a[24:27], v[64:79]
  buffer_load_dwordx4 a[8:11], v14, s[24:27], s74 offen offset:2048 sc1
  v_mfma_f32_32x32x16_bf16 v[80:95], v[44:47], a[28:31], v[80:95]
  s_waitcnt lgkmcnt(4)
  v_mfma_f32_32x32x16_bf16 v[64:79], v[48:51], a[32:35], v[64:79]
  s_waitcnt lgkmcnt(0)
  s_barrier
  ds_read_b64_tr_b16 v[40:41], v8 offset:16384
  ds_read_b64_tr_b16 v[42:43], v8 offset:16640
  ds_read2_b32 v[124:125], v16 offset0:0 offset1:32
  ds_read2_b32 v[126:127], v16 offset0:32 offset1:0
  v_mfma_f32_32x32x16_bf16 v[80:95], v[48:51], a[36:39], v[80:95]
  s_mul_i32 s33, s10, 278528
  s_lshl_b32 s32, s3, 13
  s_add_u32 s33, s33, s32
  s_add_u32 s33, s33, 8388608
  v_mfma_f32_16x16x32_bf16 v[24:27], v[32:35], v[48:51], v[24:27]
  v_mfma_f32_32x32x16_bf16 v[64:79], v[52:55], a[40:43], v[64:79]
  ds_read_b64_tr_b16 v[44:45], v9 offset:16384
  ds_read_b64_tr_b16 v[46:47], v9 offset:16640
  s_waitcnt lgkmcnt(2)
  buffer_load_dwordx4 a[12:15], v14, s[24:27], s74 offen offset:3072 sc1
  v_mfma_f32_32x32x16_bf16 v[80:95], v[52:55], a[44:47], v[80:95]
  s_add_u32 s74, s74, 4096
  buffer_load_dwordx4 a[16:19], v14, s[24:27], s74 offen offset:0 sc1
  v_mfma_f32_32x32x8_bf16 v[128:143], v[124:125], v[36:37], v[128:143]
  v_mfma_f32_32x32x8_bf16 v[144:159], v[126:127], v[36:37], v[144:159]
  buffer_load_dwordx4 a[20:23], v14, s[24:27], s74 offen offset:1024 sc1
  v_mfma_f32_32x32x8_bf16 v[160:175], v[124:125], v[38:39], v[160:175]
  v_mfma_f32_32x32x8_bf16 v[176:191], v[126:127], v[38:39], v[176:191]
  buffer_load_dwordx4 a[24:27], v14, s[24:27], s74 offen offset:2048 sc1
  v_mfma_f32_32x32x16_bf16 v[64:79], v[56:59], a[48:51], v[64:79]
  ds_read_b64_tr_b16 v[48:49], v8 offset:17408
  ds_read_b64_tr_b16 v[50:51], v8 offset:17664
  v_mfma_f32_32x32x16_bf16 v[80:95], v[56:59], a[52:55], v[80:95]
  buffer_load_dwordx4 a[28:31], v14, s[24:27], s74 offen offset:3072 sc1
  s_add_u32 s74, s74, 4096
  v_mfma_f32_16x16x32_bf16 v[24:27], v[32:35], v[56:59], v[24:27]
  v_max_f32 v128, 0, v128
  v_mfma_f32_32x32x16_bf16 v[64:79], v[60:63], a[56:59], v[64:79]
  ds_read_b64_tr_b16 v[52:53], v9 offset:17408
  ds_read_b64_tr_b16 v[54:55], v9 offset:17664
  v_max_f32 v129, 0, v129
  v_mul_f32 v144, v144, v18
  v_mul_f32 v145, v145, v18
  v_max_f32 v130, 0, v130
  v_mfma_f32_32x32x16_bf16 v[80:95], v[60:63], a[60:63], v[80:95]
  v_max_f32 v131, 0, v131
  v_mul_f32 v146, v146, v18
  v_mul_f32 v147, v147, v18
  v_mul_f32 v128, v128, v144
  v_mul_f32 v129, v129, v145
  s_waitcnt lgkmcnt(4)
  v_mfma_f32_32x32x16_bf16 v[64:79], v[40:43], a[64:67], v[64:79]
  ds_read_b64_tr_b16 v[56:57], v8 offset:18432
  ds_read_b64_tr_b16 v[58:59], v8 offset:18688
  v_cvt_pk_bf16_f32 v128, v128, v129
  v_max_f32 v132, 0, v132
  v_max_f32 v133, 0, v133
  v_mul_f32 v148, v148, v18
  v_mfma_f32_32x32x16_bf16 v[80:95], v[40:43], a[68:71], v[80:95]
  v_mul_f32 v149, v149, v18
  v_mul_f32 v130, v130, v146
  v_mul_f32 v131, v131, v147
  v_cvt_pk_bf16_f32 v129, v130, v131
  v_max_f32 v134, 0, v134
  v_max_f32 v135, 0, v135
  v_mfma_f32_16x16x32_bf16 v[24:27], v[32:35], v[40:43], v[24:27]
  v_mul_f32 v150, v150, v18
  v_mfma_f32_32x32x16_bf16 v[64:79], v[44:47], a[72:75], v[64:79]
  ds_read_b64_tr_b16 v[60:61], v9 offset:18432
  ds_read_b64_tr_b16 v[62:63], v9 offset:18688
  v_mul_f32 v151, v151, v18
  v_mul_f32 v132, v132, v148
  v_mul_f32 v133, v133, v149
  v_cvt_pk_bf16_f32 v130, v132, v133
  v_mfma_f32_32x32x16_bf16 v[80:95], v[44:47], a[76:79], v[80:95]
  v_max_f32 v136, 0, v136
  v_max_f32 v137, 0, v137
  v_mul_f32 v152, v152, v18
  v_mul_f32 v153, v153, v18
  v_mul_f32 v134, v134, v150
  s_waitcnt lgkmcnt(4)
  v_mfma_f32_32x32x16_bf16 v[64:79], v[48:51], a[80:83], v[64:79]
  ds_read_b64_tr_b16 v[40:41], v8 offset:19456
  ds_read_b64_tr_b16 v[42:43], v8 offset:19712
  v_mul_f32 v135, v135, v151
  v_cvt_pk_bf16_f32 v131, v134, v135
  v_max_f32 v138, 0, v138
  v_max_f32 v139, 0, v139
  v_mfma_f32_32x32x16_bf16 v[80:95], v[48:51], a[84:87], v[80:95]
  ds_read_b64_tr_b16 v[44:45], v9 offset:19456
  ds_read_b64_tr_b16 v[46:47], v9 offset:19712
  v_mul_f32 v154, v154, v18
  v_mul_f32 v155, v155, v18
  v_mul_f32 v136, v136, v152
  v_mul_f32 v137, v137, v153
  v_mfma_f32_16x16x32_bf16 v[24:27], v[32:35], v[48:51], v[24:27]
  v_cvt_pk_bf16_f32 v132, v136, v137
  v_mfma_f32_32x32x16_bf16 v[64:79], v[52:55], a[88:91], v[64:79]
  buffer_store_dwordx4 v[128:131], v13, s[24:27], s69 offen offset:0 sc1
  v_mfma_f32_32x32x16_bf16 v[80:95], v[52:55], a[92:95], v[80:95]
  v_max_f32 v140, 0, v140
  v_max_f32 v141, 0, v141
  v_mul_f32 v156, v156, v18
  v_mul_f32 v157, v157, v18
  v_mul_f32 v138, v138, v154
  s_waitcnt lgkmcnt(4)
  v_mfma_f32_32x32x16_bf16 v[64:79], v[56:59], a[96:99], v[64:79]
  s_waitcnt lgkmcnt(0)
  s_barrier
  ds_read_b64_tr_b16 v[48:49], v8 offset:32768
  ds_read_b64_tr_b16 v[50:51], v8 offset:33024
  v_mul_f32 v139, v139, v155
  v_cvt_pk_bf16_f32 v133, v138, v139
  v_mfma_f32_32x32x16_bf16 v[80:95], v[56:59], a[100:103], v[80:95]
  s_waitcnt vmcnt(9)
  v_cmp_eq_u32 vcc, 0, v11
  s_cbranch_vccnz .slow32
.back33:
  buffer_load_dwordx4 v[112:115], v4, s[24:27], s57 offen sc1
  v_mfma_f32_16x16x32_bf16 v[24:27], v[32:35], v[56:59], v[24:27]
  s_add_u32 m0, s64, 0
  v_mfma_f32_32x32x16_bf16 v[64:79], v[60:63], a[104:107], v[64:79]
  ds_read_b64_tr_b16 v[52:53], v9 offset:32768
  ds_read_b64_tr_b16 v[54:55], v9 offset:33024
  buffer_load_dwordx2 v[120:121], v7, s[24:27], s57 offen sc1
  v_max_f32 v142, 0, v142
  v_mfma_f32_32x32x16_bf16 v[80:95], v[60:63], a[108:111], v[80:95]
  buffer_load_dwordx4 v[116:119], v4, s[24:27], s76 offen sc1
  v_max_f32 v143, 0, v143
  v_mul_f32 v158, v158, v18
  v_mfma_f32_32x32x16_bf16 v[64:79], v[40:43], a[112:115], v[64:79]
  ds_read_b64_tr_b16 v[56:57], v8 offset:33792
  ds_read_b64_tr_b16 v[58:59], v8 offset:34048
  buffer_load_dwordx2 v[122:123], v7, s[24:27], s76 offen sc1
  v_mul_f32 v159, v159, v18
  v_mfma_f32_32x32x16_bf16 v[80:95], v[40:43], a[116:119], v[80:95]
  buffer_load_dwordx4 v4, s[24:27], s20 offen offset:0 sc1 lds
  v_mul_f32 v140, v140, v156
  v_mul_f32 v141, v141, v157
  v_cvt_pk_bf16_f32 v134, v140, v141
  v_mfma_f32_16x16x32_bf16 v[24:27], v[32:35], v[40:43], v[24:27]
  v_mul_f32 v142, v142, v158
  v_mfma_f32_32x32x16_bf16 v[64:79], v[44:47], a[120:123], v[64:79]
  ds_read_b64_tr_b16 v[60:61], v9 offset:33792
  ds_read_b64_tr_b16 v[62:63], v9 offset:34048
  v_mul_f32 v143, v143, v159
  v_cvt_pk_bf16_f32 v135, v142, v143
  v_max_f32 v160, 0, v160
  v_max_f32 v161, 0, v161
  v_mfma_f32_32x32x16_bf16 v[80:95], v[44:47], a[124:127], v[80:95]
  buffer_store_dwordx4 v[132:135], v13, s[24:27], s69 offen offset:512 sc1
  s_waitcnt lgkmcnt(4)
  v_mfma_f32_32x32x16_bf16 v[64:79], v[48:51], a[128:131], v[64:79]
  ds_read_b64_tr_b16 v[40:41], v8 offset:34816
  ds_read_b64_tr_b16 v[42:43], v8 offset:35072
  buffer_load_dwordx4 v5, s[24:27], s20 offen offset:1024 sc1 lds
  v_mul_f32 v176, v176, v19
  v_mfma_f32_32x32x16_bf16 v[80:95], v[48:51], a[132:135], v[80:95]
  buffer_load_dwordx4 v6, s[24:27], s20 offen offset:2048 sc1 lds
  s_add_u32 m0, s64, 12288
  v_mul_f32 v177, v177, v19
  v_max_f32 v162, 0, v162
  v_mfma_f32_16x16x32_bf16 v[24:27], v[32:35], v[48:51], v[24:27]
  v_max_f32 v163, 0, v163
  v_mfma_f32_32x32x16_bf16 v[64:79], v[52:55], a[136:139], v[64:79]
  ds_read_b64_tr_b16 v[44:45], v9 offset:34816
  ds_read_b64_tr_b16 v[46:47], v9 offset:35072
  buffer_load_dwordx4 v4, s[24:27], s21 offen offset:0 sc1 lds
  v_mul_f32 v178, v178, v19
  v_mfma_f32_32x32x16_bf16 v[80:95], v[52:55], a[140:143], v[80:95]
  v_mul_f32 v179, v179, v19
  v_mul_f32 v160, v160, v176
  v_mul_f32 v161, v161, v177
  v_cvt_pk_bf16_f32 v160, v160, v161
  v_max_f32 v164, 0, v164
  s_waitcnt lgkmcnt(4)
  v_mfma_f32_32x32x16_bf16 v[64:79], v[56:59], a[144:147], v[64:79]
  ds_read_b64_tr_b16 v[48:49], v8 offset:35840
  ds_read_b64_tr_b16 v[50:51], v8 offset:36096
  buffer_load_dwordx4 v5, s[24:27], s21 offen offset:1024 sc1 lds
  v_max_f32 v165, 0, v165
  v_mfma_f32_32x32x16_bf16 v[80:95], v[56:59], a[148:151], v[80:95]
  ds_read_b64_tr_b16 v[52:53], v9 offset:35840
  ds_read_b64_tr_b16 v[54:55], v9 offset:36096
  v_mul_f32 v180, v180, v19
  v_mul_f32 v181, v181, v19
  v_mul_f32 v162, v162, v178
  v_mul_f32 v163, v163, v179
  v_mfma_f32_16x16x32_bf16 v[24:27], v[32:35], v[56:59], v[24:27]
  v_cvt_pk_bf16_f32 v161, v162, v163
  v_mfma_f32_32x32x16_bf16 v[64:79], v[60:63], a[152:155], v[64:79]
  buffer_load_dwordx4 v6, s[24:27], s21 offen offset:2048 sc1 lds
  v_max_f32 v166, 0, v166
  v_max_f32 v167, 0, v167
  v_mul_f32 v182, v182, v19
  v_mfma_f32_32x32x16_bf16 v[80:95], v[60:63], a[156:159], v[80:95]
  v_mul_f32 v183, v183, v19
  v_mul_f32 v164, v164, v180
  v_mul_f32 v165, v165, v181
  v_cvt_pk_bf16_f32 v162, v164, v165
  v_max_f32 v168, 0, v168
  s_waitcnt lgkmcnt(4)
  v_mfma_f32_32x32x16_bf16 v[64:79], v[40:43], a[160:163], v[64:79]
  s_waitcnt lgkmcnt(0)
  v_add_u32 v8, 49152, v8
  v_add_u32 v9, 49152, v9
  s_barrier
  ds_read_b64_tr_b16 v[56:57], v8 offset:16384
  ds_read_b64_tr_b16 v[58:59], v8 offset:16640
  v_mfma_f32_32x32x16_bf16 v[80:95], v[40:43], a[164:167], v[80:95]
  s_add_u32 m0, s64, 24576
  v_max_f32 v169, 0, v169
  buffer_load_dwordx4 v4, s[24:27], s22 offen offset:0 sc1 lds
  v_mul_f32 v184, v184, v19
  v_mfma_f32_16x16x32_bf16 v[24:27], v[32:35], v[40:43], v[24:27]
  v_mul_f32 v185, v185, v19
  v_mfma_f32_32x32x16_bf16 v[64:79], v[44:47], a[168:171], v[64:79]
  ds_read_b64_tr_b16 v[60:61], v9 offset:16384
  ds_read_b64_tr_b16 v[62:63], v9 offset:16640
  buffer_load_dwordx4 v5, s[24:27], s22 offen offset:1024 sc1 lds
  v_mul_f32 v166, v166, v182
  v_mfma_f32_32x32x16_bf16 v[80:95], v[44:47], a[172:175], v[80:95]
  v_mul_f32 v167, v167, v183
  v_cvt_pk_bf16_f32 v163, v166, v167
  v_max_f32 v170, 0, v170
  v_max_f32 v171, 0, v171
  v_mul_f32 v186, v186, v19
  v_mfma_f32_32x32x16_bf16 v[64:79], v[48:51], a[176:179], v[64:79]
  ds_read_b64_tr_b16 v[40:41], v8 offset:17408
  ds_read_b64_tr_b16 v[42:43], v8 offset:17664
  buffer_load_dwordx4 v6, s[24:27], s22 offen offset:2048 sc1 lds
  s_add_u32 m0, s64, 36864
  v_mfma_f32_32x32x16_bf16 v[80:95], v[48:51], a[180:183], v[80:95]
  buffer_store_dwordx4 v[160:163], v13, s[24:27], s70 offen offset:0 sc1
  v_mfma_f32_16x16x32_bf16 v[24:27], v[32:35], v[48:51], v[24:27]
  v_mul_f32 v187, v187, v19
  v_mfma_f32_32x32x16_bf16 v[64:79], v[52:55], a[184:187], v[64:79]
  ds_read_b64_tr_b16 v[44:45], v9 offset:17408
  ds_read_b64_tr_b16 v[46:47], v9 offset:17664
  buffer_load_dwordx4 v4, s[24:27], s23 offen offset:0 sc1 lds
  v_mul_f32 v168, v168, v184
  v_mfma_f32_32x32x16_bf16 v[80:95], v[52:55], a[188:191], v[80:95]
  buffer_load_dwordx4 v5, s[24:27], s23 offen offset:1024 sc1 lds
  v_mul_f32 v169, v169, v185
  v_cvt_pk_bf16_f32 v164, v168, v169
  s_waitcnt lgkmcnt(4)
  v_mfma_f32_32x32x16_bf16 v[64:79], v[56:59], a[192:195], v[64:79]
  ds_read_b64_tr_b16 v[48:49], v8 offset:18432
  ds_read_b64_tr_b16 v[50:51], v8 offset:18688
  v_max_f32 v172, 0, v172
  v_max_f32 v173, 0, v173
  v_mul_f32 v188, v188, v19
  v_mul_f32 v189, v189, v19
  v_mfma_f32_32x32x16_bf16 v[80:95], v[56:59], a[196:199], v[80:95]
  v_mul_f32 v170, v170, v186
  buffer_load_dwordx4 v6, s[24:27], s23 offen offset:2048 sc1 lds
  v_mul_f32 v171, v171, v187
  v_cvt_pk_bf16_f32 v165, v170, v171
  v_mfma_f32_16x16x32_bf16 v[24:27], v[32:35], v[56:59], v[24:27]
  v_max_f32 v174, 0, v174
  v_mfma_f32_32x32x16_bf16 v[64:79], v[60:63], a[200:203], v[64:79]
  ds_read_b64_tr_b16 v[52:53], v9 offset:18432
  ds_read_b64_tr_b16 v[54:55], v9 offset:18688
  v_max_f32 v175, 0, v175
  v_mul_f32 v190, v190, v19
  v_mul_f32 v191, v191, v19
  v_mul_f32 v172, v172, v188
  v_mfma_f32_32x32x16_bf16 v[80:95], v[60:63], a[204:207], v[80:95]
  v_mul_f32 v173, v173, v189
  v_cvt_pk_bf16_f32 v166, v172, v173
  v_mul_f32 v174, v174, v190
  v_mul_f32 v175, v175, v191
  v_cvt_pk_bf16_f32 v167, v174, v175
  s_waitcnt lgkmcnt(4)
  v_mfma_f32_32x32x16_bf16 v[64:79], v[40:43], a[208:211], v[64:79]
  ds_read_b64_tr_b16 v[56:57], v8 offset:19456
  ds_read_b64_tr_b16 v[58:59], v8 offset:19712
  v_xor_b32 v144, 0xf149f2ca, v96
  v_xor_b32 v145, 0xf149f2ca, v97
  v_xor_b32 v146, 0xf149f2ca, v98
  v_xor_b32 v147, 0xf149f2ca, v99
  v_mfma_f32_32x32x16_bf16 v[80:95], v[40:43], a[212:215], v[80:95]
  ds_read_b64_tr_b16 v[60:61], v9 offset:19456
  ds_read_b64_tr_b16 v[62:63], v9 offset:19712
  v_xor_b32 v148, 0xf149f2ca, v100
  v_xor_b32 v149, 0xf149f2ca, v101
  v_xor_b32 v150, 0xf149f2ca, v102
  v_xor_b32 v151, 0xf149f2ca, v103
  v_mfma_f32_16x16x32_bf16 v[24:27], v[32:35], v[40:43], v[24:27]
  v_xor_b32 v152, 0xf149f2ca, v104
  v_mfma_f32_32x32x16_bf16 v[64:79], v[44:47], a[216:219], v[64:79]
  buffer_store_dwordx4 v[164:167], v13, s[24:27], s70 offen offset:512 sc1
  v_mfma_f32_32x32x16_bf16 v[80:95], v[44:47], a[220:223], v[80:95]
  v_xor_b32 v153, 0xf149f2ca, v105
  v_xor_b32 v154, 0xf149f2ca, v106
  v_xor_b32 v155, 0xf149f2ca, v107
  v_xor_b32 v156, 0xf149f2ca, v108
  v_xor_b32 v157, 0xf149f2ca, v109
  s_waitcnt lgkmcnt(4)
  v_mfma_f32_32x32x16_bf16 v[64:79], v[48:51], a[224:227], v[64:79]
  s_waitcnt lgkmcnt(0)
  s_barrier
  ds_read_b64_tr_b16 v[40:41], v8 offset:0
  ds_read_b64_tr_b16 v[42:43], v8 offset:256
  s_add_u32 s56, s91, 3
  s_and_b32 s56, s56, 7
  v_mfma_f32_32x32x16_bf16 v[80:95], v[48:51], a[228:231], v[80:95]
  s_mul_i32 s56, s56, 5120
  s_add_u32 s56, s56, s59
  s_add_u32 m0, s63, 140288
  buffer_load_dwordx4 a[32:35], v14, s[24:27], s74 offen offset:0 sc1
  v_mfma_f32_16x16x32_bf16 v[24:27], v[32:35], v[48:51], v[24:27]
  v_xor_b32 v158, 0xf149f2ca, v110
  v_mfma_f32_32x32x16_bf16 v[64:79], v[52:55], a[232:235], v[64:79]
  ds_read_b64_tr_b16 v[44:45], v9 offset:0
  ds_read_b64_tr_b16 v[46:47], v9 offset:256
  buffer_load_dwordx4 v14, s[24:27], s56 offen offset:0 sc1 lds
  v_xor_b32 v159, 0xf149f2ca, v111
  v_mfma_f32_32x32x16_bf16 v[80:95], v[52:55], a[236:239], v[80:95]
  buffer_load_dwordx4 v14, s[24:27], s56 offen offset:1024 sc1 lds
  v_and_b32 v127, 7, v0
  v_lshl_add_u32 v127, v127, 2, s94
  v_mfma_f32_32x32x16_bf16 v[64:79], v[56:59], a[240:243], v[64:79]
  ds_read_b64_tr_b16 v[48:49], v8 offset:1024
  ds_read_b64_tr_b16 v[50:51], v8 offset:1280
  s_xor_b32 s32, s81, 8
  s_sub_u32 s32, s32, s95
  v_writelane_b32 v127, s32, 63
  v_lshrrev_b32 v4, 4, v0
  v_mfma_f32_32x32x16_bf16 v[80:95], v[56:59], a[244:247], v[80:95]
  buffer_load_dwordx4 v14, s[24:27], s56 offen offset:2048 sc1 lds
  v_and_b32 v12, 15, v0
  v_mul_u32_u24 v12, 1280, v12
  v_lshl_add_u32 v12, v4, 3, v12
  v_mfma_f32_16x16x32_bf16 v[24:27], v[32:35], v[56:59], v[24:27]
  s_add_u32 s32, s3, 0
  v_mfma_f32_32x32x16_bf16 v[64:79], v[60:63], a[248:251], v[64:79]
  ds_read_b64_tr_b16 v[52:53], v9 offset:1024
  ds_read_b64_tr_b16 v[54:55], v9 offset:1280
  s_and_b32 s32, s32, 3
  s_mul_i32 s32, s32, 69632
  s_add_u32 s32, s33, s32
  v_add_u32 v4, s32, v14
  v_mfma_f32_32x32x16_bf16 v[80:95], v[60:63], a[252:255], v[80:95]
  buffer_load_dwordx4 v14, s[24:27], s56 offen offset:3072 sc1 lds
  s_add_u32 s56, s56, 4096
  s_add_u32 m0, s63, 144384
  s_waitcnt lgkmcnt(4)
  v_mfma_f32_32x32x16_bf16 v[64:79], v[40:43], v[192:195], v[64:79]
  ds_read_b64_tr_b16 v[56:57], v8 offset:2048
  ds_read_b64_tr_b16 v[58:59], v8 offset:2304
  s_add_u32 s32, s3, 1
  s_and_b32 s32, s32, 3
  s_mul_i32 s32, s32, 69632
  s_add_u32 s32, s33, s32
  v_mfma_f32_32x32x16_bf16 v[80:95], v[40:43], v[196:199], v[80:95]
  buffer_load_dwordx4 v14, s[24:27], s56 offen sc1 lds
  v_add_u32 v5, s32, v14
  s_add_u32 s32, s3, 2
  s_and_b32 s32, s32, 3
  v_mfma_f32_16x16x32_bf16 v[24:27], v[32:35], v[40:43], v[24:27]
  s_mul_i32 s32, s32, 69632
  v_mfma_f32_32x32x16_bf16 v[64:79], v[44:47], v[200:203], v[64:79]
  ds_read_b64_tr_b16 v[60:61], v9 offset:2048
  ds_read_b64_tr_b16 v[62:63], v9 offset:2304
  buffer_load_dwordx4 a[36:39], v14, s[24:27], s74 offen offset:1024 sc1
  s_mov_b32 s74, s75
  v_mfma_f32_32x32x16_bf16 v[80:95], v[44:47], v[204:207], v[80:95]
  s_add_u32 s32, s33, s32
  v_add_u32 v6, s32, v14
  s_add_u32 s32, s3, 3
  s_and_b32 s32, s32, 3
  s_mul_i32 s32, s32, 69632
  s_waitcnt lgkmcnt(4)
  v_mfma_f32_32x32x16_bf16 v[64:79], v[48:51], v[208:211], v[64:79]
  ds_read_b64_tr_b16 v[40:41], v8 offset:3072
  ds_read_b64_tr_b16 v[42:43], v8 offset:3328
  s_add_u32 s32, s33, s32
  buffer_load_dwordx4 a[40:43], v14, s[24:27], s74 offen offset:0 sc1
  v_mfma_f32_32x32x16_bf16 v[80:95], v[48:51], v[212:215], v[80:95]
  ds_read_b64_tr_b16 v[44:45], v9 offset:3072
  ds_read_b64_tr_b16 v[46:47], v9 offset:3328
  v_add_u32 v7, s32, v14
  v_add_u32 v1, s63, v14
  v_add_u32 v2, 119808, v1
  s_and_b32 s48, s91, 7
  v_mfma_f32_16x16x32_bf16 v[24:27], v[32:35], v[48:51], v[24:27]
  s_lshl_b32 s48, s48, 10
  v_mfma_f32_32x32x16_bf16 v[64:79], v[52:55], v[216:219], v[64:79]
  buffer_load_dwordx4 a[44:47], v14, s[24:27], s74 offen offset:1024 sc1
  s_lshl_b32 s49, s3, 12
  s_sub_u32 s49, 32768, s49
  s_mul_i32 s50, s3, 3072
  v_mfma_f32_32x32x16_bf16 v[80:95], v[52:55], v[220:223], v[80:95]
  s_sub_u32 s50, 49152, s50
  s_add_u32 s51, s50, 4096
  s_waitcnt lgkmcnt(4)
  v_mfma_f32_32x32x16_bf16 v[64:79], v[56:59], v[224:227], v[64:79]
  v_mfma_f32_32x32x16_bf16 v[80:95], v[56:59], v[228:231], v[80:95]
  buffer_load_dwordx4 a[48:51], v14, s[24:27], s74 offen offset:2048 sc1
  v_mfma_f32_16x16x32_bf16 v[24:27], v[32:35], v[56:59], v[24:27]
  v_mfma_f32_32x32x16_bf16 v[64:79], v[60:63], v[232:235], v[64:79]
  s_waitcnt vmcnt(10)
  buffer_store_dword v0, v17, s[24:27], s81 offen sc1
  v_mfma_f32_32x32x16_bf16 v[80:95], v[60:63], v[236:239], v[80:95]
  buffer_load_dwordx4 a[52:55], v14, s[24:27], s74 offen offset:3072 sc1
  s_add_u32 s74, s74, 4096
  s_waitcnt lgkmcnt(0)
  v_mfma_f32_32x32x16_bf16 v[64:79], v[40:43], v[240:243], v[64:79]
  buffer_load_dwordx4 a[56:59], v14, s[24:27], s74 offen offset:0 sc1
  v_mfma_f32_32x32x16_bf16 v[80:95], v[40:43], v[244:247], v[80:95]
  v_mfma_f32_16x16x32_bf16 v[24:27], v[32:35], v[40:43], v[24:27]
  v_mfma_f32_32x32x16_bf16 v[64:79], v[44:47], v[248:251], v[64:79]
  buffer_load_dwordx4 a[60:63], v14, s[24:27], s74 offen offset:1024 sc1
  v_mfma_f32_32x32x16_bf16 v[80:95], v[44:47], v[252:255], v[80:95]
  buffer_load_dwordx2 v[34:35], v12, s[28:31], s62 offen offset:128
  s_mov_b32 s90, 0x4e800000
  s_nop 2
  v_cvt_pk_bf16_f32 v10, v26, v26
  v_lshlrev_b32 v10, 16, v10
  ds_read_b128 a[252:255], v1 offset:24576
  v_sub_f32 v10, v26, v10
  v_cvt_pk_bf16_f32 v10, v26, v10
  ds_write2_b32 v15, v10, v10 offset0:0 offset1:32
  v_and_b32 v15, 24, v12
  v_add_u32 v15, v15, v12
  buffer_load_dwordx4 v[26:29], v15, s[28:31], s62 offen offset:0
  s_waitcnt lgkmcnt(0)
  s_barrier
  ds_read2_b32 v[10:11], v16 offset0:0 offset1:32
  s_add_u32 m0, s63, 119808
  s_add_u32 s56, s91, 4
  s_and_b32 s56, s56, 7
  s_mul_i32 s56, s56, 5120
  s_add_u32 s56, s56, s59
  ds_read_b128 v[176:179], v20 offset:0
  ds_read_b64 v[180:181], v21 offset:0
  ds_read_b128 v[182:185], v20 offset:3072
  ds_read_b64 v[186:187], v21 offset:3072
  ds_read_b128 v[224:227], v22 offset:0
  ds_read_b128 v[228:231], v22 offset:768
  ds_read_b128 v[232:235], v22 offset:3072
  ds_read_b128 v[236:239], v22 offset:3840
  s_waitcnt lgkmcnt(8)
  v_mfma_f32_32x32x8_bf16 v[64:79], v[10:11], v[36:37], v[64:79]
  v_mfma_f32_32x32x8_bf16 v[80:95], v[10:11], v[38:39], v[80:95]
  s_sub_u32 s77, s3, 1
  s_and_b32 s77, s77, 3
  s_mul_i32 s77, s77, 5120
  s_add_u32 s77, s77, 0
  v_add_u32 v8, s77, v14
  s_sub_u32 s77, s3, 2
  s_and_b32 s77, s77, 3
  s_mul_i32 s77, s77, 5120
  s_add_u32 s77, s77, 20480
  v_add_u32 v9, s77, v14
  s_sub_u32 s77, s3, 3
  s_and_b32 s77, s77, 3
  s_mul_i32 s77, s77, 5120
  s_add_u32 s77, s77, 40960
  v_add_u32 v10, s77, v14
  s_waitcnt lgkmcnt(0)
  v_mfma_f32_32x32x16_bf16 v[128:143], v[176:179], v[112:115], v[144:159]
  ds_read_b128 v[176:179], v20 offset:6144
  buffer_load_dwordx4 v[58:61], v15, s[28:31], s62 offen offset:64
  v_max_f32 v64, 0, v64
  v_max_f32 v65, 0, v65
  v_mfma_f32_32x32x8_bf16 v[128:143], v[180:181], v[120:121], v[128:143]
  ds_read_b64 v[180:181], v21 offset:6144
  v_mul_f32 v72, v72, v18
  v_mul_f32 v73, v73, v18
  v_max_f32 v66, 0, v66
  v_max_f32 v67, 0, v67
  v_mul_f32 v74, v74, v18
  v_mfma_f32_32x32x16_bf16 v[160:175], v[182:185], v[112:115], 0
  v_mul_f32 v75, v75, v18
  v_mul_f32 v64, v64, v72
  v_mul_f32 v65, v65, v73
  v_max_f32 v68, 0, v68
  v_cvt_pk_bf16_f32 v64, v64, v65
  v_max_f32 v69, 0, v69
  v_mfma_f32_32x32x8_bf16 v[160:175], v[186:187], v[120:121], v[160:175]
  v_mul_f32 v76, v76, v18
  v_mul_f32 v77, v77, v18
  v_mul_f32 v66, v66, v74
  v_mul_f32 v67, v67, v75
  v_max_f32 v70, 0, v70
  v_cvt_pk_bf16_f32 v65, v66, v67
  v_max_f32 v71, 0, v71
  v_mul_f32 v78, v78, v18
  v_mul_f32 v79, v79, v18
  v_mul_f32 v68, v68, v76
  v_mul_f32 v69, v69, v77
  v_mul_f32 v70, v70, v78
  v_cvt_pk_bf16_f32 v66, v68, v69
  v_mul_f32 v71, v71, v79
  v_max_f32 v80, 0, v80
  v_cvt_pk_bf16_f32 v67, v70, v71
  v_max_f32 v81, 0, v81
  buffer_store_dwordx4 v[64:67], v13, s[24:27], s71 offen sc1
  v_mul_f32 v88, v88, v19
  v_mul_f32 v89, v89, v19
  v_max_f32 v82, 0, v82
  v_max_f32 v83, 0, v83
  v_mul_f32 v90, v90, v19
  v_mul_f32 v91, v91, v19
  v_mul_f32 v80, v80, v88
  v_mul_f32 v81, v81, v89
  v_max_f32 v84, 0, v84
  v_cvt_pk_bf16_f32 v80, v80, v81
  v_max_f32 v85, 0, v85
  v_mul_f32 v92, v92, v19
  v_mul_f32 v93, v93, v19
  v_mul_f32 v82, v82, v90
  v_mul_f32 v83, v83, v91
  v_max_f32 v86, 0, v86
  v_cvt_pk_bf16_f32 v81, v82, v83
  ds_read_b128 v[72:75], v1 offset:2048
  ds_read_b128 v[76:79], v1 offset:3072
  ds_read_b128 v[68:71], v1 offset:1024
  ds_read_b128 v[64:67], v1 offset:0
  v_max_f32 v87, 0, v87
  v_mul_f32 v94, v94, v19
  v_mul_f32 v95, v95, v19
  v_mul_f32 v84, v84, v92
  v_mul_f32 v85, v85, v93
  v_mul_f32 v86, v86, v94
  v_cvt_pk_bf16_f32 v82, v84, v85
  v_mul_f32 v87, v87, v95
  v_exp_f32 v128, v128
  v_cvt_pk_bf16_f32 v83, v86, v87
  v_exp_f32 v129, v129
  buffer_store_dwordx4 v[80:83], v13, s[24:27], s72 offen sc1
  s_nop 1
  ds_read_b128 v[80:83], v1 offset:4096
  v_exp_f32 v130, v130
  v_exp_f32 v131, v131
  v_cvt_pk_bf16_f32 v40, v128, v129
  v_exp_f32 v132, v132
  v_exp_f32 v133, v133
  v_cvt_pk_bf16_f32 v41, v130, v131
  v_exp_f32 v134, v134
  v_exp_f32 v135, v135
  v_cvt_pk_bf16_f32 v42, v132, v133
  v_exp_f32 v136, v136
  v_exp_f32 v137, v137
  v_cvt_pk_bf16_f32 v43, v134, v135
  v_exp_f32 v138, v138
  s_nop 0
  v_mfma_f32_32x32x16_bf16 v[192:207], v[224:227], v[40:43], 0
  v_exp_f32 v139, v139
  v_cvt_pk_bf16_f32 v44, v136, v137
  v_exp_f32 v140, v140
  v_exp_f32 v141, v141
  v_cvt_pk_bf16_f32 v45, v138, v139
  v_exp_f32 v142, v142
  v_exp_f32 v143, v143
  v_cvt_pk_bf16_f32 v46, v140, v141
  v_cvt_pk_bf16_f32 v47, v142, v143
  v_mfma_f32_32x32x16_bf16 v[128:143], v[182:185], v[116:119], v[144:159]
  buffer_load_dwordx4 v14, s[24:27], s56 offen offset:0 sc1 lds
  ds_read_b128 v[144:147], v1 offset:20480
  ds_read_b128 v[148:151], v1 offset:21504
  ds_read_b128 v[152:155], v1 offset:22528
  v_mfma_f32_32x32x16_bf16 v[192:207], v[228:231], v[44:47], v[192:207]
  ds_read_b128 v[156:159], v1 offset:23552
  ds_read_b128 v[224:227], v22 offset:6144
  ds_read_b128 v[228:231], v22 offset:6912
  ds_read_b128 v[182:185], v20 offset:9216
  v_exp_f32 v160, v160
  v_mfma_f32_32x32x8_bf16 v[128:143], v[186:187], v[122:123], v[128:143]
  ds_read_b64 v[186:187], v21 offset:9216
  v_exp_f32 v161, v161
  v_exp_f32 v162, v162
  v_exp_f32 v163, v163
  buffer_load_dwordx4 v14, s[24:27], s56 offen offset:1024 sc1 lds
  v_cvt_pk_bf16_f32 v48, v160, v161
  v_exp_f32 v164, v164
  v_exp_f32 v165, v165
  v_cvt_pk_bf16_f32 v49, v162, v163
  v_exp_f32 v166, v166
  v_exp_f32 v167, v167
  v_cvt_pk_bf16_f32 v50, v164, v165
  v_exp_f32 v168, v168
  v_exp_f32 v169, v169
  v_cvt_pk_bf16_f32 v51, v166, v167
  v_exp_f32 v170, v170
  s_nop 0
  v_mfma_f32_32x32x16_bf16 v[192:207], v[232:235], v[48:51], v[192:207]
  buffer_load_dwordx4 v14, s[24:27], s56 offen offset:2048 sc1 lds
  v_exp_f32 v171, v171
  v_cvt_pk_bf16_f32 v52, v168, v169
  v_exp_f32 v172, v172
  v_exp_f32 v173, v173
  v_cvt_pk_bf16_f32 v53, v170, v171
  v_exp_f32 v174, v174
  v_exp_f32 v175, v175
  v_cvt_pk_bf16_f32 v54, v172, v173
  v_cvt_pk_bf16_f32 v55, v174, v175
  s_waitcnt lgkmcnt(0)
  v_mfma_f32_32x32x16_bf16 v[160:175], v[176:179], v[112:115], 0
  buffer_load_dwordx4 v14, s[24:27], s56 offen offset:3072 sc1 lds
  s_add_u32 m0, s63, 123904
  s_add_u32 s56, s56, 4096
  v_exp_f32 v128, v128
  v_mfma_f32_32x32x16_bf16 v[192:207], v[236:239], v[52:55], v[192:207]
  v_exp_f32 v129, v129
  v_exp_f32 v130, v130
  v_exp_f32 v131, v131
  v_mfma_f32_32x32x8_bf16 v[160:175], v[180:181], v[120:121], v[160:175]
  v_cvt_pk_bf16_f32 v40, v128, v129
  v_exp_f32 v132, v132
  v_exp_f32 v133, v133
  buffer_load_dwordx4 v14, s[24:27], s56 offen sc1 lds
  s_add_u32 m0, s63, 0
  s_add_u32 s56, s91, 5
  s_and_b32 s56, s56, 7
  s_mul_i32 s56, s56, 5120
  s_add_u32 s56, s56, s59
  v_cvt_pk_bf16_f32 v41, v130, v131
  v_exp_f32 v134, v134
  v_exp_f32 v135, v135
  v_cvt_pk_bf16_f32 v42, v132, v133
  v_exp_f32 v136, v136
  v_exp_f32 v137, v137
  v_cvt_pk_bf16_f32 v43, v134, v135
  v_exp_f32 v138, v138
  s_nop 0
  v_mfma_f32_32x32x16_bf16 v[208:223], v[232:235], v[40:43], 0
  buffer_load_dwordx4 v14, s[24:27], s56 offen offset:0 sc1 lds
  v_exp_f32 v139, v139
  v_cvt_pk_bf16_f32 v44, v136, v137
  v_exp_f32 v140, v140
  v_exp_f32 v141, v141
  v_cvt_pk_bf16_f32 v45, v138, v139
  v_exp_f32 v142, v142
  v_exp_f32 v143, v143
  v_cvt_pk_bf16_f32 v46, v140, v141
  v_cvt_pk_bf16_f32 v47, v142, v143
  v_mfma_f32_32x32x16_bf16 v[128:143], v[176:179], v[116:119], 0
  ds_read_b128 v[232:235], v22 offset:9216
  ds_read_b128 v[176:179], v20 offset:12288
  buffer_load_dwordx4 v14, s[24:27], s56 offen offset:1024 sc1 lds
  v_exp_f32 v160, v160
  v_mfma_f32_32x32x16_bf16 v[208:223], v[236:239], v[44:47], v[208:223]
  ds_read_b128 v[236:239], v22 offset:9984
  v_exp_f32 v161, v161
  v_exp_f32 v162, v162
  v_exp_f32 v163, v163
  v_mfma_f32_32x32x8_bf16 v[128:143], v[180:181], v[122:123], v[128:143]
  ds_read_b64 v[180:181], v21 offset:12288
  v_cvt_pk_bf16_f32 v48, v160, v161
  v_exp_f32 v164, v164
  v_exp_f32 v165, v165
  v_cvt_pk_bf16_f32 v49, v162, v163
  buffer_load_dwordx4 v14, s[24:27], s56 offen offset:2048 sc1 lds
  v_exp_f32 v166, v166
  v_exp_f32 v167, v167
  v_cvt_pk_bf16_f32 v50, v164, v165
  v_exp_f32 v168, v168
  v_exp_f32 v169, v169
  v_cvt_pk_bf16_f32 v51, v166, v167
  v_exp_f32 v170, v170
  s_nop 0
  v_mfma_f32_32x32x16_bf16 v[192:207], v[224:227], v[48:51], v[192:207]
  v_exp_f32 v171, v171
  v_cvt_pk_bf16_f32 v52, v168, v169
  v_exp_f32 v172, v172
  buffer_load_dwordx4 v14, s[24:27], s56 offen offset:3072 sc1 lds
  s_add_u32 m0, s63, 4096
  s_add_u32 s56, s56, 4096
  v_exp_f32 v173, v173
  v_cvt_pk_bf16_f32 v53, v170, v171
  v_exp_f32 v174, v174
  v_exp_f32 v175, v175
  v_cvt_pk_bf16_f32 v54, v172, v173
  v_cvt_pk_bf16_f32 v55, v174, v175
  v_mfma_f32_32x32x16_bf16 v[160:175], v[182:185], v[112:115], 0
  v_exp_f32 v128, v128
  v_exp_f32 v129, v129
  v_exp_f32 v130, v130
  v_mfma_f32_32x32x16_bf16 v[192:207], v[228:231], v[52:55], v[192:207]
  buffer_load_dwordx4 v14, s[24:27], s56 offen sc1 lds
  s_add_u32 m0, s63, 20480
  s_add_u32 s56, s91, 6
  s_and_b32 s56, s56, 7
  v_mfma_f32_32x32x8_bf16 v[160:175], v[186:187], v[120:121], v[160:175]
  s_mul_i32 s56, s56, 5120
  s_add_u32 s56, s56, s59
  v_exp_f32 v131, v131
  v_cvt_pk_bf16_f32 v40, v128, v129
  v_exp_f32 v132, v132
  v_exp_f32 v133, v133
  v_cvt_pk_bf16_f32 v41, v130, v131
  v_exp_f32 v134, v134
  buffer_load_dwordx4 v14, s[24:27], s56 offen offset:0 sc1 lds
  v_exp_f32 v135, v135
  v_cvt_pk_bf16_f32 v42, v132, v133
  v_exp_f32 v136, v136
  v_exp_f32 v137, v137
  v_cvt_pk_bf16_f32 v43, v134, v135
  v_exp_f32 v138, v138
  s_nop 0
  v_mfma_f32_32x32x16_bf16 v[208:223], v[224:227], v[40:43], v[208:223]
  v_exp_f32 v139, v139
  v_cvt_pk_bf16_f32 v44, v136, v137
  v_exp_f32 v140, v140
  v_exp_f32 v141, v141
  buffer_load_dwordx4 v14, s[24:27], s56 offen offset:1024 sc1 lds
  v_cvt_pk_bf16_f32 v45, v138, v139
  v_exp_f32 v142, v142
  v_exp_f32 v143, v143
  v_cvt_pk_bf16_f32 v46, v140, v141
  v_cvt_pk_bf16_f32 v47, v142, v143
  v_mfma_f32_32x32x16_bf16 v[128:143], v[182:185], v[116:119], 0
  ds_read_b128 v[224:227], v22 offset:12288
  ds_read_b128 v[182:185], v20 offset:15360
  v_exp_f32 v160, v160
  v_exp_f32 v161, v161
  v_mfma_f32_32x32x16_bf16 v[208:223], v[228:231], v[44:47], v[208:223]
  ds_read_b128 v[228:231], v22 offset:13056
  v_exp_f32 v162, v162
  buffer_load_dwordx4 v14, s[24:27], s56 offen offset:2048 sc1 lds
  v_mfma_f32_32x32x8_bf16 v[128:143], v[186:187], v[122:123], v[128:143]
  s_waitcnt vmcnt(13)
  s_add_u32 s81, s81, 4096
  s_xor_b32 s81, s81, 96
  buffer_store_dword v0, v17, s[24:27], s81 offen sc1
  ds_read_b64 v[186:187], v21 offset:15360
  v_exp_f32 v163, v163
  v_cvt_pk_bf16_f32 v48, v160, v161
  v_exp_f32 v164, v164
  v_exp_f32 v165, v165
  v_cvt_pk_bf16_f32 v49, v162, v163
  v_exp_f32 v166, v166
  v_exp_f32 v167, v167
  v_cvt_pk_bf16_f32 v50, v164, v165
  v_exp_f32 v168, v168
  buffer_load_dwordx4 v14, s[24:27], s56 offen offset:3072 sc1 lds
  s_add_u32 m0, s63, 24576
  s_add_u32 s56, s56, 4096
  v_exp_f32 v169, v169
  v_cvt_pk_bf16_f32 v51, v166, v167
  v_exp_f32 v170, v170
  s_waitcnt lgkmcnt(1)
  v_mfma_f32_32x32x16_bf16 v[192:207], v[232:235], v[48:51], v[192:207]
  v_exp_f32 v171, v171
  v_cvt_pk_bf16_f32 v52, v168, v169
  v_exp_f32 v172, v172
  v_exp_f32 v173, v173
  v_cvt_pk_bf16_f32 v53, v170, v171
  buffer_load_dword v188, v127, s[24:27], s95 offen offset:0 sc1
  buffer_load_dwordx4 v14, s[24:27], s56 offen sc1 lds
  v_exp_f32 v174, v174
  v_exp_f32 v175, v175
  v_cvt_pk_bf16_f32 v54, v172, v173
  v_cvt_pk_bf16_f32 v55, v174, v175
  v_mfma_f32_32x32x16_bf16 v[160:175], v[176:179], v[112:115], 0
  v_exp_f32 v128, v128
  v_exp_f32 v129, v129
  v_exp_f32 v130, v130
  v_mfma_f32_32x32x16_bf16 v[192:207], v[236:239], v[52:55], v[192:207]
  v_exp_f32 v131, v131
  v_cvt_pk_bf16_f32 v40, v128, v129
  buffer_load_dwordx4 a[64:67], v14, s[24:27], s74 offen offset:2048 sc1
  v_mfma_f32_32x32x8_bf16 v[160:175], v[180:181], v[120:121], v[160:175]
  v_exp_f32 v132, v132
  v_exp_f32 v133, v133
  v_cvt_pk_bf16_f32 v41, v130, v131
  v_exp_f32 v134, v134
  v_exp_f32 v135, v135
  v_cvt_pk_bf16_f32 v42, v132, v133
  v_exp_f32 v136, v136
  v_exp_f32 v137, v137
  v_cvt_pk_bf16_f32 v43, v134, v135
  v_exp_f32 v138, v138
  s_nop 0
  v_mfma_f32_32x32x16_bf16 v[208:223], v[232:235], v[40:43], v[208:223]
  buffer_load_dwordx4 a[68:71], v14, s[24:27], s74 offen offset:3072 sc1
  s_add_u32 s74, s74, 4096
  v_exp_f32 v139, v139
  v_cvt_pk_bf16_f32 v44, v136, v137
  v_exp_f32 v140, v140
  v_exp_f32 v141, v141
  v_cvt_pk_bf16_f32 v45, v138, v139
  v_exp_f32 v142, v142
  v_exp_f32 v143, v143
  v_cvt_pk_bf16_f32 v46, v140, v141
  v_cvt_pk_bf16_f32 v47, v142, v143
  v_mfma_f32_32x32x16_bf16 v[128:143], v[176:179], v[116:119], 0
  buffer_load_dwordx4 a[72:75], v14, s[24:27], s74 offen offset:0 sc1
  ds_read_b128 v[232:235], v22 offset:15360
  ds_read_b128 v[176:179], v20 offset:18432
  v_exp_f32 v160, v160
  v_mfma_f32_32x32x16_bf16 v[208:223], v[236:239], v[44:47], v[208:223]
  ds_read_b128 v[236:239], v22 offset:16128
  v_exp_f32 v161, v161
  v_exp_f32 v162, v162
  v_exp_f32 v163, v163
  v_mfma_f32_32x32x8_bf16 v[128:143], v[180:181], v[122:123], v[128:143]
  ds_read_b64 v[180:181], v21 offset:18432
  v_cvt_pk_bf16_f32 v48, v160, v161
  v_exp_f32 v164, v164
  v_exp_f32 v165, v165
  buffer_load_dwordx4 a[76:79], v14, s[24:27], s74 offen offset:1024 sc1
  v_cvt_pk_bf16_f32 v49, v162, v163
  v_exp_f32 v166, v166
  v_exp_f32 v167, v167
  v_cvt_pk_bf16_f32 v50, v164, v165
  v_exp_f32 v168, v168
  v_exp_f32 v169, v169
  v_cvt_pk_bf16_f32 v51, v166, v167
  v_exp_f32 v170, v170
  s_nop 0
  v_mfma_f32_32x32x16_bf16 v[192:207], v[224:227], v[48:51], v[192:207]
  v_exp_f32 v171, v171
  buffer_load_dwordx4 a[80:83], v14, s[24:27], s74 offen offset:2048 sc1
  v_cvt_pk_bf16_f32 v52, v168, v169
  v_exp_f32 v172, v172
  v_exp_f32 v173, v173
  v_cvt_pk_bf16_f32 v53, v170, v171
  v_exp_f32 v174, v174
  v_exp_f32 v175, v175
  v_cvt_pk_bf16_f32 v54, v172, v173
  v_cvt_pk_bf16_f32 v55, v174, v175
  v_mfma_f32_32x32x16_bf16 v[160:175], v[182:185], v[112:115], 0
  v_exp_f32 v128, v128
  v_exp_f32 v129, v129
  v_exp_f32 v130, v130
  v_mfma_f32_32x32x16_bf16 v[192:207], v[228:231], v[52:55], v[192:207]
  buffer_load_dwordx4 a[84:87], v14, s[24:27], s74 offen offset:3072 sc1
  s_add_u32 s74, s74, 4096
  v_exp_f32 v131, v131
  s_waitcnt lgkmcnt(0)
  v_mfma_f32_32x32x8_bf16 v[160:175], v[186:187], v[120:121], v[160:175]
  v_cvt_pk_bf16_f32 v40, v128, v129
  v_exp_f32 v132, v132
  v_exp_f32 v133, v133
  v_cvt_pk_bf16_f32 v41, v130, v131
  v_exp_f32 v134, v134
  v_exp_f32 v135, v135
  v_cvt_pk_bf16_f32 v42, v132, v133
  buffer_load_dwordx4 a[88:91], v14, s[24:27], s74 offen offset:0 sc1
  v_exp_f32 v136, v136
  v_exp_f32 v137, v137
  v_cvt_pk_bf16_f32 v43, v134, v135
  v_exp_f32 v138, v138
  s_nop 0
  v_mfma_f32_32x32x16_bf16 v[208:223], v[224:227], v[40:43], v[208:223]
  v_exp_f32 v139, v139
  v_cvt_pk_bf16_f32 v44, v136, v137
  v_exp_f32 v140, v140
  v_exp_f32 v141, v141
  v_cvt_pk_bf16_f32 v45, v138, v139
  v_exp_f32 v142, v142
  buffer_load_dwordx4 a[92:95], v14, s[24:27], s74 offen offset:1024 sc1
  v_exp_f32 v143, v143
  v_cvt_pk_bf16_f32 v46, v140, v141
  v_cvt_pk_bf16_f32 v47, v142, v143
  v_mfma_f32_32x32x16_bf16 v[128:143], v[182:185], v[116:119], 0
  ds_read_b128 v[224:227], v22 offset:18432
  ds_read_b128 v[182:185], v20 offset:21504
  v_exp_f32 v160, v160
  v_exp_f32 v161, v161
  v_mfma_f32_32x32x16_bf16 v[208:223], v[228:231], v[44:47], v[208:223]
  ds_read_b128 v[228:231], v22 offset:19200
  v_exp_f32 v162, v162
  v_exp_f32 v163, v163
  buffer_load_dwordx4 a[96:99], v14, s[24:27], s74 offen offset:2048 sc1
  v_mfma_f32_32x32x8_bf16 v[128:143], v[186:187], v[122:123], v[128:143]
  ds_read_b64 v[186:187], v21 offset:21504
  v_cvt_pk_bf16_f32 v48, v160, v161
  v_exp_f32 v164, v164
  v_exp_f32 v165, v165
  v_cvt_pk_bf16_f32 v49, v162, v163
  v_exp_f32 v166, v166
  v_exp_f32 v167, v167
  v_cvt_pk_bf16_f32 v50, v164, v165
  v_exp_f32 v168, v168
  v_exp_f32 v169, v169
  v_cvt_pk_bf16_f32 v51, v166, v167
  v_exp_f32 v170, v170
  s_nop 0
  v_mfma_f32_32x32x16_bf16 v[192:207], v[232:235], v[48:51], v[192:207]
  buffer_load_dwordx4 a[100:103], v14, s[24:27], s74 offen offset:3072 sc1
  s_add_u32 s74, s74, 4096
  v_exp_f32 v171, v171
  v_cvt_pk_bf16_f32 v52, v168, v169
  v_exp_f32 v172, v172
  v_exp_f32 v173, v173
  v_cvt_pk_bf16_f32 v53, v170, v171
  v_exp_f32 v174, v174
  v_exp_f32 v175, v175
  v_cvt_pk_bf16_f32 v54, v172, v173
  v_cvt_pk_bf16_f32 v55, v174, v175
  v_mfma_f32_32x32x16_bf16 v[160:175], v[176:179], v[112:115], 0
  buffer_load_dwordx4 a[104:107], v14, s[24:27], s74 offen offset:0 sc1
  v_exp_f32 v128, v128
  v_exp_f32 v129, v129
  v_mfma_f32_32x32x16_bf16 v[192:207], v[236:239], v[52:55], v[192:207]
  v_exp_f32 v130, v130
  v_exp_f32 v131, v131
  v_cvt_pk_bf16_f32 v40, v128, v129
  v_exp_f32 v132, v132
  v_mfma_f32_32x32x8_bf16 v[160:175], v[180:181], v[120:121], v[160:175]
  v_exp_f32 v133, v133
  v_cvt_pk_bf16_f32 v41, v130, v131
  buffer_load_dwordx4 a[108:111], v14, s[24:27], s74 offen offset:1024 sc1
  v_exp_f32 v134, v134
  v_exp_f32 v135, v135
  v_cvt_pk_bf16_f32 v42, v132, v133
  v_exp_f32 v136, v136
  v_exp_f32 v137, v137
  v_cvt_pk_bf16_f32 v43, v134, v135
  v_exp_f32 v138, v138
  s_nop 0
  v_mfma_f32_32x32x16_bf16 v[208:223], v[232:235], v[40:43], v[208:223]
  v_exp_f32 v139, v139
  v_cvt_pk_bf16_f32 v44, v136, v137
  v_exp_f32 v140, v140
  buffer_load_dwordx4 a[112:115], v14, s[24:27], s74 offen offset:2048 sc1
  v_exp_f32 v141, v141
  s_waitcnt vmcnt(14)
  v_cmp_eq_u32 vcc, 0, v188
  s_cbranch_vccnz .slow35
.back36:
  v_cvt_pk_bf16_f32 v45, v138, v139
  v_exp_f32 v142, v142
  v_exp_f32 v143, v143
  v_cvt_pk_bf16_f32 v46, v140, v141
  v_cvt_pk_bf16_f32 v47, v142, v143
  v_mfma_f32_32x32x16_bf16 v[128:143], v[176:179], v[116:119], 0
  ds_read_b128 v[232:235], v22 offset:21504
  ds_read_b128 v[176:179], v20 offset:24576
  buffer_load_dwordx4 a[140:143], v4, s[24:27], s48 offen offset:0 sc1
  v_lshlrev_b32 v24, 16, v26
  v_mfma_f32_32x32x16_bf16 v[208:223], v[236:239], v[44:47], v[208:223]
  ds_read_b128 v[236:239], v22 offset:22272
  v_and_b32 v25, 0xffff0000, v26
  v_lshlrev_b32 v26, 16, v27
  v_and_b32 v27, 0xffff0000, v27
  v_and_b32 v31, 0xffff0000, v29
  v_lshlrev_b32 v30, 16, v29
  v_mfma_f32_32x32x8_bf16 v[128:143], v[180:181], v[122:123], v[128:143]
  ds_read_b64 v[180:181], v21 offset:24576
  v_and_b32 v29, 0xffff0000, v28
  buffer_load_dwordx4 a[144:147], v5, s[24:27], s48 offen offset:0 sc1
  v_lshlrev_b32 v28, 16, v28
  v_lshlrev_b32 v56, 16, v58
  v_and_b32 v57, 0xffff0000, v58
  v_lshlrev_b32 v58, 16, v59
  v_and_b32 v59, 0xffff0000, v59
  v_and_b32 v63, 0xffff0000, v61
  v_lshlrev_b32 v62, 16, v61
  v_and_b32 v61, 0xffff0000, v60
  v_lshlrev_b32 v60, 16, v60
  v_lshlrev_b32 v32, 16, v34
  v_and_b32 v33, 0xffff0000, v34
  v_lshlrev_b32 v34, 16, v35
  v_and_b32 v35, 0xffff0000, v35
  v_exp_f32 v160, v160
  buffer_load_dwordx4 a[148:151], v6, s[24:27], s48 offen offset:0 sc1
  v_exp_f32 v161, v161
  v_exp_f32 v162, v162
  v_exp_f32 v163, v163
  v_cvt_pk_bf16_f32 v48, v160, v161
  v_exp_f32 v164, v164
  v_exp_f32 v165, v165
  v_cvt_pk_bf16_f32 v49, v162, v163
  v_exp_f32 v166, v166
  buffer_load_dwordx4 a[152:155], v7, s[24:27], s48 offen offset:0 sc1
  s_add_u32 s48, s48, 1024
  s_and_b32 s48, s48, 0x1fff
  v_exp_f32 v167, v167
  v_cvt_pk_bf16_f32 v50, v164, v165
  v_exp_f32 v168, v168
  v_exp_f32 v169, v169
  v_cvt_pk_bf16_f32 v51, v166, v167
  v_exp_f32 v170, v170
  s_waitcnt lgkmcnt(0)
  v_mfma_f32_32x32x16_bf16 v[192:207], v[224:227], v[48:51], v[192:207]
  buffer_load_dwordx4 a[156:159], v4, s[24:27], s48 offen offset:0 sc1
  v_exp_f32 v171, v171
  v_cvt_pk_bf16_f32 v52, v168, v169
  v_exp_f32 v172, v172
  v_exp_f32 v173, v173
  v_cvt_pk_bf16_f32 v53, v170, v171
  v_exp_f32 v174, v174
  v_exp_f32 v175, v175
  buffer_load_dwordx4 a[160:163], v5, s[24:27], s48 offen offset:0 sc1
  v_cvt_pk_bf16_f32 v54, v172, v173
  v_cvt_pk_bf16_f32 v55, v174, v175
  v_mfma_f32_32x32x16_bf16 v[160:175], v[182:185], v[112:115], 0
  v_exp_f32 v128, v128
  v_exp_f32 v129, v129
  v_exp_f32 v130, v130
  v_mfma_f32_32x32x16_bf16 v[192:207], v[228:231], v[52:55], v[192:207]
  v_exp_f32 v131, v131
  buffer_load_dwordx4 a[164:167], v6, s[24:27], s48 offen offset:0 sc1
  v_cvt_pk_bf16_f32 v40, v128, v129
  v_mfma_f32_32x32x8_bf16 v[160:175], v[186:187], v[120:121], v[160:175]
  v_exp_f32 v132, v132
  v_exp_f32 v133, v133
  v_cvt_pk_bf16_f32 v41, v130, v131
  v_exp_f32 v134, v134
  v_exp_f32 v135, v135
  v_cvt_pk_bf16_f32 v42, v132, v133
  buffer_load_dwordx4 a[168:171], v7, s[24:27], s48 offen offset:0 sc1
  s_add_u32 s48, s48, 1024
  s_and_b32 s48, s48, 0x1fff
  v_exp_f32 v136, v136
  v_exp_f32 v137, v137
  v_cvt_pk_bf16_f32 v43, v134, v135
  v_exp_f32 v138, v138
  s_nop 0
  v_mfma_f32_32x32x16_bf16 v[208:223], v[224:227], v[40:43], v[208:223]
  v_exp_f32 v139, v139
  buffer_load_dwordx4 a[172:175], v4, s[24:27], s48 offen offset:0 sc1
  v_cvt_pk_bf16_f32 v44, v136, v137
  v_exp_f32 v140, v140
  v_exp_f32 v141, v141
  v_cvt_pk_bf16_f32 v45, v138, v139
  v_exp_f32 v142, v142
  v_exp_f32 v143, v143
  v_cvt_pk_bf16_f32 v46, v140, v141
  v_cvt_pk_bf16_f32 v47, v142, v143
  v_mfma_f32_32x32x16_bf16 v[128:143], v[182:185], v[116:119], 0
  buffer_load_dwordx4 a[176:179], v5, s[24:27], s48 offen offset:0 sc1
  ds_read_b128 v[224:227], v22 offset:24576
  ds_read_b128 v[182:185], v20 offset:27648
  v_exp_f32 v160, v160
  v_mfma_f32_32x32x16_bf16 v[208:223], v[228:231], v[44:47], v[208:223]
  ds_read_b128 v[228:231], v22 offset:25344
  v_exp_f32 v161, v161
  v_exp_f32 v162, v162
  v_exp_f32 v163, v163
  v_mfma_f32_32x32x8_bf16 v[128:143], v[186:187], v[122:123], v[128:143]
  buffer_load_dwordx4 a[180:183], v6, s[24:27], s48 offen offset:0 sc1
  ds_read_b64 v[186:187], v21 offset:27648
  v_cvt_pk_bf16_f32 v48, v160, v161
  v_exp_f32 v164, v164
  v_exp_f32 v165, v165
  v_cvt_pk_bf16_f32 v49, v162, v163
  v_exp_f32 v166, v166
  v_exp_f32 v167, v167
  v_cvt_pk_bf16_f32 v50, v164, v165
  buffer_load_dwordx4 a[184:187], v7, s[24:27], s48 offen offset:0 sc1
  s_add_u32 s48, s48, 1024
  s_and_b32 s48, s48, 0x1fff
  v_exp_f32 v168, v168
  v_exp_f32 v169, v169
  v_cvt_pk_bf16_f32 v51, v166, v167
  v_exp_f32 v170, v170
  s_nop 0
  v_mfma_f32_32x32x16_bf16 v[192:207], v[232:235], v[48:51], v[192:207]
  v_exp_f32 v171, v171
  buffer_load_dwordx4 a[188:191], v4, s[24:27], s48 offen offset:0 sc1
  v_cvt_pk_bf16_f32 v52, v168, v169
  v_exp_f32 v172, v172
  v_exp_f32 v173, v173
  v_cvt_pk_bf16_f32 v53, v170, v171
  v_exp_f32 v174, v174
  v_exp_f32 v175, v175
  v_cvt_pk_bf16_f32 v54, v172, v173
  v_cvt_pk_bf16_f32 v55, v174, v175
  v_mfma_f32_32x32x16_bf16 v[160:175], v[176:179], v[112:115], v[96:111]
  buffer_load_dwordx4 a[192:195], v5, s[24:27], s48 offen offset:0 sc1
  v_exp_f32 v128, v128
  v_exp_f32 v129, v129
  v_mfma_f32_32x32x16_bf16 v[192:207], v[236:239], v[52:55], v[192:207]
  v_exp_f32 v130, v130
  v_exp_f32 v131, v131
  v_cvt_pk_bf16_f32 v40, v128, v129
  v_exp_f32 v132, v132
  v_mfma_f32_32x32x8_bf16 v[160:175], v[180:181], v[120:121], v[160:175]
  buffer_load_dwordx4 a[196:199], v6, s[24:27], s48 offen offset:0 sc1
  v_exp_f32 v133, v133
  v_cvt_pk_bf16_f32 v41, v130, v131
  v_exp_f32 v134, v134
  v_exp_f32 v135, v135
  v_cvt_pk_bf16_f32 v42, v132, v133
  v_exp_f32 v136, v136
  v_exp_f32 v137, v137
  buffer_load_dwordx4 a[200:203], v7, s[24:27], s48 offen offset:0 sc1
  s_add_u32 s48, s48, 1024
  s_and_b32 s48, s48, 0x1fff
  v_cvt_pk_bf16_f32 v43, v134, v135
  v_exp_f32 v138, v138
  s_nop 0
  v_mfma_f32_32x32x16_bf16 v[208:223], v[232:235], v[40:43], v[208:223]
  v_exp_f32 v139, v139
  v_cvt_pk_bf16_f32 v44, v136, v137
  v_exp_f32 v140, v140
  v_exp_f32 v141, v141
  buffer_load_dwordx4 a[204:207], v4, s[24:27], s48 offen offset:0 sc1
  v_cvt_pk_bf16_f32 v45, v138, v139
  v_exp_f32 v142, v142
  v_exp_f32 v143, v143
  v_cvt_pk_bf16_f32 v46, v140, v141
  v_cvt_pk_bf16_f32 v47, v142, v143
  v_mfma_f32_32x32x16_bf16 v[128:143], v[176:179], v[116:119], 0
  ds_read_b128 v[232:235], v22 offset:27648
  v_exp_f32 v160, v160
  buffer_load_dwordx4 a[208:211], v5, s[24:27], s48 offen offset:0 sc1
  v_mfma_f32_32x32x16_bf16 v[208:223], v[236:239], v[44:47], v[208:223]
  ds_read_b128 v[236:239], v22 offset:28416
  v_exp_f32 v161, v161
  v_exp_f32 v162, v162
  v_exp_f32 v163, v163
  v_mfma_f32_32x32x8_bf16 v[128:143], v[180:181], v[122:123], v[128:143]
  v_cvt_pk_bf16_f32 v48, v160, v161
  v_exp_f32 v164, v164
  buffer_load_dwordx4 a[212:215], v6, s[24:27], s48 offen offset:0 sc1
  v_exp_f32 v165, v165
  v_cvt_pk_bf16_f32 v49, v162, v163
  v_exp_f32 v166, v166
  v_exp_f32 v167, v167
  v_cvt_pk_bf16_f32 v50, v164, v165
  v_exp_f32 v168, v168
  v_exp_f32 v169, v169
  v_cvt_pk_bf16_f32 v51, v166, v167
  v_exp_f32 v170, v170
  s_waitcnt lgkmcnt(1)
  v_mfma_f32_32x32x16_bf16 v[192:207], v[224:227], v[48:51], v[192:207]
  buffer_load_dwordx4 a[216:219], v7, s[24:27], s48 offen offset:0 sc1
  s_add_u32 s48, s48, 1024
  s_and_b32 s48, s48, 0x1fff
  v_exp_f32 v171, v171
  v_cvt_pk_bf16_f32 v52, v168, v169
  v_exp_f32 v172, v172
  v_exp_f32 v173, v173
  v_cvt_pk_bf16_f32 v53, v170, v171
  buffer_load_dwordx4 a[220:223], v4, s[24:27], s48 offen offset:0 sc1
  v_exp_f32 v174, v174
  v_exp_f32 v175, v175
  v_cvt_pk_bf16_f32 v54, v172, v173
  v_cvt_pk_bf16_f32 v55, v174, v175
  v_mfma_f32_32x32x16_bf16 v[160:175], v[182:185], v[116:119], v[96:111]
  v_exp_f32 v128, v128
  v_exp_f32 v129, v129
  v_exp_f32 v130, v130
  v_mfma_f32_32x32x16_bf16 v[192:207], v[228:231], v[52:55], v[192:207]
  buffer_load_dwordx4 a[224:227], v5, s[24:27], s48 offen offset:0 sc1
  v_exp_f32 v131, v131
  v_cvt_pk_bf16_f32 v40, v128, v129
  v_mfma_f32_32x32x8_bf16 v[160:175], v[186:187], v[122:123], v[160:175]
  v_exp_f32 v132, v132
  s_nop 6
  v_rcp_f32 v205, v204
  buffer_load_dwordx4 a[228:231], v6, s[24:27], s48 offen offset:0 sc1
  v_max_f32 v204, v204, v205
  v_mul_f32 v192, v192, v205
  v_cmp_nge_f32 s[86:87], s90, v204
  v_mul_f32 v193, v193, v205
  v_mul_f32 v194, v194, v205
  v_mul_f32 v195, v195, v205
  v_cvt_pk_bf16_f32 v192, v192, v193
  v_mul_f32 v196, v196, v205
  v_mul_f32 v197, v197, v205
  v_cvt_pk_bf16_f32 v193, v194, v195
  v_mul_f32 v198, v198, v205
  v_mul_f32 v199, v199, v205
  buffer_load_dword v188, v23, s[24:27], s95 offen offset:0 sc1
  v_cvt_pk_bf16_f32 v194, v196, v197
  v_mul_f32 v200, v200, v205
  buffer_load_dwordx4 a[232:235], v7, s[24:27], s48 offen offset:0 sc1
  s_add_u32 s48, s48, 1024
  s_and_b32 s48, s48, 0x1fff
  v_mul_f32 v201, v201, v205
  v_cvt_pk_bf16_f32 v195, v198, v199
  v_mul_f32 v202, v202, v205
  v_mul_f32 v203, v203, v205
  v_cvt_pk_bf16_f32 v196, v200, v201
  v_cvt_pk_bf16_f32 v197, v202, v203
  s_cmp_lg_u64 s[86:87], 0
  s_cselect_b32 s96, 1073741824, s82
  s_cselect_b32 s97, 1073741824, s83
  buffer_store_dwordx4 v[192:195], v13, s[24:27], s96 offen sc1
  s_mov_b32 exec_hi, 0
  buffer_store_dwordx2 v[196:197], v13, s[24:27], s97 offen sc1
  s_mov_b32 exec_hi, -1
  v_exp_f32 v133, v133
  v_cvt_pk_bf16_f32 v41, v130, v131
  v_exp_f32 v134, v134
  v_exp_f32 v135, v135
  v_cvt_pk_bf16_f32 v42, v132, v133
  v_exp_f32 v136, v136
  v_exp_f32 v137, v137
  v_cvt_pk_bf16_f32 v43, v134, v135
  v_exp_f32 v138, v138
  s_nop 0
  v_mfma_f32_32x32x16_bf16 v[208:223], v[224:227], v[40:43], v[208:223]
  v_exp_f32 v139, v139
  v_cvt_pk_bf16_f32 v44, v136, v137
  v_exp_f32 v140, v140
  v_exp_f32 v141, v141
  v_cvt_pk_bf16_f32 v45, v138, v139
  v_exp_f32 v142, v142
  v_exp_f32 v143, v143
  v_cvt_pk_bf16_f32 v46, v140, v141
  v_cvt_pk_bf16_f32 v47, v142, v143
  v_exp_f32 v160, v160
  s_nop 0
  v_mfma_f32_32x32x16_bf16 v[208:223], v[228:231], v[44:47], v[208:223]
  v_exp_f32 v161, v161
  buffer_load_dwordx4 a[236:239], v4, s[24:27], s48 offen offset:0 sc1
  v_exp_f32 v162, v162
  v_exp_f32 v163, v163
  v_cvt_pk_bf16_f32 v48, v160, v161
  v_exp_f32 v164, v164
  v_exp_f32 v165, v165
  v_cvt_pk_bf16_f32 v49, v162, v163
  v_exp_f32 v166, v166
  v_exp_f32 v167, v167
  buffer_load_dwordx4 a[240:243], v5, s[24:27], s48 offen offset:0 sc1
  v_cvt_pk_bf16_f32 v50, v164, v165
  v_exp_f32 v168, v168
  v_exp_f32 v169, v169
  v_cvt_pk_bf16_f32 v51, v166, v167
  v_exp_f32 v170, v170
  s_nop 0
  v_mfma_f32_32x32x16_bf16 v[208:223], v[232:235], v[48:51], v[208:223]
  v_exp_f32 v171, v171
  v_cvt_pk_bf16_f32 v52, v168, v169
  buffer_load_dwordx4 a[244:247], v6, s[24:27], s48 offen offset:0 sc1
  v_exp_f32 v172, v172
  v_exp_f32 v173, v173
  v_cvt_pk_bf16_f32 v53, v170, v171
  v_exp_f32 v174, v174
  v_exp_f32 v175, v175
  v_cvt_pk_bf16_f32 v54, v172, v173
  v_cvt_pk_bf16_f32 v55, v174, v175
  s_waitcnt lgkmcnt(0)
  s_nop 0
  v_mfma_f32_32x32x16_bf16 v[208:223], v[236:239], v[52:55], v[208:223]
  buffer_load_dwordx4 a[248:251], v7, s[24:27], s48 offen offset:0 sc1
  s_add_u32 s48, s48, 1024
  s_and_b32 s48, s48, 0x1fff
  s_nop 7
  s_nop 0
  v_rcp_f32 v221, v220
  s_nop 0
  v_max_f32 v220, v220, v221
  v_cmp_nge_f32 s[88:89], s90, v220
  buffer_load_dwordx4 v[240:243], v4, s[24:27], s48 offen offset:0 sc1
  s_or_b64 vcc, s[86:87], s[88:89]
  s_cbranch_vccnz .fb38
.fbb39:
  v_mul_f32 v208, v208, v221
  v_mul_f32 v209, v209, v221
  v_mul_f32 v210, v210, v221
  v_mul_f32 v211, v211, v221
  v_mul_f32 v212, v212, v221
  v_mul_f32 v213, v213, v221
  v_mul_f32 v214, v214, v221
  v_mul_f32 v215, v215, v221
  v_mul_f32 v216, v216, v221
  v_mul_f32 v217, v217, v221
  v_mul_f32 v218, v218, v221
  v_mul_f32 v219, v219, v221
  v_cvt_pk_bf16_f32 v208, v208, v209
  v_cvt_pk_bf16_f32 v209, v210, v211
  v_cvt_pk_bf16_f32 v210, v212, v213
  v_cvt_pk_bf16_f32 v211, v214, v215
  v_cvt_pk_bf16_f32 v212, v216, v217
  v_cvt_pk_bf16_f32 v213, v218, v219
  buffer_store_dwordx4 v[208:211], v13, s[24:27], s84 offen sc1
  s_mov_b32 exec_hi, 0
  buffer_store_dwordx2 v[212:213], v13, s[24:27], s85 offen sc1
  s_mov_b32 exec_hi, -1
  s_waitcnt vmcnt(30)
  v_mfma_f32_16x16x32_bf16 v[24:27], v[64:67], a[140:143], v[24:27]
  ds_read_b128 v[128:131], v2 offset:20480
  v_mfma_f32_16x16x32_bf16 v[84:87], v[64:67], a[144:147], 0
  ds_read_b128 v[132:135], v2 offset:21504
  v_mfma_f32_16x16x32_bf16 v[28:31], v[68:71], a[140:143], v[28:31]
  ds_read_b128 v[136:139], v2 offset:22528
  v_mfma_f32_16x16x32_bf16 v[88:91], v[68:71], a[144:147], 0
  ds_read_b128 v[140:143], v2 offset:23552
  v_mfma_f32_16x16x32_bf16 v[56:59], v[72:75], a[140:143], v[56:59]
  ds_read_b128 v[160:163], v2 offset:24576
  v_mfma_f32_16x16x32_bf16 v[92:95], v[72:75], a[144:147], 0
  buffer_load_dwordx4 v[244:247], v5, s[24:27], s48 offen offset:0 sc1
  v_mfma_f32_16x16x32_bf16 v[60:63], v[76:79], a[140:143], v[60:63]
  v_mfma_f32_16x16x32_bf16 v[32:35], v[80:83], a[140:143], v[32:35]
  v_mfma_f32_16x16x32_bf16 v[104:107], v[64:67], a[148:151], 0
  v_mfma_f32_16x16x32_bf16 v[40:43], v[64:67], a[152:155], 0
  buffer_load_dwordx4 v[248:251], v6, s[24:27], s48 offen offset:0 sc1
  v_mfma_f32_16x16x32_bf16 v[108:111], v[68:71], a[148:151], 0
  ds_read_b128 v[64:67], v1 offset:40960
  v_mfma_f32_16x16x32_bf16 v[44:47], v[68:71], a[152:155], 0
  ds_read_b128 v[68:71], v1 offset:41984
  v_mfma_f32_16x16x32_bf16 v[112:115], v[72:75], a[148:151], 0
  v_mfma_f32_16x16x32_bf16 v[48:51], v[72:75], a[152:155], 0
  buffer_load_dwordx4 v[252:255], v7, s[24:27], s48 offen offset:0 sc1
  v_mfma_f32_16x16x32_bf16 v[96:99], v[76:79], a[144:147], 0
  ds_read_b128 v[72:75], v1 offset:43008
  v_mfma_f32_16x16x32_bf16 v[116:119], v[76:79], a[148:151], 0
  v_mfma_f32_16x16x32_bf16 v[52:55], v[76:79], a[152:155], 0
  ds_read_b128 v[76:79], v1 offset:44032
  v_mfma_f32_16x16x32_bf16 v[100:103], v[80:83], a[144:147], 0
  buffer_load_dwordx4 a[116:119], v14, s[24:27], s74 offen offset:3072 sc1
  v_mfma_f32_16x16x32_bf16 v[120:123], v[80:83], a[148:151], 0
  s_add_u32 s74, s74, 4096
  v_mfma_f32_16x16x32_bf16 v[36:39], v[80:83], a[152:155], 0
  ds_read_b128 v[80:83], v1 offset:45056
  s_waitcnt vmcnt(30)
  v_mfma_f32_16x16x32_bf16 v[24:27], v[144:147], a[156:159], v[24:27]
  v_mfma_f32_16x16x32_bf16 v[84:87], v[144:147], a[160:163], v[84:87]
  v_mfma_f32_16x16x32_bf16 v[104:107], v[144:147], a[164:167], v[104:107]
  buffer_load_dwordx4 a[120:123], v14, s[24:27], s74 offen offset:0 sc1
  v_mfma_f32_16x16x32_bf16 v[40:43], v[144:147], a[168:171], v[40:43]
  v_mfma_f32_16x16x32_bf16 v[28:31], v[148:151], a[156:159], v[28:31]
  v_mfma_f32_16x16x32_bf16 v[88:91], v[148:151], a[160:163], v[88:91]
  v_mfma_f32_16x16x32_bf16 v[108:111], v[148:151], a[164:167], v[108:111]
  v_mfma_f32_16x16x32_bf16 v[44:47], v[148:151], a[168:171], v[44:47]
  s_waitcnt lgkmcnt(0)
  s_add_u32 m0, s63, 40960
  v_mfma_f32_16x16x32_bf16 v[56:59], v[152:155], a[156:159], v[56:59]
  s_waitcnt vmcnt(15)
  v_cmp_eq_u32 vcc, 0, v188
  s_cbranch_vccnz .slow40
.back41:
  v_mfma_f32_16x16x32_bf16 v[92:95], v[152:155], a[160:163], v[92:95]
  s_add_u32 s56, s91, 7
  v_mfma_f32_16x16x32_bf16 v[112:115], v[152:155], a[164:167], v[112:115]
  s_and_b32 s56, s56, 7
  v_mfma_f32_16x16x32_bf16 v[48:51], v[152:155], a[168:171], v[48:51]
  s_mul_i32 s56, s56, 5120
  v_mfma_f32_16x16x32_bf16 v[60:63], v[156:159], a[156:159], v[60:63]
  s_add_u32 s56, s56, s59
  v_mfma_f32_16x16x32_bf16 v[96:99], v[156:159], a[160:163], v[96:99]
  buffer_load_dwordx4 v14, s[24:27], s56 offen offset:0 sc1 lds
  v_mfma_f32_16x16x32_bf16 v[116:119], v[156:159], a[164:167], v[116:119]
  buffer_load_dwordx4 v14, s[24:27], s56 offen offset:1024 sc1 lds
  v_mfma_f32_16x16x32_bf16 v[52:55], v[156:159], a[168:171], v[52:55]
  buffer_load_dwordx4 v14, s[24:27], s56 offen offset:2048 sc1 lds
  v_mfma_f32_16x16x32_bf16 v[32:35], a[252:255], a[156:159], v[32:35]
  v_mfma_f32_16x16x32_bf16 v[100:103], a[252:255], a[160:163], v[100:103]
  v_mfma_f32_16x16x32_bf16 v[120:123], a[252:255], a[164:167], v[120:123]
  buffer_load_dwordx4 v14, s[24:27], s56 offen offset:3072 sc1 lds
  v_mfma_f32_16x16x32_bf16 v[36:39], a[252:255], a[168:171], v[36:39]
  s_add_u32 m0, s63, 45056
  v_mfma_f32_16x16x32_bf16 v[24:27], v[64:67], a[172:175], v[24:27]
  s_add_u32 s56, s56, 4096
  v_mfma_f32_16x16x32_bf16 v[84:87], v[64:67], a[176:179], v[84:87]
  v_mfma_f32_16x16x32_bf16 v[104:107], v[64:67], a[180:183], v[104:107]
  buffer_load_dwordx4 v14, s[24:27], s56 offen sc1 lds
  v_mfma_f32_16x16x32_bf16 v[40:43], v[64:67], a[184:187], v[40:43]
  s_add_u32 m0, s63, 140288
  v_mfma_f32_16x16x32_bf16 v[28:31], v[68:71], a[172:175], v[28:31]
  s_mov_b32 s56, s60
  v_mfma_f32_16x16x32_bf16 v[88:91], v[68:71], a[176:179], v[88:91]
  ds_read_b128 v[64:67], v2 offset:0
  v_mfma_f32_16x16x32_bf16 v[108:111], v[68:71], a[180:183], v[108:111]
  buffer_load_dwordx4 v14, s[24:27], s56 offen offset:0 sc1 lds
  v_mfma_f32_16x16x32_bf16 v[44:47], v[68:71], a[184:187], v[44:47]
  ds_read_b128 v[68:71], v2 offset:1024
  v_mfma_f32_16x16x32_bf16 v[56:59], v[72:75], a[172:175], v[56:59]
  v_mfma_f32_16x16x32_bf16 v[92:95], v[72:75], a[176:179], v[92:95]
  v_mfma_f32_16x16x32_bf16 v[112:115], v[72:75], a[180:183], v[112:115]
  buffer_load_dwordx4 v14, s[24:27], s56 offen offset:1024 sc1 lds
  v_mfma_f32_16x16x32_bf16 v[48:51], v[72:75], a[184:187], v[48:51]
  ds_read_b128 v[72:75], v2 offset:2048
  v_mfma_f32_16x16x32_bf16 v[60:63], v[76:79], a[172:175], v[60:63]
  v_mfma_f32_16x16x32_bf16 v[96:99], v[76:79], a[176:179], v[96:99]
  v_mfma_f32_16x16x32_bf16 v[116:119], v[76:79], a[180:183], v[116:119]
  buffer_load_dwordx4 v14, s[24:27], s56 offen offset:2048 sc1 lds
  v_mfma_f32_16x16x32_bf16 v[52:55], v[76:79], a[184:187], v[52:55]
  ds_read_b128 v[76:79], v2 offset:3072
  v_mfma_f32_16x16x32_bf16 v[32:35], v[80:83], a[172:175], v[32:35]
  v_mfma_f32_16x16x32_bf16 v[100:103], v[80:83], a[176:179], v[100:103]
  v_mfma_f32_16x16x32_bf16 v[120:123], v[80:83], a[180:183], v[120:123]
  buffer_load_dwordx4 v14, s[24:27], s56 offen offset:3072 sc1 lds
  v_mfma_f32_16x16x32_bf16 v[36:39], v[80:83], a[184:187], v[36:39]
  s_add_u32 m0, s63, 144384
  v_mfma_f32_16x16x32_bf16 v[24:27], v[128:131], a[188:191], v[24:27]
  s_add_u32 s56, s56, 4096
  v_mfma_f32_16x16x32_bf16 v[84:87], v[128:131], a[192:195], v[84:87]
  ds_read_b128 v[80:83], v2 offset:4096
  buffer_load_dwordx4 v14, s[24:27], s56 offen sc1 lds
  v_mfma_f32_16x16x32_bf16 v[104:107], v[128:131], a[196:199], v[104:107]
  v_mfma_f32_16x16x32_bf16 v[40:43], v[128:131], a[200:203], v[40:43]
  ds_read_b128 v[128:131], v1 offset:0
  v_mfma_f32_16x16x32_bf16 v[28:31], v[132:135], a[188:191], v[28:31]
  v_mfma_f32_16x16x32_bf16 v[88:91], v[132:135], a[192:195], v[88:91]
  buffer_load_dwordx4 v[144:147], v4, s[24:27], s49 offen offset:0 sc1
  v_mfma_f32_16x16x32_bf16 v[108:111], v[132:135], a[196:199], v[108:111]
  v_mfma_f32_16x16x32_bf16 v[44:47], v[132:135], a[200:203], v[44:47]
  ds_read_b128 v[132:135], v1 offset:1024
  v_mfma_f32_16x16x32_bf16 v[56:59], v[136:139], a[188:191], v[56:59]
  v_mfma_f32_16x16x32_bf16 v[92:95], v[136:139], a[192:195], v[92:95]
  buffer_load_dwordx4 v[148:151], v5, s[24:27], s49 offen offset:0 sc1
  v_mfma_f32_16x16x32_bf16 v[112:115], v[136:139], a[196:199], v[112:115]
  s_waitcnt lgkmcnt(2)
  s_add_u32 m0, s63, 119808
  v_mfma_f32_16x16x32_bf16 v[48:51], v[136:139], a[200:203], v[48:51]
  s_add_u32 s56, s56, 1024
  v_mfma_f32_16x16x32_bf16 v[60:63], v[140:143], a[188:191], v[60:63]
  ds_read_b128 v[136:139], v1 offset:2048
  v_mfma_f32_16x16x32_bf16 v[96:99], v[140:143], a[192:195], v[96:99]
  buffer_load_dwordx4 v[152:155], v6, s[24:27], s49 offen offset:0 sc1
  v_mfma_f32_16x16x32_bf16 v[116:119], v[140:143], a[196:199], v[116:119]
  v_mfma_f32_16x16x32_bf16 v[52:55], v[140:143], a[200:203], v[52:55]
  ds_read_b128 v[140:143], v1 offset:3072
  v_mfma_f32_16x16x32_bf16 v[32:35], v[160:163], a[188:191], v[32:35]
  v_mfma_f32_16x16x32_bf16 v[100:103], v[160:163], a[192:195], v[100:103]
  buffer_load_dwordx4 v[156:159], v7, s[24:27], s49 offen offset:0 sc1
  v_mfma_f32_16x16x32_bf16 v[120:123], v[160:163], a[196:199], v[120:123]
  v_mfma_f32_16x16x32_bf16 v[36:39], v[160:163], a[200:203], v[36:39]
  ds_read_b128 v[160:163], v1 offset:4096
  v_mfma_f32_16x16x32_bf16 v[24:27], v[64:67], a[204:207], v[24:27]
  v_mfma_f32_16x16x32_bf16 v[84:87], v[64:67], a[208:211], v[84:87]
  buffer_load_dwordx4 v14, s[24:27], s56 offen offset:0 sc1 lds
  v_mfma_f32_16x16x32_bf16 v[104:107], v[64:67], a[212:215], v[104:107]
  v_mfma_f32_16x16x32_bf16 v[40:43], v[64:67], a[216:219], v[40:43]
  ds_read_b128 v[64:67], v1 offset:20480
  v_mfma_f32_16x16x32_bf16 v[28:31], v[68:71], a[204:207], v[28:31]
  v_mfma_f32_16x16x32_bf16 v[88:91], v[68:71], a[208:211], v[88:91]
  buffer_load_dwordx4 v14, s[24:27], s56 offen offset:1024 sc1 lds
  v_mfma_f32_16x16x32_bf16 v[108:111], v[68:71], a[212:215], v[108:111]
  v_mfma_f32_16x16x32_bf16 v[44:47], v[68:71], a[216:219], v[44:47]
  ds_read_b128 v[68:71], v1 offset:21504
  v_mfma_f32_16x16x32_bf16 v[56:59], v[72:75], a[204:207], v[56:59]
  v_mfma_f32_16x16x32_bf16 v[92:95], v[72:75], a[208:211], v[92:95]
  buffer_load_dwordx4 v14, s[24:27], s56 offen offset:2048 sc1 lds
  v_mfma_f32_16x16x32_bf16 v[112:115], v[72:75], a[212:215], v[112:115]
  v_mfma_f32_16x16x32_bf16 v[48:51], v[72:75], a[216:219], v[48:51]
  ds_read_b128 v[72:75], v1 offset:22528
  v_mfma_f32_16x16x32_bf16 v[60:63], v[76:79], a[204:207], v[60:63]
  buffer_load_dwordx4 v14, s[24:27], s56 offen offset:3072 sc1 lds
  v_mfma_f32_16x16x32_bf16 v[96:99], v[76:79], a[208:211], v[96:99]
  s_add_u32 m0, s63, 123904
  v_mfma_f32_16x16x32_bf16 v[116:119], v[76:79], a[212:215], v[116:119]
  s_add_u32 s56, s56, 4096
  v_mfma_f32_16x16x32_bf16 v[52:55], v[76:79], a[216:219], v[52:55]
  ds_read_b128 v[76:79], v1 offset:23552
  v_mfma_f32_16x16x32_bf16 v[32:35], v[80:83], a[204:207], v[32:35]
  buffer_load_dwordx4 v14, s[24:27], s56 offen sc1 lds
  v_mfma_f32_16x16x32_bf16 v[100:103], v[80:83], a[208:211], v[100:103]
  v_mfma_f32_16x16x32_bf16 v[120:123], v[80:83], a[212:215], v[120:123]
  v_mfma_f32_16x16x32_bf16 v[36:39], v[80:83], a[216:219], v[36:39]
  ds_read_b128 v[80:83], v1 offset:24576
  s_waitcnt vmcnt(33) lgkmcnt(2)
  v_mfma_f32_16x16x32_bf16 v[24:27], v[128:131], a[220:223], v[24:27]
  buffer_load_dwordx4 v[192:195], v4, s[24:27], s49 offen offset:1024 sc1
  v_mfma_f32_16x16x32_bf16 v[84:87], v[128:131], a[224:227], v[84:87]
  v_mfma_f32_16x16x32_bf16 v[104:107], v[128:131], a[228:231], v[104:107]
  v_mfma_f32_16x16x32_bf16 v[40:43], v[128:131], a[232:235], v[40:43]
  v_mfma_f32_16x16x32_bf16 v[28:31], v[132:135], a[220:223], v[28:31]
  buffer_load_dwordx4 v[196:199], v5, s[24:27], s49 offen offset:1024 sc1
  v_mfma_f32_16x16x32_bf16 v[88:91], v[132:135], a[224:227], v[88:91]
  v_mfma_f32_16x16x32_bf16 v[108:111], v[132:135], a[228:231], v[108:111]
  v_mfma_f32_16x16x32_bf16 v[44:47], v[132:135], a[232:235], v[44:47]
  buffer_load_dwordx4 v[200:203], v6, s[24:27], s49 offen offset:1024 sc1
  v_mfma_f32_16x16x32_bf16 v[56:59], v[136:139], a[220:223], v[56:59]
  v_mfma_f32_16x16x32_bf16 v[92:95], v[136:139], a[224:227], v[92:95]
  v_mfma_f32_16x16x32_bf16 v[112:115], v[136:139], a[228:231], v[112:115]
  v_mfma_f32_16x16x32_bf16 v[48:51], v[136:139], a[232:235], v[48:51]
  buffer_load_dwordx4 v[204:207], v7, s[24:27], s49 offen offset:1024 sc1
  v_mfma_f32_16x16x32_bf16 v[60:63], v[140:143], a[220:223], v[60:63]
  v_mfma_f32_16x16x32_bf16 v[96:99], v[140:143], a[224:227], v[96:99]
  v_mfma_f32_16x16x32_bf16 v[116:119], v[140:143], a[228:231], v[116:119]
  s_waitcnt vmcnt(18)
  ds_read_b128 v[128:131], v1 offset:40960
  v_mfma_f32_16x16x32_bf16 v[52:55], v[140:143], a[232:235], v[52:55]
  buffer_load_dwordx4 v[208:211], v4, s[24:27], s49 offen offset:2048 sc1
  v_mfma_f32_16x16x32_bf16 v[32:35], v[160:163], a[220:223], v[32:35]
  ds_read_b128 v[132:135], v1 offset:41984
  v_mfma_f32_16x16x32_bf16 v[100:103], v[160:163], a[224:227], v[100:103]
  ds_read_b128 v[136:139], v1 offset:43008
  v_mfma_f32_16x16x32_bf16 v[120:123], v[160:163], a[228:231], v[120:123]
  ds_read_b128 v[140:143], v1 offset:44032
  buffer_load_dwordx4 v[212:215], v5, s[24:27], s49 offen offset:2048 sc1
  v_mfma_f32_16x16x32_bf16 v[36:39], v[160:163], a[232:235], v[36:39]
  ds_read_b128 v[160:163], v1 offset:45056
  v_mfma_f32_16x16x32_bf16 v[24:27], v[64:67], a[236:239], v[24:27]
  v_mfma_f32_16x16x32_bf16 v[84:87], v[64:67], a[240:243], v[84:87]
  v_mfma_f32_16x16x32_bf16 v[104:107], v[64:67], a[244:247], v[104:107]
  buffer_load_dwordx4 v[216:219], v6, s[24:27], s49 offen offset:2048 sc1
  v_mfma_f32_16x16x32_bf16 v[40:43], v[64:67], a[248:251], v[40:43]
  v_mfma_f32_16x16x32_bf16 v[28:31], v[68:71], a[236:239], v[28:31]
  v_mfma_f32_16x16x32_bf16 v[88:91], v[68:71], a[240:243], v[88:91]
  v_mfma_f32_16x16x32_bf16 v[108:111], v[68:71], a[244:247], v[108:111]
  buffer_load_dwordx4 v[220:223], v7, s[24:27], s49 offen offset:2048 sc1
  v_mfma_f32_16x16x32_bf16 v[44:47], v[68:71], a[248:251], v[44:47]
  v_mfma_f32_16x16x32_bf16 v[56:59], v[72:75], a[236:239], v[56:59]
  v_mfma_f32_16x16x32_bf16 v[92:95], v[72:75], a[240:243], v[92:95]
  v_mfma_f32_16x16x32_bf16 v[112:115], v[72:75], a[244:247], v[112:115]
  buffer_load_dwordx4 v[224:227], v4, s[24:27], s49 offen offset:3072 sc1
  v_mfma_f32_16x16x32_bf16 v[48:51], v[72:75], a[248:251], v[48:51]
  s_waitcnt lgkmcnt(0)
  v_mfma_f32_16x16x32_bf16 v[60:63], v[76:79], a[236:239], v[60:63]
  v_mfma_f32_16x16x32_bf16 v[96:99], v[76:79], a[240:243], v[96:99]
  s_waitcnt vmcnt(18)
  ds_read_b128 v[64:67], v2 offset:20480
  v_mfma_f32_16x16x32_bf16 v[116:119], v[76:79], a[244:247], v[116:119]
  buffer_load_dwordx4 v[228:231], v5, s[24:27], s49 offen offset:3072 sc1
  v_mfma_f32_16x16x32_bf16 v[52:55], v[76:79], a[248:251], v[52:55]
  ds_read_b128 v[68:71], v2 offset:21504
  v_mfma_f32_16x16x32_bf16 v[32:35], v[80:83], a[236:239], v[32:35]
  ds_read_b128 v[72:75], v2 offset:22528
  v_mfma_f32_16x16x32_bf16 v[100:103], v[80:83], a[240:243], v[100:103]
  ds_read_b128 v[76:79], v2 offset:23552
  buffer_load_dwordx4 v[232:235], v6, s[24:27], s49 offen offset:3072 sc1
  v_mfma_f32_16x16x32_bf16 v[120:123], v[80:83], a[244:247], v[120:123]
  v_mfma_f32_16x16x32_bf16 v[36:39], v[80:83], a[248:251], v[36:39]
  ds_read_b128 v[80:83], v2 offset:24576
  v_mfma_f32_16x16x32_bf16 v[24:27], v[128:131], v[240:243], v[24:27]
  v_mfma_f32_16x16x32_bf16 v[84:87], v[128:131], v[244:247], v[84:87]
  buffer_load_dwordx4 v[236:239], v7, s[24:27], s49 offen offset:3072 sc1
  v_mfma_f32_16x16x32_bf16 v[104:107], v[128:131], v[248:251], v[104:107]
  v_mfma_f32_16x16x32_bf16 v[40:43], v[128:131], v[252:255], v[40:43]
  v_mfma_f32_16x16x32_bf16 v[28:31], v[132:135], v[240:243], v[28:31]
  v_mfma_f32_16x16x32_bf16 v[88:91], v[132:135], v[244:247], v[88:91]
  buffer_load_dwordx4 a[124:127], v14, s[24:27], s74 offen offset:1024 sc1
  v_mfma_f32_16x16x32_bf16 v[108:111], v[132:135], v[248:251], v[108:111]
  v_mfma_f32_16x16x32_bf16 v[44:47], v[132:135], v[252:255], v[44:47]
  v_mfma_f32_16x16x32_bf16 v[56:59], v[136:139], v[240:243], v[56:59]
  v_mfma_f32_16x16x32_bf16 v[92:95], v[136:139], v[244:247], v[92:95]
  v_mfma_f32_16x16x32_bf16 v[112:115], v[136:139], v[248:251], v[112:115]
  buffer_load_dwordx4 a[128:131], v14, s[24:27], s74 offen offset:2048 sc1
  v_mfma_f32_16x16x32_bf16 v[48:51], v[136:139], v[252:255], v[48:51]
  v_mfma_f32_16x16x32_bf16 v[60:63], v[140:143], v[240:243], v[60:63]
  v_mfma_f32_16x16x32_bf16 v[96:99], v[140:143], v[244:247], v[96:99]
  v_mfma_f32_16x16x32_bf16 v[116:119], v[140:143], v[248:251], v[116:119]
  v_mfma_f32_16x16x32_bf16 v[52:55], v[140:143], v[252:255], v[52:55]
  buffer_load_dwordx4 a[132:135], v14, s[24:27], s74 offen offset:3072 sc1
  v_mfma_f32_16x16x32_bf16 v[32:35], v[160:163], v[240:243], v[32:35]
  s_add_u32 s74, s74, 4096
  v_mfma_f32_16x16x32_bf16 v[100:103], v[160:163], v[244:247], v[100:103]
  v_mfma_f32_16x16x32_bf16 v[120:123], v[160:163], v[248:251], v[120:123]
  v_mfma_f32_16x16x32_bf16 v[36:39], v[160:163], v[252:255], v[36:39]
  s_waitcnt vmcnt(20) lgkmcnt(0)
  v_mfma_f32_16x16x32_bf16 v[24:27], v[64:67], v[144:147], v[24:27]
  buffer_load_dwordx4 a[136:139], v14, s[24:27], s74 offen offset:0 sc1
  v_mfma_f32_16x16x32_bf16 v[84:87], v[64:67], v[148:151], v[84:87]
  v_mfma_f32_16x16x32_bf16 v[104:107], v[64:67], v[152:155], v[104:107]
  v_mfma_f32_16x16x32_bf16 v[40:43], v[64:67], v[156:159], v[40:43]
  v_mfma_f32_16x16x32_bf16 v[28:31], v[68:71], v[144:147], v[28:31]
  v_mfma_f32_16x16x32_bf16 v[88:91], v[68:71], v[148:151], v[88:91]
  buffer_load_dwordx4 a[140:143], v5, s[24:27], s50 offen offset:0 sc1
  v_mfma_f32_16x16x32_bf16 v[108:111], v[68:71], v[152:155], v[108:111]
  v_mfma_f32_16x16x32_bf16 v[44:47], v[68:71], v[156:159], v[44:47]
  s_waitcnt vmcnt(17)
  ds_read_b128 v[128:131], v2 offset:0
  v_mfma_f32_16x16x32_bf16 v[56:59], v[72:75], v[144:147], v[56:59]
  ds_read_b128 v[132:135], v2 offset:1024
  v_mfma_f32_16x16x32_bf16 v[92:95], v[72:75], v[148:151], v[92:95]
  buffer_load_dwordx4 a[144:147], v5, s[24:27], s50 offen offset:1024 sc1
  v_mfma_f32_16x16x32_bf16 v[112:115], v[72:75], v[152:155], v[112:115]
  ds_read_b128 v[136:139], v2 offset:2048
  v_mfma_f32_16x16x32_bf16 v[48:51], v[72:75], v[156:159], v[48:51]
  ds_read_b128 v[140:143], v2 offset:3072
  v_mfma_f32_16x16x32_bf16 v[60:63], v[76:79], v[144:147], v[60:63]
  ds_read_b128 v[160:163], v2 offset:4096
  v_mfma_f32_16x16x32_bf16 v[96:99], v[76:79], v[148:151], v[96:99]
  buffer_load_dwordx4 a[148:151], v5, s[24:27], s50 offen offset:2048 sc1
  v_mfma_f32_16x16x32_bf16 v[116:119], v[76:79], v[152:155], v[116:119]
  v_mfma_f32_16x16x32_bf16 v[52:55], v[76:79], v[156:159], v[52:55]
  v_mfma_f32_16x16x32_bf16 v[32:35], v[80:83], v[144:147], v[32:35]
  v_mfma_f32_16x16x32_bf16 v[100:103], v[80:83], v[148:151], v[100:103]
  buffer_load_dwordx4 a[152:155], v5, s[24:27], s50 offen offset:3072 sc1
  v_mfma_f32_16x16x32_bf16 v[120:123], v[80:83], v[152:155], v[120:123]
  v_mfma_f32_16x16x32_bf16 v[36:39], v[80:83], v[156:159], v[36:39]
  buffer_load_dwordx4 a[156:159], v5, s[24:27], s51 offen offset:0 sc1
  s_waitcnt vmcnt(17) lgkmcnt(0)
  v_mfma_f32_16x16x32_bf16 v[24:27], v[128:131], v[192:195], v[24:27]
  v_mfma_f32_16x16x32_bf16 v[84:87], v[128:131], v[196:199], v[84:87]
  buffer_load_dwordx4 a[160:163], v6, s[24:27], s50 offen offset:0 sc1
  v_mfma_f32_16x16x32_bf16 v[104:107], v[128:131], v[200:203], v[104:107]
  v_mfma_f32_16x16x32_bf16 v[40:43], v[128:131], v[204:207], v[40:43]
  v_mfma_f32_16x16x32_bf16 v[28:31], v[132:135], v[192:195], v[28:31]
  v_mfma_f32_16x16x32_bf16 v[88:91], v[132:135], v[196:199], v[88:91]
  buffer_load_dwordx4 a[164:167], v6, s[24:27], s50 offen offset:1024 sc1
  v_mfma_f32_16x16x32_bf16 v[108:111], v[132:135], v[200:203], v[108:111]
  v_mfma_f32_16x16x32_bf16 v[44:47], v[132:135], v[204:207], v[44:47]
  v_mfma_f32_16x16x32_bf16 v[56:59], v[136:139], v[192:195], v[56:59]
  v_mfma_f32_16x16x32_bf16 v[92:95], v[136:139], v[196:199], v[92:95]
  buffer_load_dwordx4 a[168:171], v6, s[24:27], s50 offen offset:2048 sc1
  v_mfma_f32_16x16x32_bf16 v[112:115], v[136:139], v[200:203], v[112:115]
  v_mfma_f32_16x16x32_bf16 v[48:51], v[136:139], v[204:207], v[48:51]
  v_mfma_f32_16x16x32_bf16 v[60:63], v[140:143], v[192:195], v[60:63]
  v_mfma_f32_16x16x32_bf16 v[96:99], v[140:143], v[196:199], v[96:99]
  buffer_load_dwordx4 a[172:175], v6, s[24:27], s50 offen offset:3072 sc1
  v_mfma_f32_16x16x32_bf16 v[116:119], v[140:143], v[200:203], v[116:119]
  v_mfma_f32_16x16x32_bf16 v[52:55], v[140:143], v[204:207], v[52:55]
  v_mfma_f32_16x16x32_bf16 v[32:35], v[160:163], v[192:195], v[32:35]
  v_mfma_f32_16x16x32_bf16 v[100:103], v[160:163], v[196:199], v[100:103]
  buffer_load_dwordx4 a[176:179], v6, s[24:27], s51 offen offset:0 sc1
  v_mfma_f32_16x16x32_bf16 v[120:123], v[160:163], v[200:203], v[120:123]
  v_mfma_f32_16x16x32_bf16 v[36:39], v[160:163], v[204:207], v[36:39]
  s_waitcnt vmcnt(18)
  v_mfma_f32_16x16x32_bf16 v[24:27], a[0:3], v[208:211], v[24:27]
  buffer_load_dwordx4 a[180:183], v7, s[24:27], s50 offen offset:0 sc1
  v_mfma_f32_16x16x32_bf16 v[84:87], a[0:3], v[212:215], v[84:87]
  v_mfma_f32_16x16x32_bf16 v[104:107], a[0:3], v[216:219], v[104:107]
  v_mfma_f32_16x16x32_bf16 v[40:43], a[0:3], v[220:223], v[40:43]
  v_mfma_f32_16x16x32_bf16 v[28:31], a[4:7], v[208:211], v[28:31]
  buffer_load_dwordx4 a[184:187], v7, s[24:27], s50 offen offset:1024 sc1
  v_mfma_f32_16x16x32_bf16 v[88:91], a[4:7], v[212:215], v[88:91]
  v_mfma_f32_16x16x32_bf16 v[108:111], a[4:7], v[216:219], v[108:111]
  v_mfma_f32_16x16x32_bf16 v[44:47], a[4:7], v[220:223], v[44:47]
  v_mfma_f32_16x16x32_bf16 v[56:59], a[8:11], v[208:211], v[56:59]
  buffer_load_dwordx4 a[188:191], v7, s[24:27], s50 offen offset:2048 sc1
  v_mfma_f32_16x16x32_bf16 v[92:95], a[8:11], v[212:215], v[92:95]
  v_mfma_f32_16x16x32_bf16 v[112:115], a[8:11], v[216:219], v[112:115]
  v_mfma_f32_16x16x32_bf16 v[48:51], a[8:11], v[220:223], v[48:51]
  v_mfma_f32_16x16x32_bf16 v[60:63], a[12:15], v[208:211], v[60:63]
  buffer_load_dwordx4 a[192:195], v7, s[24:27], s50 offen offset:3072 sc1
  v_mfma_f32_16x16x32_bf16 v[96:99], a[12:15], v[212:215], v[96:99]
  v_mfma_f32_16x16x32_bf16 v[116:119], a[12:15], v[216:219], v[116:119]
  v_mfma_f32_16x16x32_bf16 v[52:55], a[12:15], v[220:223], v[52:55]
  v_mfma_f32_16x16x32_bf16 v[32:35], a[16:19], v[208:211], v[32:35]
  buffer_load_dwordx4 a[196:199], v7, s[24:27], s51 offen offset:0 sc1
  v_mfma_f32_16x16x32_bf16 v[100:103], a[16:19], v[212:215], v[100:103]
  v_mfma_f32_16x16x32_bf16 v[120:123], a[16:19], v[216:219], v[120:123]
  v_mfma_f32_16x16x32_bf16 v[36:39], a[16:19], v[220:223], v[36:39]
  s_waitcnt vmcnt(19)
  v_mfma_f32_16x16x32_bf16 v[24:27], a[20:23], v[224:227], v[24:27]
  buffer_load_dwordx4 a[200:203], v4, s[24:27], s50 offen offset:0 sc1
  v_mfma_f32_16x16x32_bf16 v[84:87], a[20:23], v[228:231], v[84:87]
  v_mfma_f32_16x16x32_bf16 v[104:107], a[20:23], v[232:235], v[104:107]
  v_mfma_f32_16x16x32_bf16 v[40:43], a[20:23], v[236:239], v[40:43]
  buffer_load_dwordx4 a[204:207], v4, s[24:27], s50 offen offset:1024 sc1
  v_mfma_f32_16x16x32_bf16 v[28:31], a[24:27], v[224:227], v[28:31]
  v_mfma_f32_16x16x32_bf16 v[88:91], a[24:27], v[228:231], v[88:91]
  v_mfma_f32_16x16x32_bf16 v[108:111], a[24:27], v[232:235], v[108:111]
  v_mfma_f32_16x16x32_bf16 v[44:47], a[24:27], v[236:239], v[44:47]
  buffer_load_dwordx4 a[208:211], v4, s[24:27], s50 offen offset:2048 sc1
  v_mfma_f32_16x16x32_bf16 v[56:59], a[28:31], v[224:227], v[56:59]
  v_mfma_f32_16x16x32_bf16 v[92:95], a[28:31], v[228:231], v[92:95]
  v_mfma_f32_16x16x32_bf16 v[112:115], a[28:31], v[232:235], v[112:115]
  v_mfma_f32_16x16x32_bf16 v[48:51], a[28:31], v[236:239], v[48:51]
  buffer_load_dwordx4 a[212:215], v4, s[24:27], s50 offen offset:3072 sc1
  v_mfma_f32_16x16x32_bf16 v[60:63], a[32:35], v[224:227], v[60:63]
  v_mfma_f32_16x16x32_bf16 v[96:99], a[32:35], v[228:231], v[96:99]
  v_mfma_f32_16x16x32_bf16 v[116:119], a[32:35], v[232:235], v[116:119]
  v_mfma_f32_16x16x32_bf16 v[52:55], a[32:35], v[236:239], v[52:55]
  buffer_load_dwordx4 a[216:219], v4, s[24:27], s51 offen offset:0 sc1
  v_mfma_f32_16x16x32_bf16 v[32:35], a[36:39], v[224:227], v[32:35]
  v_mfma_f32_16x16x32_bf16 v[100:103], a[36:39], v[228:231], v[100:103]
  v_mfma_f32_16x16x32_bf16 v[120:123], a[36:39], v[232:235], v[120:123]
  v_mfma_f32_16x16x32_bf16 v[36:39], a[36:39], v[236:239], v[36:39]
  s_waitcnt vmcnt(15)
  v_mfma_f32_16x16x32_bf16 v[64:67], a[40:43], a[140:143], v[84:87]
  v_mfma_f32_16x16x32_bf16 v[68:71], a[44:47], a[140:143], v[88:91]
  v_mfma_f32_16x16x32_bf16 v[72:75], a[48:51], a[140:143], v[92:95]
  v_mfma_f32_16x16x32_bf16 v[76:79], a[52:55], a[140:143], v[96:99]
  v_mfma_f32_16x16x32_bf16 v[80:83], a[56:59], a[140:143], v[100:103]
  v_mfma_f32_16x16x32_bf16 v[64:67], a[60:63], a[144:147], v[64:67]
  v_mfma_f32_16x16x32_bf16 v[68:71], a[64:67], a[144:147], v[68:71]
  v_mfma_f32_16x16x32_bf16 v[72:75], a[68:71], a[144:147], v[72:75]
  v_mfma_f32_16x16x32_bf16 v[76:79], a[72:75], a[144:147], v[76:79]
  v_mfma_f32_16x16x32_bf16 v[80:83], a[76:79], a[144:147], v[80:83]
  v_mfma_f32_16x16x32_bf16 v[64:67], a[80:83], a[148:151], v[64:67]
  v_mfma_f32_16x16x32_bf16 v[68:71], a[84:87], a[148:151], v[68:71]
  v_mfma_f32_16x16x32_bf16 v[72:75], a[88:91], a[148:151], v[72:75]
  v_mfma_f32_16x16x32_bf16 v[76:79], a[92:95], a[148:151], v[76:79]
  v_mfma_f32_16x16x32_bf16 v[80:83], a[96:99], a[148:151], v[80:83]
  v_mfma_f32_16x16x32_bf16 v[64:67], a[100:103], a[152:155], v[64:67]
  v_mfma_f32_16x16x32_bf16 v[68:71], a[104:107], a[152:155], v[68:71]
  v_mfma_f32_16x16x32_bf16 v[72:75], a[108:111], a[152:155], v[72:75]
  v_mfma_f32_16x16x32_bf16 v[76:79], a[112:115], a[152:155], v[76:79]
  v_mfma_f32_16x16x32_bf16 v[80:83], a[116:119], a[152:155], v[80:83]
  v_mfma_f32_16x16x32_bf16 v[64:67], a[120:123], a[156:159], v[64:67]
  v_mfma_f32_16x16x32_bf16 v[68:71], a[124:127], a[156:159], v[68:71]
  v_mfma_f32_16x16x32_bf16 v[72:75], a[128:131], a[156:159], v[72:75]
  v_mfma_f32_16x16x32_bf16 v[76:79], a[132:135], a[156:159], v[76:79]
  v_mfma_f32_16x16x32_bf16 v[80:83], a[136:139], a[156:159], v[80:83]
  s_waitcnt vmcnt(10)
  v_mfma_f32_16x16x32_bf16 v[128:131], a[40:43], a[160:163], v[104:107]
  s_nop 1
  v_cmp_u_f32 vcc, v64, v64
  s_cbranch_vccnz .oc43
.ocb44:
  v_mfma_f32_16x16x32_bf16 v[132:135], a[44:47], a[160:163], v[108:111]
  ds_write_b128 v1, v[64:67] offset:0
  v_mfma_f32_16x16x32_bf16 v[136:139], a[48:51], a[160:163], v[112:115]
  ds_write_b128 v1, v[68:71] offset:1024
  v_mfma_f32_16x16x32_bf16 v[140:143], a[52:55], a[160:163], v[116:119]
  ds_write_b128 v1, v[72:75] offset:2048
  v_mfma_f32_16x16x32_bf16 v[160:163], a[56:59], a[160:163], v[120:123]
  ds_write_b128 v1, v[76:79] offset:3072
  v_mfma_f32_16x16x32_bf16 v[128:131], a[60:63], a[164:167], v[128:131]
  ds_write_b128 v1, v[80:83] offset:4096
  v_mfma_f32_16x16x32_bf16 v[132:135], a[64:67], a[164:167], v[132:135]
  v_mfma_f32_16x16x32_bf16 v[136:139], a[68:71], a[164:167], v[136:139]
  v_mfma_f32_16x16x32_bf16 v[140:143], a[72:75], a[164:167], v[140:143]
  v_mfma_f32_16x16x32_bf16 v[160:163], a[76:79], a[164:167], v[160:163]
  v_mfma_f32_16x16x32_bf16 v[128:131], a[80:83], a[168:171], v[128:131]
  v_mfma_f32_16x16x32_bf16 v[132:135], a[84:87], a[168:171], v[132:135]
  v_mfma_f32_16x16x32_bf16 v[136:139], a[88:91], a[168:171], v[136:139]
  v_mfma_f32_16x16x32_bf16 v[140:143], a[92:95], a[168:171], v[140:143]
  v_mfma_f32_16x16x32_bf16 v[160:163], a[96:99], a[168:171], v[160:163]
  v_mfma_f32_16x16x32_bf16 v[128:131], a[100:103], a[172:175], v[128:131]
  v_mfma_f32_16x16x32_bf16 v[132:135], a[104:107], a[172:175], v[132:135]
  v_mfma_f32_16x16x32_bf16 v[136:139], a[108:111], a[172:175], v[136:139]
  v_mfma_f32_16x16x32_bf16 v[140:143], a[112:115], a[172:175], v[140:143]
  v_mfma_f32_16x16x32_bf16 v[160:163], a[116:119], a[172:175], v[160:163]
  v_mfma_f32_16x16x32_bf16 v[128:131], a[120:123], a[176:179], v[128:131]
  v_mfma_f32_16x16x32_bf16 v[132:135], a[124:127], a[176:179], v[132:135]
  v_mfma_f32_16x16x32_bf16 v[136:139], a[128:131], a[176:179], v[136:139]
  v_mfma_f32_16x16x32_bf16 v[140:143], a[132:135], a[176:179], v[140:143]
  v_mfma_f32_16x16x32_bf16 v[160:163], a[136:139], a[176:179], v[160:163]
  s_waitcnt vmcnt(5)
  v_mfma_f32_16x16x32_bf16 v[84:87], a[40:43], a[180:183], v[40:43]
  s_nop 1
  v_cmp_u_f32 vcc, v128, v128
  s_cbranch_vccnz .oc45
.ocb46:
  v_mfma_f32_16x16x32_bf16 v[88:91], a[44:47], a[180:183], v[44:47]
  ds_write_b128 v1, v[128:131] offset:20480
  v_mfma_f32_16x16x32_bf16 v[92:95], a[48:51], a[180:183], v[48:51]
  ds_write_b128 v1, v[132:135] offset:21504
  v_mfma_f32_16x16x32_bf16 v[96:99], a[52:55], a[180:183], v[52:55]
  ds_write_b128 v1, v[136:139] offset:22528
  v_mfma_f32_16x16x32_bf16 v[100:103], a[56:59], a[180:183], v[36:39]
  ds_write_b128 v1, v[140:143] offset:23552
  v_mfma_f32_16x16x32_bf16 v[84:87], a[60:63], a[184:187], v[84:87]
  ds_write_b128 v1, v[160:163] offset:24576
  v_mfma_f32_16x16x32_bf16 v[88:91], a[64:67], a[184:187], v[88:91]
  v_mfma_f32_16x16x32_bf16 v[92:95], a[68:71], a[184:187], v[92:95]
  v_mfma_f32_16x16x32_bf16 v[96:99], a[72:75], a[184:187], v[96:99]
  v_mfma_f32_16x16x32_bf16 v[100:103], a[76:79], a[184:187], v[100:103]
  v_mfma_f32_16x16x32_bf16 v[84:87], a[80:83], a[188:191], v[84:87]
  v_mfma_f32_16x16x32_bf16 v[88:91], a[84:87], a[188:191], v[88:91]
  v_mfma_f32_16x16x32_bf16 v[92:95], a[88:91], a[188:191], v[92:95]
  v_mfma_f32_16x16x32_bf16 v[96:99], a[92:95], a[188:191], v[96:99]
  v_mfma_f32_16x16x32_bf16 v[100:103], a[96:99], a[188:191], v[100:103]
  v_mfma_f32_16x16x32_bf16 v[84:87], a[100:103], a[192:195], v[84:87]
  v_mfma_f32_16x16x32_bf16 v[88:91], a[104:107], a[192:195], v[88:91]
  v_mfma_f32_16x16x32_bf16 v[92:95], a[108:111], a[192:195], v[92:95]
  v_mfma_f32_16x16x32_bf16 v[96:99], a[112:115], a[192:195], v[96:99]
  v_mfma_f32_16x16x32_bf16 v[100:103], a[116:119], a[192:195], v[100:103]
  v_mfma_f32_16x16x32_bf16 v[84:87], a[120:123], a[196:199], v[84:87]
  v_mfma_f32_16x16x32_bf16 v[88:91], a[124:127], a[196:199], v[88:91]
  v_mfma_f32_16x16x32_bf16 v[92:95], a[128:131], a[196:199], v[92:95]
  v_mfma_f32_16x16x32_bf16 v[96:99], a[132:135], a[196:199], v[96:99]
  v_mfma_f32_16x16x32_bf16 v[100:103], a[136:139], a[196:199], v[100:103]
  s_waitcnt vmcnt(0)
  v_mfma_f32_16x16x32_bf16 v[104:107], a[40:43], a[200:203], v[24:27]
  s_nop 1
  v_cmp_u_f32 vcc, v84, v84
  s_cbranch_vccnz .oc47
.ocb48:
  v_mfma_f32_16x16x32_bf16 v[108:111], a[44:47], a[200:203], v[28:31]
  ds_write_b128 v1, v[84:87] offset:40960
  v_mfma_f32_16x16x32_bf16 v[112:115], a[48:51], a[200:203], v[56:59]
  ds_write_b128 v1, v[88:91] offset:41984
  v_mfma_f32_16x16x32_bf16 v[116:119], a[52:55], a[200:203], v[60:63]
  ds_write_b128 v1, v[92:95] offset:43008
  v_mfma_f32_16x16x32_bf16 v[120:123], a[56:59], a[200:203], v[32:35]
  ds_write_b128 v1, v[96:99] offset:44032
  v_mfma_f32_16x16x32_bf16 v[104:107], a[60:63], a[204:207], v[104:107]
  ds_write_b128 v1, v[100:103] offset:45056
  v_mfma_f32_16x16x32_bf16 v[108:111], a[64:67], a[204:207], v[108:111]
  v_mfma_f32_16x16x32_bf16 v[112:115], a[68:71], a[204:207], v[112:115]
  v_mfma_f32_16x16x32_bf16 v[116:119], a[72:75], a[204:207], v[116:119]
  v_mfma_f32_16x16x32_bf16 v[120:123], a[76:79], a[204:207], v[120:123]
  v_mfma_f32_16x16x32_bf16 v[104:107], a[80:83], a[208:211], v[104:107]
  v_mfma_f32_16x16x32_bf16 v[108:111], a[84:87], a[208:211], v[108:111]
  s_waitcnt lgkmcnt(0)
  s_barrier
  v_mfma_f32_16x16x32_bf16 v[112:115], a[88:91], a[208:211], v[112:115]
  ds_read_b128 v[192:195], v8 offset:0
  v_mfma_f32_16x16x32_bf16 v[116:119], a[92:95], a[208:211], v[116:119]
  ds_read_b128 v[196:199], v9 offset:0
  v_mfma_f32_16x16x32_bf16 v[120:123], a[96:99], a[208:211], v[120:123]
  ds_read_b128 v[200:203], v10 offset:0
  v_mfma_f32_16x16x32_bf16 v[104:107], a[100:103], a[212:215], v[104:107]
  ds_read_b128 v[204:207], v8 offset:1024
  v_mfma_f32_16x16x32_bf16 v[108:111], a[104:107], a[212:215], v[108:111]
  ds_read_b128 v[208:211], v9 offset:1024
  v_mfma_f32_16x16x32_bf16 v[112:115], a[108:111], a[212:215], v[112:115]
  ds_read_b128 v[212:215], v10 offset:1024
  v_mfma_f32_16x16x32_bf16 v[116:119], a[112:115], a[212:215], v[116:119]
  ds_read_b128 v[216:219], v8 offset:2048
  v_mfma_f32_16x16x32_bf16 v[120:123], a[116:119], a[212:215], v[120:123]
  ds_read_b128 v[220:223], v9 offset:2048
  v_mfma_f32_16x16x32_bf16 v[104:107], a[120:123], a[216:219], v[104:107]
  ds_read_b128 v[224:227], v10 offset:2048
  v_mfma_f32_16x16x32_bf16 v[108:111], a[124:127], a[216:219], v[108:111]
  ds_read_b128 v[228:231], v8 offset:3072
  v_mfma_f32_16x16x32_bf16 v[112:115], a[128:131], a[216:219], v[112:115]
  ds_read_b128 v[232:235], v9 offset:3072
  v_mfma_f32_16x16x32_bf16 v[116:119], a[132:135], a[216:219], v[116:119]
  ds_read_b128 v[236:239], v10 offset:3072
  v_mfma_f32_16x16x32_bf16 v[120:123], a[136:139], a[216:219], v[120:123]
  ds_read_b128 v[240:243], v8 offset:4096
  ds_read_b128 v[244:247], v9 offset:4096
  ds_read_b128 v[248:251], v10 offset:4096
  s_waitcnt lgkmcnt(10)
  v_add_f32 v192, v192, v196
  v_add_f32 v193, v193, v197
  v_cmp_u_f32 vcc, v104, v104
  s_cbranch_vccnz .oc49
.ocb50:
  v_add_f32 v194, v194, v198
  v_add_f32 v195, v195, v199
  v_add_f32 v192, v192, v200
  v_add_f32 v193, v193, v201
  v_add_f32 v194, v194, v202
  v_add_f32 v195, v195, v203
  v_add_f32 v204, v204, v208
  v_add_f32 v205, v205, v209
  v_add_f32 v206, v206, v210
  v_add_f32 v207, v207, v211
  s_waitcnt lgkmcnt(6)
  v_add_f32 v204, v204, v212
  v_add_f32 v205, v205, v213
  v_add_f32 v206, v206, v214
  v_add_f32 v207, v207, v215
  v_add_f32 v216, v216, v220
  v_add_f32 v217, v217, v221
  v_add_f32 v218, v218, v222
  v_add_f32 v219, v219, v223
  v_add_f32 v216, v216, v224
  v_add_f32 v217, v217, v225
  v_add_f32 v218, v218, v226
  v_add_f32 v219, v219, v227
  s_waitcnt lgkmcnt(3)
  v_add_f32 v228, v228, v232
  v_add_f32 v229, v229, v233
  v_add_f32 v230, v230, v234
  v_add_f32 v231, v231, v235
  v_add_f32 v228, v228, v236
  v_add_f32 v229, v229, v237
  v_add_f32 v230, v230, v238
  v_add_f32 v231, v231, v239
  s_waitcnt lgkmcnt(0)
  v_add_f32 v240, v240, v244
  v_add_f32 v241, v241, v245
  v_add_f32 v242, v242, v246
  v_add_f32 v243, v243, v247
  v_add_f32 v240, v240, v248
  v_add_f32 v241, v241, v249
  v_add_f32 v242, v242, v250
  v_add_f32 v243, v243, v251
  v_add_f32 v104, v104, v192
  v_add_f32 v105, v105, v193
  v_add_f32 v106, v106, v194
  v_add_f32 v107, v107, v195
  v_cvt_pk_bf16_f32 v104, v104, v105
  v_cvt_pk_bf16_f32 v105, v106, v107
  v_add_f32 v108, v108, v204
  v_add_f32 v109, v109, v205
  v_add_f32 v110, v110, v206
  v_add_f32 v111, v111, v207
  v_cvt_pk_bf16_f32 v106, v108, v109
  v_cvt_pk_bf16_f32 v107, v110, v111
  v_add_f32 v112, v112, v216
  buffer_store_dwordx4 v[104:107], v15, s[16:19], s62 offen offset:0
  v_add_f32 v113, v113, v217
  v_add_f32 v114, v114, v218
  v_add_f32 v115, v115, v219
  v_cvt_pk_bf16_f32 v112, v112, v113
  v_cvt_pk_bf16_f32 v113, v114, v115
  v_add_f32 v116, v116, v228
  v_add_f32 v117, v117, v229
  v_add_f32 v118, v118, v230
  v_add_f32 v119, v119, v231
  v_cvt_pk_bf16_f32 v114, v116, v117
  v_cvt_pk_bf16_f32 v115, v118, v119
  v_add_f32 v120, v120, v240
  buffer_store_dwordx4 v[112:115], v15, s[16:19], s62 offen offset:64
  v_add_f32 v121, v121, v241
  v_add_f32 v122, v122, v242
  v_add_f32 v123, v123, v243
  v_cvt_pk_bf16_f32 v120, v120, v121
  v_cvt_pk_bf16_f32 v121, v122, v123
  buffer_store_dwordx2 v[120:121], v12, s[16:19], s62 offen offset:128
  s_endpgm
.LH:
  s_lshl_b32 s87, s86, 11
  s_add_u32 s65, s65, s87
  s_cmp_eq_u32 s64, 15
  s_cselect_b32 s65, 1073741824, s65
  s_add_u32 s66, s65, 4096
  s_add_u32 s67, s65, 123392
  s_add_u32 s68, s66, 123392
  s_mul_i32 s64, s3, 3072
  s_add_u32 s64, s64, 65536
  s_add_u32 s87, s78, 4096
  s_waitcnt vmcnt(8)
  s_barrier
  ds_read_b128 a[0:3], v8 offset:0
  ds_read_b128 a[4:7], v8 offset:4096
  ds_read_b128 v[132:135], v152 offset:0
  ds_read_b128 a[8:11], v9 offset:0
  ds_read_b128 a[12:15], v9 offset:4096
  ds_read_b128 v[136:139], v152 offset:2048
  ds_read_b128 a[16:19], v8 offset:512
  ds_read_b128 a[20:23], v8 offset:4608
  ds_read_b128 v[140:143], v152 offset:512
  ds_read_b128 a[24:27], v9 offset:512
  ds_read_b128 a[28:31], v9 offset:4608
  ds_read_b128 v[144:147], v152 offset:2560
  s_cmp_eq_u32 s60, 2
  s_cselect_b32 s77, -1152, s74
  s_add_u32 m0, s62, 32768
  s_waitcnt lgkmcnt(9)
  buffer_load_dwordx4 v128, s[28:31], s59 offen offset:0 lds
  v_mfma_f32_16x16x32_bf16 v[176:179], v[132:135], v[132:135], 0
  v_mfma_f32_16x16x32_bf16 v[184:187], v[148:151], v[132:135], 0
  buffer_load_dwordx4 v129, s[28:31], s59 offen offset:1024 lds
  s_waitcnt lgkmcnt(6)
  buffer_load_dwordx4 v130, s[28:31], s59 offen offset:2048 lds
  v_mfma_f32_16x16x32_bf16 v[180:183], v[136:139], v[136:139], 0
  v_mfma_f32_16x16x32_bf16 v[188:191], v[148:151], v[136:139], 0
  s_waitcnt lgkmcnt(3)
  buffer_load_dwordx4 v131, s[28:31], s59 offen offset:3072 lds
  s_add_u32 s59, s59, s77
  s_sub_u32 m0, s90, 4096
  v_mfma_f32_16x16x32_bf16 v[176:179], v[140:143], v[140:143], v[176:179]
  v_mfma_f32_16x16x32_bf16 v[184:187], v[148:151], v[140:143], v[184:187]
  s_waitcnt lgkmcnt(0)
  buffer_load_dwordx4 v232, s[48:51], s76 offen offset:0 nt lds
  v_mfma_f32_16x16x32_bf16 v[180:183], v[144:147], v[144:147], v[180:183]
  v_mfma_f32_16x16x32_bf16 v[188:191], v[148:151], v[144:147], v[188:191]
  s_waitcnt vmcnt(5)
  buffer_store_dword v5, v37, s[52:55], s101 offen sc1
  s_barrier
  ds_read_b128 v[132:135], v152 offset:16384
  ds_read_b128 a[32:35], v8 offset:16384
  ds_read_b128 a[36:39], v8 offset:20480
  buffer_load_dwordx4 v233, s[48:51], s76 offen offset:1024 nt lds
  ds_read_b128 v[136:139], v152 offset:18432
  ds_read_b128 a[40:43], v9 offset:16384
  ds_read_b128 a[44:47], v9 offset:20480
  buffer_load_dwordx4 v234, s[48:51], s76 offen offset:2048 nt lds
  ds_read_b128 v[140:143], v152 offset:16896
  ds_read_b128 a[48:51], v8 offset:16896
  ds_read_b128 a[52:55], v8 offset:20992
  s_waitcnt lgkmcnt(5)
  v_mfma_f32_16x16x32_bf16 v[176:179], v[132:135], v[132:135], v[176:179]
  v_mfma_f32_16x16x32_bf16 v[184:187], v[148:151], v[132:135], v[184:187]
  ds_read_b128 v[144:147], v152 offset:18944
  buffer_load_dwordx4 v235, s[48:51], s76 offen offset:3072 nt lds
  s_mov_b32 m0, s90
  ds_read_b128 a[56:59], v9 offset:16896
  ds_read_b128 a[60:63], v9 offset:20992
  v_mfma_f32_16x16x32_bf16 v[180:183], v[136:139], v[136:139], v[180:183]
  v_mfma_f32_16x16x32_bf16 v[188:191], v[148:151], v[136:139], v[188:191]
  buffer_load_dwordx4 v236, s[48:51], s76 offen nt lds
  s_cmp_eq_u32 s60, 3
  s_cselect_b32 s77, -1152, s74
  s_add_u32 m0, s62, 49152
  s_waitcnt lgkmcnt(5)
  buffer_load_dwordx4 v128, s[28:31], s59 offen offset:0 lds
  v_mfma_f32_16x16x32_bf16 v[176:179], v[140:143], v[140:143], v[176:179]
  v_mfma_f32_16x16x32_bf16 v[184:187], v[148:151], v[140:143], v[184:187]
  buffer_load_dwordx4 v129, s[28:31], s59 offen offset:1024 lds
  s_waitcnt lgkmcnt(2)
  v_mfma_f32_16x16x32_bf16 v[180:183], v[144:147], v[144:147], v[180:183]
  v_mfma_f32_16x16x32_bf16 v[188:191], v[148:151], v[144:147], v[188:191]
  s_waitcnt vmcnt(8) lgkmcnt(0)
  s_barrier
  ds_read_b128 v[132:135], v152 offset:32768
  buffer_load_dwordx4 v130, s[28:31], s59 offen offset:2048 lds
  ds_read_b128 a[64:67], v8 offset:32768
  ds_read_b128 a[68:71], v8 offset:36864
  ds_read_b128 v[136:139], v152 offset:34816
  ds_read_b128 a[72:75], v9 offset:32768
  ds_read_b128 a[76:79], v9 offset:36864
  buffer_load_dwordx4 v131, s[28:31], s59 offen offset:3072 lds
  ds_read_b128 v[140:143], v152 offset:33280
  s_add_u32 s59, s59, s77
  s_cmp_eq_u32 s60, 4
  s_cselect_b32 s77, -1152, s74
  s_add_u32 m0, s62, 0
  ds_read_b128 a[80:83], v8 offset:33280
  ds_read_b128 a[84:87], v8 offset:37376
  s_waitcnt lgkmcnt(5)
  v_mfma_f32_16x16x32_bf16 v[176:179], v[132:135], v[132:135], v[176:179]
  v_mfma_f32_16x16x32_bf16 v[184:187], v[148:151], v[132:135], v[184:187]
  ds_read_b128 v[144:147], v152 offset:35328
  buffer_load_dwordx4 v128, s[28:31], s59 offen offset:0 lds
  ds_read_b128 a[88:91], v9 offset:33280
  ds_read_b128 a[92:95], v9 offset:37376
  buffer_load_dwordx4 v129, s[28:31], s59 offen offset:1024 lds
  v_mfma_f32_16x16x32_bf16 v[180:183], v[136:139], v[136:139], v[180:183]
  v_mfma_f32_16x16x32_bf16 v[188:191], v[148:151], v[136:139], v[188:191]
  s_waitcnt vmcnt(6)
  ds_read_b64_tr_b16 v[156:157], v20 offset:0
  ds_read_b64_tr_b16 v[158:159], v20 offset:256
  ds_read_b64_tr_b16 v[160:161], v21 offset:0
  ds_read_b64_tr_b16 v[162:163], v21 offset:256
  ds_read_b64_tr_b16 v[164:165], v20 offset:512
  ds_read_b64_tr_b16 v[166:167], v20 offset:768
  buffer_load_dwordx4 v130, s[28:31], s59 offen offset:2048 lds
  ds_read_b64_tr_b16 v[168:169], v21 offset:512
  ds_read_b64_tr_b16 v[170:171], v21 offset:768
  ds_read_b64_tr_b16 v[172:173], v155 offset:0
  ds_read_b64_tr_b16 v[174:175], v155 offset:512
  s_waitcnt lgkmcnt(15)
  buffer_load_dwordx4 v131, s[28:31], s59 offen offset:3072 lds
  s_add_u32 s59, s59, s77
  v_mfma_f32_16x16x32_bf16 v[176:179], v[140:143], v[140:143], v[176:179]
  v_mfma_f32_16x16x32_bf16 v[184:187], v[148:151], v[140:143], v[184:187]
  s_cmp_eq_u32 s60, 5
  s_cselect_b32 s77, -1152, s74
  s_add_u32 m0, s62, 16384
  s_waitcnt lgkmcnt(0)
  buffer_store_dwordx4 v[156:159], v14, s[24:27], s78 offen offset:0 sc1
  buffer_store_dwordx4 v[160:163], v14, s[24:27], s78 offen offset:1024 sc1
  buffer_store_dwordx4 v[164:167], v14, s[24:27], s78 offen offset:2048 sc1
  buffer_store_dwordx4 v[168:171], v14, s[24:27], s78 offen offset:3072 sc1
  buffer_store_dwordx4 v[172:175], v14, s[24:27], s87 offen offset:0 sc1
  v_mfma_f32_16x16x32_bf16 v[180:183], v[144:147], v[144:147], v[180:183]
  v_mfma_f32_16x16x32_bf16 v[188:191], v[148:151], v[144:147], v[188:191]
  s_waitcnt vmcnt(9)
  s_barrier
  ds_read_b128 v[132:135], v152 offset:49152
  buffer_load_dwordx4 v128, s[28:31], s59 offen offset:0 lds
  ds_read_b128 a[96:99], v8 offset:49152
  ds_read_b128 a[100:103], v8 offset:53248
  buffer_load_dwordx4 v129, s[28:31], s59 offen offset:1024 lds
  ds_read_b128 v[136:139], v152 offset:51200
  ds_read_b128 a[104:107], v9 offset:49152
  ds_read_b128 a[108:111], v9 offset:53248
  buffer_load_dwordx4 v130, s[28:31], s59 offen offset:2048 lds
  ds_read_b128 v[140:143], v152 offset:49664
  ds_read_b128 a[112:115], v8 offset:49664
  ds_read_b128 a[116:119], v8 offset:53760
  s_waitcnt lgkmcnt(5)
  v_mfma_f32_16x16x32_bf16 v[176:179], v[132:135], v[132:135], v[176:179]
  v_mfma_f32_16x16x32_bf16 v[184:187], v[148:151], v[132:135], v[184:187]
  ds_read_b128 v[144:147], v152 offset:51712
  buffer_load_dwordx4 v131, s[28:31], s59 offen offset:3072 lds
  s_add_u32 s59, s59, s77
  ds_read_b128 a[120:123], v9 offset:49664
  ds_read_b128 a[124:127], v9 offset:53760
  s_cmp_eq_u32 s60, 6
  s_cselect_b32 s77, -1152, s74
  s_add_u32 m0, s62, 32768
  v_mfma_f32_16x16x32_bf16 v[180:183], v[136:139], v[136:139], v[180:183]
  v_mfma_f32_16x16x32_bf16 v[188:191], v[148:151], v[136:139], v[188:191]
  buffer_load_dwordx4 v128, s[28:31], s59 offen offset:0 lds
  buffer_load_dwordx4 v129, s[28:31], s59 offen offset:1024 lds
  s_waitcnt lgkmcnt(5)
  v_mfma_f32_16x16x32_bf16 v[176:179], v[140:143], v[140:143], v[176:179]
  v_mfma_f32_16x16x32_bf16 v[184:187], v[148:151], v[140:143], v[184:187]
  buffer_load_dwordx4 v130, s[28:31], s59 offen offset:2048 lds
  s_waitcnt lgkmcnt(2)
  v_mfma_f32_16x16x32_bf16 v[180:183], v[144:147], v[144:147], v[180:183]
  v_mfma_f32_16x16x32_bf16 v[188:191], v[148:151], v[144:147], v[188:191]
  s_waitcnt vmcnt(12) lgkmcnt(0)
  s_barrier
  ds_read_b128 v[132:135], v152 offset:0
  buffer_load_dwordx4 v131, s[28:31], s59 offen offset:3072 lds
  ds_read_b128 a[128:131], v8 offset:0
  ds_read_b128 a[132:135], v8 offset:4096
  s_add_u32 s59, s59, s77
  s_cmp_eq_u32 s60, 7
  s_cselect_b32 s77, -1152, s74
  s_add_u32 m0, s62, 49152
  ds_read_b128 v[136:139], v152 offset:2048
  buffer_load_dwordx4 v128, s[28:31], s59 offen offset:0 lds
  ds_read_b128 a[136:139], v9 offset:0
  ds_read_b128 a[140:143], v9 offset:4096
  ds_read_b128 v[140:143], v152 offset:512
  ds_read_b128 a[144:147], v8 offset:512
  ds_read_b128 a[148:151], v8 offset:4608
  s_waitcnt lgkmcnt(5)
  buffer_load_dwordx4 v129, s[28:31], s59 offen offset:1024 lds
  v_mfma_f32_16x16x32_bf16 v[176:179], v[132:135], v[132:135], v[176:179]
  v_mfma_f32_16x16x32_bf16 v[184:187], v[148:151], v[132:135], v[184:187]
  ds_read_b128 v[144:147], v152 offset:2560
  ds_read_b128 a[152:155], v9 offset:512
  ds_read_b128 a[156:159], v9 offset:4608
  buffer_load_dwordx4 v130, s[28:31], s59 offen offset:2048 lds
  v_mfma_f32_16x16x32_bf16 v[180:183], v[136:139], v[136:139], v[180:183]
  v_mfma_f32_16x16x32_bf16 v[188:191], v[148:151], v[136:139], v[188:191]
  buffer_load_dwordx4 v131, s[28:31], s59 offen offset:3072 lds
  s_add_u32 s59, s59, s77
  s_waitcnt lgkmcnt(5)
  v_mfma_f32_16x16x32_bf16 v[176:179], v[140:143], v[140:143], v[176:179]
  v_mfma_f32_16x16x32_bf16 v[184:187], v[148:151], v[140:143], v[184:187]
  s_waitcnt lgkmcnt(2)
  v_mfma_f32_16x16x32_bf16 v[180:183], v[144:147], v[144:147], v[180:183]
  v_mfma_f32_16x16x32_bf16 v[188:191], v[148:151], v[144:147], v[188:191]
  s_waitcnt vmcnt(8) lgkmcnt(0)
  s_barrier
  ds_read_b128 v[132:135], v152 offset:16384
  s_cmp_eq_u32 s60, 8
  s_cselect_b32 s77, -1152, s74
  s_add_u32 m0, s62, 0
  ds_read_b128 a[160:163], v8 offset:16384
  ds_read_b128 a[164:167], v8 offset:20480
  buffer_load_dwordx4 v128, s[28:31], s59 offen offset:0 lds
  ds_read_b128 v[136:139], v152 offset:18432
  buffer_load_dwordx4 v129, s[28:31], s59 offen offset:1024 lds
  ds_read_b128 a[168:171], v9 offset:16384
  ds_read_b128 a[172:175], v9 offset:20480
  ds_read_b128 v[140:143], v152 offset:16896
  ds_read_b128 a[176:179], v8 offset:16896
  ds_read_b128 a[180:183], v8 offset:20992
  s_waitcnt lgkmcnt(5)
  buffer_load_dwordx4 v130, s[28:31], s59 offen offset:2048 lds
  v_mfma_f32_16x16x32_bf16 v[176:179], v[132:135], v[132:135], v[176:179]
  v_mfma_f32_16x16x32_bf16 v[184:187], v[148:151], v[132:135], v[184:187]
  ds_read_b128 v[144:147], v152 offset:18944
  ds_read_b128 a[184:187], v9 offset:16896
  ds_read_b128 a[188:191], v9 offset:20992
  buffer_load_dwordx4 v131, s[28:31], s59 offen offset:3072 lds
  s_add_u32 s59, s59, s77
  v_mfma_f32_16x16x32_bf16 v[180:183], v[136:139], v[136:139], v[180:183]
  v_mfma_f32_16x16x32_bf16 v[188:191], v[148:151], v[136:139], v[188:191]
  s_waitcnt lgkmcnt(5)
  v_mfma_f32_16x16x32_bf16 v[176:179], v[140:143], v[140:143], v[176:179]
  v_mfma_f32_16x16x32_bf16 v[184:187], v[148:151], v[140:143], v[184:187]
  s_waitcnt lgkmcnt(2)
  v_mfma_f32_16x16x32_bf16 v[180:183], v[144:147], v[144:147], v[180:183]
  v_mfma_f32_16x16x32_bf16 v[188:191], v[148:151], v[144:147], v[188:191]
  s_waitcnt vmcnt(8) lgkmcnt(0)
  s_barrier
  ds_read_b128 v[132:135], v152 offset:32768
  s_add_u32 m0, s62, 16384
  ds_read_b128 a[192:195], v8 offset:32768
  ds_read_b128 a[196:199], v8 offset:36864
  buffer_load_dwordx4 v128, s[28:31], s59 offen offset:0 lds
  ds_read_b128 v[136:139], v152 offset:34816
  buffer_load_dwordx4 v129, s[28:31], s59 offen offset:1024 lds
  ds_read_b128 a[200:203], v9 offset:32768
  ds_read_b128 a[204:207], v9 offset:36864
  ds_read_b128 v[140:143], v152 offset:33280
  ds_read_b128 a[208:211], v8 offset:33280
  ds_read_b128 a[212:215], v8 offset:37376
  s_waitcnt lgkmcnt(5)
  buffer_load_dwordx4 v130, s[28:31], s59 offen offset:2048 lds
  v_mfma_f32_16x16x32_bf16 v[176:179], v[132:135], v[132:135], v[176:179]
  v_mfma_f32_16x16x32_bf16 v[184:187], v[148:151], v[132:135], v[184:187]
  ds_read_b128 v[144:147], v152 offset:35328
  ds_read_b128 a[216:219], v9 offset:33280
  ds_read_b128 a[220:223], v9 offset:37376
  buffer_load_dwordx4 v131, s[28:31], s59 offen offset:3072 lds
  v_mov_b32 v1, v154
  v_mfma_f32_16x16x32_bf16 v[180:183], v[136:139], v[136:139], v[180:183]
  v_add_u32 v2, 23552, v1
  v_mfma_f32_16x16x32_bf16 v[188:191], v[148:151], v[136:139], v[188:191]
  s_mul_i32 s32, s11, 348160
  s_add_u32 s32, s32, 18874368
  s_lshl3_add_u32 s59, s63, s32
  buffer_load_dword v10, v37, s[52:55], 0 offen offset:0 sc1
  s_add_u32 m0, s61, 65536
  s_lshl2_add_u32 s60, s63, s32
  buffer_load_dwordx4 v1, s[36:39], s4 offen offset:0 lds
  s_add_u32 s75, s60, s63
  s_add_u32 s60, s60, 163840
  s_add_u32 s75, s75, 245760
  s_add_u32 s74, s60, 10240
  s_lshl2_add_u32 s33, s93, s3
  s_mul_i32 s33, s33, 10880
  s_add_u32 s33, s33, s32
  s_lshl_b32 s34, s11, 7
  s_lshr_b32 s35, s11, 2
  s_lshl_b32 s35, s35, 6
  s_and_b32 s62, s11, 3
  s_lshl3_add_u32 s35, s62, s35
  s_add_u32 s35, s35, 928
  s_lshl2_add_u32 s62, s10, s3
  s_mul_i32 s62, s62, 20480
  s_mul_i32 s32, s11, 160
  s_add_u32 s62, s62, s32
  s_lshl_b32 s93, s93, 7
  s_sub_u32 s93, s93, 128
  s_waitcnt lgkmcnt(5)
  buffer_load_dwordx4 v2, s[36:39], s4 offen offset:1024 lds
  v_mfma_f32_16x16x32_bf16 v[176:179], v[140:143], v[140:143], v[176:179]
  v_mfma_f32_16x16x32_bf16 v[184:187], v[148:151], v[140:143], v[184:187]
  s_add_u32 m0, s61, 67584
  s_waitcnt lgkmcnt(2)
  buffer_load_dwordx4 v1, s[40:43], s4 offen offset:0 lds
  v_mfma_f32_16x16x32_bf16 v[180:183], v[144:147], v[144:147], v[180:183]
  v_mfma_f32_16x16x32_bf16 v[188:191], v[148:151], v[144:147], v[188:191]
  s_waitcnt vmcnt(12) lgkmcnt(0)
  s_barrier
  ds_read_b128 v[132:135], v152 offset:49152
  ds_read_b128 a[224:227], v8 offset:49152
  ds_read_b128 a[228:231], v8 offset:53248
  ds_read_b128 v[136:139], v152 offset:51200
  ds_read_b128 a[232:235], v9 offset:49152
  ds_read_b128 a[236:239], v9 offset:53248
  buffer_load_dwordx4 v2, s[40:43], s4 offen offset:1024 lds
  ds_read_b128 v[140:143], v152 offset:49664
  ds_read_b128 a[240:243], v8 offset:49664
  ds_read_b128 a[244:247], v8 offset:53760
  s_waitcnt lgkmcnt(5)
  s_add_u32 m0, s61, 81920
  v_mfma_f32_16x16x32_bf16 v[176:179], v[132:135], v[132:135], v[176:179]
  v_mfma_f32_16x16x32_bf16 v[184:187], v[148:151], v[132:135], v[184:187]
  ds_read_b128 v[144:147], v152 offset:51712
  buffer_load_dwordx4 v1, s[36:39], s5 offen offset:0 lds
  ds_read_b128 a[248:251], v9 offset:49664
  ds_read_b128 a[252:255], v9 offset:53760
  v_mfma_f32_16x16x32_bf16 v[180:183], v[136:139], v[136:139], v[180:183]
  v_mfma_f32_16x16x32_bf16 v[188:191], v[148:151], v[136:139], v[188:191]
  buffer_load_dwordx4 v2, s[36:39], s5 offen offset:1024 lds
  s_add_u32 m0, s61, 83968
  s_waitcnt lgkmcnt(5)
  v_mfma_f32_16x16x32_bf16 v[176:179], v[140:143], v[140:143], v[176:179]
  v_mfma_f32_16x16x32_bf16 v[184:187], v[148:151], v[140:143], v[184:187]
  buffer_load_dwordx4 v1, s[40:43], s5 offen offset:0 lds
  s_waitcnt lgkmcnt(2)
  v_mfma_f32_16x16x32_bf16 v[180:183], v[144:147], v[144:147], v[180:183]
  v_mfma_f32_16x16x32_bf16 v[188:191], v[148:151], v[144:147], v[188:191]
  s_waitcnt vmcnt(12) lgkmcnt(0)
  s_barrier
  ds_read_b128 v[132:135], v152 offset:0
  buffer_load_dwordx4 v2, s[40:43], s5 offen offset:1024 lds
  ds_read_b128 v[192:195], v8 offset:0
  ds_read_b128 v[196:199], v8 offset:4096
  s_and_b32 s77, s3, 2
  s_lshl_b32 s77, s77, 4
  v_lshrrev_b32 v2, 5, v0
  v_mul_u32_u24 v2, 24512, v2
  ds_read_b128 v[136:139], v152 offset:2048
  v_xad_u32 v2, v1, s77, v2
  v_add_u32 v2, s58, v2
  s_add_u32 s77, s12, 97280
  s_add_u32 m0, s61, 131072
  ds_read_b128 v[200:203], v9 offset:0
  ds_read_b128 v[204:207], v9 offset:4096
  buffer_load_dwordx4 v2, s[44:47], s12 offen offset:0 lds
  ds_read_b128 v[140:143], v152 offset:512
  s_waitcnt vmcnt(9)
  v_cmp_eq_u32 vcc, 0, v10
  s_cbranch_vccnz .slow51
.back52:
  ds_read_b128 v[208:211], v8 offset:512
  ds_read_b128 v[212:215], v8 offset:4608
  s_waitcnt lgkmcnt(5)
  v_mfma_f32_16x16x32_bf16 v[176:179], v[132:135], v[132:135], v[176:179]
  v_mfma_f32_16x16x32_bf16 v[184:187], v[148:151], v[132:135], v[184:187]
  ds_read_b128 v[144:147], v152 offset:2560
  ds_read_b128 v[216:219], v9 offset:512
  ds_read_b128 v[220:223], v9 offset:4608
  v_mfma_f32_16x16x32_bf16 v[180:183], v[136:139], v[136:139], v[180:183]
  v_mfma_f32_16x16x32_bf16 v[188:191], v[148:151], v[136:139], v[188:191]
  buffer_load_dwordx4 v2, s[44:47], s77 offen offset:1024 lds
  s_add_u32 s77, s13, 97280
  s_waitcnt lgkmcnt(5)
  s_add_u32 m0, s61, 133120
  v_mfma_f32_16x16x32_bf16 v[176:179], v[140:143], v[140:143], v[176:179]
  v_mfma_f32_16x16x32_bf16 v[184:187], v[148:151], v[140:143], v[184:187]
  buffer_load_dwordx4 v2, s[44:47], s13 offen offset:0 lds
  s_waitcnt lgkmcnt(2)
  v_mfma_f32_16x16x32_bf16 v[180:183], v[144:147], v[144:147], v[180:183]
  v_mfma_f32_16x16x32_bf16 v[188:191], v[148:151], v[144:147], v[188:191]
  s_waitcnt lgkmcnt(0)
  s_barrier
  ds_read_b128 v[132:135], v152 offset:16384
  ds_read_b128 v[224:227], v8 offset:16384
  ds_read_b128 v[228:231], v8 offset:20480
  ds_read_b128 v[136:139], v152 offset:18432
  ds_read_b128 v[232:235], v9 offset:16384
  ds_read_b128 v[236:239], v9 offset:20480
  buffer_load_dwordx4 v2, s[44:47], s77 offen offset:1024 lds
  ds_read_b128 v[140:143], v152 offset:16896
  v_add_u32 v2, 23552, v1
  ds_read_b128 v[240:243], v8 offset:16896
  ds_read_b128 v[244:247], v8 offset:20992
  s_waitcnt lgkmcnt(5)
  v_mfma_f32_16x16x32_bf16 v[176:179], v[132:135], v[132:135], v[176:179]
  v_mfma_f32_16x16x32_bf16 v[184:187], v[148:151], v[132:135], v[184:187]
  s_add_u32 m0, s61, 0
  ds_read_b128 v[144:147], v152 offset:18944
  ds_read_b128 v[248:251], v9 offset:16896
  ds_read_b128 v[252:255], v9 offset:20992
  buffer_load_dwordx4 v1, s[36:39], s6 offen offset:0 lds
  v_mfma_f32_16x16x32_bf16 v[180:183], v[136:139], v[136:139], v[180:183]
  v_mfma_f32_16x16x32_bf16 v[188:191], v[148:151], v[136:139], v[188:191]
  buffer_load_dwordx4 v2, s[36:39], s6 offen offset:1024 lds
  s_add_u32 m0, s61, 2048
  s_waitcnt lgkmcnt(5)
  buffer_load_dwordx4 v1, s[40:43], s6 offen offset:0 lds
  v_mfma_f32_16x16x32_bf16 v[176:179], v[140:143], v[140:143], v[176:179]
  v_mfma_f32_16x16x32_bf16 v[184:187], v[148:151], v[140:143], v[184:187]
  s_waitcnt lgkmcnt(2)
  buffer_load_dwordx4 v2, s[40:43], s6 offen offset:1024 lds
  v_mfma_f32_16x16x32_bf16 v[180:183], v[144:147], v[144:147], v[180:183]
  s_add_u32 m0, s61, 16384
  v_mfma_f32_16x16x32_bf16 v[188:191], v[148:151], v[144:147], v[188:191]
  s_waitcnt vmcnt(12) lgkmcnt(0)
  s_barrier
  ds_read_b64_tr_b16 v[48:49], v5 offset:0
  ds_read_b64_tr_b16 v[50:51], v5 offset:256
  buffer_load_dwordx4 v1, s[36:39], s7 offen offset:0 lds
  ds_read_b64_tr_b16 v[52:53], v5 offset:2048
  ds_read_b64_tr_b16 v[54:55], v5 offset:2304
  v_cndmask_b32 v180, v180, v181, s[0:1]
  v_cndmask_b32 v182, v182, v183, s[0:1]
  v_cndmask_b32 v176, v176, v177, s[0:1]
  v_cndmask_b32 v178, v178, v179, s[0:1]
  v_cndmask_b32 v180, v180, v182, s[88:89]
  v_cndmask_b32 v176, v176, v178, s[88:89]
  ds_read_b64_tr_b16 v[56:57], v7 offset:0
  ds_read_b64_tr_b16 v[58:59], v7 offset:256
  s_mov_b32 vcc_lo, 0x00f0000f
  s_mov_b32 vcc_hi, 0xf0000f00
  v_cndmask_b32_dpp v10, v188, v184, vcc row_ror:8 row_mask:0xf bank_mask:0xf
  v_cndmask_b32_dpp v11, v180, v176, vcc row_ror:8 row_mask:0xf bank_mask:0xf
  buffer_load_dwordx4 v2, s[36:39], s7 offen offset:1024 lds
  v_mul_f32 v10, 0xbacccccd, v10
  s_add_u32 m0, s61, 18432
  v_mul_f32 v11, 0x3acccccd, v11
  ds_read_b64_tr_b16 v[60:61], v7 offset:2048
  ds_read_b64_tr_b16 v[62:63], v7 offset:2304
  v_fma_f32 v11, -v10, v10, v11
  v_max_f32 v11, 0, v11
  v_cvt_pk_bf16_f32 v11, v11, v11
  v_lshlrev_b32 v11, 16, v11
  v_add_f32 v11, 0x3727c5ac, v11
  v_cvt_pk_bf16_f32 v11, v11, v11
  buffer_load_dwordx4 v1, s[40:43], s7 offen offset:0 lds
  v_lshlrev_b32 v11, 16, v11
  v_sqrt_f32 v11, v11
  v_cvt_pk_bf16_f32 v10, v10, v10
  v_cvt_pk_bf16_f32 v11, v11, v11
  v_lshlrev_b32 v11, 16, v11
  v_rcp_f32 v11, v11
  s_nop 0
  ds_write2_b32 v23, v10, v11 offset0:0 offset1:128
  v_mov_b32_dpp v32, v32 quad_perm:[3,0,1,2] row_mask:0xf bank_mask:0xf
  v_mov_b32_dpp v33, v33 quad_perm:[3,0,1,2] row_mask:0xf bank_mask:0xf
  v_mov_b32_dpp v34, v34 quad_perm:[3,0,1,2] row_mask:0xf bank_mask:0xf
  v_mov_b32_dpp v35, v35 quad_perm:[3,0,1,2] row_mask:0xf bank_mask:0xf
  s_waitcnt lgkmcnt(5)
  v_mfma_f32_32x32x16_bf16 v[128:143], v[48:51], a[0:3], 0
  ds_read_b64_tr_b16 v[40:41], v5 offset:8192
  ds_read_b64_tr_b16 v[42:43], v5 offset:8448
  buffer_load_dwordx4 v2, s[40:43], s7 offen offset:1024 lds
  s_and_b32 s77, s3, 2
  v_mfma_f32_32x32x16_bf16 v[160:175], v[48:51], a[4:7], 0
  s_lshl_b32 s77, s77, 4
  v_lshrrev_b32 v2, 5, v0
  v_mul_u32_u24 v2, 24512, v2
  v_xad_u32 v2, v1, s77, v2
  v_add_u32 v2, s58, v2
  s_add_u32 s77, s8, 97280
  v_mfma_f32_16x16x32_bf16 v[24:27], v[32:35], v[48:51], 0
  s_add_u32 m0, s61, 98304
  v_mfma_f32_32x32x16_bf16 v[144:159], v[52:55], a[0:3], 0
  ds_read_b64_tr_b16 v[44:45], v5 offset:10240
  ds_read_b64_tr_b16 v[46:47], v5 offset:10496
  buffer_load_dwordx4 v2, s[44:47], s8 offen offset:0 lds
  v_mfma_f32_32x32x16_bf16 v[176:191], v[52:55], a[4:7], 0
  v_mfma_f32_16x16x32_bf16 v[28:31], v[32:35], v[52:55], 0
  s_waitcnt lgkmcnt(5)
  v_mfma_f32_32x32x16_bf16 v[128:143], v[56:59], a[8:11], v[128:143]
  ds_read_b64_tr_b16 v[48:49], v7 offset:8192
  ds_read_b64_tr_b16 v[50:51], v7 offset:8448
  v_cvt_pk_bf16_f32 v8, v24, v24
  v_mfma_f32_32x32x16_bf16 v[160:175], v[56:59], a[12:15], v[160:175]
  ds_read_b64_tr_b16 v[52:53], v7 offset:10240
  ds_read_b64_tr_b16 v[54:55], v7 offset:10496
  buffer_load_dwordx4 v2, s[44:47], s77 offen offset:1024 lds
  s_add_u32 s77, s9, 97280
  v_mfma_f32_32x32x16_bf16 v[144:159], v[60:63], a[8:11], v[144:159]
  v_cvt_pk_bf16_f32 v9, v28, v28
  v_lshlrev_b32 v8, 16, v8
  v_lshlrev_b32 v9, 16, v9
  v_sub_f32 v8, v24, v8
  v_sub_f32 v9, v28, v9
  v_cvt_pk_bf16_f32 v8, v24, v8
  v_mfma_f32_32x32x16_bf16 v[176:191], v[60:63], a[12:15], v[176:191]
  v_cvt_pk_bf16_f32 v9, v28, v9
  ds_write2_b32 v15, v8, v9 offset0:0 offset1:32
  s_waitcnt lgkmcnt(5)
  v_mfma_f32_32x32x16_bf16 v[128:143], v[40:43], a[16:19], v[128:143]
  s_waitcnt vmcnt(14) lgkmcnt(0)
  s_barrier
  ds_read_b64_tr_b16 v[56:57], v5 offset:16384
  ds_read_b64_tr_b16 v[58:59], v5 offset:16640
  s_add_u32 m0, s61, 100352
  ds_read2_b32 v[8:9], v16 offset0:0 offset1:32
  v_mfma_f32_32x32x16_bf16 v[160:175], v[40:43], a[20:23], v[160:175]
  buffer_load_dwordx4 v2, s[44:47], s9 offen offset:0 lds
  ds_read2_b32 v[10:11], v16 offset0:32 offset1:0
  ds_read_b32 v36, v19
  ds_read_b32 v38, v19 offset:128
  v_mfma_f32_16x16x32_bf16 v[24:27], v[32:35], v[40:43], v[24:27]
  ds_read2_b32 v[18:19], v19 offset0:128 offset1:160
  v_mfma_f32_32x32x16_bf16 v[144:159], v[44:47], a[16:19], v[144:159]
  ds_read_b64_tr_b16 v[60:61], v5 offset:18432
  ds_read_b64_tr_b16 v[62:63], v5 offset:18688
  buffer_store_dword v0, v17, s[24:27], s80 offen sc1
  v_mfma_f32_32x32x16_bf16 v[176:191], v[44:47], a[20:23], v[176:191]
  v_mfma_f32_16x16x32_bf16 v[28:31], v[32:35], v[44:47], v[28:31]
  v_mfma_f32_32x32x16_bf16 v[128:143], v[48:51], a[24:27], v[128:143]
  ds_read_b64_tr_b16 v[40:41], v7 offset:16384
  ds_read_b64_tr_b16 v[42:43], v7 offset:16640
  buffer_load_dwordx4 v2, s[44:47], s77 offen offset:1024 lds
  v_add_u32 v2, 23552, v1
  v_mfma_f32_32x32x16_bf16 v[160:175], v[48:51], a[28:31], v[160:175]
  s_waitcnt lgkmcnt(5)
  s_waitcnt lgkmcnt(4)
  v_mul_f32 v18, v18, v18
  v_mul_f32 v19, v19, v19
  v_lshl_add_u32 v93, v0, 2, s34
  v_and_b32 v72, 1, v0
  v_mfma_f32_32x32x16_bf16 v[144:159], v[52:55], a[24:27], v[144:159]
  ds_read_b64_tr_b16 v[44:45], v7 offset:18432
  ds_read_b64_tr_b16 v[46:47], v7 offset:18688
  v_lshl_add_u32 v72, v72, 2, s35
  s_mov_b32 s0, -1
  s_mov_b32 s1, 0
  v_cndmask_b32 v93, v72, v93, s[0:1]
  v_mfma_f32_32x32x16_bf16 v[176:191], v[52:55], a[28:31], v[176:191]
  v_lshlrev_b32 v79, 7, v0
  s_add_u32 m0, s61, 32768
  v_min_u32 v78, 20, v0
  v_lshlrev_b32 v78, 7, v78
  s_add_u32 s34, s33, 8192
  s_waitcnt lgkmcnt(4)
  v_mfma_f32_32x32x16_bf16 v[128:143], v[56:59], a[32:35], v[128:143]
  ds_read_b64_tr_b16 v[48:49], v5 offset:24576
  ds_read_b64_tr_b16 v[50:51], v5 offset:24832
  v_and_b32 v72, 1, v0
  buffer_load_dwordx4 v1, s[36:39], s8 offen offset:0 lds
  v_mfma_f32_32x32x16_bf16 v[160:175], v[56:59], a[36:39], v[160:175]
  v_mul_u32_u24 v72, 304, v72
  v_add_u32 v72, s94, v72
  v_lshrrev_b32 v72, 11, v72
  v_bfe_u32 v73, v0, 1, 2
  v_mad_u32_u24 v72, v73, 5, v72
  v_min_u32 v72, 15, v72
  v_mfma_f32_16x16x32_bf16 v[24:27], v[32:35], v[56:59], v[24:27]
  v_bfe_u32 v73, v0, 3, 2
  v_mfma_f32_32x32x16_bf16 v[144:159], v[60:63], a[32:35], v[144:159]
  ds_read_b64_tr_b16 v[52:53], v5 offset:26624
  ds_read_b64_tr_b16 v[54:55], v5 offset:26880
  buffer_load_dwordx4 v2, s[36:39], s8 offen offset:1024 lds
  v_lshl_add_u32 v73, v73, 6, s93
  v_mfma_f32_32x32x16_bf16 v[176:191], v[60:63], a[36:39], v[176:191]
  s_add_u32 m0, s61, 34816
  v_max_i32 v73, 0, v73
  v_lshl_add_u32 v10, v72, 2, v73
  v_and_b32 v72, 31, v0
  v_lshrrev_b32 v73, 5, v0
  v_add_u32 v88, s96, v14
  v_mfma_f32_16x16x32_bf16 v[28:31], v[32:35], v[60:63], v[28:31]
  v_lshlrev_b32 v21, 4, v72
  s_waitcnt lgkmcnt(4)
  v_mfma_f32_32x32x16_bf16 v[128:143], v[40:43], a[40:43], v[128:143]
  ds_read_b64_tr_b16 v[56:57], v7 offset:24576
  ds_read_b64_tr_b16 v[58:59], v7 offset:24832
  buffer_load_dwordx4 v1, s[40:43], s8 offen offset:0 lds
  v_lshl_add_u32 v21, v73, 3, v21
  v_mfma_f32_32x32x16_bf16 v[160:175], v[40:43], a[44:47], v[160:175]
  ds_read_b64_tr_b16 v[60:61], v7 offset:26624
  ds_read_b64_tr_b16 v[62:63], v7 offset:26880
  v_add_u32 v91, s97, v21
  v_mov_b32 v74, 1073741824
  v_mfma_f32_32x32x16_bf16 v[144:159], v[44:47], a[40:43], v[144:159]
  buffer_load_dwordx4 v2, s[40:43], s8 offen offset:1024 lds
  v_mfma_f32_32x32x16_bf16 v[176:191], v[44:47], a[44:47], v[176:191]
  s_add_u32 m0, s61, 49152
  v_cmp_eq_u32 vcc, s92, v73
  s_add_u32 s76, s57, 123392
  s_sub_u32 s97, s97, 1024
  v_cndmask_b32 v91, v74, v91, vcc
  s_waitcnt lgkmcnt(4)
  v_mfma_f32_32x32x16_bf16 v[128:143], v[48:51], a[48:51], v[128:143]
  s_waitcnt vmcnt(13) lgkmcnt(0)
  s_barrier
  ds_read_b64_tr_b16 v[40:41], v4 offset:0
  ds_read_b64_tr_b16 v[42:43], v4 offset:256
  s_add_u32 s94, s94, 39936
  v_lshl_add_u32 v74, v72, 4, s94
  v_mfma_f32_32x32x16_bf16 v[160:175], v[48:51], a[52:55], v[160:175]
  buffer_load_dwordx4 v1, s[36:39], s9 offen offset:0 lds
  v_add_u32 v75, 9920, v74
  v_add_u32 v76, s97, v14
  v_mfma_f32_16x16x32_bf16 v[24:27], v[32:35], v[48:51], v[24:27]
  v_mfma_f32_32x32x16_bf16 v[144:159], v[52:55], a[48:51], v[144:159]
  ds_read_b64_tr_b16 v[44:45], v4 offset:2048
  ds_read_b64_tr_b16 v[46:47], v4 offset:2304
  buffer_load_dwordx4 v2, s[36:39], s9 offen offset:1024 lds
  s_add_u32 m0, s61, 51200
  v_mfma_f32_32x32x16_bf16 v[176:191], v[52:55], a[52:55], v[176:191]
  v_cmp_gt_u32 vcc, 20, v72
  s_sub_u32 s94, s94, 512
  v_add_u32 v77, s94, v14
  v_cndmask_b32 v74, v75, v74, vcc
  v_cndmask_b32 v89, v74, v76, s[0:1]
  v_add_u32 v74, 9920, v77
  v_mfma_f32_16x16x32_bf16 v[28:31], v[32:35], v[52:55], v[28:31]
  v_add_u32 v75, 19712, v77
  v_mfma_f32_32x32x16_bf16 v[128:143], v[56:59], a[56:59], v[128:143]
  ds_read_b64_tr_b16 v[48:49], v6 offset:0
  ds_read_b64_tr_b16 v[50:51], v6 offset:256
  buffer_load_dwordx4 v1, s[40:43], s9 offen offset:0 lds
  v_add_u32 v76, 29632, v77
  v_mfma_f32_32x32x16_bf16 v[160:175], v[56:59], a[60:63], v[160:175]
  v_mov_b32 v77, 79872
  buffer_load_dwordx4 v2, s[40:43], s9 offen offset:1024 lds
  v_mfma_f32_32x32x16_bf16 v[144:159], v[60:63], a[56:59], v[144:159]
  ds_read_b64_tr_b16 v[52:53], v6 offset:2048
  ds_read_b64_tr_b16 v[54:55], v6 offset:2304
  s_mov_b32 vcc_lo, 0xff
  s_mov_b32 vcc_hi, 0
  v_cndmask_b32 v77, v77, v74, vcc
  v_mfma_f32_32x32x16_bf16 v[176:191], v[60:63], a[60:63], v[176:191]
  s_mov_b32 vcc_lo, 0xffff0000
  s_mov_b32 vcc_hi, 15
  v_cndmask_b32 v77, v77, v75, vcc
  s_waitcnt lgkmcnt(4)
  v_mfma_f32_32x32x16_bf16 v[128:143], v[40:43], a[64:67], v[128:143]
  ds_read_b64_tr_b16 v[56:57], v4 offset:8192
  ds_read_b64_tr_b16 v[58:59], v4 offset:8448
  s_mov_b32 vcc_lo, 0
  s_mov_b32 vcc_hi, 0xfffff0
  v_cndmask_b32 v90, v77, v76, vcc
  s_mul_i32 s32, s3, 6144
  v_mfma_f32_32x32x16_bf16 v[160:175], v[40:43], a[68:71], v[160:175]
  s_add_u32 s32, s32, 65536
  v_add_u32 v20, s32, v14
  s_add_u32 s32, s32, 1024
  v_add_u32 v21, s32, v21
  v_mul_u32_u24 v74, 10240, v73
  v_sub_u32 v74, v12, v74
  v_mfma_f32_16x16x32_bf16 v[24:27], v[32:35], v[40:43], v[24:27]
  s_lshl_b32 s94, s92, 6
  v_mfma_f32_32x32x16_bf16 v[144:159], v[44:47], a[64:67], v[144:159]
  ds_read_b64_tr_b16 v[60:61], v4 offset:10240
  ds_read_b64_tr_b16 v[62:63], v4 offset:10496
  v_add_u32 v75, s94, v74
  v_subrev_u32 v76, 320, v75
  v_min_u32 v75, v75, v76
  v_mul_u32_u24 v76, 320, v73
  v_mfma_f32_32x32x16_bf16 v[176:191], v[44:47], a[68:71], v[176:191]
  v_add_u32 v75, v75, v76
  v_mov_b32 v76, 640
  v_cmp_gt_u32 vcc, 320, v74
  s_add_u32 s32, s32, 512
  s_lshr_b32 s94, s3, 1
  v_cndmask_b32 v75, v76, v75, vcc
  v_mfma_f32_16x16x32_bf16 v[28:31], v[32:35], v[44:47], v[28:31]
  v_add_u32 v22, s32, v75
  s_waitcnt lgkmcnt(4)
  v_mfma_f32_32x32x16_bf16 v[128:143], v[48:51], a[72:75], v[128:143]
  ds_read_b64_tr_b16 v[40:41], v6 offset:8192
  ds_read_b64_tr_b16 v[42:43], v6 offset:8448
  v_and_b32 v8, 0x10df, v4
  v_lshl_add_u32 v8, v73, 9, v8
  v_bfe_u32 v74, v0, 4, 1
  v_lshl_add_u32 v8, v74, 13, v8
  v_mfma_f32_32x32x16_bf16 v[160:175], v[48:51], a[76:79], v[160:175]
  ds_read_b64_tr_b16 v[44:45], v6 offset:10240
  ds_read_b64_tr_b16 v[46:47], v6 offset:10496
  v_xor_b32 v74, s94, v74
  v_lshl_add_u32 v8, v74, 5, v8
  v_add_u32 v8, 65536, v8
  v_xor_b32 v9, 4096, v8
  v_mfma_f32_32x32x16_bf16 v[144:159], v[52:55], a[72:75], v[144:159]
  v_lshlrev_b32 v73, 2, v73
  v_sub_u32 v73, v72, v73
  v_mov_b32 v74, 0xf149f2ca
  v_mfma_f32_32x32x16_bf16 v[176:191], v[52:55], a[76:79], v[176:191]
  v_cmp_le_i32 vcc, 0, v73
  v_cmp_le_i32 s[0:1], 1, v73
  s_nop 0
  v_cndmask_b32 v96, v74, 0, vcc
  v_cndmask_b32 v97, v74, 0, s[0:1]
  s_waitcnt lgkmcnt(4)
  v_mfma_f32_32x32x16_bf16 v[128:143], v[56:59], a[80:83], v[128:143]
  s_waitcnt vmcnt(8) lgkmcnt(0)
  s_barrier
  ds_read_b64_tr_b16 v[48:49], v4 offset:16384
  ds_read_b64_tr_b16 v[50:51], v4 offset:16640
  s_add_u32 m0, s61, 0
  v_mfma_f32_32x32x16_bf16 v[160:175], v[56:59], a[84:87], v[160:175]
  buffer_load_dwordx4 v1, s[36:39], s12 offen offset:0 lds
  v_mfma_f32_16x16x32_bf16 v[24:27], v[32:35], v[56:59], v[24:27]
  v_mfma_f32_32x32x16_bf16 v[144:159], v[60:63], a[80:83], v[144:159]
  ds_read_b64_tr_b16 v[52:53], v4 offset:18432
  ds_read_b64_tr_b16 v[54:55], v4 offset:18688
  buffer_load_dwordx4 v2, s[36:39], s12 offen offset:1024 lds
  s_add_u32 m0, s61, 2048
  v_mfma_f32_32x32x16_bf16 v[176:191], v[60:63], a[84:87], v[176:191]
  buffer_load_dwordx4 v1, s[40:43], s12 offen offset:0 lds
  v_mfma_f32_16x16x32_bf16 v[28:31], v[32:35], v[60:63], v[28:31]
  v_mfma_f32_32x32x16_bf16 v[128:143], v[40:43], a[88:91], v[128:143]
  ds_read_b64_tr_b16 v[56:57], v6 offset:16384
  ds_read_b64_tr_b16 v[58:59], v6 offset:16640
  buffer_load_dwordx4 v2, s[40:43], s12 offen offset:1024 lds
  s_and_b32 s77, s3, 2
  v_mfma_f32_32x32x16_bf16 v[160:175], v[40:43], a[92:95], v[160:175]
  s_lshl_b32 s77, s77, 4
  v_lshrrev_b32 v2, 5, v0
  v_mul_u32_u24 v2, 24512, v2
  v_xad_u32 v2, v1, s77, v2
  v_add_u32 v2, s58, v2
  s_add_u32 s77, s14, 97280
  v_mfma_f32_32x32x16_bf16 v[144:159], v[44:47], a[88:91], v[144:159]
  ds_read_b64_tr_b16 v[60:61], v6 offset:18432
  ds_read_b64_tr_b16 v[62:63], v6 offset:18688
  s_add_u32 m0, s61, 114688
  v_mfma_f32_32x32x16_bf16 v[176:191], v[44:47], a[92:95], v[176:191]
  buffer_load_dwordx4 v2, s[44:47], s14 offen offset:0 lds
  s_waitcnt lgkmcnt(4)
  v_mfma_f32_32x32x16_bf16 v[128:143], v[48:51], a[96:99], v[128:143]
  ds_read_b64_tr_b16 v[40:41], v4 offset:24576
  ds_read_b64_tr_b16 v[42:43], v4 offset:24832
  buffer_store_dword v0, v17, s[24:27], s79 offen sc1
  v_mfma_f32_32x32x16_bf16 v[160:175], v[48:51], a[100:103], v[160:175]
  v_cmp_le_i32 vcc, 2, v73
  v_cmp_le_i32 s[0:1], 3, v73
  s_nop 0
  v_cndmask_b32 v98, v74, 0, vcc
  v_cndmask_b32 v99, v74, 0, s[0:1]
  v_mfma_f32_16x16x32_bf16 v[24:27], v[32:35], v[48:51], v[24:27]
  v_mfma_f32_32x32x16_bf16 v[144:159], v[52:55], a[96:99], v[144:159]
  ds_read_b64_tr_b16 v[44:45], v4 offset:26624
  ds_read_b64_tr_b16 v[46:47], v4 offset:26880
  buffer_load_dwordx4 v2, s[44:47], s77 offen offset:1024 lds
  s_add_u32 s77, s15, 97280
  v_mfma_f32_32x32x16_bf16 v[176:191], v[52:55], a[100:103], v[176:191]
  v_cmp_le_i32 vcc, 8, v73
  v_cmp_le_i32 s[0:1], 9, v73
  s_nop 0
  v_cndmask_b32 v100, v74, 0, vcc
  v_cndmask_b32 v101, v74, 0, s[0:1]
  v_mfma_f32_16x16x32_bf16 v[28:31], v[32:35], v[52:55], v[28:31]
  s_waitcnt lgkmcnt(4)
  v_mfma_f32_32x32x16_bf16 v[128:143], v[56:59], a[104:107], v[128:143]
  ds_read_b64_tr_b16 v[48:49], v6 offset:24576
  ds_read_b64_tr_b16 v[50:51], v6 offset:24832
  v_mfma_f32_32x32x16_bf16 v[160:175], v[56:59], a[108:111], v[160:175]
  ds_read_b64_tr_b16 v[52:53], v6 offset:26624
  ds_read_b64_tr_b16 v[54:55], v6 offset:26880
  s_add_u32 m0, s61, 116736
  v_mfma_f32_32x32x16_bf16 v[144:159], v[60:63], a[104:107], v[144:159]
  buffer_load_dwordx4 v2, s[44:47], s15 offen offset:0 lds
  v_mfma_f32_32x32x16_bf16 v[176:191], v[60:63], a[108:111], v[176:191]
  v_cmp_le_i32 vcc, 10, v73
  v_cmp_le_i32 s[0:1], 11, v73
  s_nop 0
  v_cndmask_b32 v102, v74, 0, vcc
  v_cndmask_b32 v103, v74, 0, s[0:1]
  s_waitcnt lgkmcnt(4)
  v_mfma_f32_32x32x16_bf16 v[128:143], v[40:43], a[112:115], v[128:143]
  s_waitcnt vmcnt(12) lgkmcnt(0)
  s_barrier
  ds_read_b64_tr_b16 v[56:57], v4 offset:32768
  ds_read_b64_tr_b16 v[58:59], v4 offset:33024
  v_mfma_f32_32x32x16_bf16 v[160:175], v[40:43], a[116:119], v[160:175]
  v_cmp_le_i32 vcc, 16, v73
  v_cmp_le_i32 s[0:1], 17, v73
  s_nop 0
  v_cndmask_b32 v104, v74, 0, vcc
  v_cndmask_b32 v105, v74, 0, s[0:1]
  v_mfma_f32_16x16x32_bf16 v[24:27], v[32:35], v[40:43], v[24:27]
  v_mfma_f32_32x32x16_bf16 v[144:159], v[44:47], a[112:115], v[144:159]
  ds_read_b64_tr_b16 v[60:61], v4 offset:34816
  ds_read_b64_tr_b16 v[62:63], v4 offset:35072
  buffer_load_dwordx4 v2, s[44:47], s77 offen offset:1024 lds
  v_add_u32 v2, 23552, v1
  v_mfma_f32_32x32x16_bf16 v[176:191], v[44:47], a[116:119], v[176:191]
  v_cmp_le_i32 vcc, 18, v73
  v_cmp_le_i32 s[0:1], 19, v73
  s_nop 0
  v_cndmask_b32 v106, v74, 0, vcc
  v_cndmask_b32 v107, v74, 0, s[0:1]
  v_mfma_f32_16x16x32_bf16 v[28:31], v[32:35], v[44:47], v[28:31]
  v_mfma_f32_32x32x16_bf16 v[128:143], v[48:51], a[120:123], v[128:143]
  ds_read_b64_tr_b16 v[40:41], v6 offset:32768
  ds_read_b64_tr_b16 v[42:43], v6 offset:33024
  s_add_u32 m0, s61, 16384
  v_mfma_f32_32x32x16_bf16 v[160:175], v[48:51], a[124:127], v[160:175]
  buffer_load_dwordx4 v1, s[36:39], s13 offen offset:0 lds
  v_mfma_f32_32x32x16_bf16 v[144:159], v[52:55], a[120:123], v[144:159]
  ds_read_b64_tr_b16 v[44:45], v6 offset:34816
  ds_read_b64_tr_b16 v[46:47], v6 offset:35072
  v_mfma_f32_32x32x16_bf16 v[176:191], v[52:55], a[124:127], v[176:191]
  v_cmp_le_i32 vcc, 24, v73
  v_cmp_le_i32 s[0:1], 25, v73
  s_nop 0
  v_cndmask_b32 v108, v74, 0, vcc
  v_cndmask_b32 v109, v74, 0, s[0:1]
  s_waitcnt lgkmcnt(4)
  v_mfma_f32_32x32x16_bf16 v[128:143], v[56:59], a[128:131], v[128:143]
  ds_read_b64_tr_b16 v[48:49], v4 offset:40960
  ds_read_b64_tr_b16 v[50:51], v4 offset:41216
  buffer_load_dwordx4 v2, s[36:39], s13 offen offset:1024 lds
  s_add_u32 m0, s61, 18432
  v_mfma_f32_32x32x16_bf16 v[160:175], v[56:59], a[132:135], v[160:175]
  v_cmp_le_i32 vcc, 26, v73
  v_cmp_le_i32 s[0:1], 27, v73
  s_nop 0
  v_cndmask_b32 v110, v74, 0, vcc
  v_cndmask_b32 v111, v74, 0, s[0:1]
  s_lshl2_add_u32 s94, s10, s3
  v_mfma_f32_16x16x32_bf16 v[24:27], v[32:35], v[56:59], v[24:27]
  s_lshl_b32 s94, s94, 5
  v_mfma_f32_32x32x16_bf16 v[144:159], v[60:63], a[128:131], v[144:159]
  ds_read_b64_tr_b16 v[52:53], v4 offset:43008
  ds_read_b64_tr_b16 v[54:55], v4 offset:43264
  buffer_load_dwordx4 v1, s[40:43], s13 offen offset:0 lds
  s_add_u32 s94, s94, 6144
  v_mfma_f32_32x32x16_bf16 v[176:191], v[60:63], a[132:135], v[176:191]
  buffer_load_dwordx4 v2, s[40:43], s13 offen offset:1024 lds
  s_and_b32 s77, s3, 2
  s_lshl_b32 s77, s77, 4
  v_lshrrev_b32 v2, 5, v0
  v_mfma_f32_16x16x32_bf16 v[28:31], v[32:35], v[60:63], v[28:31]
  v_mul_u32_u24 v2, 24512, v2
  s_waitcnt lgkmcnt(4)
  v_mfma_f32_32x32x16_bf16 v[128:143], v[40:43], a[136:139], v[128:143]
  ds_read_b64_tr_b16 v[56:57], v6 offset:40960
  ds_read_b64_tr_b16 v[58:59], v6 offset:41216
  v_xad_u32 v2, v1, s77, v2
  v_add_u32 v2, s58, v2
  s_add_u32 s77, s4, 97280
  s_add_u32 m0, s61, 65536
  v_mfma_f32_32x32x16_bf16 v[160:175], v[40:43], a[140:143], v[160:175]
  ds_read_b64_tr_b16 v[60:61], v6 offset:43008
  ds_read_b64_tr_b16 v[62:63], v6 offset:43264
  buffer_load_dwordx4 v2, s[44:47], s4 offen offset:0 lds
  s_lshr_b32 s32, s10, 2
  v_mfma_f32_32x32x16_bf16 v[144:159], v[44:47], a[136:139], v[144:159]
  s_lshl_b32 s32, s32, 1
  s_and_b32 s35, s10, 1
  s_add_u32 s32, s32, s35
  s_xor_b32 s35, s3, 1
  s_lshl2_add_u32 s32, s32, s35
  s_lshl_b32 s32, s32, 5
  v_mfma_f32_32x32x16_bf16 v[176:191], v[44:47], a[140:143], v[176:191]
  s_and_b32 s35, s10, 2
  s_lshl1_add_u32 s32, s35, s32
  s_add_u32 s32, s32, 2048
  v_and_b32 v72, 7, v0
  v_lshl_add_u32 v23, v72, 2, s94
  s_waitcnt lgkmcnt(4)
  v_mfma_f32_32x32x16_bf16 v[128:143], v[48:51], a[144:147], v[128:143]
  s_waitcnt vmcnt(14) lgkmcnt(0)
  s_barrier
  ds_read_b64_tr_b16 v[40:41], v4 offset:49152
  ds_read_b64_tr_b16 v[42:43], v4 offset:49408
  v_and_b32 v72, 3, v0
  v_lshl_add_u32 v72, v72, 3, s32
  v_mfma_f32_32x32x16_bf16 v[160:175], v[48:51], a[148:151], v[160:175]
  buffer_load_dwordx4 v2, s[44:47], s77 offen offset:1024 lds
  s_add_u32 s77, s5, 97280
  v_bfe_u32 v73, v0, 2, 1
  v_lshl_add_u32 v72, v73, 11, v72
  v_mfma_f32_16x16x32_bf16 v[24:27], v[32:35], v[48:51], v[24:27]
  v_mfma_f32_32x32x16_bf16 v[144:159], v[52:55], a[144:147], v[144:159]
  ds_read_b64_tr_b16 v[44:45], v4 offset:51200
  ds_read_b64_tr_b16 v[46:47], v4 offset:51456
  s_mov_b32 vcc_lo, 0
  s_mov_b32 vcc_hi, -1
  v_cndmask_b32 v23, v23, v72, vcc
  s_sub_u32 s94, s94, 4096
  v_mfma_f32_32x32x16_bf16 v[176:191], v[52:55], a[148:151], v[176:191]
  s_add_u32 m0, s61, 67584
  v_mfma_f32_16x16x32_bf16 v[28:31], v[32:35], v[52:55], v[28:31]
  v_mfma_f32_32x32x16_bf16 v[128:143], v[56:59], a[152:155], v[128:143]
  ds_read_b64_tr_b16 v[48:49], v6 offset:49152
  ds_read_b64_tr_b16 v[50:51], v6 offset:49408
  buffer_load_dwordx4 v2, s[44:47], s5 offen offset:0 lds
  v_mfma_f32_32x32x16_bf16 v[160:175], v[56:59], a[156:159], v[160:175]
  v_mfma_f32_32x32x16_bf16 v[144:159], v[60:63], a[152:155], v[144:159]
  ds_read_b64_tr_b16 v[52:53], v6 offset:51200
  ds_read_b64_tr_b16 v[54:55], v6 offset:51456
  v_mfma_f32_32x32x16_bf16 v[176:191], v[60:63], a[156:159], v[176:191]
  s_waitcnt lgkmcnt(4)
  v_mfma_f32_32x32x16_bf16 v[128:143], v[40:43], a[160:163], v[128:143]
  ds_read_b64_tr_b16 v[56:57], v4 offset:57344
  ds_read_b64_tr_b16 v[58:59], v4 offset:57600
  buffer_load_dword v11, v93, s[24:27], s95 offen offset:0 sc1
  v_mfma_f32_32x32x16_bf16 v[160:175], v[40:43], a[164:167], v[160:175]
  buffer_load_dwordx4 v2, s[44:47], s77 offen offset:1024 lds
  v_add_u32 v2, 23552, v1
  v_mfma_f32_16x16x32_bf16 v[24:27], v[32:35], v[40:43], v[24:27]
  v_mfma_f32_32x32x16_bf16 v[144:159], v[44:47], a[160:163], v[144:159]
  ds_read_b64_tr_b16 v[60:61], v4 offset:59392
  ds_read_b64_tr_b16 v[62:63], v4 offset:59648
  v_mfma_f32_32x32x16_bf16 v[176:191], v[44:47], a[164:167], v[176:191]
  s_add_u32 m0, s61, 32768
  v_mfma_f32_16x16x32_bf16 v[28:31], v[32:35], v[44:47], v[28:31]
  s_waitcnt lgkmcnt(4)
  v_mfma_f32_32x32x16_bf16 v[128:143], v[48:51], a[168:171], v[128:143]
  ds_read_b64_tr_b16 v[40:41], v6 offset:57344
  ds_read_b64_tr_b16 v[42:43], v6 offset:57600
  buffer_load_dwordx4 v1, s[36:39], s14 offen offset:0 lds
  v_mfma_f32_32x32x16_bf16 v[160:175], v[48:51], a[172:175], v[160:175]
  ds_read_b64_tr_b16 v[44:45], v6 offset:59392
  ds_read_b64_tr_b16 v[46:47], v6 offset:59648
  v_mfma_f32_32x32x16_bf16 v[144:159], v[52:55], a[168:171], v[144:159]
  buffer_load_dwordx4 v2, s[36:39], s14 offen offset:1024 lds
  s_add_u32 m0, s61, 34816
  v_mfma_f32_32x32x16_bf16 v[176:191], v[52:55], a[172:175], v[176:191]
  s_waitcnt lgkmcnt(4)
  v_mfma_f32_32x32x16_bf16 v[128:143], v[56:59], a[176:179], v[128:143]
  s_waitcnt vmcnt(16) lgkmcnt(0)
  s_barrier
  ds_read_b64_tr_b16 v[48:49], v4 offset:0
  ds_read_b64_tr_b16 v[50:51], v4 offset:256
  v_mfma_f32_32x32x16_bf16 v[160:175], v[56:59], a[180:183], v[160:175]
  buffer_load_dwordx4 v1, s[40:43], s14 offen offset:0 lds
  v_mfma_f32_16x16x32_bf16 v[24:27], v[32:35], v[56:59], v[24:27]
  v_mfma_f32_32x32x16_bf16 v[144:159], v[60:63], a[176:179], v[144:159]
  ds_read_b64_tr_b16 v[52:53], v4 offset:2048
  ds_read_b64_tr_b16 v[54:55], v4 offset:2304
  buffer_load_dwordx4 v2, s[40:43], s14 offen offset:1024 lds
  s_and_b32 s77, s3, 2
  v_mfma_f32_32x32x16_bf16 v[176:191], v[60:63], a[180:183], v[176:191]
  s_lshl_b32 s77, s77, 4
  v_lshrrev_b32 v2, 5, v0
  v_mul_u32_u24 v2, 24512, v2
  v_xad_u32 v2, v1, s77, v2
  v_add_u32 v2, s58, v2
  s_add_u32 s77, s6, 97280
  v_mfma_f32_16x16x32_bf16 v[28:31], v[32:35], v[60:63], v[28:31]
  s_add_u32 m0, s61, 81920
  v_mfma_f32_32x32x16_bf16 v[128:143], v[40:43], a[184:187], v[128:143]
  ds_read_b64_tr_b16 v[56:57], v6 offset:0
  ds_read_b64_tr_b16 v[58:59], v6 offset:256
  buffer_load_dwordx4 v2, s[44:47], s6 offen offset:0 lds
  v_mfma_f32_32x32x16_bf16 v[160:175], v[40:43], a[188:191], v[160:175]
  v_mfma_f32_32x32x16_bf16 v[144:159], v[44:47], a[184:187], v[144:159]
  ds_read_b64_tr_b16 v[60:61], v6 offset:2048
  ds_read_b64_tr_b16 v[62:63], v6 offset:2304
  v_mfma_f32_32x32x16_bf16 v[176:191], v[44:47], a[188:191], v[176:191]
  buffer_load_dwordx4 v2, s[44:47], s77 offen offset:1024 lds
  s_add_u32 s77, s7, 97280
  s_waitcnt lgkmcnt(4)
  v_mfma_f32_32x32x16_bf16 v[128:143], v[48:51], a[192:195], v[128:143]
  ds_read_b64_tr_b16 v[40:41], v4 offset:8192
  ds_read_b64_tr_b16 v[42:43], v4 offset:8448
  v_mov_b32 v64, -1
  v_mov_b32 v65, -1
  v_mov_b32 v66, -1
  v_mov_b32 v67, -1
  v_mfma_f32_32x32x16_bf16 v[160:175], v[48:51], a[196:199], v[160:175]
  s_sub_u32 s65, s85, 8
  s_cmp_eq_u32 s92, 0
  s_cselect_b32 s65, s83, s65
  v_mfma_f32_16x16x32_bf16 v[24:27], v[32:35], v[48:51], v[24:27]
  s_add_u32 m0, s61, 83968
  v_mfma_f32_32x32x16_bf16 v[144:159], v[52:55], a[192:195], v[144:159]
  ds_read_b64_tr_b16 v[44:45], v4 offset:10240
  ds_read_b64_tr_b16 v[46:47], v4 offset:10496
  v_mfma_f32_32x32x16_bf16 v[176:191], v[52:55], a[196:199], v[176:191]
  buffer_load_dwordx4 v2, s[44:47], s7 offen offset:0 lds
  v_mfma_f32_16x16x32_bf16 v[28:31], v[32:35], v[52:55], v[28:31]
  s_waitcnt lgkmcnt(4)
  v_mfma_f32_32x32x16_bf16 v[128:143], v[56:59], a[200:203], v[128:143]
  ds_read_b64_tr_b16 v[48:49], v6 offset:8192
  ds_read_b64_tr_b16 v[50:51], v6 offset:8448
  v_mfma_f32_32x32x16_bf16 v[160:175], v[56:59], a[204:207], v[160:175]
  ds_read_b64_tr_b16 v[52:53], v6 offset:10240
  ds_read_b64_tr_b16 v[54:55], v6 offset:10496
  v_mfma_f32_32x32x16_bf16 v[144:159], v[60:63], a[200:203], v[144:159]
  s_mov_b32 exec_hi, 0
  buffer_store_dwordx4 v[64:67], v13, s[24:27], s65 offen sc1
  s_mov_b32 exec_hi, -1
  v_mfma_f32_32x32x16_bf16 v[176:191], v[60:63], a[204:207], v[176:191]
  buffer_load_dwordx4 v2, s[44:47], s77 offen offset:1024 lds
  v_add_u32 v2, 23552, v1
  s_waitcnt lgkmcnt(4)
  v_mfma_f32_32x32x16_bf16 v[128:143], v[40:43], a[208:211], v[128:143]
  s_waitcnt vmcnt(14) lgkmcnt(0)
  s_barrier
  ds_read_b64_tr_b16 v[56:57], v4 offset:16384
  ds_read_b64_tr_b16 v[58:59], v4 offset:16640
  v_mfma_f32_32x32x16_bf16 v[160:175], v[40:43], a[212:215], v[160:175]
  s_add_u32 m0, s61, 49152
  buffer_store_dwordx4 v[64:67], v13, s[24:27], s82 offen sc1
  v_mfma_f32_16x16x32_bf16 v[24:27], v[32:35], v[40:43], v[24:27]
  v_mfma_f32_32x32x16_bf16 v[144:159], v[44:47], a[208:211], v[144:159]
  ds_read_b64_tr_b16 v[60:61], v4 offset:18432
  ds_read_b64_tr_b16 v[62:63], v4 offset:18688
  buffer_load_dwordx4 v1, s[36:39], s15 offen offset:0 lds
  v_mfma_f32_32x32x16_bf16 v[176:191], v[44:47], a[212:215], v[176:191]
  v_mfma_f32_16x16x32_bf16 v[28:31], v[32:35], v[44:47], v[28:31]
  v_mfma_f32_32x32x16_bf16 v[128:143], v[48:51], a[216:219], v[128:143]
  ds_read_b64_tr_b16 v[40:41], v6 offset:16384
  ds_read_b64_tr_b16 v[42:43], v6 offset:16640
  buffer_load_dwordx4 v2, s[36:39], s15 offen offset:1024 lds
  s_add_u32 m0, s61, 51200
  v_mfma_f32_32x32x16_bf16 v[160:175], v[48:51], a[220:223], v[160:175]
  buffer_load_dwordx4 v1, s[40:43], s15 offen offset:0 lds
  v_mfma_f32_32x32x16_bf16 v[144:159], v[52:55], a[216:219], v[144:159]
  ds_read_b64_tr_b16 v[44:45], v6 offset:18432
  ds_read_b64_tr_b16 v[46:47], v6 offset:18688
  v_mfma_f32_32x32x16_bf16 v[176:191], v[52:55], a[220:223], v[176:191]
  buffer_store_dwordx4 v[64:67], v13, s[24:27], s84 offen sc1
  s_waitcnt lgkmcnt(4)
  v_mfma_f32_32x32x16_bf16 v[128:143], v[56:59], a[224:227], v[128:143]
  ds_read_b64_tr_b16 v[48:49], v4 offset:24576
  ds_read_b64_tr_b16 v[50:51], v4 offset:24832
  buffer_load_dwordx4 v2, s[40:43], s15 offen offset:1024 lds
  v_mfma_f32_32x32x16_bf16 v[160:175], v[56:59], a[228:231], v[160:175]
  v_mfma_f32_16x16x32_bf16 v[24:27], v[32:35], v[56:59], v[24:27]
  v_mfma_f32_32x32x16_bf16 v[144:159], v[60:63], a[224:227], v[144:159]
  ds_read_b64_tr_b16 v[52:53], v4 offset:26624
  ds_read_b64_tr_b16 v[54:55], v4 offset:26880
  v_mfma_f32_32x32x16_bf16 v[176:191], v[60:63], a[228:231], v[176:191]
  v_mfma_f32_16x16x32_bf16 v[28:31], v[32:35], v[60:63], v[28:31]
  s_waitcnt lgkmcnt(4)
  v_mfma_f32_32x32x16_bf16 v[128:143], v[40:43], a[232:235], v[128:143]
  ds_read_b64_tr_b16 v[56:57], v6 offset:24576
  ds_read_b64_tr_b16 v[58:59], v6 offset:24832
  s_waitcnt vmcnt(16)
  v_cmp_eq_u32 vcc, 0, v11
  s_cbranch_vccnz .slow54
.back55:
  v_mfma_f32_32x32x16_bf16 v[160:175], v[40:43], a[236:239], v[160:175]
  ds_read_b64_tr_b16 v[60:61], v6 offset:26624
  ds_read_b64_tr_b16 v[62:63], v6 offset:26880
  v_mfma_f32_32x32x16_bf16 v[144:159], v[44:47], a[232:235], v[144:159]
  v_mfma_f32_32x32x16_bf16 v[176:191], v[44:47], a[236:239], v[176:191]
  s_waitcnt lgkmcnt(4)
  v_mfma_f32_32x32x16_bf16 v[128:143], v[48:51], a[240:243], v[128:143]
  s_waitcnt vmcnt(11) lgkmcnt(0)
  s_barrier
  ds_read_b64_tr_b16 v[40:41], v4 offset:32768
  ds_read_b64_tr_b16 v[42:43], v4 offset:33024
  s_add_u32 s56, s91, 0
  s_and_b32 s56, s56, 7
  v_mfma_f32_32x32x16_bf16 v[160:175], v[48:51], a[244:247], v[160:175]
  s_mul_i32 s56, s56, 5120
  s_add_u32 s56, s56, s59
  s_add_u32 m0, s63, 0
  v_mfma_f32_16x16x32_bf16 v[24:27], v[32:35], v[48:51], v[24:27]
  v_mfma_f32_32x32x16_bf16 v[144:159], v[52:55], a[240:243], v[144:159]
  ds_read_b64_tr_b16 v[44:45], v4 offset:34816
  ds_read_b64_tr_b16 v[46:47], v4 offset:35072
  buffer_load_dwordx4 v14, s[24:27], s56 offen offset:0 sc1 lds
  v_mfma_f32_32x32x16_bf16 v[176:191], v[52:55], a[244:247], v[176:191]
  buffer_load_dwordx4 v14, s[24:27], s56 offen offset:1024 sc1 lds
  v_mfma_f32_16x16x32_bf16 v[28:31], v[32:35], v[52:55], v[28:31]
  v_mfma_f32_32x32x16_bf16 v[128:143], v[56:59], a[248:251], v[128:143]
  ds_read_b64_tr_b16 v[48:49], v6 offset:32768
  ds_read_b64_tr_b16 v[50:51], v6 offset:33024
  buffer_load_dwordx4 v14, s[24:27], s56 offen offset:2048 sc1 lds
  v_mfma_f32_32x32x16_bf16 v[160:175], v[56:59], a[252:255], v[160:175]
  v_mfma_f32_32x32x16_bf16 v[144:159], v[60:63], a[248:251], v[144:159]
  ds_read_b64_tr_b16 v[52:53], v6 offset:34816
  ds_read_b64_tr_b16 v[54:55], v6 offset:35072
  buffer_load_dwordx4 v14, s[24:27], s56 offen offset:3072 sc1 lds
  s_add_u32 s56, s56, 4096
  v_mfma_f32_32x32x16_bf16 v[176:191], v[60:63], a[252:255], v[176:191]
  s_add_u32 m0, s63, 4096
  s_waitcnt lgkmcnt(4)
  v_mfma_f32_32x32x16_bf16 v[128:143], v[40:43], v[192:195], v[128:143]
  ds_read_b64_tr_b16 v[56:57], v4 offset:40960
  ds_read_b64_tr_b16 v[58:59], v4 offset:41216
  buffer_load_dwordx4 v14, s[24:27], s56 offen sc1 lds
  v_mfma_f32_32x32x16_bf16 v[160:175], v[40:43], v[196:199], v[160:175]
  v_mfma_f32_16x16x32_bf16 v[24:27], v[32:35], v[40:43], v[24:27]
  v_mfma_f32_32x32x16_bf16 v[144:159], v[44:47], v[192:195], v[144:159]
  ds_read_b64_tr_b16 v[60:61], v4 offset:43008
  ds_read_b64_tr_b16 v[62:63], v4 offset:43264
  v_mfma_f32_32x32x16_bf16 v[176:191], v[44:47], v[196:199], v[176:191]
  v_mfma_f32_16x16x32_bf16 v[28:31], v[32:35], v[44:47], v[28:31]
  s_waitcnt lgkmcnt(4)
  v_mfma_f32_32x32x16_bf16 v[128:143], v[48:51], v[200:203], v[128:143]
  ds_read_b64_tr_b16 v[40:41], v6 offset:40960
  ds_read_b64_tr_b16 v[42:43], v6 offset:41216
  v_mfma_f32_32x32x16_bf16 v[160:175], v[48:51], v[204:207], v[160:175]
  ds_read_b64_tr_b16 v[44:45], v6 offset:43008
  ds_read_b64_tr_b16 v[46:47], v6 offset:43264
  v_mfma_f32_32x32x16_bf16 v[144:159], v[52:55], v[200:203], v[144:159]
  v_mfma_f32_32x32x16_bf16 v[176:191], v[52:55], v[204:207], v[176:191]
  s_waitcnt lgkmcnt(4)
  v_mfma_f32_32x32x16_bf16 v[128:143], v[56:59], v[208:211], v[128:143]
  s_waitcnt vmcnt(5) lgkmcnt(0)
  s_barrier
  ds_read_b64_tr_b16 v[48:49], v4 offset:49152
  ds_read_b64_tr_b16 v[50:51], v4 offset:49408
  s_add_u32 s56, s91, 1
  s_and_b32 s56, s56, 7
  v_mfma_f32_32x32x16_bf16 v[160:175], v[56:59], v[212:215], v[160:175]
  s_mul_i32 s56, s56, 5120
  s_add_u32 s56, s56, s59
  s_add_u32 m0, s63, 20480
  v_mfma_f32_16x16x32_bf16 v[24:27], v[32:35], v[56:59], v[24:27]
  v_mfma_f32_32x32x16_bf16 v[144:159], v[60:63], v[208:211], v[144:159]
  ds_read_b64_tr_b16 v[52:53], v4 offset:51200
  ds_read_b64_tr_b16 v[54:55], v4 offset:51456
  buffer_load_dwordx4 v14, s[24:27], s56 offen offset:0 sc1 lds
  v_mfma_f32_32x32x16_bf16 v[176:191], v[60:63], v[212:215], v[176:191]
  buffer_load_dwordx4 v14, s[24:27], s56 offen offset:1024 sc1 lds
  v_mfma_f32_16x16x32_bf16 v[28:31], v[32:35], v[60:63], v[28:31]
  v_mfma_f32_32x32x16_bf16 v[128:143], v[40:43], v[216:219], v[128:143]
  ds_read_b64_tr_b16 v[56:57], v6 offset:49152
  ds_read_b64_tr_b16 v[58:59], v6 offset:49408
  buffer_load_dwordx4 v14, s[24:27], s56 offen offset:2048 sc1 lds
  v_mfma_f32_32x32x16_bf16 v[160:175], v[40:43], v[220:223], v[160:175]
  v_mfma_f32_32x32x16_bf16 v[144:159], v[44:47], v[216:219], v[144:159]
  ds_read_b64_tr_b16 v[60:61], v6 offset:51200
  ds_read_b64_tr_b16 v[62:63], v6 offset:51456
  buffer_load_dwordx4 v14, s[24:27], s56 offen offset:3072 sc1 lds
  s_add_u32 s56, s56, 4096
  v_mfma_f32_32x32x16_bf16 v[176:191], v[44:47], v[220:223], v[176:191]
  s_add_u32 m0, s63, 24576
  s_waitcnt lgkmcnt(4)
  v_mfma_f32_32x32x16_bf16 v[128:143], v[48:51], v[224:227], v[128:143]
  ds_read_b64_tr_b16 v[40:41], v4 offset:57344
  ds_read_b64_tr_b16 v[42:43], v4 offset:57600
  buffer_load_dwordx4 v14, s[24:27], s56 offen sc1 lds
  v_mfma_f32_32x32x16_bf16 v[160:175], v[48:51], v[228:231], v[160:175]
  v_mfma_f32_16x16x32_bf16 v[24:27], v[32:35], v[48:51], v[24:27]
  v_mfma_f32_32x32x16_bf16 v[144:159], v[52:55], v[224:227], v[144:159]
  ds_read_b64_tr_b16 v[44:45], v4 offset:59392
  ds_read_b64_tr_b16 v[46:47], v4 offset:59648
  v_mfma_f32_32x32x16_bf16 v[176:191], v[52:55], v[228:231], v[176:191]
  v_mfma_f32_16x16x32_bf16 v[28:31], v[32:35], v[52:55], v[28:31]
  s_waitcnt lgkmcnt(4)
  v_mfma_f32_32x32x16_bf16 v[128:143], v[56:59], v[232:235], v[128:143]
  ds_read_b64_tr_b16 v[48:49], v6 offset:57344
  ds_read_b64_tr_b16 v[50:51], v6 offset:57600
  v_mfma_f32_32x32x16_bf16 v[160:175], v[56:59], v[236:239], v[160:175]
  ds_read_b64_tr_b16 v[52:53], v6 offset:59392
  ds_read_b64_tr_b16 v[54:55], v6 offset:59648
  v_mfma_f32_32x32x16_bf16 v[144:159], v[60:63], v[232:235], v[144:159]
  v_mfma_f32_32x32x16_bf16 v[176:191], v[60:63], v[236:239], v[176:191]
  s_waitcnt lgkmcnt(4)
  v_mfma_f32_32x32x16_bf16 v[128:143], v[40:43], v[240:243], v[128:143]
  s_waitcnt lgkmcnt(0)
  s_barrier
  ds_read_b64_tr_b16 v[56:57], v8 offset:0
  ds_read_b64_tr_b16 v[58:59], v8 offset:256
  s_add_u32 s56, s91, 2
  s_and_b32 s56, s56, 7
  v_mfma_f32_32x32x16_bf16 v[160:175], v[40:43], v[244:247], v[160:175]
  s_mul_i32 s56, s56, 5120
  s_add_u32 s56, s56, s59
  s_add_u32 m0, s63, 40960
  v_mov_b32 v4, v88
  v_mov_b32 v5, v89
  v_mov_b32 v6, v90
  v_mfma_f32_16x16x32_bf16 v[24:27], v[32:35], v[40:43], v[24:27]
  v_mov_b32 v7, v91
  v_mfma_f32_32x32x16_bf16 v[144:159], v[44:47], v[240:243], v[144:159]
  ds_read_b64_tr_b16 v[60:61], v9 offset:0
  ds_read_b64_tr_b16 v[62:63], v9 offset:256
  buffer_load_dwordx4 v14, s[24:27], s56 offen offset:0 sc1 lds
  v_mfma_f32_32x32x16_bf16 v[176:191], v[44:47], v[244:247], v[176:191]
  buffer_load_dwordx4 v14, s[24:27], s56 offen offset:1024 sc1 lds
  v_mfma_f32_16x16x32_bf16 v[28:31], v[32:35], v[44:47], v[28:31]
  v_mfma_f32_32x32x16_bf16 v[128:143], v[48:51], v[248:251], v[128:143]
  ds_read_b64_tr_b16 v[40:41], v8 offset:1024
  ds_read_b64_tr_b16 v[42:43], v8 offset:1280
  buffer_load_dwordx4 v14, s[24:27], s56 offen offset:2048 sc1 lds
  v_mov_b32_dpp v32, v32 quad_perm:[3,0,1,2] row_mask:0xf bank_mask:0xf
  v_mfma_f32_32x32x16_bf16 v[160:175], v[48:51], v[252:255], v[160:175]
  v_mov_b32_dpp v33, v33 quad_perm:[3,0,1,2] row_mask:0xf bank_mask:0xf
  v_mov_b32_dpp v34, v34 quad_perm:[3,0,1,2] row_mask:0xf bank_mask:0xf
  v_mov_b32_dpp v35, v35 quad_perm:[3,0,1,2] row_mask:0xf bank_mask:0xf
  v_cvt_pk_bf16_f32 v124, v25, v25
  v_cvt_pk_bf16_f32 v125, v29, v29
  v_lshlrev_b32 v124, 16, v124
  v_mfma_f32_32x32x16_bf16 v[144:159], v[52:55], v[248:251], v[144:159]
  ds_read_b64_tr_b16 v[44:45], v9 offset:1024
  ds_read_b64_tr_b16 v[46:47], v9 offset:1280
  buffer_load_dwordx4 v14, s[24:27], s56 offen offset:3072 sc1 lds
  s_add_u32 s56, s56, 4096
  v_mfma_f32_32x32x16_bf16 v[176:191], v[52:55], v[252:255], v[176:191]
  s_add_u32 m0, s63, 45056
  v_lshlrev_b32 v125, 16, v125
  v_sub_f32 v124, v25, v124
  v_sub_f32 v125, v29, v125
  v_cvt_pk_bf16_f32 v124, v25, v124
  s_waitcnt lgkmcnt(4)
  v_mfma_f32_32x32x16_bf16 v[64:79], v[56:59], a[0:3], 0
  ds_read_b64_tr_b16 v[48:49], v8 offset:2048
  ds_read_b64_tr_b16 v[50:51], v8 offset:2304
  buffer_load_dwordx4 v14, s[24:27], s56 offen sc1 lds
  v_cvt_pk_bf16_f32 v125, v29, v125
  v_mfma_f32_32x32x16_bf16 v[80:95], v[56:59], a[4:7], 0
  ds_write2_b32 v15, v124, v125 offset0:0 offset1:32
  v_mfma_f32_16x16x32_bf16 v[24:27], v[32:35], v[56:59], v[24:27]
  v_mfma_f32_32x32x16_bf16 v[64:79], v[60:63], a[8:11], v[64:79]
  ds_read_b64_tr_b16 v[52:53], v9 offset:2048
  ds_read_b64_tr_b16 v[54:55], v9 offset:2304
  buffer_load_dword v11, v10, s[24:27], s95 offen offset:1024 sc1
  v_mfma_f32_32x32x16_bf16 v[80:95], v[60:63], a[12:15], v[80:95]
  buffer_load_dwordx4 a[0:3], v14, s[24:27], s74 offen offset:0 sc1
  s_waitcnt lgkmcnt(5)
  v_mfma_f32_32x32x16_bf16 v[64:79], v[40:43], a[16:19], v[64:79]
  ds_read_b64_tr_b16 v[56:57], v8 offset:3072
  ds_read_b64_tr_b16 v[58:59], v8 offset:3328
  buffer_load_dwordx4 a[4:7], v14, s[24:27], s74 offen offset:1024 sc1
  v_mfma_f32_32x32x16_bf16 v[80:95], v[40:43], a[20:23], v[80:95]
  ds_read_b64_tr_b16 v[60:61], v9 offset:3072
  ds_read_b64_tr_b16 v[62:63], v9 offset:3328
  v_mfma_f32_16x16x32_bf16 v[24:27], v[32:35], v[40:43], v[24:27]
  v_mfma_f32_32x32x16_bf16 v[64:79], v[44:47], a[24:27], v[64:79]
  buffer_load_dwordx4 a[8:11], v14, s[24:27], s74 offen offset:2048 sc1
  v_mfma_f32_32x32x16_bf16 v[80:95], v[44:47], a[28:31], v[80:95]
  s_waitcnt lgkmcnt(4)
  v_mfma_f32_32x32x16_bf16 v[64:79], v[48:51], a[32:35], v[64:79]
  s_waitcnt lgkmcnt(0)
  s_barrier
  ds_read_b64_tr_b16 v[40:41], v8 offset:16384
  ds_read_b64_tr_b16 v[42:43], v8 offset:16640
  ds_read2_b32 v[124:125], v16 offset0:0 offset1:32
  ds_read2_b32 v[126:127], v16 offset0:32 offset1:0
  v_mfma_f32_32x32x16_bf16 v[80:95], v[48:51], a[36:39], v[80:95]
  s_mul_i32 s33, s10, 278528
  s_lshl_b32 s32, s3, 13
  s_add_u32 s33, s33, s32
  s_add_u32 s33, s33, 8388608
  v_mfma_f32_16x16x32_bf16 v[24:27], v[32:35], v[48:51], v[24:27]
  v_mfma_f32_32x32x16_bf16 v[64:79], v[52:55], a[40:43], v[64:79]
  ds_read_b64_tr_b16 v[44:45], v9 offset:16384
  ds_read_b64_tr_b16 v[46:47], v9 offset:16640
  s_waitcnt lgkmcnt(2)
  buffer_load_dwordx4 a[12:15], v14, s[24:27], s74 offen offset:3072 sc1
  v_mfma_f32_32x32x16_bf16 v[80:95], v[52:55], a[44:47], v[80:95]
  s_add_u32 s74, s74, 4096
  buffer_load_dwordx4 a[16:19], v14, s[24:27], s74 offen offset:0 sc1
  v_mfma_f32_32x32x8_bf16 v[128:143], v[124:125], v[36:37], v[128:143]
  v_mfma_f32_32x32x8_bf16 v[144:159], v[126:127], v[36:37], v[144:159]
  buffer_load_dwordx4 a[20:23], v14, s[24:27], s74 offen offset:1024 sc1
  v_mfma_f32_32x32x8_bf16 v[160:175], v[124:125], v[38:39], v[160:175]
  v_mfma_f32_32x32x8_bf16 v[176:191], v[126:127], v[38:39], v[176:191]
  buffer_load_dwordx4 a[24:27], v14, s[24:27], s74 offen offset:2048 sc1
  v_mfma_f32_32x32x16_bf16 v[64:79], v[56:59], a[48:51], v[64:79]
  ds_read_b64_tr_b16 v[48:49], v8 offset:17408
  ds_read_b64_tr_b16 v[50:51], v8 offset:17664
  v_mfma_f32_32x32x16_bf16 v[80:95], v[56:59], a[52:55], v[80:95]
  buffer_load_dwordx4 a[28:31], v14, s[24:27], s74 offen offset:3072 sc1
  s_add_u32 s74, s74, 4096
  v_mfma_f32_16x16x32_bf16 v[24:27], v[32:35], v[56:59], v[24:27]
  v_max_f32 v128, 0, v128
  v_mfma_f32_32x32x16_bf16 v[64:79], v[60:63], a[56:59], v[64:79]
  ds_read_b64_tr_b16 v[52:53], v9 offset:17408
  ds_read_b64_tr_b16 v[54:55], v9 offset:17664
  v_max_f32 v129, 0, v129
  v_mul_f32 v144, v144, v18
  v_mul_f32 v145, v145, v18
  v_max_f32 v130, 0, v130
  v_mfma_f32_32x32x16_bf16 v[80:95], v[60:63], a[60:63], v[80:95]
  v_max_f32 v131, 0, v131
  v_mul_f32 v146, v146, v18
  v_mul_f32 v147, v147, v18
  v_mul_f32 v128, v128, v144
  v_mul_f32 v129, v129, v145
  s_waitcnt lgkmcnt(4)
  v_mfma_f32_32x32x16_bf16 v[64:79], v[40:43], a[64:67], v[64:79]
  ds_read_b64_tr_b16 v[56:57], v8 offset:18432
  ds_read_b64_tr_b16 v[58:59], v8 offset:18688
  v_cvt_pk_bf16_f32 v128, v128, v129
  v_max_f32 v132, 0, v132
  v_max_f32 v133, 0, v133
  v_mul_f32 v148, v148, v18
  v_mfma_f32_32x32x16_bf16 v[80:95], v[40:43], a[68:71], v[80:95]
  v_mul_f32 v149, v149, v18
  v_mul_f32 v130, v130, v146
  v_mul_f32 v131, v131, v147
  v_cvt_pk_bf16_f32 v129, v130, v131
  v_max_f32 v134, 0, v134
  v_max_f32 v135, 0, v135
  v_mfma_f32_16x16x32_bf16 v[24:27], v[32:35], v[40:43], v[24:27]
  v_mul_f32 v150, v150, v18
  v_mfma_f32_32x32x16_bf16 v[64:79], v[44:47], a[72:75], v[64:79]
  ds_read_b64_tr_b16 v[60:61], v9 offset:18432
  ds_read_b64_tr_b16 v[62:63], v9 offset:18688
  v_mul_f32 v151, v151, v18
  v_mul_f32 v132, v132, v148
  v_mul_f32 v133, v133, v149
  v_cvt_pk_bf16_f32 v130, v132, v133
  v_mfma_f32_32x32x16_bf16 v[80:95], v[44:47], a[76:79], v[80:95]
  v_max_f32 v136, 0, v136
  v_max_f32 v137, 0, v137
  v_mul_f32 v152, v152, v18
  v_mul_f32 v153, v153, v18
  v_mul_f32 v134, v134, v150
  s_waitcnt lgkmcnt(4)
  v_mfma_f32_32x32x16_bf16 v[64:79], v[48:51], a[80:83], v[64:79]
  ds_read_b64_tr_b16 v[40:41], v8 offset:19456
  ds_read_b64_tr_b16 v[42:43], v8 offset:19712
  v_mul_f32 v135, v135, v151
  v_cvt_pk_bf16_f32 v131, v134, v135
  v_max_f32 v138, 0, v138
  v_max_f32 v139, 0, v139
  v_mfma_f32_32x32x16_bf16 v[80:95], v[48:51], a[84:87], v[80:95]
  ds_read_b64_tr_b16 v[44:45], v9 offset:19456
  ds_read_b64_tr_b16 v[46:47], v9 offset:19712
  v_mul_f32 v154, v154, v18
  v_mul_f32 v155, v155, v18
  v_mul_f32 v136, v136, v152
  v_mul_f32 v137, v137, v153
  v_mfma_f32_16x16x32_bf16 v[24:27], v[32:35], v[48:51], v[24:27]
  v_cvt_pk_bf16_f32 v132, v136, v137
  v_mfma_f32_32x32x16_bf16 v[64:79], v[52:55], a[88:91], v[64:79]
  buffer_store_dwordx4 v[128:131], v13, s[24:27], s69 offen offset:0 sc1
  v_mfma_f32_32x32x16_bf16 v[80:95], v[52:55], a[92:95], v[80:95]
  v_max_f32 v140, 0, v140
  v_max_f32 v141, 0, v141
  v_mul_f32 v156, v156, v18
  v_mul_f32 v157, v157, v18
  v_mul_f32 v138, v138, v154
  s_waitcnt lgkmcnt(4)
  v_mfma_f32_32x32x16_bf16 v[64:79], v[56:59], a[96:99], v[64:79]
  s_waitcnt lgkmcnt(0)
  s_barrier
  ds_read_b64_tr_b16 v[48:49], v8 offset:32768
  ds_read_b64_tr_b16 v[50:51], v8 offset:33024
  v_mul_f32 v139, v139, v155
  v_cvt_pk_bf16_f32 v133, v138, v139
  v_mfma_f32_32x32x16_bf16 v[80:95], v[56:59], a[100:103], v[80:95]
  s_waitcnt vmcnt(9)
  v_cmp_eq_u32 vcc, 0, v11
  s_cbranch_vccnz .slow57
.back58:
  buffer_load_dwordx4 v[112:115], v4, s[24:27], s57 offen sc1
  v_mfma_f32_16x16x32_bf16 v[24:27], v[32:35], v[56:59], v[24:27]
  s_add_u32 m0, s64, 0
  v_mfma_f32_32x32x16_bf16 v[64:79], v[60:63], a[104:107], v[64:79]
  ds_read_b64_tr_b16 v[52:53], v9 offset:32768
  ds_read_b64_tr_b16 v[54:55], v9 offset:33024
  buffer_load_dwordx2 v[120:121], v7, s[24:27], s57 offen sc1
  v_max_f32 v142, 0, v142
  v_mfma_f32_32x32x16_bf16 v[80:95], v[60:63], a[108:111], v[80:95]
  buffer_load_dwordx4 v[116:119], v4, s[24:27], s76 offen sc1
  v_max_f32 v143, 0, v143
  v_mul_f32 v158, v158, v18
  v_mfma_f32_32x32x16_bf16 v[64:79], v[40:43], a[112:115], v[64:79]
  ds_read_b64_tr_b16 v[56:57], v8 offset:33792
  ds_read_b64_tr_b16 v[58:59], v8 offset:34048
  buffer_load_dwordx2 v[122:123], v7, s[24:27], s76 offen sc1
  v_mul_f32 v159, v159, v18
  v_mfma_f32_32x32x16_bf16 v[80:95], v[40:43], a[116:119], v[80:95]
  buffer_load_dwordx4 v4, s[24:27], s20 offen offset:0 sc1 lds
  v_mul_f32 v140, v140, v156
  v_mul_f32 v141, v141, v157
  v_cvt_pk_bf16_f32 v134, v140, v141
  v_mfma_f32_16x16x32_bf16 v[24:27], v[32:35], v[40:43], v[24:27]
  v_mul_f32 v142, v142, v158
  v_mfma_f32_32x32x16_bf16 v[64:79], v[44:47], a[120:123], v[64:79]
  ds_read_b64_tr_b16 v[60:61], v9 offset:33792
  ds_read_b64_tr_b16 v[62:63], v9 offset:34048
  v_mul_f32 v143, v143, v159
  v_cvt_pk_bf16_f32 v135, v142, v143
  v_max_f32 v160, 0, v160
  v_max_f32 v161, 0, v161
  v_mfma_f32_32x32x16_bf16 v[80:95], v[44:47], a[124:127], v[80:95]
  buffer_store_dwordx4 v[132:135], v13, s[24:27], s69 offen offset:512 sc1
  s_waitcnt lgkmcnt(4)
  v_mfma_f32_32x32x16_bf16 v[64:79], v[48:51], a[128:131], v[64:79]
  ds_read_b64_tr_b16 v[40:41], v8 offset:34816
  ds_read_b64_tr_b16 v[42:43], v8 offset:35072
  buffer_load_dwordx4 v5, s[24:27], s20 offen offset:1024 sc1 lds
  v_mul_f32 v176, v176, v19
  v_mfma_f32_32x32x16_bf16 v[80:95], v[48:51], a[132:135], v[80:95]
  buffer_load_dwordx4 v6, s[24:27], s20 offen offset:2048 sc1 lds
  s_add_u32 m0, s64, 12288
  v_mul_f32 v177, v177, v19
  v_max_f32 v162, 0, v162
  v_mfma_f32_16x16x32_bf16 v[24:27], v[32:35], v[48:51], v[24:27]
  v_max_f32 v163, 0, v163
  v_mfma_f32_32x32x16_bf16 v[64:79], v[52:55], a[136:139], v[64:79]
  ds_read_b64_tr_b16 v[44:45], v9 offset:34816
  ds_read_b64_tr_b16 v[46:47], v9 offset:35072
  buffer_load_dwordx4 v4, s[24:27], s21 offen offset:0 sc1 lds
  v_mul_f32 v178, v178, v19
  v_mfma_f32_32x32x16_bf16 v[80:95], v[52:55], a[140:143], v[80:95]
  v_mul_f32 v179, v179, v19
  v_mul_f32 v160, v160, v176
  v_mul_f32 v161, v161, v177
  v_cvt_pk_bf16_f32 v160, v160, v161
  v_max_f32 v164, 0, v164
  s_waitcnt lgkmcnt(4)
  v_mfma_f32_32x32x16_bf16 v[64:79], v[56:59], a[144:147], v[64:79]
  ds_read_b64_tr_b16 v[48:49], v8 offset:35840
  ds_read_b64_tr_b16 v[50:51], v8 offset:36096
  buffer_load_dwordx4 v5, s[24:27], s21 offen offset:1024 sc1 lds
  v_max_f32 v165, 0, v165
  v_mfma_f32_32x32x16_bf16 v[80:95], v[56:59], a[148:151], v[80:95]
  ds_read_b64_tr_b16 v[52:53], v9 offset:35840
  ds_read_b64_tr_b16 v[54:55], v9 offset:36096
  v_mul_f32 v180, v180, v19
  v_mul_f32 v181, v181, v19
  v_mul_f32 v162, v162, v178
  v_mul_f32 v163, v163, v179
  v_mfma_f32_16x16x32_bf16 v[24:27], v[32:35], v[56:59], v[24:27]
  v_cvt_pk_bf16_f32 v161, v162, v163
  v_mfma_f32_32x32x16_bf16 v[64:79], v[60:63], a[152:155], v[64:79]
  buffer_load_dwordx4 v6, s[24:27], s21 offen offset:2048 sc1 lds
  v_max_f32 v166, 0, v166
  v_max_f32 v167, 0, v167
  v_mul_f32 v182, v182, v19
  v_mfma_f32_32x32x16_bf16 v[80:95], v[60:63], a[156:159], v[80:95]
  v_mul_f32 v183, v183, v19
  v_mul_f32 v164, v164, v180
  v_mul_f32 v165, v165, v181
  v_cvt_pk_bf16_f32 v162, v164, v165
  v_max_f32 v168, 0, v168
  s_waitcnt lgkmcnt(4)
  v_mfma_f32_32x32x16_bf16 v[64:79], v[40:43], a[160:163], v[64:79]
  s_waitcnt lgkmcnt(0)
  v_add_u32 v8, 49152, v8
  v_add_u32 v9, 49152, v9
  s_barrier
  ds_read_b64_tr_b16 v[56:57], v8 offset:16384
  ds_read_b64_tr_b16 v[58:59], v8 offset:16640
  v_mfma_f32_32x32x16_bf16 v[80:95], v[40:43], a[164:167], v[80:95]
  s_add_u32 m0, s64, 24576
  v_max_f32 v169, 0, v169
  buffer_load_dwordx4 v4, s[24:27], s22 offen offset:0 sc1 lds
  v_mul_f32 v184, v184, v19
  v_mfma_f32_16x16x32_bf16 v[24:27], v[32:35], v[40:43], v[24:27]
  v_mul_f32 v185, v185, v19
  v_mfma_f32_32x32x16_bf16 v[64:79], v[44:47], a[168:171], v[64:79]
  ds_read_b64_tr_b16 v[60:61], v9 offset:16384
  ds_read_b64_tr_b16 v[62:63], v9 offset:16640
  buffer_load_dwordx4 v5, s[24:27], s22 offen offset:1024 sc1 lds
  v_mul_f32 v166, v166, v182
  v_mfma_f32_32x32x16_bf16 v[80:95], v[44:47], a[172:175], v[80:95]
  v_mul_f32 v167, v167, v183
  v_cvt_pk_bf16_f32 v163, v166, v167
  v_max_f32 v170, 0, v170
  v_max_f32 v171, 0, v171
  v_mul_f32 v186, v186, v19
  v_mfma_f32_32x32x16_bf16 v[64:79], v[48:51], a[176:179], v[64:79]
  ds_read_b64_tr_b16 v[40:41], v8 offset:17408
  ds_read_b64_tr_b16 v[42:43], v8 offset:17664
  buffer_load_dwordx4 v6, s[24:27], s22 offen offset:2048 sc1 lds
  s_add_u32 m0, s64, 36864
  v_mfma_f32_32x32x16_bf16 v[80:95], v[48:51], a[180:183], v[80:95]
  buffer_store_dwordx4 v[160:163], v13, s[24:27], s70 offen offset:0 sc1
  v_mfma_f32_16x16x32_bf16 v[24:27], v[32:35], v[48:51], v[24:27]
  v_mul_f32 v187, v187, v19
  v_mfma_f32_32x32x16_bf16 v[64:79], v[52:55], a[184:187], v[64:79]
  ds_read_b64_tr_b16 v[44:45], v9 offset:17408
  ds_read_b64_tr_b16 v[46:47], v9 offset:17664
  buffer_load_dwordx4 v4, s[24:27], s23 offen offset:0 sc1 lds
  v_mul_f32 v168, v168, v184
  v_mfma_f32_32x32x16_bf16 v[80:95], v[52:55], a[188:191], v[80:95]
  buffer_load_dwordx4 v5, s[24:27], s23 offen offset:1024 sc1 lds
  v_mul_f32 v169, v169, v185
  v_cvt_pk_bf16_f32 v164, v168, v169
  s_waitcnt lgkmcnt(4)
  v_mfma_f32_32x32x16_bf16 v[64:79], v[56:59], a[192:195], v[64:79]
  ds_read_b64_tr_b16 v[48:49], v8 offset:18432
  ds_read_b64_tr_b16 v[50:51], v8 offset:18688
  v_max_f32 v172, 0, v172
  v_max_f32 v173, 0, v173
  v_mul_f32 v188, v188, v19
  v_mul_f32 v189, v189, v19
  v_mfma_f32_32x32x16_bf16 v[80:95], v[56:59], a[196:199], v[80:95]
  v_mul_f32 v170, v170, v186
  buffer_load_dwordx4 v6, s[24:27], s23 offen offset:2048 sc1 lds
  v_mul_f32 v171, v171, v187
  v_cvt_pk_bf16_f32 v165, v170, v171
  v_mfma_f32_16x16x32_bf16 v[24:27], v[32:35], v[56:59], v[24:27]
  v_max_f32 v174, 0, v174
  v_mfma_f32_32x32x16_bf16 v[64:79], v[60:63], a[200:203], v[64:79]
  ds_read_b64_tr_b16 v[52:53], v9 offset:18432
  ds_read_b64_tr_b16 v[54:55], v9 offset:18688
  v_max_f32 v175, 0, v175
  v_mul_f32 v190, v190, v19
  v_mul_f32 v191, v191, v19
  v_mul_f32 v172, v172, v188
  v_mfma_f32_32x32x16_bf16 v[80:95], v[60:63], a[204:207], v[80:95]
  v_mul_f32 v173, v173, v189
  v_cvt_pk_bf16_f32 v166, v172, v173
  v_mul_f32 v174, v174, v190
  v_mul_f32 v175, v175, v191
  v_cvt_pk_bf16_f32 v167, v174, v175
  s_waitcnt lgkmcnt(4)
  v_mfma_f32_32x32x16_bf16 v[64:79], v[40:43], a[208:211], v[64:79]
  ds_read_b64_tr_b16 v[56:57], v8 offset:19456
  ds_read_b64_tr_b16 v[58:59], v8 offset:19712
  v_xor_b32 v144, 0xf149f2ca, v96
  v_xor_b32 v145, 0xf149f2ca, v97
  v_xor_b32 v146, 0xf149f2ca, v98
  v_xor_b32 v147, 0xf149f2ca, v99
  v_mfma_f32_32x32x16_bf16 v[80:95], v[40:43], a[212:215], v[80:95]
  ds_read_b64_tr_b16 v[60:61], v9 offset:19456
  ds_read_b64_tr_b16 v[62:63], v9 offset:19712
  v_xor_b32 v148, 0xf149f2ca, v100
  v_xor_b32 v149, 0xf149f2ca, v101
  v_xor_b32 v150, 0xf149f2ca, v102
  v_xor_b32 v151, 0xf149f2ca, v103
  v_mfma_f32_16x16x32_bf16 v[24:27], v[32:35], v[40:43], v[24:27]
  v_xor_b32 v152, 0xf149f2ca, v104
  v_mfma_f32_32x32x16_bf16 v[64:79], v[44:47], a[216:219], v[64:79]
  buffer_store_dwordx4 v[164:167], v13, s[24:27], s70 offen offset:512 sc1
  v_mfma_f32_32x32x16_bf16 v[80:95], v[44:47], a[220:223], v[80:95]
  v_xor_b32 v153, 0xf149f2ca, v105
  v_xor_b32 v154, 0xf149f2ca, v106
  v_xor_b32 v155, 0xf149f2ca, v107
  v_xor_b32 v156, 0xf149f2ca, v108
  v_xor_b32 v157, 0xf149f2ca, v109
  s_waitcnt lgkmcnt(4)
  v_mfma_f32_32x32x16_bf16 v[64:79], v[48:51], a[224:227], v[64:79]
  s_waitcnt lgkmcnt(0)
  s_barrier
  ds_read_b64_tr_b16 v[40:41], v8 offset:0
  ds_read_b64_tr_b16 v[42:43], v8 offset:256
  s_add_u32 s56, s91, 3
  s_and_b32 s56, s56, 7
  v_mfma_f32_32x32x16_bf16 v[80:95], v[48:51], a[228:231], v[80:95]
  s_mul_i32 s56, s56, 5120
  s_add_u32 s56, s56, s59
  s_add_u32 m0, s63, 140288
  buffer_load_dwordx4 a[32:35], v14, s[24:27], s74 offen offset:0 sc1
  v_mfma_f32_16x16x32_bf16 v[24:27], v[32:35], v[48:51], v[24:27]
  v_xor_b32 v158, 0xf149f2ca, v110
  v_mfma_f32_32x32x16_bf16 v[64:79], v[52:55], a[232:235], v[64:79]
  ds_read_b64_tr_b16 v[44:45], v9 offset:0
  ds_read_b64_tr_b16 v[46:47], v9 offset:256
  buffer_load_dwordx4 v14, s[24:27], s56 offen offset:0 sc1 lds
  v_xor_b32 v159, 0xf149f2ca, v111
  v_mfma_f32_32x32x16_bf16 v[80:95], v[52:55], a[236:239], v[80:95]
  buffer_load_dwordx4 v14, s[24:27], s56 offen offset:1024 sc1 lds
  v_and_b32 v127, 7, v0
  v_lshl_add_u32 v127, v127, 2, s94
  v_mfma_f32_32x32x16_bf16 v[64:79], v[56:59], a[240:243], v[64:79]
  ds_read_b64_tr_b16 v[48:49], v8 offset:1024
  ds_read_b64_tr_b16 v[50:51], v8 offset:1280
  s_xor_b32 s32, s81, 8
  s_sub_u32 s32, s32, s95
  v_writelane_b32 v127, s32, 63
  v_lshrrev_b32 v4, 4, v0
  v_mfma_f32_32x32x16_bf16 v[80:95], v[56:59], a[244:247], v[80:95]
  buffer_load_dwordx4 v14, s[24:27], s56 offen offset:2048 sc1 lds
  v_and_b32 v12, 15, v0
  v_mul_u32_u24 v12, 1280, v12
  v_lshl_add_u32 v12, v4, 3, v12
  v_mfma_f32_16x16x32_bf16 v[24:27], v[32:35], v[56:59], v[24:27]
  s_add_u32 s32, s3, 0
  v_mfma_f32_32x32x16_bf16 v[64:79], v[60:63], a[248:251], v[64:79]
  ds_read_b64_tr_b16 v[52:53], v9 offset:1024
  ds_read_b64_tr_b16 v[54:55], v9 offset:1280
  s_and_b32 s32, s32, 3
  s_mul_i32 s32, s32, 69632
  s_add_u32 s32, s33, s32
  v_add_u32 v4, s32, v14
  v_mfma_f32_32x32x16_bf16 v[80:95], v[60:63], a[252:255], v[80:95]
  buffer_load_dwordx4 v14, s[24:27], s56 offen offset:3072 sc1 lds
  s_add_u32 s56, s56, 4096
  s_add_u32 m0, s63, 144384
  s_waitcnt lgkmcnt(4)
  v_mfma_f32_32x32x16_bf16 v[64:79], v[40:43], v[192:195], v[64:79]
  ds_read_b64_tr_b16 v[56:57], v8 offset:2048
  ds_read_b64_tr_b16 v[58:59], v8 offset:2304
  s_add_u32 s32, s3, 1
  s_and_b32 s32, s32, 3
  s_mul_i32 s32, s32, 69632
  s_add_u32 s32, s33, s32
  v_mfma_f32_32x32x16_bf16 v[80:95], v[40:43], v[196:199], v[80:95]
  buffer_load_dwordx4 v14, s[24:27], s56 offen sc1 lds
  v_add_u32 v5, s32, v14
  s_add_u32 s32, s3, 2
  s_and_b32 s32, s32, 3
  v_mfma_f32_16x16x32_bf16 v[24:27], v[32:35], v[40:43], v[24:27]
  s_mul_i32 s32, s32, 69632
  v_mfma_f32_32x32x16_bf16 v[64:79], v[44:47], v[200:203], v[64:79]
  ds_read_b64_tr_b16 v[60:61], v9 offset:2048
  ds_read_b64_tr_b16 v[62:63], v9 offset:2304
  buffer_load_dwordx4 a[36:39], v14, s[24:27], s74 offen offset:1024 sc1
  s_mov_b32 s74, s75
  v_mfma_f32_32x32x16_bf16 v[80:95], v[44:47], v[204:207], v[80:95]
  s_add_u32 s32, s33, s32
  v_add_u32 v6, s32, v14
  s_add_u32 s32, s3, 3
  s_and_b32 s32, s32, 3
  s_mul_i32 s32, s32, 69632
  s_waitcnt lgkmcnt(4)
  v_mfma_f32_32x32x16_bf16 v[64:79], v[48:51], v[208:211], v[64:79]
  ds_read_b64_tr_b16 v[40:41], v8 offset:3072
  ds_read_b64_tr_b16 v[42:43], v8 offset:3328
  s_add_u32 s32, s33, s32
  buffer_load_dwordx4 a[40:43], v14, s[24:27], s74 offen offset:0 sc1
  v_mfma_f32_32x32x16_bf16 v[80:95], v[48:51], v[212:215], v[80:95]
  ds_read_b64_tr_b16 v[44:45], v9 offset:3072
  ds_read_b64_tr_b16 v[46:47], v9 offset:3328
  v_add_u32 v7, s32, v14
  v_add_u32 v1, s63, v14
  v_add_u32 v2, 119808, v1
  s_and_b32 s48, s91, 7
  v_mfma_f32_16x16x32_bf16 v[24:27], v[32:35], v[48:51], v[24:27]
  s_lshl_b32 s48, s48, 10
  v_mfma_f32_32x32x16_bf16 v[64:79], v[52:55], v[216:219], v[64:79]
  buffer_load_dwordx4 a[44:47], v14, s[24:27], s74 offen offset:1024 sc1
  s_lshl_b32 s49, s3, 12
  s_sub_u32 s49, 32768, s49
  s_mul_i32 s50, s3, 3072
  v_mfma_f32_32x32x16_bf16 v[80:95], v[52:55], v[220:223], v[80:95]
  s_sub_u32 s50, 49152, s50
  s_add_u32 s51, s50, 4096
  s_waitcnt lgkmcnt(4)
  v_mfma_f32_32x32x16_bf16 v[64:79], v[56:59], v[224:227], v[64:79]
  v_mfma_f32_32x32x16_bf16 v[80:95], v[56:59], v[228:231], v[80:95]
  buffer_load_dwordx4 a[48:51], v14, s[24:27], s74 offen offset:2048 sc1
  v_mfma_f32_16x16x32_bf16 v[24:27], v[32:35], v[56:59], v[24:27]
  v_mfma_f32_32x32x16_bf16 v[64:79], v[60:63], v[232:235], v[64:79]
  s_waitcnt vmcnt(10)
  buffer_store_dword v0, v17, s[24:27], s81 offen sc1
  v_mfma_f32_32x32x16_bf16 v[80:95], v[60:63], v[236:239], v[80:95]
  buffer_load_dwordx4 a[52:55], v14, s[24:27], s74 offen offset:3072 sc1
  s_add_u32 s74, s74, 4096
  s_waitcnt lgkmcnt(0)
  v_mfma_f32_32x32x16_bf16 v[64:79], v[40:43], v[240:243], v[64:79]
  buffer_load_dwordx4 a[56:59], v14, s[24:27], s74 offen offset:0 sc1
  v_mfma_f32_32x32x16_bf16 v[80:95], v[40:43], v[244:247], v[80:95]
  v_mfma_f32_16x16x32_bf16 v[24:27], v[32:35], v[40:43], v[24:27]
  v_mfma_f32_32x32x16_bf16 v[64:79], v[44:47], v[248:251], v[64:79]
  buffer_load_dwordx4 a[60:63], v14, s[24:27], s74 offen offset:1024 sc1
  v_mfma_f32_32x32x16_bf16 v[80:95], v[44:47], v[252:255], v[80:95]
  buffer_load_dwordx2 v[34:35], v12, s[28:31], s62 offen offset:128
  s_mov_b32 s90, 0x4e800000
  s_nop 2
  v_cvt_pk_bf16_f32 v10, v26, v26
  v_lshlrev_b32 v10, 16, v10
  ds_read_b128 a[252:255], v1 offset:24576
  v_sub_f32 v10, v26, v10
  v_cvt_pk_bf16_f32 v10, v26, v10
  ds_write2_b32 v15, v10, v10 offset0:0 offset1:32
  v_and_b32 v15, 24, v12
  v_add_u32 v15, v15, v12
  buffer_load_dwordx4 v[26:29], v15, s[28:31], s62 offen offset:0
  s_waitcnt lgkmcnt(0)
  s_barrier
  ds_read2_b32 v[10:11], v16 offset0:0 offset1:32
  s_add_u32 m0, s63, 119808
  s_add_u32 s56, s91, 4
  s_and_b32 s56, s56, 7
  s_mul_i32 s56, s56, 5120
  s_add_u32 s56, s56, s59
  ds_read_b128 v[176:179], v20 offset:0
  ds_read_b64 v[180:181], v21 offset:0
  ds_read_b128 v[182:185], v20 offset:3072
  ds_read_b64 v[186:187], v21 offset:3072
  ds_read_b128 v[224:227], v22 offset:0
  ds_read_b128 v[228:231], v22 offset:768
  ds_read_b128 v[232:235], v22 offset:3072
  ds_read_b128 v[236:239], v22 offset:3840
  s_waitcnt lgkmcnt(8)
  v_mfma_f32_32x32x8_bf16 v[64:79], v[10:11], v[36:37], v[64:79]
  v_mfma_f32_32x32x8_bf16 v[80:95], v[10:11], v[38:39], v[80:95]
  s_sub_u32 s77, s3, 1
  s_and_b32 s77, s77, 3
  s_mul_i32 s77, s77, 5120
  s_add_u32 s77, s77, 0
  v_add_u32 v8, s77, v14
  s_sub_u32 s77, s3, 2
  s_and_b32 s77, s77, 3
  s_mul_i32 s77, s77, 5120
  s_add_u32 s77, s77, 20480
  v_add_u32 v9, s77, v14
  s_sub_u32 s77, s3, 3
  s_and_b32 s77, s77, 3
  s_mul_i32 s77, s77, 5120
  s_add_u32 s77, s77, 40960
  v_add_u32 v10, s77, v14
  s_waitcnt lgkmcnt(0)
  v_mfma_f32_32x32x16_bf16 v[128:143], v[176:179], v[112:115], v[144:159]
  ds_read_b128 v[176:179], v20 offset:6144
  buffer_load_dwordx4 v[58:61], v15, s[28:31], s62 offen offset:64
  v_max_f32 v64, 0, v64
  v_max_f32 v65, 0, v65
  v_mfma_f32_32x32x8_bf16 v[128:143], v[180:181], v[120:121], v[128:143]
  ds_read_b64 v[180:181], v21 offset:6144
  v_mul_f32 v72, v72, v18
  v_mul_f32 v73, v73, v18
  v_max_f32 v66, 0, v66
  v_max_f32 v67, 0, v67
  v_mul_f32 v74, v74, v18
  v_mfma_f32_32x32x16_bf16 v[160:175], v[182:185], v[112:115], 0
  v_mul_f32 v75, v75, v18
  v_mul_f32 v64, v64, v72
  v_mul_f32 v65, v65, v73
  v_max_f32 v68, 0, v68
  v_cvt_pk_bf16_f32 v64, v64, v65
  v_max_f32 v69, 0, v69
  v_mfma_f32_32x32x8_bf16 v[160:175], v[186:187], v[120:121], v[160:175]
  v_mul_f32 v76, v76, v18
  v_mul_f32 v77, v77, v18
  v_mul_f32 v66, v66, v74
  v_mul_f32 v67, v67, v75
  v_max_f32 v70, 0, v70
  v_cvt_pk_bf16_f32 v65, v66, v67
  v_max_f32 v71, 0, v71
  v_mul_f32 v78, v78, v18
  v_mul_f32 v79, v79, v18
  v_mul_f32 v68, v68, v76
  v_mul_f32 v69, v69, v77
  v_mul_f32 v70, v70, v78
  v_cvt_pk_bf16_f32 v66, v68, v69
  v_mul_f32 v71, v71, v79
  v_max_f32 v80, 0, v80
  v_cvt_pk_bf16_f32 v67, v70, v71
  v_max_f32 v81, 0, v81
  buffer_store_dwordx4 v[64:67], v13, s[24:27], s71 offen sc1
  v_mul_f32 v88, v88, v19
  v_mul_f32 v89, v89, v19
  v_max_f32 v82, 0, v82
  v_max_f32 v83, 0, v83
  v_mul_f32 v90, v90, v19
  v_mul_f32 v91, v91, v19
  v_mul_f32 v80, v80, v88
  v_mul_f32 v81, v81, v89
  v_max_f32 v84, 0, v84
  v_cvt_pk_bf16_f32 v80, v80, v81
  v_max_f32 v85, 0, v85
  v_mul_f32 v92, v92, v19
  v_mul_f32 v93, v93, v19
  v_mul_f32 v82, v82, v90
  v_mul_f32 v83, v83, v91
  v_max_f32 v86, 0, v86
  v_cvt_pk_bf16_f32 v81, v82, v83
  ds_read_b128 v[72:75], v1 offset:2048
  ds_read_b128 v[76:79], v1 offset:3072
  ds_read_b128 v[68:71], v1 offset:1024
  ds_read_b128 v[64:67], v1 offset:0
  v_max_f32 v87, 0, v87
  v_mul_f32 v94, v94, v19
  v_mul_f32 v95, v95, v19
  v_mul_f32 v84, v84, v92
  v_mul_f32 v85, v85, v93
  v_mul_f32 v86, v86, v94
  v_cvt_pk_bf16_f32 v82, v84, v85
  v_mul_f32 v87, v87, v95
  v_exp_f32 v128, v128
  v_cvt_pk_bf16_f32 v83, v86, v87
  v_exp_f32 v129, v129
  buffer_store_dwordx4 v[80:83], v13, s[24:27], s72 offen sc1
  s_nop 1
  ds_read_b128 v[80:83], v1 offset:4096
  v_exp_f32 v130, v130
  v_exp_f32 v131, v131
  v_cvt_pk_bf16_f32 v40, v128, v129
  v_exp_f32 v132, v132
  v_exp_f32 v133, v133
  v_cvt_pk_bf16_f32 v41, v130, v131
  v_exp_f32 v134, v134
  v_exp_f32 v135, v135
  v_cvt_pk_bf16_f32 v42, v132, v133
  v_exp_f32 v136, v136
  v_exp_f32 v137, v137
  v_cvt_pk_bf16_f32 v43, v134, v135
  v_exp_f32 v138, v138
  s_nop 0
  v_mfma_f32_32x32x16_bf16 v[192:207], v[224:227], v[40:43], 0
  v_exp_f32 v139, v139
  v_cvt_pk_bf16_f32 v44, v136, v137
  v_exp_f32 v140, v140
  v_exp_f32 v141, v141
  v_cvt_pk_bf16_f32 v45, v138, v139
  v_exp_f32 v142, v142
  v_exp_f32 v143, v143
  v_cvt_pk_bf16_f32 v46, v140, v141
  v_cvt_pk_bf16_f32 v47, v142, v143
  v_mfma_f32_32x32x16_bf16 v[128:143], v[182:185], v[116:119], v[144:159]
  buffer_load_dwordx4 v14, s[24:27], s56 offen offset:0 sc1 lds
  ds_read_b128 v[144:147], v1 offset:20480
  ds_read_b128 v[148:151], v1 offset:21504
  ds_read_b128 v[152:155], v1 offset:22528
  v_mfma_f32_32x32x16_bf16 v[192:207], v[228:231], v[44:47], v[192:207]
  ds_read_b128 v[156:159], v1 offset:23552
  ds_read_b128 v[224:227], v22 offset:6144
  ds_read_b128 v[228:231], v22 offset:6912
  ds_read_b128 v[182:185], v20 offset:9216
  v_exp_f32 v160, v160
  v_mfma_f32_32x32x8_bf16 v[128:143], v[186:187], v[122:123], v[128:143]
  ds_read_b64 v[186:187], v21 offset:9216
  v_exp_f32 v161, v161
  v_exp_f32 v162, v162
  v_exp_f32 v163, v163
  buffer_load_dwordx4 v14, s[24:27], s56 offen offset:1024 sc1 lds
  v_cvt_pk_bf16_f32 v48, v160, v161
  v_exp_f32 v164, v164
  v_exp_f32 v165, v165
  v_cvt_pk_bf16_f32 v49, v162, v163
  v_exp_f32 v166, v166
  v_exp_f32 v167, v167
  v_cvt_pk_bf16_f32 v50, v164, v165
  v_exp_f32 v168, v168
  v_exp_f32 v169, v169
  v_cvt_pk_bf16_f32 v51, v166, v167
  v_exp_f32 v170, v170
  s_nop 0
  v_mfma_f32_32x32x16_bf16 v[192:207], v[232:235], v[48:51], v[192:207]
  buffer_load_dwordx4 v14, s[24:27], s56 offen offset:2048 sc1 lds
  v_exp_f32 v171, v171
  v_cvt_pk_bf16_f32 v52, v168, v169
  v_exp_f32 v172, v172
  v_exp_f32 v173, v173
  v_cvt_pk_bf16_f32 v53, v170, v171
  v_exp_f32 v174, v174
  v_exp_f32 v175, v175
  v_cvt_pk_bf16_f32 v54, v172, v173
  v_cvt_pk_bf16_f32 v55, v174, v175
  s_waitcnt lgkmcnt(0)
  v_mfma_f32_32x32x16_bf16 v[160:175], v[176:179], v[112:115], 0
  buffer_load_dwordx4 v14, s[24:27], s56 offen offset:3072 sc1 lds
  s_add_u32 m0, s63, 123904
  s_add_u32 s56, s56, 4096
  v_exp_f32 v128, v128
  v_mfma_f32_32x32x16_bf16 v[192:207], v[236:239], v[52:55], v[192:207]
  v_exp_f32 v129, v129
  v_exp_f32 v130, v130
  v_exp_f32 v131, v131
  v_mfma_f32_32x32x8_bf16 v[160:175], v[180:181], v[120:121], v[160:175]
  v_cvt_pk_bf16_f32 v40, v128, v129
  v_exp_f32 v132, v132
  v_exp_f32 v133, v133
  buffer_load_dwordx4 v14, s[24:27], s56 offen sc1 lds
  s_add_u32 m0, s63, 0
  s_add_u32 s56, s91, 5
  s_and_b32 s56, s56, 7
  s_mul_i32 s56, s56, 5120
  s_add_u32 s56, s56, s59
  v_cvt_pk_bf16_f32 v41, v130, v131
  v_exp_f32 v134, v134
  v_exp_f32 v135, v135
  v_cvt_pk_bf16_f32 v42, v132, v133
  v_exp_f32 v136, v136
  v_exp_f32 v137, v137
  v_cvt_pk_bf16_f32 v43, v134, v135
  v_exp_f32 v138, v138
  s_nop 0
  v_mfma_f32_32x32x16_bf16 v[208:223], v[232:235], v[40:43], 0
  buffer_load_dwordx4 v14, s[24:27], s56 offen offset:0 sc1 lds
  v_exp_f32 v139, v139
  v_cvt_pk_bf16_f32 v44, v136, v137
  v_exp_f32 v140, v140
  v_exp_f32 v141, v141
  v_cvt_pk_bf16_f32 v45, v138, v139
  v_exp_f32 v142, v142
  v_exp_f32 v143, v143
  v_cvt_pk_bf16_f32 v46, v140, v141
  v_cvt_pk_bf16_f32 v47, v142, v143
  v_mfma_f32_32x32x16_bf16 v[128:143], v[176:179], v[116:119], 0
  ds_read_b128 v[232:235], v22 offset:9216
  ds_read_b128 v[176:179], v20 offset:12288
  buffer_load_dwordx4 v14, s[24:27], s56 offen offset:1024 sc1 lds
  v_exp_f32 v160, v160
  v_mfma_f32_32x32x16_bf16 v[208:223], v[236:239], v[44:47], v[208:223]
  ds_read_b128 v[236:239], v22 offset:9984
  v_exp_f32 v161, v161
  v_exp_f32 v162, v162
  v_exp_f32 v163, v163
  v_mfma_f32_32x32x8_bf16 v[128:143], v[180:181], v[122:123], v[128:143]
  ds_read_b64 v[180:181], v21 offset:12288
  v_cvt_pk_bf16_f32 v48, v160, v161
  v_exp_f32 v164, v164
  v_exp_f32 v165, v165
  v_cvt_pk_bf16_f32 v49, v162, v163
  buffer_load_dwordx4 v14, s[24:27], s56 offen offset:2048 sc1 lds
  v_exp_f32 v166, v166
  v_exp_f32 v167, v167
  v_cvt_pk_bf16_f32 v50, v164, v165
  v_exp_f32 v168, v168
  v_exp_f32 v169, v169
  v_cvt_pk_bf16_f32 v51, v166, v167
  v_exp_f32 v170, v170
  s_nop 0
  v_mfma_f32_32x32x16_bf16 v[192:207], v[224:227], v[48:51], v[192:207]
  v_exp_f32 v171, v171
  v_cvt_pk_bf16_f32 v52, v168, v169
  v_exp_f32 v172, v172
  buffer_load_dwordx4 v14, s[24:27], s56 offen offset:3072 sc1 lds
  s_add_u32 m0, s63, 4096
  s_add_u32 s56, s56, 4096
  v_exp_f32 v173, v173
  v_cvt_pk_bf16_f32 v53, v170, v171
  v_exp_f32 v174, v174
  v_exp_f32 v175, v175
  v_cvt_pk_bf16_f32 v54, v172, v173
  v_cvt_pk_bf16_f32 v55, v174, v175
  v_mfma_f32_32x32x16_bf16 v[160:175], v[182:185], v[112:115], 0
  v_exp_f32 v128, v128
  v_exp_f32 v129, v129
  v_exp_f32 v130, v130
  v_mfma_f32_32x32x16_bf16 v[192:207], v[228:231], v[52:55], v[192:207]
  buffer_load_dwordx4 v14, s[24:27], s56 offen sc1 lds
  s_add_u32 m0, s63, 20480
  s_add_u32 s56, s91, 6
  s_and_b32 s56, s56, 7
  v_mfma_f32_32x32x8_bf16 v[160:175], v[186:187], v[120:121], v[160:175]
  s_mul_i32 s56, s56, 5120
  s_add_u32 s56, s56, s59
  v_exp_f32 v131, v131
  v_cvt_pk_bf16_f32 v40, v128, v129
  v_exp_f32 v132, v132
  v_exp_f32 v133, v133
  v_cvt_pk_bf16_f32 v41, v130, v131
  v_exp_f32 v134, v134
  buffer_load_dwordx4 v14, s[24:27], s56 offen offset:0 sc1 lds
  v_exp_f32 v135, v135
  v_cvt_pk_bf16_f32 v42, v132, v133
  v_exp_f32 v136, v136
  v_exp_f32 v137, v137
  v_cvt_pk_bf16_f32 v43, v134, v135
  v_exp_f32 v138, v138
  s_nop 0
  v_mfma_f32_32x32x16_bf16 v[208:223], v[224:227], v[40:43], v[208:223]
  v_exp_f32 v139, v139
  v_cvt_pk_bf16_f32 v44, v136, v137
  v_exp_f32 v140, v140
  v_exp_f32 v141, v141
  buffer_load_dwordx4 v14, s[24:27], s56 offen offset:1024 sc1 lds
  v_cvt_pk_bf16_f32 v45, v138, v139
  v_exp_f32 v142, v142
  v_exp_f32 v143, v143
  v_cvt_pk_bf16_f32 v46, v140, v141
  v_cvt_pk_bf16_f32 v47, v142, v143
  v_mfma_f32_32x32x16_bf16 v[128:143], v[182:185], v[116:119], 0
  ds_read_b128 v[224:227], v22 offset:12288
  ds_read_b128 v[182:185], v20 offset:15360
  v_exp_f32 v160, v160
  v_exp_f32 v161, v161
  v_mfma_f32_32x32x16_bf16 v[208:223], v[228:231], v[44:47], v[208:223]
  ds_read_b128 v[228:231], v22 offset:13056
  v_exp_f32 v162, v162
  buffer_load_dwordx4 v14, s[24:27], s56 offen offset:2048 sc1 lds
  v_mfma_f32_32x32x8_bf16 v[128:143], v[186:187], v[122:123], v[128:143]
  s_waitcnt vmcnt(13)
  s_add_u32 s81, s81, 4096
  s_xor_b32 s81, s81, 96
  buffer_store_dword v0, v17, s[24:27], s81 offen sc1
  ds_read_b64 v[186:187], v21 offset:15360
  v_exp_f32 v163, v163
  v_cvt_pk_bf16_f32 v48, v160, v161
  v_exp_f32 v164, v164
  v_exp_f32 v165, v165
  v_cvt_pk_bf16_f32 v49, v162, v163
  v_exp_f32 v166, v166
  v_exp_f32 v167, v167
  v_cvt_pk_bf16_f32 v50, v164, v165
  v_exp_f32 v168, v168
  buffer_load_dwordx4 v14, s[24:27], s56 offen offset:3072 sc1 lds
  s_add_u32 m0, s63, 24576
  s_add_u32 s56, s56, 4096
  v_exp_f32 v169, v169
  v_cvt_pk_bf16_f32 v51, v166, v167
  v_exp_f32 v170, v170
  s_waitcnt lgkmcnt(1)
  v_mfma_f32_32x32x16_bf16 v[192:207], v[232:235], v[48:51], v[192:207]
  v_exp_f32 v171, v171
  v_cvt_pk_bf16_f32 v52, v168, v169
  v_exp_f32 v172, v172
  v_exp_f32 v173, v173
  v_cvt_pk_bf16_f32 v53, v170, v171
  buffer_load_dword v188, v127, s[24:27], s95 offen offset:0 sc1
  buffer_load_dwordx4 v14, s[24:27], s56 offen sc1 lds
  v_exp_f32 v174, v174
  v_exp_f32 v175, v175
  v_cvt_pk_bf16_f32 v54, v172, v173
  v_cvt_pk_bf16_f32 v55, v174, v175
  v_mfma_f32_32x32x16_bf16 v[160:175], v[176:179], v[112:115], 0
  v_exp_f32 v128, v128
  v_exp_f32 v129, v129
  v_exp_f32 v130, v130
  v_mfma_f32_32x32x16_bf16 v[192:207], v[236:239], v[52:55], v[192:207]
  v_exp_f32 v131, v131
  v_cvt_pk_bf16_f32 v40, v128, v129
  buffer_load_dwordx4 a[64:67], v14, s[24:27], s74 offen offset:2048 sc1
  v_mfma_f32_32x32x8_bf16 v[160:175], v[180:181], v[120:121], v[160:175]
  v_exp_f32 v132, v132
  v_exp_f32 v133, v133
  v_cvt_pk_bf16_f32 v41, v130, v131
  v_exp_f32 v134, v134
  v_exp_f32 v135, v135
  v_cvt_pk_bf16_f32 v42, v132, v133
  v_exp_f32 v136, v136
  v_exp_f32 v137, v137
  v_cvt_pk_bf16_f32 v43, v134, v135
  v_exp_f32 v138, v138
  s_nop 0
  v_mfma_f32_32x32x16_bf16 v[208:223], v[232:235], v[40:43], v[208:223]
  buffer_load_dwordx4 a[68:71], v14, s[24:27], s74 offen offset:3072 sc1
  s_add_u32 s74, s74, 4096
  v_exp_f32 v139, v139
  v_cvt_pk_bf16_f32 v44, v136, v137
  v_exp_f32 v140, v140
  v_exp_f32 v141, v141
  v_cvt_pk_bf16_f32 v45, v138, v139
  v_exp_f32 v142, v142
  v_exp_f32 v143, v143
  v_cvt_pk_bf16_f32 v46, v140, v141
  v_cvt_pk_bf16_f32 v47, v142, v143
  v_mfma_f32_32x32x16_bf16 v[128:143], v[176:179], v[116:119], 0
  buffer_load_dwordx4 a[72:75], v14, s[24:27], s74 offen offset:0 sc1
  ds_read_b128 v[232:235], v22 offset:15360
  ds_read_b128 v[176:179], v20 offset:18432
  v_exp_f32 v160, v160
  v_mfma_f32_32x32x16_bf16 v[208:223], v[236:239], v[44:47], v[208:223]
  ds_read_b128 v[236:239], v22 offset:16128
  v_exp_f32 v161, v161
  v_exp_f32 v162, v162
  v_exp_f32 v163, v163
  v_mfma_f32_32x32x8_bf16 v[128:143], v[180:181], v[122:123], v[128:143]
  ds_read_b64 v[180:181], v21 offset:18432
  v_cvt_pk_bf16_f32 v48, v160, v161
  v_exp_f32 v164, v164
  v_exp_f32 v165, v165
  buffer_load_dwordx4 a[76:79], v14, s[24:27], s74 offen offset:1024 sc1
  v_cvt_pk_bf16_f32 v49, v162, v163
  v_exp_f32 v166, v166
  v_exp_f32 v167, v167
  v_cvt_pk_bf16_f32 v50, v164, v165
  v_exp_f32 v168, v168
  v_exp_f32 v169, v169
  v_cvt_pk_bf16_f32 v51, v166, v167
  v_exp_f32 v170, v170
  s_nop 0
  v_mfma_f32_32x32x16_bf16 v[192:207], v[224:227], v[48:51], v[192:207]
  v_exp_f32 v171, v171
  buffer_load_dwordx4 a[80:83], v14, s[24:27], s74 offen offset:2048 sc1
  v_cvt_pk_bf16_f32 v52, v168, v169
  v_exp_f32 v172, v172
  v_exp_f32 v173, v173
  v_cvt_pk_bf16_f32 v53, v170, v171
  v_exp_f32 v174, v174
  v_exp_f32 v175, v175
  v_cvt_pk_bf16_f32 v54, v172, v173
  v_cvt_pk_bf16_f32 v55, v174, v175
  v_mfma_f32_32x32x16_bf16 v[160:175], v[182:185], v[112:115], 0
  v_exp_f32 v128, v128
  v_exp_f32 v129, v129
  v_exp_f32 v130, v130
  v_mfma_f32_32x32x16_bf16 v[192:207], v[228:231], v[52:55], v[192:207]
  buffer_load_dwordx4 a[84:87], v14, s[24:27], s74 offen offset:3072 sc1
  s_add_u32 s74, s74, 4096
  v_exp_f32 v131, v131
  s_waitcnt lgkmcnt(0)
  v_mfma_f32_32x32x8_bf16 v[160:175], v[186:187], v[120:121], v[160:175]
  v_cvt_pk_bf16_f32 v40, v128, v129
  v_exp_f32 v132, v132
  v_exp_f32 v133, v133
  v_cvt_pk_bf16_f32 v41, v130, v131
  v_exp_f32 v134, v134
  v_exp_f32 v135, v135
  v_cvt_pk_bf16_f32 v42, v132, v133
  buffer_load_dwordx4 a[88:91], v14, s[24:27], s74 offen offset:0 sc1
  v_exp_f32 v136, v136
  v_exp_f32 v137, v137
  v_cvt_pk_bf16_f32 v43, v134, v135
  v_exp_f32 v138, v138
  s_nop 0
  v_mfma_f32_32x32x16_bf16 v[208:223], v[224:227], v[40:43], v[208:223]
  v_exp_f32 v139, v139
  v_cvt_pk_bf16_f32 v44, v136, v137
  v_exp_f32 v140, v140
  v_exp_f32 v141, v141
  v_cvt_pk_bf16_f32 v45, v138, v139
  v_exp_f32 v142, v142
  buffer_load_dwordx4 a[92:95], v14, s[24:27], s74 offen offset:1024 sc1
  v_exp_f32 v143, v143
  v_cvt_pk_bf16_f32 v46, v140, v141
  v_cvt_pk_bf16_f32 v47, v142, v143
  v_mfma_f32_32x32x16_bf16 v[128:143], v[182:185], v[116:119], 0
  ds_read_b128 v[224:227], v22 offset:18432
  ds_read_b128 v[182:185], v20 offset:21504
  v_exp_f32 v160, v160
  v_exp_f32 v161, v161
  v_mfma_f32_32x32x16_bf16 v[208:223], v[228:231], v[44:47], v[208:223]
  ds_read_b128 v[228:231], v22 offset:19200
  v_exp_f32 v162, v162
  v_exp_f32 v163, v163
  buffer_load_dwordx4 a[96:99], v14, s[24:27], s74 offen offset:2048 sc1
  v_mfma_f32_32x32x8_bf16 v[128:143], v[186:187], v[122:123], v[128:143]
  ds_read_b64 v[186:187], v21 offset:21504
  v_cvt_pk_bf16_f32 v48, v160, v161
  v_exp_f32 v164, v164
  v_exp_f32 v165, v165
  v_cvt_pk_bf16_f32 v49, v162, v163
  v_exp_f32 v166, v166
  v_exp_f32 v167, v167
  v_cvt_pk_bf16_f32 v50, v164, v165
  v_exp_f32 v168, v168
  v_exp_f32 v169, v169
  v_cvt_pk_bf16_f32 v51, v166, v167
  v_exp_f32 v170, v170
  s_nop 0
  v_mfma_f32_32x32x16_bf16 v[192:207], v[232:235], v[48:51], v[192:207]
  buffer_load_dwordx4 a[100:103], v14, s[24:27], s74 offen offset:3072 sc1
  s_add_u32 s74, s74, 4096
  v_exp_f32 v171, v171
  v_cvt_pk_bf16_f32 v52, v168, v169
  v_exp_f32 v172, v172
  v_exp_f32 v173, v173
  v_cvt_pk_bf16_f32 v53, v170, v171
  v_exp_f32 v174, v174
  v_exp_f32 v175, v175
  v_cvt_pk_bf16_f32 v54, v172, v173
  v_cvt_pk_bf16_f32 v55, v174, v175
  v_mfma_f32_32x32x16_bf16 v[160:175], v[176:179], v[112:115], 0
  buffer_load_dwordx4 a[104:107], v14, s[24:27], s74 offen offset:0 sc1
  v_exp_f32 v128, v128
  v_exp_f32 v129, v129
  v_mfma_f32_32x32x16_bf16 v[192:207], v[236:239], v[52:55], v[192:207]
  v_exp_f32 v130, v130
  v_exp_f32 v131, v131
  v_cvt_pk_bf16_f32 v40, v128, v129
  v_exp_f32 v132, v132
  v_mfma_f32_32x32x8_bf16 v[160:175], v[180:181], v[120:121], v[160:175]
  v_exp_f32 v133, v133
  v_cvt_pk_bf16_f32 v41, v130, v131
  buffer_load_dwordx4 a[108:111], v14, s[24:27], s74 offen offset:1024 sc1
  v_exp_f32 v134, v134
  v_exp_f32 v135, v135
  v_cvt_pk_bf16_f32 v42, v132, v133
  v_exp_f32 v136, v136
  v_exp_f32 v137, v137
  v_cvt_pk_bf16_f32 v43, v134, v135
  v_exp_f32 v138, v138
  s_nop 0
  v_mfma_f32_32x32x16_bf16 v[208:223], v[232:235], v[40:43], v[208:223]
  v_exp_f32 v139, v139
  v_cvt_pk_bf16_f32 v44, v136, v137
  v_exp_f32 v140, v140
  buffer_load_dwordx4 a[112:115], v14, s[24:27], s74 offen offset:2048 sc1
  v_exp_f32 v141, v141
  s_waitcnt vmcnt(14)
  v_cmp_eq_u32 vcc, 0, v188
  s_cbranch_vccnz .slow60
.back61:
  v_cvt_pk_bf16_f32 v45, v138, v139
  v_exp_f32 v142, v142
  v_exp_f32 v143, v143
  v_cvt_pk_bf16_f32 v46, v140, v141
  v_cvt_pk_bf16_f32 v47, v142, v143
  v_mfma_f32_32x32x16_bf16 v[128:143], v[176:179], v[116:119], 0
  ds_read_b128 v[232:235], v22 offset:21504
  ds_read_b128 v[176:179], v20 offset:24576
  buffer_load_dwordx4 a[140:143], v4, s[24:27], s48 offen offset:0 sc1
  v_lshlrev_b32 v24, 16, v26
  v_mfma_f32_32x32x16_bf16 v[208:223], v[236:239], v[44:47], v[208:223]
  ds_read_b128 v[236:239], v22 offset:22272
  v_and_b32 v25, 0xffff0000, v26
  v_lshlrev_b32 v26, 16, v27
  v_and_b32 v27, 0xffff0000, v27
  v_and_b32 v31, 0xffff0000, v29
  v_lshlrev_b32 v30, 16, v29
  v_mfma_f32_32x32x8_bf16 v[128:143], v[180:181], v[122:123], v[128:143]
  ds_read_b64 v[180:181], v21 offset:24576
  v_and_b32 v29, 0xffff0000, v28
  buffer_load_dwordx4 a[144:147], v5, s[24:27], s48 offen offset:0 sc1
  v_lshlrev_b32 v28, 16, v28
  v_lshlrev_b32 v56, 16, v58
  v_and_b32 v57, 0xffff0000, v58
  v_lshlrev_b32 v58, 16, v59
  v_and_b32 v59, 0xffff0000, v59
  v_and_b32 v63, 0xffff0000, v61
  v_lshlrev_b32 v62, 16, v61
  v_and_b32 v61, 0xffff0000, v60
  v_lshlrev_b32 v60, 16, v60
  v_lshlrev_b32 v32, 16, v34
  v_and_b32 v33, 0xffff0000, v34
  v_lshlrev_b32 v34, 16, v35
  v_and_b32 v35, 0xffff0000, v35
  v_exp_f32 v160, v160
  buffer_load_dwordx4 a[148:151], v6, s[24:27], s48 offen offset:0 sc1
  v_exp_f32 v161, v161
  v_exp_f32 v162, v162
  v_exp_f32 v163, v163
  v_cvt_pk_bf16_f32 v48, v160, v161
  v_exp_f32 v164, v164
  v_exp_f32 v165, v165
  v_cvt_pk_bf16_f32 v49, v162, v163
  v_exp_f32 v166, v166
  buffer_load_dwordx4 a[152:155], v7, s[24:27], s48 offen offset:0 sc1
  s_add_u32 s48, s48, 1024
  s_and_b32 s48, s48, 0x1fff
  v_exp_f32 v167, v167
  v_cvt_pk_bf16_f32 v50, v164, v165
  v_exp_f32 v168, v168
  v_exp_f32 v169, v169
  v_cvt_pk_bf16_f32 v51, v166, v167
  v_exp_f32 v170, v170
  s_waitcnt lgkmcnt(0)
  v_mfma_f32_32x32x16_bf16 v[192:207], v[224:227], v[48:51], v[192:207]
  buffer_load_dwordx4 a[156:159], v4, s[24:27], s48 offen offset:0 sc1
  v_exp_f32 v171, v171
  v_cvt_pk_bf16_f32 v52, v168, v169
  v_exp_f32 v172, v172
  v_exp_f32 v173, v173
  v_cvt_pk_bf16_f32 v53, v170, v171
  v_exp_f32 v174, v174
  v_exp_f32 v175, v175
  buffer_load_dwordx4 a[160:163], v5, s[24:27], s48 offen offset:0 sc1
  v_cvt_pk_bf16_f32 v54, v172, v173
  v_cvt_pk_bf16_f32 v55, v174, v175
  v_mfma_f32_32x32x16_bf16 v[160:175], v[182:185], v[112:115], 0
  v_exp_f32 v128, v128
  v_exp_f32 v129, v129
  v_exp_f32 v130, v130
  v_mfma_f32_32x32x16_bf16 v[192:207], v[228:231], v[52:55], v[192:207]
  v_exp_f32 v131, v131
  buffer_load_dwordx4 a[164:167], v6, s[24:27], s48 offen offset:0 sc1
  v_cvt_pk_bf16_f32 v40, v128, v129
  v_mfma_f32_32x32x8_bf16 v[160:175], v[186:187], v[120:121], v[160:175]
  v_exp_f32 v132, v132
  v_exp_f32 v133, v133
  v_cvt_pk_bf16_f32 v41, v130, v131
  v_exp_f32 v134, v134
  v_exp_f32 v135, v135
  v_cvt_pk_bf16_f32 v42, v132, v133
  buffer_load_dwordx4 a[168:171], v7, s[24:27], s48 offen offset:0 sc1
  s_add_u32 s48, s48, 1024
  s_and_b32 s48, s48, 0x1fff
  v_exp_f32 v136, v136
  v_exp_f32 v137, v137
  v_cvt_pk_bf16_f32 v43, v134, v135
  v_exp_f32 v138, v138
  s_nop 0
  v_mfma_f32_32x32x16_bf16 v[208:223], v[224:227], v[40:43], v[208:223]
  v_exp_f32 v139, v139
  buffer_load_dwordx4 a[172:175], v4, s[24:27], s48 offen offset:0 sc1
  v_cvt_pk_bf16_f32 v44, v136, v137
  v_exp_f32 v140, v140
  v_exp_f32 v141, v141
  v_cvt_pk_bf16_f32 v45, v138, v139
  v_exp_f32 v142, v142
  v_exp_f32 v143, v143
  v_cvt_pk_bf16_f32 v46, v140, v141
  v_cvt_pk_bf16_f32 v47, v142, v143
  v_mfma_f32_32x32x16_bf16 v[128:143], v[182:185], v[116:119], 0
  buffer_load_dwordx4 a[176:179], v5, s[24:27], s48 offen offset:0 sc1
  ds_read_b128 v[224:227], v22 offset:24576
  ds_read_b128 v[182:185], v20 offset:27648
  v_exp_f32 v160, v160
  v_mfma_f32_32x32x16_bf16 v[208:223], v[228:231], v[44:47], v[208:223]
  ds_read_b128 v[228:231], v22 offset:25344
  v_exp_f32 v161, v161
  v_exp_f32 v162, v162
  v_exp_f32 v163, v163
  v_mfma_f32_32x32x8_bf16 v[128:143], v[186:187], v[122:123], v[128:143]
  buffer_load_dwordx4 a[180:183], v6, s[24:27], s48 offen offset:0 sc1
  ds_read_b64 v[186:187], v21 offset:27648
  v_cvt_pk_bf16_f32 v48, v160, v161
  v_exp_f32 v164, v164
  v_exp_f32 v165, v165
  v_cvt_pk_bf16_f32 v49, v162, v163
  v_exp_f32 v166, v166
  v_exp_f32 v167, v167
  v_cvt_pk_bf16_f32 v50, v164, v165
  buffer_load_dwordx4 a[184:187], v7, s[24:27], s48 offen offset:0 sc1
  s_add_u32 s48, s48, 1024
  s_and_b32 s48, s48, 0x1fff
  v_exp_f32 v168, v168
  v_exp_f32 v169, v169
  v_cvt_pk_bf16_f32 v51, v166, v167
  v_exp_f32 v170, v170
  s_nop 0
  v_mfma_f32_32x32x16_bf16 v[192:207], v[232:235], v[48:51], v[192:207]
  v_exp_f32 v171, v171
  buffer_load_dwordx4 a[188:191], v4, s[24:27], s48 offen offset:0 sc1
  v_cvt_pk_bf16_f32 v52, v168, v169
  v_exp_f32 v172, v172
  v_exp_f32 v173, v173
  v_cvt_pk_bf16_f32 v53, v170, v171
  v_exp_f32 v174, v174
  v_exp_f32 v175, v175
  v_cvt_pk_bf16_f32 v54, v172, v173
  v_cvt_pk_bf16_f32 v55, v174, v175
  v_mfma_f32_32x32x16_bf16 v[160:175], v[176:179], v[112:115], v[96:111]
  buffer_load_dwordx4 a[192:195], v5, s[24:27], s48 offen offset:0 sc1
  v_exp_f32 v128, v128
  v_exp_f32 v129, v129
  v_mfma_f32_32x32x16_bf16 v[192:207], v[236:239], v[52:55], v[192:207]
  v_exp_f32 v130, v130
  v_exp_f32 v131, v131
  v_cvt_pk_bf16_f32 v40, v128, v129
  v_exp_f32 v132, v132
  v_mfma_f32_32x32x8_bf16 v[160:175], v[180:181], v[120:121], v[160:175]
  buffer_load_dwordx4 a[196:199], v6, s[24:27], s48 offen offset:0 sc1
  v_exp_f32 v133, v133
  v_cvt_pk_bf16_f32 v41, v130, v131
  v_exp_f32 v134, v134
  v_exp_f32 v135, v135
  v_cvt_pk_bf16_f32 v42, v132, v133
  v_exp_f32 v136, v136
  v_exp_f32 v137, v137
  buffer_load_dwordx4 a[200:203], v7, s[24:27], s48 offen offset:0 sc1
  s_add_u32 s48, s48, 1024
  s_and_b32 s48, s48, 0x1fff
  v_cvt_pk_bf16_f32 v43, v134, v135
  v_exp_f32 v138, v138
  s_nop 0
  v_mfma_f32_32x32x16_bf16 v[208:223], v[232:235], v[40:43], v[208:223]
  v_exp_f32 v139, v139
  v_cvt_pk_bf16_f32 v44, v136, v137
  v_exp_f32 v140, v140
  v_exp_f32 v141, v141
  buffer_load_dwordx4 a[204:207], v4, s[24:27], s48 offen offset:0 sc1
  v_cvt_pk_bf16_f32 v45, v138, v139
  v_exp_f32 v142, v142
  v_exp_f32 v143, v143
  v_cvt_pk_bf16_f32 v46, v140, v141
  v_cvt_pk_bf16_f32 v47, v142, v143
  v_mfma_f32_32x32x16_bf16 v[128:143], v[176:179], v[116:119], 0
  ds_read_b128 v[232:235], v22 offset:27648
  v_exp_f32 v160, v160
  buffer_load_dwordx4 a[208:211], v5, s[24:27], s48 offen offset:0 sc1
  v_mfma_f32_32x32x16_bf16 v[208:223], v[236:239], v[44:47], v[208:223]
  ds_read_b128 v[236:239], v22 offset:28416
  v_exp_f32 v161, v161
  v_exp_f32 v162, v162
  v_exp_f32 v163, v163
  v_mfma_f32_32x32x8_bf16 v[128:143], v[180:181], v[122:123], v[128:143]
  v_cvt_pk_bf16_f32 v48, v160, v161
  v_exp_f32 v164, v164
  buffer_load_dwordx4 a[212:215], v6, s[24:27], s48 offen offset:0 sc1
  v_exp_f32 v165, v165
  v_cvt_pk_bf16_f32 v49, v162, v163
  v_exp_f32 v166, v166
  v_exp_f32 v167, v167
  v_cvt_pk_bf16_f32 v50, v164, v165
  v_exp_f32 v168, v168
  v_exp_f32 v169, v169
  v_cvt_pk_bf16_f32 v51, v166, v167
  v_exp_f32 v170, v170
  s_waitcnt lgkmcnt(1)
  v_mfma_f32_32x32x16_bf16 v[192:207], v[224:227], v[48:51], v[192:207]
  buffer_load_dwordx4 a[216:219], v7, s[24:27], s48 offen offset:0 sc1
  s_add_u32 s48, s48, 1024
  s_and_b32 s48, s48, 0x1fff
  v_exp_f32 v171, v171
  v_cvt_pk_bf16_f32 v52, v168, v169
  v_exp_f32 v172, v172
  v_exp_f32 v173, v173
  v_cvt_pk_bf16_f32 v53, v170, v171
  buffer_load_dwordx4 a[220:223], v4, s[24:27], s48 offen offset:0 sc1
  v_exp_f32 v174, v174
  v_exp_f32 v175, v175
  v_cvt_pk_bf16_f32 v54, v172, v173
  v_cvt_pk_bf16_f32 v55, v174, v175
  v_mfma_f32_32x32x16_bf16 v[160:175], v[182:185], v[116:119], v[96:111]
  v_exp_f32 v128, v128
  v_exp_f32 v129, v129
  v_exp_f32 v130, v130
  v_mfma_f32_32x32x16_bf16 v[192:207], v[228:231], v[52:55], v[192:207]
  buffer_load_dwordx4 a[224:227], v5, s[24:27], s48 offen offset:0 sc1
  v_exp_f32 v131, v131
  v_cvt_pk_bf16_f32 v40, v128, v129
  v_mfma_f32_32x32x8_bf16 v[160:175], v[186:187], v[122:123], v[160:175]
  v_exp_f32 v132, v132
  s_nop 6
  v_rcp_f32 v205, v204
  buffer_load_dwordx4 a[228:231], v6, s[24:27], s48 offen offset:0 sc1
  v_max_f32 v204, v204, v205
  v_mul_f32 v192, v192, v205
  v_cmp_nge_f32 s[86:87], s90, v204
  v_mul_f32 v193, v193, v205
  v_mul_f32 v194, v194, v205
  v_mul_f32 v195, v195, v205
  v_cvt_pk_bf16_f32 v192, v192, v193
  v_mul_f32 v196, v196, v205
  v_mul_f32 v197, v197, v205
  v_cvt_pk_bf16_f32 v193, v194, v195
  v_mul_f32 v198, v198, v205
  v_mul_f32 v199, v199, v205
  buffer_load_dword v188, v23, s[24:27], s95 offen offset:0 sc1
  v_cvt_pk_bf16_f32 v194, v196, v197
  v_mul_f32 v200, v200, v205
  buffer_load_dwordx4 a[232:235], v7, s[24:27], s48 offen offset:0 sc1
  s_add_u32 s48, s48, 1024
  s_and_b32 s48, s48, 0x1fff
  v_mul_f32 v201, v201, v205
  v_cvt_pk_bf16_f32 v195, v198, v199
  v_mul_f32 v202, v202, v205
  v_mul_f32 v203, v203, v205
  v_cvt_pk_bf16_f32 v196, v200, v201
  v_cvt_pk_bf16_f32 v197, v202, v203
  s_cmp_lg_u64 s[86:87], 0
  s_cselect_b32 s96, 1073741824, s82
  s_cselect_b32 s97, 1073741824, s83
  buffer_store_dwordx4 v[192:195], v13, s[24:27], s96 offen sc1
  s_mov_b32 exec_hi, 0
  buffer_store_dwordx2 v[196:197], v13, s[24:27], s97 offen sc1
  s_mov_b32 exec_hi, -1
  v_exp_f32 v133, v133
  v_cvt_pk_bf16_f32 v41, v130, v131
  v_exp_f32 v134, v134
  v_exp_f32 v135, v135
  v_cvt_pk_bf16_f32 v42, v132, v133
  v_exp_f32 v136, v136
  v_exp_f32 v137, v137
  v_cvt_pk_bf16_f32 v43, v134, v135
  v_exp_f32 v138, v138
  s_nop 0
  v_mfma_f32_32x32x16_bf16 v[208:223], v[224:227], v[40:43], v[208:223]
  v_exp_f32 v139, v139
  v_cvt_pk_bf16_f32 v44, v136, v137
  v_exp_f32 v140, v140
  v_exp_f32 v141, v141
  v_cvt_pk_bf16_f32 v45, v138, v139
  v_exp_f32 v142, v142
  v_exp_f32 v143, v143
  v_cvt_pk_bf16_f32 v46, v140, v141
  v_cvt_pk_bf16_f32 v47, v142, v143
  v_exp_f32 v160, v160
  s_nop 0
  v_mfma_f32_32x32x16_bf16 v[208:223], v[228:231], v[44:47], v[208:223]
  v_exp_f32 v161, v161
  buffer_load_dwordx4 a[236:239], v4, s[24:27], s48 offen offset:0 sc1
  v_exp_f32 v162, v162
  v_exp_f32 v163, v163
  v_cvt_pk_bf16_f32 v48, v160, v161
  v_exp_f32 v164, v164
  v_exp_f32 v165, v165
  v_cvt_pk_bf16_f32 v49, v162, v163
  v_exp_f32 v166, v166
  v_exp_f32 v167, v167
  buffer_load_dwordx4 a[240:243], v5, s[24:27], s48 offen offset:0 sc1
  v_cvt_pk_bf16_f32 v50, v164, v165
  v_exp_f32 v168, v168
  v_exp_f32 v169, v169
  v_cvt_pk_bf16_f32 v51, v166, v167
  v_exp_f32 v170, v170
  s_nop 0
  v_mfma_f32_32x32x16_bf16 v[208:223], v[232:235], v[48:51], v[208:223]
  v_exp_f32 v171, v171
  v_cvt_pk_bf16_f32 v52, v168, v169
  buffer_load_dwordx4 a[244:247], v6, s[24:27], s48 offen offset:0 sc1
  v_exp_f32 v172, v172
  v_exp_f32 v173, v173
  v_cvt_pk_bf16_f32 v53, v170, v171
  v_exp_f32 v174, v174
  v_exp_f32 v175, v175
  v_cvt_pk_bf16_f32 v54, v172, v173
  v_cvt_pk_bf16_f32 v55, v174, v175
  s_waitcnt lgkmcnt(0)
  s_nop 0
  v_mfma_f32_32x32x16_bf16 v[208:223], v[236:239], v[52:55], v[208:223]
  buffer_load_dwordx4 a[248:251], v7, s[24:27], s48 offen offset:0 sc1
  s_add_u32 s48, s48, 1024
  s_and_b32 s48, s48, 0x1fff
  s_nop 7
  s_nop 0
  v_rcp_f32 v221, v220
  s_nop 0
  v_max_f32 v220, v220, v221
  v_cmp_nge_f32 s[88:89], s90, v220
  buffer_load_dwordx4 v[240:243], v4, s[24:27], s48 offen offset:0 sc1
  s_or_b64 vcc, s[86:87], s[88:89]
  s_cbranch_vccnz .fb63
.fbb64:
  v_mul_f32 v208, v208, v221
  v_mul_f32 v209, v209, v221
  v_mul_f32 v210, v210, v221
  v_mul_f32 v211, v211, v221
  v_mul_f32 v212, v212, v221
  v_mul_f32 v213, v213, v221
  v_mul_f32 v214, v214, v221
  v_mul_f32 v215, v215, v221
  v_mul_f32 v216, v216, v221
  v_mul_f32 v217, v217, v221
  v_mul_f32 v218, v218, v221
  v_mul_f32 v219, v219, v221
  v_cvt_pk_bf16_f32 v208, v208, v209
  v_cvt_pk_bf16_f32 v209, v210, v211
  v_cvt_pk_bf16_f32 v210, v212, v213
  v_cvt_pk_bf16_f32 v211, v214, v215
  v_cvt_pk_bf16_f32 v212, v216, v217
  v_cvt_pk_bf16_f32 v213, v218, v219
  buffer_store_dwordx4 v[208:211], v13, s[24:27], s84 offen sc1
  s_mov_b32 exec_hi, 0
  buffer_store_dwordx2 v[212:213], v13, s[24:27], s85 offen sc1
  s_mov_b32 exec_hi, -1
  s_waitcnt vmcnt(30)
  v_mfma_f32_16x16x32_bf16 v[24:27], v[64:67], a[140:143], v[24:27]
  ds_read_b128 v[128:131], v2 offset:20480
  v_mfma_f32_16x16x32_bf16 v[84:87], v[64:67], a[144:147], 0
  ds_read_b128 v[132:135], v2 offset:21504
  v_mfma_f32_16x16x32_bf16 v[28:31], v[68:71], a[140:143], v[28:31]
  ds_read_b128 v[136:139], v2 offset:22528
  v_mfma_f32_16x16x32_bf16 v[88:91], v[68:71], a[144:147], 0
  ds_read_b128 v[140:143], v2 offset:23552
  v_mfma_f32_16x16x32_bf16 v[56:59], v[72:75], a[140:143], v[56:59]
  ds_read_b128 v[160:163], v2 offset:24576
  v_mfma_f32_16x16x32_bf16 v[92:95], v[72:75], a[144:147], 0
  buffer_load_dwordx4 v[244:247], v5, s[24:27], s48 offen offset:0 sc1
  v_mfma_f32_16x16x32_bf16 v[60:63], v[76:79], a[140:143], v[60:63]
  v_mfma_f32_16x16x32_bf16 v[32:35], v[80:83], a[140:143], v[32:35]
  v_mfma_f32_16x16x32_bf16 v[104:107], v[64:67], a[148:151], 0
  v_mfma_f32_16x16x32_bf16 v[40:43], v[64:67], a[152:155], 0
  buffer_load_dwordx4 v[248:251], v6, s[24:27], s48 offen offset:0 sc1
  v_mfma_f32_16x16x32_bf16 v[108:111], v[68:71], a[148:151], 0
  ds_read_b128 v[64:67], v1 offset:40960
  v_mfma_f32_16x16x32_bf16 v[44:47], v[68:71], a[152:155], 0
  ds_read_b128 v[68:71], v1 offset:41984
  v_mfma_f32_16x16x32_bf16 v[112:115], v[72:75], a[148:151], 0
  v_mfma_f32_16x16x32_bf16 v[48:51], v[72:75], a[152:155], 0
  buffer_load_dwordx4 v[252:255], v7, s[24:27], s48 offen offset:0 sc1
  v_mfma_f32_16x16x32_bf16 v[96:99], v[76:79], a[144:147], 0
  ds_read_b128 v[72:75], v1 offset:43008
  v_mfma_f32_16x16x32_bf16 v[116:119], v[76:79], a[148:151], 0
  v_mfma_f32_16x16x32_bf16 v[52:55], v[76:79], a[152:155], 0
  ds_read_b128 v[76:79], v1 offset:44032
  v_mfma_f32_16x16x32_bf16 v[100:103], v[80:83], a[144:147], 0
  buffer_load_dwordx4 a[116:119], v14, s[24:27], s74 offen offset:3072 sc1
  v_mfma_f32_16x16x32_bf16 v[120:123], v[80:83], a[148:151], 0
  s_add_u32 s74, s74, 4096
  v_mfma_f32_16x16x32_bf16 v[36:39], v[80:83], a[152:155], 0
  ds_read_b128 v[80:83], v1 offset:45056
  s_waitcnt vmcnt(30)
  v_mfma_f32_16x16x32_bf16 v[24:27], v[144:147], a[156:159], v[24:27]
  v_mfma_f32_16x16x32_bf16 v[84:87], v[144:147], a[160:163], v[84:87]
  v_mfma_f32_16x16x32_bf16 v[104:107], v[144:147], a[164:167], v[104:107]
  buffer_load_dwordx4 a[120:123], v14, s[24:27], s74 offen offset:0 sc1
  v_mfma_f32_16x16x32_bf16 v[40:43], v[144:147], a[168:171], v[40:43]
  v_mfma_f32_16x16x32_bf16 v[28:31], v[148:151], a[156:159], v[28:31]
  v_mfma_f32_16x16x32_bf16 v[88:91], v[148:151], a[160:163], v[88:91]
  v_mfma_f32_16x16x32_bf16 v[108:111], v[148:151], a[164:167], v[108:111]
  v_mfma_f32_16x16x32_bf16 v[44:47], v[148:151], a[168:171], v[44:47]
  s_waitcnt lgkmcnt(0)
  s_add_u32 m0, s63, 40960
  v_mfma_f32_16x16x32_bf16 v[56:59], v[152:155], a[156:159], v[56:59]
  s_waitcnt vmcnt(15)
  v_cmp_eq_u32 vcc, 0, v188
  s_cbranch_vccnz .slow65
.back66:
  v_mfma_f32_16x16x32_bf16 v[92:95], v[152:155], a[160:163], v[92:95]
  s_add_u32 s56, s91, 7
  v_mfma_f32_16x16x32_bf16 v[112:115], v[152:155], a[164:167], v[112:115]
  s_and_b32 s56, s56, 7
  v_mfma_f32_16x16x32_bf16 v[48:51], v[152:155], a[168:171], v[48:51]
  s_mul_i32 s56, s56, 5120
  v_mfma_f32_16x16x32_bf16 v[60:63], v[156:159], a[156:159], v[60:63]
  s_add_u32 s56, s56, s59
  v_mfma_f32_16x16x32_bf16 v[96:99], v[156:159], a[160:163], v[96:99]
  buffer_load_dwordx4 v14, s[24:27], s56 offen offset:0 sc1 lds
  v_mfma_f32_16x16x32_bf16 v[116:119], v[156:159], a[164:167], v[116:119]
  buffer_load_dwordx4 v14, s[24:27], s56 offen offset:1024 sc1 lds
  v_mfma_f32_16x16x32_bf16 v[52:55], v[156:159], a[168:171], v[52:55]
  buffer_load_dwordx4 v14, s[24:27], s56 offen offset:2048 sc1 lds
  v_mfma_f32_16x16x32_bf16 v[32:35], a[252:255], a[156:159], v[32:35]
  v_mfma_f32_16x16x32_bf16 v[100:103], a[252:255], a[160:163], v[100:103]
  v_mfma_f32_16x16x32_bf16 v[120:123], a[252:255], a[164:167], v[120:123]
  buffer_load_dwordx4 v14, s[24:27], s56 offen offset:3072 sc1 lds
  v_mfma_f32_16x16x32_bf16 v[36:39], a[252:255], a[168:171], v[36:39]
  s_add_u32 m0, s63, 45056
  v_mfma_f32_16x16x32_bf16 v[24:27], v[64:67], a[172:175], v[24:27]
  s_add_u32 s56, s56, 4096
  v_mfma_f32_16x16x32_bf16 v[84:87], v[64:67], a[176:179], v[84:87]
  v_mfma_f32_16x16x32_bf16 v[104:107], v[64:67], a[180:183], v[104:107]
  buffer_load_dwordx4 v14, s[24:27], s56 offen sc1 lds
  v_mfma_f32_16x16x32_bf16 v[40:43], v[64:67], a[184:187], v[40:43]
  s_add_u32 m0, s63, 140288
  v_mfma_f32_16x16x32_bf16 v[28:31], v[68:71], a[172:175], v[28:31]
  s_mov_b32 s56, s60
  v_mfma_f32_16x16x32_bf16 v[88:91], v[68:71], a[176:179], v[88:91]
  ds_read_b128 v[64:67], v2 offset:0
  v_mfma_f32_16x16x32_bf16 v[108:111], v[68:71], a[180:183], v[108:111]
  buffer_load_dwordx4 v14, s[24:27], s56 offen offset:0 sc1 lds
  v_mfma_f32_16x16x32_bf16 v[44:47], v[68:71], a[184:187], v[44:47]
  ds_read_b128 v[68:71], v2 offset:1024
  v_mfma_f32_16x16x32_bf16 v[56:59], v[72:75], a[172:175], v[56:59]
  v_mfma_f32_16x16x32_bf16 v[92:95], v[72:75], a[176:179], v[92:95]
  v_mfma_f32_16x16x32_bf16 v[112:115], v[72:75], a[180:183], v[112:115]
  buffer_load_dwordx4 v14, s[24:27], s56 offen offset:1024 sc1 lds
  v_mfma_f32_16x16x32_bf16 v[48:51], v[72:75], a[184:187], v[48:51]
  ds_read_b128 v[72:75], v2 offset:2048
  v_mfma_f32_16x16x32_bf16 v[60:63], v[76:79], a[172:175], v[60:63]
  v_mfma_f32_16x16x32_bf16 v[96:99], v[76:79], a[176:179], v[96:99]
  v_mfma_f32_16x16x32_bf16 v[116:119], v[76:79], a[180:183], v[116:119]
  buffer_load_dwordx4 v14, s[24:27], s56 offen offset:2048 sc1 lds
  v_mfma_f32_16x16x32_bf16 v[52:55], v[76:79], a[184:187], v[52:55]
  ds_read_b128 v[76:79], v2 offset:3072
  v_mfma_f32_16x16x32_bf16 v[32:35], v[80:83], a[172:175], v[32:35]
  v_mfma_f32_16x16x32_bf16 v[100:103], v[80:83], a[176:179], v[100:103]
  v_mfma_f32_16x16x32_bf16 v[120:123], v[80:83], a[180:183], v[120:123]
  buffer_load_dwordx4 v14, s[24:27], s56 offen offset:3072 sc1 lds
  v_mfma_f32_16x16x32_bf16 v[36:39], v[80:83], a[184:187], v[36:39]
  s_add_u32 m0, s63, 144384
  v_mfma_f32_16x16x32_bf16 v[24:27], v[128:131], a[188:191], v[24:27]
  s_add_u32 s56, s56, 4096
  v_mfma_f32_16x16x32_bf16 v[84:87], v[128:131], a[192:195], v[84:87]
  ds_read_b128 v[80:83], v2 offset:4096
  buffer_load_dwordx4 v14, s[24:27], s56 offen sc1 lds
  v_mfma_f32_16x16x32_bf16 v[104:107], v[128:131], a[196:199], v[104:107]
  v_mfma_f32_16x16x32_bf16 v[40:43], v[128:131], a[200:203], v[40:43]
  ds_read_b128 v[128:131], v1 offset:0
  v_mfma_f32_16x16x32_bf16 v[28:31], v[132:135], a[188:191], v[28:31]
  v_mfma_f32_16x16x32_bf16 v[88:91], v[132:135], a[192:195], v[88:91]
  buffer_load_dwordx4 v[144:147], v4, s[24:27], s49 offen offset:0 sc1
  v_mfma_f32_16x16x32_bf16 v[108:111], v[132:135], a[196:199], v[108:111]
  v_mfma_f32_16x16x32_bf16 v[44:47], v[132:135], a[200:203], v[44:47]
  ds_read_b128 v[132:135], v1 offset:1024
  v_mfma_f32_16x16x32_bf16 v[56:59], v[136:139], a[188:191], v[56:59]
  v_mfma_f32_16x16x32_bf16 v[92:95], v[136:139], a[192:195], v[92:95]
  buffer_load_dwordx4 v[148:151], v5, s[24:27], s49 offen offset:0 sc1
  v_mfma_f32_16x16x32_bf16 v[112:115], v[136:139], a[196:199], v[112:115]
  s_waitcnt lgkmcnt(2)
  s_add_u32 m0, s63, 119808
  v_mfma_f32_16x16x32_bf16 v[48:51], v[136:139], a[200:203], v[48:51]
  s_add_u32 s56, s56, 1024
  v_mfma_f32_16x16x32_bf16 v[60:63], v[140:143], a[188:191], v[60:63]
  ds_read_b128 v[136:139], v1 offset:2048
  v_mfma_f32_16x16x32_bf16 v[96:99], v[140:143], a[192:195], v[96:99]
  buffer_load_dwordx4 v[152:155], v6, s[24:27], s49 offen offset:0 sc1
  v_mfma_f32_16x16x32_bf16 v[116:119], v[140:143], a[196:199], v[116:119]
  v_mfma_f32_16x16x32_bf16 v[52:55], v[140:143], a[200:203], v[52:55]
  ds_read_b128 v[140:143], v1 offset:3072
  v_mfma_f32_16x16x32_bf16 v[32:35], v[160:163], a[188:191], v[32:35]
  v_mfma_f32_16x16x32_bf16 v[100:103], v[160:163], a[192:195], v[100:103]
  buffer_load_dwordx4 v[156:159], v7, s[24:27], s49 offen offset:0 sc1
  v_mfma_f32_16x16x32_bf16 v[120:123], v[160:163], a[196:199], v[120:123]
  v_mfma_f32_16x16x32_bf16 v[36:39], v[160:163], a[200:203], v[36:39]
  ds_read_b128 v[160:163], v1 offset:4096
  v_mfma_f32_16x16x32_bf16 v[24:27], v[64:67], a[204:207], v[24:27]
  v_mfma_f32_16x16x32_bf16 v[84:87], v[64:67], a[208:211], v[84:87]
  buffer_load_dwordx4 v14, s[24:27], s56 offen offset:0 sc1 lds
  v_mfma_f32_16x16x32_bf16 v[104:107], v[64:67], a[212:215], v[104:107]
  v_mfma_f32_16x16x32_bf16 v[40:43], v[64:67], a[216:219], v[40:43]
  ds_read_b128 v[64:67], v1 offset:20480
  v_mfma_f32_16x16x32_bf16 v[28:31], v[68:71], a[204:207], v[28:31]
  v_mfma_f32_16x16x32_bf16 v[88:91], v[68:71], a[208:211], v[88:91]
  buffer_load_dwordx4 v14, s[24:27], s56 offen offset:1024 sc1 lds
  v_mfma_f32_16x16x32_bf16 v[108:111], v[68:71], a[212:215], v[108:111]
  v_mfma_f32_16x16x32_bf16 v[44:47], v[68:71], a[216:219], v[44:47]
  ds_read_b128 v[68:71], v1 offset:21504
  v_mfma_f32_16x16x32_bf16 v[56:59], v[72:75], a[204:207], v[56:59]
  v_mfma_f32_16x16x32_bf16 v[92:95], v[72:75], a[208:211], v[92:95]
  buffer_load_dwordx4 v14, s[24:27], s56 offen offset:2048 sc1 lds
  v_mfma_f32_16x16x32_bf16 v[112:115], v[72:75], a[212:215], v[112:115]
  v_mfma_f32_16x16x32_bf16 v[48:51], v[72:75], a[216:219], v[48:51]
  ds_read_b128 v[72:75], v1 offset:22528
  v_mfma_f32_16x16x32_bf16 v[60:63], v[76:79], a[204:207], v[60:63]
  buffer_load_dwordx4 v14, s[24:27], s56 offen offset:3072 sc1 lds
  v_mfma_f32_16x16x32_bf16 v[96:99], v[76:79], a[208:211], v[96:99]
  s_add_u32 m0, s63, 123904
  v_mfma_f32_16x16x32_bf16 v[116:119], v[76:79], a[212:215], v[116:119]
  s_add_u32 s56, s56, 4096
  v_mfma_f32_16x16x32_bf16 v[52:55], v[76:79], a[216:219], v[52:55]
  ds_read_b128 v[76:79], v1 offset:23552
  v_mfma_f32_16x16x32_bf16 v[32:35], v[80:83], a[204:207], v[32:35]
  buffer_load_dwordx4 v14, s[24:27], s56 offen sc1 lds
  v_mfma_f32_16x16x32_bf16 v[100:103], v[80:83], a[208:211], v[100:103]
  v_mfma_f32_16x16x32_bf16 v[120:123], v[80:83], a[212:215], v[120:123]
  v_mfma_f32_16x16x32_bf16 v[36:39], v[80:83], a[216:219], v[36:39]
  ds_read_b128 v[80:83], v1 offset:24576
  s_waitcnt vmcnt(33) lgkmcnt(2)
  v_mfma_f32_16x16x32_bf16 v[24:27], v[128:131], a[220:223], v[24:27]
  buffer_load_dwordx4 v[192:195], v4, s[24:27], s49 offen offset:1024 sc1
  v_mfma_f32_16x16x32_bf16 v[84:87], v[128:131], a[224:227], v[84:87]
  v_mfma_f32_16x16x32_bf16 v[104:107], v[128:131], a[228:231], v[104:107]
  v_mfma_f32_16x16x32_bf16 v[40:43], v[128:131], a[232:235], v[40:43]
  v_mfma_f32_16x16x32_bf16 v[28:31], v[132:135], a[220:223], v[28:31]
  buffer_load_dwordx4 v[196:199], v5, s[24:27], s49 offen offset:1024 sc1
  v_mfma_f32_16x16x32_bf16 v[88:91], v[132:135], a[224:227], v[88:91]
  v_mfma_f32_16x16x32_bf16 v[108:111], v[132:135], a[228:231], v[108:111]
  v_mfma_f32_16x16x32_bf16 v[44:47], v[132:135], a[232:235], v[44:47]
  buffer_load_dwordx4 v[200:203], v6, s[24:27], s49 offen offset:1024 sc1
  v_mfma_f32_16x16x32_bf16 v[56:59], v[136:139], a[220:223], v[56:59]
  v_mfma_f32_16x16x32_bf16 v[92:95], v[136:139], a[224:227], v[92:95]
  v_mfma_f32_16x16x32_bf16 v[112:115], v[136:139], a[228:231], v[112:115]
  v_mfma_f32_16x16x32_bf16 v[48:51], v[136:139], a[232:235], v[48:51]
  buffer_load_dwordx4 v[204:207], v7, s[24:27], s49 offen offset:1024 sc1
  v_mfma_f32_16x16x32_bf16 v[60:63], v[140:143], a[220:223], v[60:63]
  v_mfma_f32_16x16x32_bf16 v[96:99], v[140:143], a[224:227], v[96:99]
  v_mfma_f32_16x16x32_bf16 v[116:119], v[140:143], a[228:231], v[116:119]
  s_waitcnt vmcnt(18)
  ds_read_b128 v[128:131], v1 offset:40960
  v_mfma_f32_16x16x32_bf16 v[52:55], v[140:143], a[232:235], v[52:55]
  buffer_load_dwordx4 v[208:211], v4, s[24:27], s49 offen offset:2048 sc1
  v_mfma_f32_16x16x32_bf16 v[32:35], v[160:163], a[220:223], v[32:35]
  ds_read_b128 v[132:135], v1 offset:41984
  v_mfma_f32_16x16x32_bf16 v[100:103], v[160:163], a[224:227], v[100:103]
  ds_read_b128 v[136:139], v1 offset:43008
  v_mfma_f32_16x16x32_bf16 v[120:123], v[160:163], a[228:231], v[120:123]
  ds_read_b128 v[140:143], v1 offset:44032
  buffer_load_dwordx4 v[212:215], v5, s[24:27], s49 offen offset:2048 sc1
  v_mfma_f32_16x16x32_bf16 v[36:39], v[160:163], a[232:235], v[36:39]
  ds_read_b128 v[160:163], v1 offset:45056
  v_mfma_f32_16x16x32_bf16 v[24:27], v[64:67], a[236:239], v[24:27]
  v_mfma_f32_16x16x32_bf16 v[84:87], v[64:67], a[240:243], v[84:87]
  v_mfma_f32_16x16x32_bf16 v[104:107], v[64:67], a[244:247], v[104:107]
  buffer_load_dwordx4 v[216:219], v6, s[24:27], s49 offen offset:2048 sc1
  v_mfma_f32_16x16x32_bf16 v[40:43], v[64:67], a[248:251], v[40:43]
  v_mfma_f32_16x16x32_bf16 v[28:31], v[68:71], a[236:239], v[28:31]
  v_mfma_f32_16x16x32_bf16 v[88:91], v[68:71], a[240:243], v[88:91]
  v_mfma_f32_16x16x32_bf16 v[108:111], v[68:71], a[244:247], v[108:111]
  buffer_load_dwordx4 v[220:223], v7, s[24:27], s49 offen offset:2048 sc1
  v_mfma_f32_16x16x32_bf16 v[44:47], v[68:71], a[248:251], v[44:47]
  v_mfma_f32_16x16x32_bf16 v[56:59], v[72:75], a[236:239], v[56:59]
  v_mfma_f32_16x16x32_bf16 v[92:95], v[72:75], a[240:243], v[92:95]
  v_mfma_f32_16x16x32_bf16 v[112:115], v[72:75], a[244:247], v[112:115]
  buffer_load_dwordx4 v[224:227], v4, s[24:27], s49 offen offset:3072 sc1
  v_mfma_f32_16x16x32_bf16 v[48:51], v[72:75], a[248:251], v[48:51]
  s_waitcnt lgkmcnt(0)
  v_mfma_f32_16x16x32_bf16 v[60:63], v[76:79], a[236:239], v[60:63]
  v_mfma_f32_16x16x32_bf16 v[96:99], v[76:79], a[240:243], v[96:99]
  s_waitcnt vmcnt(18)
  ds_read_b128 v[64:67], v2 offset:20480
  v_mfma_f32_16x16x32_bf16 v[116:119], v[76:79], a[244:247], v[116:119]
  buffer_load_dwordx4 v[228:231], v5, s[24:27], s49 offen offset:3072 sc1
  v_mfma_f32_16x16x32_bf16 v[52:55], v[76:79], a[248:251], v[52:55]
  ds_read_b128 v[68:71], v2 offset:21504
  v_mfma_f32_16x16x32_bf16 v[32:35], v[80:83], a[236:239], v[32:35]
  ds_read_b128 v[72:75], v2 offset:22528
  v_mfma_f32_16x16x32_bf16 v[100:103], v[80:83], a[240:243], v[100:103]
  ds_read_b128 v[76:79], v2 offset:23552
  buffer_load_dwordx4 v[232:235], v6, s[24:27], s49 offen offset:3072 sc1
  v_mfma_f32_16x16x32_bf16 v[120:123], v[80:83], a[244:247], v[120:123]
  v_mfma_f32_16x16x32_bf16 v[36:39], v[80:83], a[248:251], v[36:39]
  ds_read_b128 v[80:83], v2 offset:24576
  v_mfma_f32_16x16x32_bf16 v[24:27], v[128:131], v[240:243], v[24:27]
  v_mfma_f32_16x16x32_bf16 v[84:87], v[128:131], v[244:247], v[84:87]
  buffer_load_dwordx4 v[236:239], v7, s[24:27], s49 offen offset:3072 sc1
  v_mfma_f32_16x16x32_bf16 v[104:107], v[128:131], v[248:251], v[104:107]
  v_mfma_f32_16x16x32_bf16 v[40:43], v[128:131], v[252:255], v[40:43]
  v_mfma_f32_16x16x32_bf16 v[28:31], v[132:135], v[240:243], v[28:31]
  v_mfma_f32_16x16x32_bf16 v[88:91], v[132:135], v[244:247], v[88:91]
  buffer_load_dwordx4 a[124:127], v14, s[24:27], s74 offen offset:1024 sc1
  v_mfma_f32_16x16x32_bf16 v[108:111], v[132:135], v[248:251], v[108:111]
  v_mfma_f32_16x16x32_bf16 v[44:47], v[132:135], v[252:255], v[44:47]
  v_mfma_f32_16x16x32_bf16 v[56:59], v[136:139], v[240:243], v[56:59]
  v_mfma_f32_16x16x32_bf16 v[92:95], v[136:139], v[244:247], v[92:95]
  v_mfma_f32_16x16x32_bf16 v[112:115], v[136:139], v[248:251], v[112:115]
  buffer_load_dwordx4 a[128:131], v14, s[24:27], s74 offen offset:2048 sc1
  v_mfma_f32_16x16x32_bf16 v[48:51], v[136:139], v[252:255], v[48:51]
  v_mfma_f32_16x16x32_bf16 v[60:63], v[140:143], v[240:243], v[60:63]
  v_mfma_f32_16x16x32_bf16 v[96:99], v[140:143], v[244:247], v[96:99]
  v_mfma_f32_16x16x32_bf16 v[116:119], v[140:143], v[248:251], v[116:119]
  v_mfma_f32_16x16x32_bf16 v[52:55], v[140:143], v[252:255], v[52:55]
  buffer_load_dwordx4 a[132:135], v14, s[24:27], s74 offen offset:3072 sc1
  v_mfma_f32_16x16x32_bf16 v[32:35], v[160:163], v[240:243], v[32:35]
  s_add_u32 s74, s74, 4096
  v_mfma_f32_16x16x32_bf16 v[100:103], v[160:163], v[244:247], v[100:103]
  v_mfma_f32_16x16x32_bf16 v[120:123], v[160:163], v[248:251], v[120:123]
  v_mfma_f32_16x16x32_bf16 v[36:39], v[160:163], v[252:255], v[36:39]
  s_waitcnt vmcnt(20) lgkmcnt(0)
  v_mfma_f32_16x16x32_bf16 v[24:27], v[64:67], v[144:147], v[24:27]
  buffer_load_dwordx4 a[136:139], v14, s[24:27], s74 offen offset:0 sc1
  v_mfma_f32_16x16x32_bf16 v[84:87], v[64:67], v[148:151], v[84:87]
  v_mfma_f32_16x16x32_bf16 v[104:107], v[64:67], v[152:155], v[104:107]
  v_mfma_f32_16x16x32_bf16 v[40:43], v[64:67], v[156:159], v[40:43]
  v_mfma_f32_16x16x32_bf16 v[28:31], v[68:71], v[144:147], v[28:31]
  v_mfma_f32_16x16x32_bf16 v[88:91], v[68:71], v[148:151], v[88:91]
  buffer_load_dwordx4 a[140:143], v5, s[24:27], s50 offen offset:0 sc1
  v_mfma_f32_16x16x32_bf16 v[108:111], v[68:71], v[152:155], v[108:111]
  v_mfma_f32_16x16x32_bf16 v[44:47], v[68:71], v[156:159], v[44:47]
  s_waitcnt vmcnt(17)
  ds_read_b128 v[128:131], v2 offset:0
  v_mfma_f32_16x16x32_bf16 v[56:59], v[72:75], v[144:147], v[56:59]
  ds_read_b128 v[132:135], v2 offset:1024
  v_mfma_f32_16x16x32_bf16 v[92:95], v[72:75], v[148:151], v[92:95]
  buffer_load_dwordx4 a[144:147], v5, s[24:27], s50 offen offset:1024 sc1
  v_mfma_f32_16x16x32_bf16 v[112:115], v[72:75], v[152:155], v[112:115]
  ds_read_b128 v[136:139], v2 offset:2048
  v_mfma_f32_16x16x32_bf16 v[48:51], v[72:75], v[156:159], v[48:51]
  ds_read_b128 v[140:143], v2 offset:3072
  v_mfma_f32_16x16x32_bf16 v[60:63], v[76:79], v[144:147], v[60:63]
  ds_read_b128 v[160:163], v2 offset:4096
  v_mfma_f32_16x16x32_bf16 v[96:99], v[76:79], v[148:151], v[96:99]
  buffer_load_dwordx4 a[148:151], v5, s[24:27], s50 offen offset:2048 sc1
  v_mfma_f32_16x16x32_bf16 v[116:119], v[76:79], v[152:155], v[116:119]
  v_mfma_f32_16x16x32_bf16 v[52:55], v[76:79], v[156:159], v[52:55]
  v_mfma_f32_16x16x32_bf16 v[32:35], v[80:83], v[144:147], v[32:35]
  v_mfma_f32_16x16x32_bf16 v[100:103], v[80:83], v[148:151], v[100:103]
  buffer_load_dwordx4 a[152:155], v5, s[24:27], s50 offen offset:3072 sc1
  v_mfma_f32_16x16x32_bf16 v[120:123], v[80:83], v[152:155], v[120:123]
  v_mfma_f32_16x16x32_bf16 v[36:39], v[80:83], v[156:159], v[36:39]
  buffer_load_dwordx4 a[156:159], v5, s[24:27], s51 offen offset:0 sc1
  s_waitcnt vmcnt(17) lgkmcnt(0)
  v_mfma_f32_16x16x32_bf16 v[24:27], v[128:131], v[192:195], v[24:27]
  v_mfma_f32_16x16x32_bf16 v[84:87], v[128:131], v[196:199], v[84:87]
  buffer_load_dwordx4 a[160:163], v6, s[24:27], s50 offen offset:0 sc1
  v_mfma_f32_16x16x32_bf16 v[104:107], v[128:131], v[200:203], v[104:107]
  v_mfma_f32_16x16x32_bf16 v[40:43], v[128:131], v[204:207], v[40:43]
  v_mfma_f32_16x16x32_bf16 v[28:31], v[132:135], v[192:195], v[28:31]
  v_mfma_f32_16x16x32_bf16 v[88:91], v[132:135], v[196:199], v[88:91]
  buffer_load_dwordx4 a[164:167], v6, s[24:27], s50 offen offset:1024 sc1
  v_mfma_f32_16x16x32_bf16 v[108:111], v[132:135], v[200:203], v[108:111]
  v_mfma_f32_16x16x32_bf16 v[44:47], v[132:135], v[204:207], v[44:47]
  v_mfma_f32_16x16x32_bf16 v[56:59], v[136:139], v[192:195], v[56:59]
  v_mfma_f32_16x16x32_bf16 v[92:95], v[136:139], v[196:199], v[92:95]
  buffer_load_dwordx4 a[168:171], v6, s[24:27], s50 offen offset:2048 sc1
  v_mfma_f32_16x16x32_bf16 v[112:115], v[136:139], v[200:203], v[112:115]
  v_mfma_f32_16x16x32_bf16 v[48:51], v[136:139], v[204:207], v[48:51]
  v_mfma_f32_16x16x32_bf16 v[60:63], v[140:143], v[192:195], v[60:63]
  v_mfma_f32_16x16x32_bf16 v[96:99], v[140:143], v[196:199], v[96:99]
  buffer_load_dwordx4 a[172:175], v6, s[24:27], s50 offen offset:3072 sc1
  v_mfma_f32_16x16x32_bf16 v[116:119], v[140:143], v[200:203], v[116:119]
  v_mfma_f32_16x16x32_bf16 v[52:55], v[140:143], v[204:207], v[52:55]
  v_mfma_f32_16x16x32_bf16 v[32:35], v[160:163], v[192:195], v[32:35]
  v_mfma_f32_16x16x32_bf16 v[100:103], v[160:163], v[196:199], v[100:103]
  buffer_load_dwordx4 a[176:179], v6, s[24:27], s51 offen offset:0 sc1
  v_mfma_f32_16x16x32_bf16 v[120:123], v[160:163], v[200:203], v[120:123]
  v_mfma_f32_16x16x32_bf16 v[36:39], v[160:163], v[204:207], v[36:39]
  s_waitcnt vmcnt(18)
  v_mfma_f32_16x16x32_bf16 v[24:27], a[0:3], v[208:211], v[24:27]
  buffer_load_dwordx4 a[180:183], v7, s[24:27], s50 offen offset:0 sc1
  v_mfma_f32_16x16x32_bf16 v[84:87], a[0:3], v[212:215], v[84:87]
  v_mfma_f32_16x16x32_bf16 v[104:107], a[0:3], v[216:219], v[104:107]
  v_mfma_f32_16x16x32_bf16 v[40:43], a[0:3], v[220:223], v[40:43]
  v_mfma_f32_16x16x32_bf16 v[28:31], a[4:7], v[208:211], v[28:31]
  buffer_load_dwordx4 a[184:187], v7, s[24:27], s50 offen offset:1024 sc1
  v_mfma_f32_16x16x32_bf16 v[88:91], a[4:7], v[212:215], v[88:91]
  v_mfma_f32_16x16x32_bf16 v[108:111], a[4:7], v[216:219], v[108:111]
  v_mfma_f32_16x16x32_bf16 v[44:47], a[4:7], v[220:223], v[44:47]
  v_mfma_f32_16x16x32_bf16 v[56:59], a[8:11], v[208:211], v[56:59]
  buffer_load_dwordx4 a[188:191], v7, s[24:27], s50 offen offset:2048 sc1
  v_mfma_f32_16x16x32_bf16 v[92:95], a[8:11], v[212:215], v[92:95]
  v_mfma_f32_16x16x32_bf16 v[112:115], a[8:11], v[216:219], v[112:115]
  v_mfma_f32_16x16x32_bf16 v[48:51], a[8:11], v[220:223], v[48:51]
  v_mfma_f32_16x16x32_bf16 v[60:63], a[12:15], v[208:211], v[60:63]
  buffer_load_dwordx4 a[192:195], v7, s[24:27], s50 offen offset:3072 sc1
  v_mfma_f32_16x16x32_bf16 v[96:99], a[12:15], v[212:215], v[96:99]
  v_mfma_f32_16x16x32_bf16 v[116:119], a[12:15], v[216:219], v[116:119]
  v_mfma_f32_16x16x32_bf16 v[52:55], a[12:15], v[220:223], v[52:55]
  v_mfma_f32_16x16x32_bf16 v[32:35], a[16:19], v[208:211], v[32:35]
  buffer_load_dwordx4 a[196:199], v7, s[24:27], s51 offen offset:0 sc1
  v_mfma_f32_16x16x32_bf16 v[100:103], a[16:19], v[212:215], v[100:103]
  v_mfma_f32_16x16x32_bf16 v[120:123], a[16:19], v[216:219], v[120:123]
  v_mfma_f32_16x16x32_bf16 v[36:39], a[16:19], v[220:223], v[36:39]
  s_waitcnt vmcnt(19)
  v_mfma_f32_16x16x32_bf16 v[24:27], a[20:23], v[224:227], v[24:27]
  buffer_load_dwordx4 a[200:203], v4, s[24:27], s50 offen offset:0 sc1
  v_mfma_f32_16x16x32_bf16 v[84:87], a[20:23], v[228:231], v[84:87]
  v_mfma_f32_16x16x32_bf16 v[104:107], a[20:23], v[232:235], v[104:107]
  v_mfma_f32_16x16x32_bf16 v[40:43], a[20:23], v[236:239], v[40:43]
  buffer_load_dwordx4 a[204:207], v4, s[24:27], s50 offen offset:1024 sc1
  v_mfma_f32_16x16x32_bf16 v[28:31], a[24:27], v[224:227], v[28:31]
  v_mfma_f32_16x16x32_bf16 v[88:91], a[24:27], v[228:231], v[88:91]
  v_mfma_f32_16x16x32_bf16 v[108:111], a[24:27], v[232:235], v[108:111]
  v_mfma_f32_16x16x32_bf16 v[44:47], a[24:27], v[236:239], v[44:47]
  buffer_load_dwordx4 a[208:211], v4, s[24:27], s50 offen offset:2048 sc1
  v_mfma_f32_16x16x32_bf16 v[56:59], a[28:31], v[224:227], v[56:59]
  v_mfma_f32_16x16x32_bf16 v[92:95], a[28:31], v[228:231], v[92:95]
  v_mfma_f32_16x16x32_bf16 v[112:115], a[28:31], v[232:235], v[112:115]
  v_mfma_f32_16x16x32_bf16 v[48:51], a[28:31], v[236:239], v[48:51]
  buffer_load_dwordx4 a[212:215], v4, s[24:27], s50 offen offset:3072 sc1
  v_mfma_f32_16x16x32_bf16 v[60:63], a[32:35], v[224:227], v[60:63]
  v_mfma_f32_16x16x32_bf16 v[96:99], a[32:35], v[228:231], v[96:99]
  v_mfma_f32_16x16x32_bf16 v[116:119], a[32:35], v[232:235], v[116:119]
  v_mfma_f32_16x16x32_bf16 v[52:55], a[32:35], v[236:239], v[52:55]
  buffer_load_dwordx4 a[216:219], v4, s[24:27], s51 offen offset:0 sc1
  v_mfma_f32_16x16x32_bf16 v[32:35], a[36:39], v[224:227], v[32:35]
  v_mfma_f32_16x16x32_bf16 v[100:103], a[36:39], v[228:231], v[100:103]
  v_mfma_f32_16x16x32_bf16 v[120:123], a[36:39], v[232:235], v[120:123]
  v_mfma_f32_16x16x32_bf16 v[36:39], a[36:39], v[236:239], v[36:39]
  s_waitcnt vmcnt(15)
  v_mfma_f32_16x16x32_bf16 v[64:67], a[40:43], a[140:143], v[84:87]
  v_mfma_f32_16x16x32_bf16 v[68:71], a[44:47], a[140:143], v[88:91]
  v_mfma_f32_16x16x32_bf16 v[72:75], a[48:51], a[140:143], v[92:95]
  v_mfma_f32_16x16x32_bf16 v[76:79], a[52:55], a[140:143], v[96:99]
  v_mfma_f32_16x16x32_bf16 v[80:83], a[56:59], a[140:143], v[100:103]
  v_mfma_f32_16x16x32_bf16 v[64:67], a[60:63], a[144:147], v[64:67]
  v_mfma_f32_16x16x32_bf16 v[68:71], a[64:67], a[144:147], v[68:71]
  v_mfma_f32_16x16x32_bf16 v[72:75], a[68:71], a[144:147], v[72:75]
  v_mfma_f32_16x16x32_bf16 v[76:79], a[72:75], a[144:147], v[76:79]
  v_mfma_f32_16x16x32_bf16 v[80:83], a[76:79], a[144:147], v[80:83]
  v_mfma_f32_16x16x32_bf16 v[64:67], a[80:83], a[148:151], v[64:67]
  v_mfma_f32_16x16x32_bf16 v[68:71], a[84:87], a[148:151], v[68:71]
  v_mfma_f32_16x16x32_bf16 v[72:75], a[88:91], a[148:151], v[72:75]
  v_mfma_f32_16x16x32_bf16 v[76:79], a[92:95], a[148:151], v[76:79]
  v_mfma_f32_16x16x32_bf16 v[80:83], a[96:99], a[148:151], v[80:83]
  v_mfma_f32_16x16x32_bf16 v[64:67], a[100:103], a[152:155], v[64:67]
  v_mfma_f32_16x16x32_bf16 v[68:71], a[104:107], a[152:155], v[68:71]
  v_mfma_f32_16x16x32_bf16 v[72:75], a[108:111], a[152:155], v[72:75]
  v_mfma_f32_16x16x32_bf16 v[76:79], a[112:115], a[152:155], v[76:79]
  v_mfma_f32_16x16x32_bf16 v[80:83], a[116:119], a[152:155], v[80:83]
  v_mfma_f32_16x16x32_bf16 v[64:67], a[120:123], a[156:159], v[64:67]
  v_mfma_f32_16x16x32_bf16 v[68:71], a[124:127], a[156:159], v[68:71]
  v_mfma_f32_16x16x32_bf16 v[72:75], a[128:131], a[156:159], v[72:75]
  v_mfma_f32_16x16x32_bf16 v[76:79], a[132:135], a[156:159], v[76:79]
  v_mfma_f32_16x16x32_bf16 v[80:83], a[136:139], a[156:159], v[80:83]
  s_waitcnt vmcnt(10)
  v_mfma_f32_16x16x32_bf16 v[128:131], a[40:43], a[160:163], v[104:107]
  s_nop 1
  v_cmp_u_f32 vcc, v64, v64
  s_cbranch_vccnz .oc68
.ocb69:
  v_mfma_f32_16x16x32_bf16 v[132:135], a[44:47], a[160:163], v[108:111]
  ds_write_b128 v1, v[64:67] offset:0
  v_mfma_f32_16x16x32_bf16 v[136:139], a[48:51], a[160:163], v[112:115]
  ds_write_b128 v1, v[68:71] offset:1024
  v_mfma_f32_16x16x32_bf16 v[140:143], a[52:55], a[160:163], v[116:119]
  ds_write_b128 v1, v[72:75] offset:2048
  v_mfma_f32_16x16x32_bf16 v[160:163], a[56:59], a[160:163], v[120:123]
  ds_write_b128 v1, v[76:79] offset:3072
  v_mfma_f32_16x16x32_bf16 v[128:131], a[60:63], a[164:167], v[128:131]
  ds_write_b128 v1, v[80:83] offset:4096
  v_mfma_f32_16x16x32_bf16 v[132:135], a[64:67], a[164:167], v[132:135]
  v_mfma_f32_16x16x32_bf16 v[136:139], a[68:71], a[164:167], v[136:139]
  v_mfma_f32_16x16x32_bf16 v[140:143], a[72:75], a[164:167], v[140:143]
  v_mfma_f32_16x16x32_bf16 v[160:163], a[76:79], a[164:167], v[160:163]
  v_mfma_f32_16x16x32_bf16 v[128:131], a[80:83], a[168:171], v[128:131]
  v_mfma_f32_16x16x32_bf16 v[132:135], a[84:87], a[168:171], v[132:135]
  v_mfma_f32_16x16x32_bf16 v[136:139], a[88:91], a[168:171], v[136:139]
  v_mfma_f32_16x16x32_bf16 v[140:143], a[92:95], a[168:171], v[140:143]
  v_mfma_f32_16x16x32_bf16 v[160:163], a[96:99], a[168:171], v[160:163]
  v_mfma_f32_16x16x32_bf16 v[128:131], a[100:103], a[172:175], v[128:131]
  v_mfma_f32_16x16x32_bf16 v[132:135], a[104:107], a[172:175], v[132:135]
  v_mfma_f32_16x16x32_bf16 v[136:139], a[108:111], a[172:175], v[136:139]
  v_mfma_f32_16x16x32_bf16 v[140:143], a[112:115], a[172:175], v[140:143]
  v_mfma_f32_16x16x32_bf16 v[160:163], a[116:119], a[172:175], v[160:163]
  v_mfma_f32_16x16x32_bf16 v[128:131], a[120:123], a[176:179], v[128:131]
  v_mfma_f32_16x16x32_bf16 v[132:135], a[124:127], a[176:179], v[132:135]
  v_mfma_f32_16x16x32_bf16 v[136:139], a[128:131], a[176:179], v[136:139]
  v_mfma_f32_16x16x32_bf16 v[140:143], a[132:135], a[176:179], v[140:143]
  v_mfma_f32_16x16x32_bf16 v[160:163], a[136:139], a[176:179], v[160:163]
  s_waitcnt vmcnt(5)
  v_mfma_f32_16x16x32_bf16 v[84:87], a[40:43], a[180:183], v[40:43]
  s_nop 1
  v_cmp_u_f32 vcc, v128, v128
  s_cbranch_vccnz .oc70
.ocb71:
  v_mfma_f32_16x16x32_bf16 v[88:91], a[44:47], a[180:183], v[44:47]
  ds_write_b128 v1, v[128:131] offset:20480
  v_mfma_f32_16x16x32_bf16 v[92:95], a[48:51], a[180:183], v[48:51]
  ds_write_b128 v1, v[132:135] offset:21504
  v_mfma_f32_16x16x32_bf16 v[96:99], a[52:55], a[180:183], v[52:55]
  ds_write_b128 v1, v[136:139] offset:22528
  v_mfma_f32_16x16x32_bf16 v[100:103], a[56:59], a[180:183], v[36:39]
  ds_write_b128 v1, v[140:143] offset:23552
  v_mfma_f32_16x16x32_bf16 v[84:87], a[60:63], a[184:187], v[84:87]
  ds_write_b128 v1, v[160:163] offset:24576
  v_mfma_f32_16x16x32_bf16 v[88:91], a[64:67], a[184:187], v[88:91]
  v_mfma_f32_16x16x32_bf16 v[92:95], a[68:71], a[184:187], v[92:95]
  v_mfma_f32_16x16x32_bf16 v[96:99], a[72:75], a[184:187], v[96:99]
  v_mfma_f32_16x16x32_bf16 v[100:103], a[76:79], a[184:187], v[100:103]
  v_mfma_f32_16x16x32_bf16 v[84:87], a[80:83], a[188:191], v[84:87]
  v_mfma_f32_16x16x32_bf16 v[88:91], a[84:87], a[188:191], v[88:91]
  v_mfma_f32_16x16x32_bf16 v[92:95], a[88:91], a[188:191], v[92:95]
  v_mfma_f32_16x16x32_bf16 v[96:99], a[92:95], a[188:191], v[96:99]
  v_mfma_f32_16x16x32_bf16 v[100:103], a[96:99], a[188:191], v[100:103]
  v_mfma_f32_16x16x32_bf16 v[84:87], a[100:103], a[192:195], v[84:87]
  v_mfma_f32_16x16x32_bf16 v[88:91], a[104:107], a[192:195], v[88:91]
  v_mfma_f32_16x16x32_bf16 v[92:95], a[108:111], a[192:195], v[92:95]
  v_mfma_f32_16x16x32_bf16 v[96:99], a[112:115], a[192:195], v[96:99]
  v_mfma_f32_16x16x32_bf16 v[100:103], a[116:119], a[192:195], v[100:103]
  v_mfma_f32_16x16x32_bf16 v[84:87], a[120:123], a[196:199], v[84:87]
  v_mfma_f32_16x16x32_bf16 v[88:91], a[124:127], a[196:199], v[88:91]
  v_mfma_f32_16x16x32_bf16 v[92:95], a[128:131], a[196:199], v[92:95]
  v_mfma_f32_16x16x32_bf16 v[96:99], a[132:135], a[196:199], v[96:99]
  v_mfma_f32_16x16x32_bf16 v[100:103], a[136:139], a[196:199], v[100:103]
  s_waitcnt vmcnt(0)
  v_mfma_f32_16x16x32_bf16 v[104:107], a[40:43], a[200:203], v[24:27]
  s_nop 1
  v_cmp_u_f32 vcc, v84, v84
  s_cbranch_vccnz .oc72
.ocb73:
  v_mfma_f32_16x16x32_bf16 v[108:111], a[44:47], a[200:203], v[28:31]
  ds_write_b128 v1, v[84:87] offset:40960
  v_mfma_f32_16x16x32_bf16 v[112:115], a[48:51], a[200:203], v[56:59]
  ds_write_b128 v1, v[88:91] offset:41984
  v_mfma_f32_16x16x32_bf16 v[116:119], a[52:55], a[200:203], v[60:63]
  ds_write_b128 v1, v[92:95] offset:43008
  v_mfma_f32_16x16x32_bf16 v[120:123], a[56:59], a[200:203], v[32:35]
  ds_write_b128 v1, v[96:99] offset:44032
  v_mfma_f32_16x16x32_bf16 v[104:107], a[60:63], a[204:207], v[104:107]
  ds_write_b128 v1, v[100:103] offset:45056
  v_mfma_f32_16x16x32_bf16 v[108:111], a[64:67], a[204:207], v[108:111]
  v_mfma_f32_16x16x32_bf16 v[112:115], a[68:71], a[204:207], v[112:115]
  v_mfma_f32_16x16x32_bf16 v[116:119], a[72:75], a[204:207], v[116:119]
  v_mfma_f32_16x16x32_bf16 v[120:123], a[76:79], a[204:207], v[120:123]
  v_mfma_f32_16x16x32_bf16 v[104:107], a[80:83], a[208:211], v[104:107]
  v_mfma_f32_16x16x32_bf16 v[108:111], a[84:87], a[208:211], v[108:111]
  s_waitcnt lgkmcnt(0)
  s_barrier
  v_mfma_f32_16x16x32_bf16 v[112:115], a[88:91], a[208:211], v[112:115]
  ds_read_b128 v[192:195], v8 offset:0
  v_mfma_f32_16x16x32_bf16 v[116:119], a[92:95], a[208:211], v[116:119]
  ds_read_b128 v[196:199], v9 offset:0
  v_mfma_f32_16x16x32_bf16 v[120:123], a[96:99], a[208:211], v[120:123]
  ds_read_b128 v[200:203], v10 offset:0
  v_mfma_f32_16x16x32_bf16 v[104:107], a[100:103], a[212:215], v[104:107]
  ds_read_b128 v[204:207], v8 offset:1024
  v_mfma_f32_16x16x32_bf16 v[108:111], a[104:107], a[212:215], v[108:111]
  ds_read_b128 v[208:211], v9 offset:1024
  v_mfma_f32_16x16x32_bf16 v[112:115], a[108:111], a[212:215], v[112:115]
  ds_read_b128 v[212:215], v10 offset:1024
  v_mfma_f32_16x16x32_bf16 v[116:119], a[112:115], a[212:215], v[116:119]
  ds_read_b128 v[216:219], v8 offset:2048
  v_mfma_f32_16x16x32_bf16 v[120:123], a[116:119], a[212:215], v[120:123]
  ds_read_b128 v[220:223], v9 offset:2048
  v_mfma_f32_16x16x32_bf16 v[104:107], a[120:123], a[216:219], v[104:107]
  ds_read_b128 v[224:227], v10 offset:2048
  v_mfma_f32_16x16x32_bf16 v[108:111], a[124:127], a[216:219], v[108:111]
  ds_read_b128 v[228:231], v8 offset:3072
  v_mfma_f32_16x16x32_bf16 v[112:115], a[128:131], a[216:219], v[112:115]
  ds_read_b128 v[232:235], v9 offset:3072
  v_mfma_f32_16x16x32_bf16 v[116:119], a[132:135], a[216:219], v[116:119]
  ds_read_b128 v[236:239], v10 offset:3072
  v_mfma_f32_16x16x32_bf16 v[120:123], a[136:139], a[216:219], v[120:123]
  ds_read_b128 v[240:243], v8 offset:4096
  ds_read_b128 v[244:247], v9 offset:4096
  ds_read_b128 v[248:251], v10 offset:4096
  s_waitcnt lgkmcnt(10)
  v_add_f32 v192, v192, v196
  v_add_f32 v193, v193, v197
  v_cmp_u_f32 vcc, v104, v104
  s_cbranch_vccnz .oc74
.ocb75:
  v_add_f32 v194, v194, v198
  v_add_f32 v195, v195, v199
  v_add_f32 v192, v192, v200
  v_add_f32 v193, v193, v201
  v_add_f32 v194, v194, v202
  v_add_f32 v195, v195, v203
  v_add_f32 v204, v204, v208
  v_add_f32 v205, v205, v209
  v_add_f32 v206, v206, v210
  v_add_f32 v207, v207, v211
  s_waitcnt lgkmcnt(6)
  v_add_f32 v204, v204, v212
  v_add_f32 v205, v205, v213
  v_add_f32 v206, v206, v214
  v_add_f32 v207, v207, v215
  v_add_f32 v216, v216, v220
  v_add_f32 v217, v217, v221
  v_add_f32 v218, v218, v222
  v_add_f32 v219, v219, v223
  v_add_f32 v216, v216, v224
  v_add_f32 v217, v217, v225
  v_add_f32 v218, v218, v226
  v_add_f32 v219, v219, v227
  s_waitcnt lgkmcnt(3)
  v_add_f32 v228, v228, v232
  v_add_f32 v229, v229, v233
  v_add_f32 v230, v230, v234
  v_add_f32 v231, v231, v235
  v_add_f32 v228, v228, v236
  v_add_f32 v229, v229, v237
  v_add_f32 v230, v230, v238
  v_add_f32 v231, v231, v239
  s_waitcnt lgkmcnt(0)
  v_add_f32 v240, v240, v244
  v_add_f32 v241, v241, v245
  v_add_f32 v242, v242, v246
  v_add_f32 v243, v243, v247
  v_add_f32 v240, v240, v248
  v_add_f32 v241, v241, v249
  v_add_f32 v242, v242, v250
  v_add_f32 v243, v243, v251
  v_add_f32 v104, v104, v192
  v_add_f32 v105, v105, v193
  v_add_f32 v106, v106, v194
  v_add_f32 v107, v107, v195
  v_cvt_pk_bf16_f32 v104, v104, v105
  v_cvt_pk_bf16_f32 v105, v106, v107
  v_add_f32 v108, v108, v204
  v_add_f32 v109, v109, v205
  v_add_f32 v110, v110, v206
  v_add_f32 v111, v111, v207
  v_cvt_pk_bf16_f32 v106, v108, v109
  v_cvt_pk_bf16_f32 v107, v110, v111
  v_add_f32 v112, v112, v216
  buffer_store_dwordx4 v[104:107], v15, s[16:19], s62 offen offset:0
  v_add_f32 v113, v113, v217
  v_add_f32 v114, v114, v218
  v_add_f32 v115, v115, v219
  v_cvt_pk_bf16_f32 v112, v112, v113
  v_cvt_pk_bf16_f32 v113, v114, v115
  v_add_f32 v116, v116, v228
  v_add_f32 v117, v117, v229
  v_add_f32 v118, v118, v230
  v_add_f32 v119, v119, v231
  v_cvt_pk_bf16_f32 v114, v116, v117
  v_cvt_pk_bf16_f32 v115, v118, v119
  v_add_f32 v120, v120, v240
  buffer_store_dwordx4 v[112:115], v15, s[16:19], s62 offen offset:64
  v_add_f32 v121, v121, v241
  v_add_f32 v122, v122, v242
  v_add_f32 v123, v123, v243
  v_cvt_pk_bf16_f32 v120, v120, v121
  v_cvt_pk_bf16_f32 v121, v122, v123
  buffer_store_dwordx2 v[120:121], v12, s[16:19], s62 offen offset:128
  s_endpgm
.slow1:
  s_mov_b32 s100, 40000
.spin3:
  buffer_load_dword v10, v37, s[52:55], 0 offen offset:0 sc1
  s_waitcnt vmcnt(0)
  v_cmp_eq_u32 vcc, 0, v10
  s_cbranch_vccz .back2
  s_sub_u32 s100, s100, 1
  s_cbranch_scc0 .spin3
  s_branch .back2
.slow4:
  s_mov_b32 s100, 40000
.spin6:
  buffer_load_dword v11, v93, s[24:27], s95 offen offset:0 sc1
  s_waitcnt vmcnt(0)
  v_cmp_eq_u32 vcc, 0, v11
  s_cbranch_vccz .back5
  s_sub_u32 s100, s100, 1
  s_cbranch_scc0 .spin6
  s_branch .back5
.slow7:
  s_mov_b32 s100, 40000
.spin9:
  buffer_load_dword v11, v10, s[24:27], s95 offen offset:1024 sc1
  s_waitcnt vmcnt(0)
  v_cmp_eq_u32 vcc, 0, v11
  s_cbranch_vccz .back8
  s_sub_u32 s100, s100, 1
  s_cbranch_scc0 .spin9
  s_branch .back8
.slow10:
  s_mov_b32 s100, 40000
.spin12:
  buffer_load_dword v188, v127, s[24:27], s95 offen offset:0 sc1
  s_waitcnt vmcnt(0)
  v_cmp_eq_u32 vcc, 0, v188
  s_cbranch_vccz .back11
  s_sub_u32 s100, s100, 1
  s_cbranch_scc0 .spin12
  s_branch .back11
.fb13:
  s_nop 7
  s_nop 7
  s_waitcnt lgkmcnt(0)
  v_mov_b32 v182, 0xff7fffff
  v_mov_b32 v192, 0
  v_mov_b32 v193, 0
  v_mov_b32 v194, 0
  v_mov_b32 v195, 0
  v_mov_b32 v196, 0
  v_mov_b32 v197, 0
  v_mov_b32 v198, 0
  v_mov_b32 v199, 0
  v_mov_b32 v200, 0
  v_mov_b32 v201, 0
  v_mov_b32 v202, 0
  v_mov_b32 v203, 0
  v_mov_b32 v204, 0
  v_mov_b32 v205, 0
  v_mov_b32 v206, 0
  v_mov_b32 v207, 0
  s_lshl_b32 s100, s3, 1
  s_sub_u32 s100, 8, s100
  s_cmp_lt_i32 s93, 0
  s_cselect_b32 s100, s100, 0
.fl5015:
  s_add_u32 s96, s100, 0
  s_mul_i32 s96, s96, 3072
  v_add_u32 v183, s96, v20
  v_add_u32 v184, s96, v21
  v_add_u32 v185, s96, v22
  ds_read_b128 v[176:179], v183
  ds_read_b64 v[180:181], v184
  ds_read_b128 v[224:227], v185
  ds_read_b128 v[228:231], v185 offset:768
  s_cmp_eq_u32 s100, 0
  s_cselect_b32 s96, 0xf149f2ca, 0
  s_and_b32 s97, s100, 7
  s_cselect_b32 s97, 0, -1
  v_xor_b32 v160, s96, v96
  v_and_b32 v160, s97, v160
  v_xor_b32 v161, s96, v97
  v_and_b32 v161, s97, v161
  v_xor_b32 v162, s96, v98
  v_and_b32 v162, s97, v162
  v_xor_b32 v163, s96, v99
  v_and_b32 v163, s97, v163
  v_xor_b32 v164, s96, v100
  v_and_b32 v164, s97, v164
  v_xor_b32 v165, s96, v101
  v_and_b32 v165, s97, v165
  v_xor_b32 v166, s96, v102
  v_and_b32 v166, s97, v166
  v_xor_b32 v167, s96, v103
  v_and_b32 v167, s97, v167
  v_xor_b32 v168, s96, v104
  v_and_b32 v168, s97, v168
  v_xor_b32 v169, s96, v105
  v_and_b32 v169, s97, v169
  v_xor_b32 v170, s96, v106
  v_and_b32 v170, s97, v170
  v_xor_b32 v171, s96, v107
  v_and_b32 v171, s97, v171
  v_xor_b32 v172, s96, v108
  v_and_b32 v172, s97, v172
  v_xor_b32 v173, s96, v109
  v_and_b32 v173, s97, v173
  v_xor_b32 v174, s96, v110
  v_and_b32 v174, s97, v174
  v_xor_b32 v175, s96, v111
  v_and_b32 v175, s97, v175
  s_waitcnt lgkmcnt(0)
  s_nop 0
  v_mfma_f32_32x32x16_bf16 v[128:143], v[176:179], v[112:115], v[160:175]
  v_mfma_f32_32x32x8_bf16 v[128:143], v[180:181], v[120:121], v[128:143]
  s_nop 7
  s_nop 3
  v_max_f32 v182, v182, v128
  v_max_f32 v182, v182, v129
  v_max_f32 v182, v182, v130
  v_max_f32 v182, v182, v131
  v_max_f32 v182, v182, v132
  v_max_f32 v182, v182, v133
  v_max_f32 v182, v182, v134
  v_max_f32 v182, v182, v135
  v_max_f32 v182, v182, v136
  v_max_f32 v182, v182, v137
  v_max_f32 v182, v182, v138
  v_max_f32 v182, v182, v139
  v_max_f32 v182, v182, v140
  v_max_f32 v182, v182, v141
  v_max_f32 v182, v182, v142
  v_max_f32 v182, v182, v143
  s_nop 7
  s_nop 7
  s_add_u32 s100, s100, 1
  s_cmp_lt_u32 s100, 9
  s_cbranch_scc1 .fl5015
  v_mov_b32 v186, v182
  s_nop 1
  v_permlane32_swap_b32 v182, v186
  v_max_f32 v182, v182, v186
  s_lshl_b32 s100, s3, 1
  s_sub_u32 s100, 8, s100
  s_cmp_lt_i32 s93, 0
  s_cselect_b32 s100, s100, 0
.fl5016:
  s_add_u32 s96, s100, 0
  s_mul_i32 s96, s96, 3072
  v_add_u32 v183, s96, v20
  v_add_u32 v184, s96, v21
  v_add_u32 v185, s96, v22
  ds_read_b128 v[176:179], v183
  ds_read_b64 v[180:181], v184
  ds_read_b128 v[224:227], v185
  ds_read_b128 v[228:231], v185 offset:768
  s_cmp_eq_u32 s100, 0
  s_cselect_b32 s96, 0xf149f2ca, 0
  s_and_b32 s97, s100, 7
  s_cselect_b32 s97, 0, -1
  v_xor_b32 v160, s96, v96
  v_and_b32 v160, s97, v160
  v_xor_b32 v161, s96, v97
  v_and_b32 v161, s97, v161
  v_xor_b32 v162, s96, v98
  v_and_b32 v162, s97, v162
  v_xor_b32 v163, s96, v99
  v_and_b32 v163, s97, v163
  v_xor_b32 v164, s96, v100
  v_and_b32 v164, s97, v164
  v_xor_b32 v165, s96, v101
  v_and_b32 v165, s97, v165
  v_xor_b32 v166, s96, v102
  v_and_b32 v166, s97, v166
  v_xor_b32 v167, s96, v103
  v_and_b32 v167, s97, v167
  v_xor_b32 v168, s96, v104
  v_and_b32 v168, s97, v168
  v_xor_b32 v169, s96, v105
  v_and_b32 v169, s97, v169
  v_xor_b32 v170, s96, v106
  v_and_b32 v170, s97, v170
  v_xor_b32 v171, s96, v107
  v_and_b32 v171, s97, v171
  v_xor_b32 v172, s96, v108
  v_and_b32 v172, s97, v172
  v_xor_b32 v173, s96, v109
  v_and_b32 v173, s97, v173
  v_xor_b32 v174, s96, v110
  v_and_b32 v174, s97, v174
  v_xor_b32 v175, s96, v111
  v_and_b32 v175, s97, v175
  s_waitcnt lgkmcnt(0)
  s_nop 0
  v_mfma_f32_32x32x16_bf16 v[128:143], v[176:179], v[112:115], v[160:175]
  v_mfma_f32_32x32x8_bf16 v[128:143], v[180:181], v[120:121], v[128:143]
  s_nop 7
  s_nop 3
  v_sub_f32 v128, v128, v182
  v_sub_f32 v129, v129, v182
  v_sub_f32 v130, v130, v182
  v_sub_f32 v131, v131, v182
  v_sub_f32 v132, v132, v182
  v_sub_f32 v133, v133, v182
  v_sub_f32 v134, v134, v182
  v_sub_f32 v135, v135, v182
  v_sub_f32 v136, v136, v182
  v_sub_f32 v137, v137, v182
  v_sub_f32 v138, v138, v182
  v_sub_f32 v139, v139, v182
  v_sub_f32 v140, v140, v182
  v_sub_f32 v141, v141, v182
  v_sub_f32 v142, v142, v182
  v_sub_f32 v143, v143, v182
  v_exp_f32 v128, v128
  v_exp_f32 v129, v129
  v_exp_f32 v130, v130
  v_exp_f32 v131, v131
  v_exp_f32 v132, v132
  v_exp_f32 v133, v133
  v_exp_f32 v134, v134
  v_exp_f32 v135, v135
  v_exp_f32 v136, v136
  v_exp_f32 v137, v137
  v_exp_f32 v138, v138
  v_exp_f32 v139, v139
  v_exp_f32 v140, v140
  v_exp_f32 v141, v141
  v_exp_f32 v142, v142
  v_exp_f32 v143, v143
  v_cvt_pk_bf16_f32 v232, v128, v129
  v_cvt_pk_bf16_f32 v233, v130, v131
  v_cvt_pk_bf16_f32 v234, v132, v133
  v_cvt_pk_bf16_f32 v235, v134, v135
  v_cvt_pk_bf16_f32 v236, v136, v137
  v_cvt_pk_bf16_f32 v237, v138, v139
  v_cvt_pk_bf16_f32 v238, v140, v141
  v_cvt_pk_bf16_f32 v239, v142, v143
  v_mfma_f32_32x32x16_bf16 v[192:207], v[224:227], v[232:235], v[192:207]
  s_nop 0
  v_mfma_f32_32x32x16_bf16 v[192:207], v[228:231], v[236:239], v[192:207]
  s_nop 7
  s_nop 7
  s_add_u32 s100, s100, 1
  s_cmp_lt_u32 s100, 9
  s_cbranch_scc1 .fl5016
  v_rcp_f32 v205, v204
  s_nop 0
  v_mul_f32 v192, v192, v205
  v_mul_f32 v193, v193, v205
  v_mul_f32 v194, v194, v205
  v_mul_f32 v195, v195, v205
  v_cvt_pk_bf16_f32 v192, v192, v193
  v_mul_f32 v196, v196, v205
  v_mul_f32 v197, v197, v205
  v_cvt_pk_bf16_f32 v193, v194, v195
  v_mul_f32 v198, v198, v205
  v_mul_f32 v199, v199, v205
  v_cvt_pk_bf16_f32 v194, v196, v197
  v_mul_f32 v200, v200, v205
  v_mul_f32 v201, v201, v205
  v_cvt_pk_bf16_f32 v195, v198, v199
  v_mul_f32 v202, v202, v205
  v_mul_f32 v203, v203, v205
  v_cvt_pk_bf16_f32 v196, v200, v201
  v_cvt_pk_bf16_f32 v197, v202, v203
  buffer_store_dwordx4 v[192:195], v13, s[24:27], s82 offen sc1
  s_mov_b32 exec_hi, 0
  buffer_store_dwordx2 v[196:197], v13, s[24:27], s83 offen sc1
  s_mov_b32 exec_hi, -1
  v_mov_b32 v182, 0xff7fffff
  v_mov_b32 v208, 0
  v_mov_b32 v209, 0
  v_mov_b32 v210, 0
  v_mov_b32 v211, 0
  v_mov_b32 v212, 0
  v_mov_b32 v213, 0
  v_mov_b32 v214, 0
  v_mov_b32 v215, 0
  v_mov_b32 v216, 0
  v_mov_b32 v217, 0
  v_mov_b32 v218, 0
  v_mov_b32 v219, 0
  v_mov_b32 v220, 0
  v_mov_b32 v221, 0
  v_mov_b32 v222, 0
  v_mov_b32 v223, 0
  s_lshl_b32 s100, s3, 1
  s_sub_u32 s100, 7, s100
  s_cmp_lt_i32 s93, 0
  s_cselect_b32 s100, s100, 0
.fl5017:
  s_add_u32 s96, s100, 1
  s_mul_i32 s96, s96, 3072
  v_add_u32 v183, s96, v20
  v_add_u32 v184, s96, v21
  v_add_u32 v185, s96, v22
  ds_read_b128 v[176:179], v183
  ds_read_b64 v[180:181], v184
  ds_read_b128 v[224:227], v185
  ds_read_b128 v[228:231], v185 offset:768
  s_cmp_eq_u32 s100, 0
  s_cselect_b32 s96, 0xf149f2ca, 0
  s_and_b32 s97, s100, 7
  s_cselect_b32 s97, 0, -1
  v_xor_b32 v160, s96, v96
  v_and_b32 v160, s97, v160
  v_xor_b32 v161, s96, v97
  v_and_b32 v161, s97, v161
  v_xor_b32 v162, s96, v98
  v_and_b32 v162, s97, v162
  v_xor_b32 v163, s96, v99
  v_and_b32 v163, s97, v163
  v_xor_b32 v164, s96, v100
  v_and_b32 v164, s97, v164
  v_xor_b32 v165, s96, v101
  v_and_b32 v165, s97, v165
  v_xor_b32 v166, s96, v102
  v_and_b32 v166, s97, v166
  v_xor_b32 v167, s96, v103
  v_and_b32 v167, s97, v167
  v_xor_b32 v168, s96, v104
  v_and_b32 v168, s97, v168
  v_xor_b32 v169, s96, v105
  v_and_b32 v169, s97, v169
  v_xor_b32 v170, s96, v106
  v_and_b32 v170, s97, v170
  v_xor_b32 v171, s96, v107
  v_and_b32 v171, s97, v171
  v_xor_b32 v172, s96, v108
  v_and_b32 v172, s97, v172
  v_xor_b32 v173, s96, v109
  v_and_b32 v173, s97, v173
  v_xor_b32 v174, s96, v110
  v_and_b32 v174, s97, v174
  v_xor_b32 v175, s96, v111
  v_and_b32 v175, s97, v175
  s_waitcnt lgkmcnt(0)
  s_nop 0
  v_mfma_f32_32x32x16_bf16 v[128:143], v[176:179], v[116:119], v[160:175]
  v_mfma_f32_32x32x8_bf16 v[128:143], v[180:181], v[122:123], v[128:143]
  s_nop 7
  s_nop 3
  v_max_f32 v182, v182, v128
  v_max_f32 v182, v182, v129
  v_max_f32 v182, v182, v130
  v_max_f32 v182, v182, v131
  v_max_f32 v182, v182, v132
  v_max_f32 v182, v182, v133
  v_max_f32 v182, v182, v134
  v_max_f32 v182, v182, v135
  v_max_f32 v182, v182, v136
  v_max_f32 v182, v182, v137
  v_max_f32 v182, v182, v138
  v_max_f32 v182, v182, v139
  v_max_f32 v182, v182, v140
  v_max_f32 v182, v182, v141
  v_max_f32 v182, v182, v142
  v_max_f32 v182, v182, v143
  s_nop 7
  s_nop 7
  s_add_u32 s100, s100, 1
  s_cmp_lt_u32 s100, 9
  s_cbranch_scc1 .fl5017
  v_mov_b32 v186, v182
  s_nop 1
  v_permlane32_swap_b32 v182, v186
  v_max_f32 v182, v182, v186
  s_lshl_b32 s100, s3, 1
  s_sub_u32 s100, 7, s100
  s_cmp_lt_i32 s93, 0
  s_cselect_b32 s100, s100, 0
.fl5018:
  s_add_u32 s96, s100, 1
  s_mul_i32 s96, s96, 3072
  v_add_u32 v183, s96, v20
  v_add_u32 v184, s96, v21
  v_add_u32 v185, s96, v22
  ds_read_b128 v[176:179], v183
  ds_read_b64 v[180:181], v184
  ds_read_b128 v[224:227], v185
  ds_read_b128 v[228:231], v185 offset:768
  s_cmp_eq_u32 s100, 0
  s_cselect_b32 s96, 0xf149f2ca, 0
  s_and_b32 s97, s100, 7
  s_cselect_b32 s97, 0, -1
  v_xor_b32 v160, s96, v96
  v_and_b32 v160, s97, v160
  v_xor_b32 v161, s96, v97
  v_and_b32 v161, s97, v161
  v_xor_b32 v162, s96, v98
  v_and_b32 v162, s97, v162
  v_xor_b32 v163, s96, v99
  v_and_b32 v163, s97, v163
  v_xor_b32 v164, s96, v100
  v_and_b32 v164, s97, v164
  v_xor_b32 v165, s96, v101
  v_and_b32 v165, s97, v165
  v_xor_b32 v166, s96, v102
  v_and_b32 v166, s97, v166
  v_xor_b32 v167, s96, v103
  v_and_b32 v167, s97, v167
  v_xor_b32 v168, s96, v104
  v_and_b32 v168, s97, v168
  v_xor_b32 v169, s96, v105
  v_and_b32 v169, s97, v169
  v_xor_b32 v170, s96, v106
  v_and_b32 v170, s97, v170
  v_xor_b32 v171, s96, v107
  v_and_b32 v171, s97, v171
  v_xor_b32 v172, s96, v108
  v_and_b32 v172, s97, v172
  v_xor_b32 v173, s96, v109
  v_and_b32 v173, s97, v173
  v_xor_b32 v174, s96, v110
  v_and_b32 v174, s97, v174
  v_xor_b32 v175, s96, v111
  v_and_b32 v175, s97, v175
  s_waitcnt lgkmcnt(0)
  s_nop 0
  v_mfma_f32_32x32x16_bf16 v[128:143], v[176:179], v[116:119], v[160:175]
  v_mfma_f32_32x32x8_bf16 v[128:143], v[180:181], v[122:123], v[128:143]
  s_nop 7
  s_nop 3
  v_sub_f32 v128, v128, v182
  v_sub_f32 v129, v129, v182
  v_sub_f32 v130, v130, v182
  v_sub_f32 v131, v131, v182
  v_sub_f32 v132, v132, v182
  v_sub_f32 v133, v133, v182
  v_sub_f32 v134, v134, v182
  v_sub_f32 v135, v135, v182
  v_sub_f32 v136, v136, v182
  v_sub_f32 v137, v137, v182
  v_sub_f32 v138, v138, v182
  v_sub_f32 v139, v139, v182
  v_sub_f32 v140, v140, v182
  v_sub_f32 v141, v141, v182
  v_sub_f32 v142, v142, v182
  v_sub_f32 v143, v143, v182
  v_exp_f32 v128, v128
  v_exp_f32 v129, v129
  v_exp_f32 v130, v130
  v_exp_f32 v131, v131
  v_exp_f32 v132, v132
  v_exp_f32 v133, v133
  v_exp_f32 v134, v134
  v_exp_f32 v135, v135
  v_exp_f32 v136, v136
  v_exp_f32 v137, v137
  v_exp_f32 v138, v138
  v_exp_f32 v139, v139
  v_exp_f32 v140, v140
  v_exp_f32 v141, v141
  v_exp_f32 v142, v142
  v_exp_f32 v143, v143
  v_cvt_pk_bf16_f32 v232, v128, v129
  v_cvt_pk_bf16_f32 v233, v130, v131
  v_cvt_pk_bf16_f32 v234, v132, v133
  v_cvt_pk_bf16_f32 v235, v134, v135
  v_cvt_pk_bf16_f32 v236, v136, v137
  v_cvt_pk_bf16_f32 v237, v138, v139
  v_cvt_pk_bf16_f32 v238, v140, v141
  v_cvt_pk_bf16_f32 v239, v142, v143
  v_mfma_f32_32x32x16_bf16 v[208:223], v[224:227], v[232:235], v[208:223]
  s_nop 0
  v_mfma_f32_32x32x16_bf16 v[208:223], v[228:231], v[236:239], v[208:223]
  s_nop 7
  s_nop 7
  s_add_u32 s100, s100, 1
  s_cmp_lt_u32 s100, 9
  s_cbranch_scc1 .fl5018
  v_rcp_f32 v221, v220
  s_waitcnt vmcnt(0)
  s_nop 7
  s_branch .fbb14

.slow15:
  s_mov_b32 s100, 40000
.spin17:
  buffer_load_dword v188, v23, s[24:27], s95 offen offset:0 sc1
  s_waitcnt vmcnt(0)
  v_cmp_eq_u32 vcc, 0, v188
  s_cbranch_vccz .back16
  s_sub_u32 s100, s100, 1
  s_cbranch_scc0 .spin17
  s_branch .back16
.oc18:
  s_nop 7
  s_nop 7
  s_movk_i32 s100, 20000
.rt7020:
  s_waitcnt vmcnt(0)
  v_mov_b32 v124, 0
  v_accvgpr_read_b32 v125, a140
  v_accvgpr_read_b32 v126, a141
  s_nop 0
  v_max3_u32 v124, v124, v125, v126
  v_accvgpr_read_b32 v125, a142
  v_accvgpr_read_b32 v126, a143
  s_nop 0
  v_max3_u32 v124, v124, v125, v126
  v_accvgpr_read_b32 v125, a144
  v_accvgpr_read_b32 v126, a145
  s_nop 0
  v_max3_u32 v124, v124, v125, v126
  v_accvgpr_read_b32 v125, a146
  v_accvgpr_read_b32 v126, a147
  s_nop 0
  v_max3_u32 v124, v124, v125, v126
  v_accvgpr_read_b32 v125, a148
  v_accvgpr_read_b32 v126, a149
  s_nop 0
  v_max3_u32 v124, v124, v125, v126
  v_accvgpr_read_b32 v125, a150
  v_accvgpr_read_b32 v126, a151
  s_nop 0
  v_max3_u32 v124, v124, v125, v126
  v_accvgpr_read_b32 v125, a152
  v_accvgpr_read_b32 v126, a153
  s_nop 0
  v_max3_u32 v124, v124, v125, v126
  v_accvgpr_read_b32 v125, a154
  v_accvgpr_read_b32 v126, a155
  s_nop 0
  v_max3_u32 v124, v124, v125, v126
  v_accvgpr_read_b32 v125, a156
  v_accvgpr_read_b32 v126, a157
  s_nop 0
  v_max3_u32 v124, v124, v125, v126
  v_accvgpr_read_b32 v125, a158
  v_accvgpr_read_b32 v126, a159
  s_nop 0
  v_max3_u32 v124, v124, v125, v126
  v_cmp_eq_u32 vcc, -1, v124
  s_nop 0
  s_cbranch_vccz .rd7021
  s_sub_u32 s100, s100, 1
  s_cbranch_scc1 .rd7021
  buffer_load_dwordx4 a[140:143], v5, s[24:27], s50 offen offset:0 sc1
  buffer_load_dwordx4 a[144:147], v5, s[24:27], s50 offen offset:1024 sc1
  buffer_load_dwordx4 a[148:151], v5, s[24:27], s50 offen offset:2048 sc1
  buffer_load_dwordx4 a[152:155], v5, s[24:27], s50 offen offset:3072 sc1
  buffer_load_dwordx4 a[156:159], v5, s[24:27], s51 offen offset:0 sc1
  buffer_load_dwordx4 a[160:163], v6, s[24:27], s50 offen offset:0 sc1
  buffer_load_dwordx4 a[164:167], v6, s[24:27], s50 offen offset:1024 sc1
  buffer_load_dwordx4 a[168:171], v6, s[24:27], s50 offen offset:2048 sc1
  buffer_load_dwordx4 a[172:175], v6, s[24:27], s50 offen offset:3072 sc1
  buffer_load_dwordx4 a[176:179], v6, s[24:27], s51 offen offset:0 sc1
  buffer_load_dwordx4 a[180:183], v7, s[24:27], s50 offen offset:0 sc1
  buffer_load_dwordx4 a[184:187], v7, s[24:27], s50 offen offset:1024 sc1
  buffer_load_dwordx4 a[188:191], v7, s[24:27], s50 offen offset:2048 sc1
  buffer_load_dwordx4 a[192:195], v7, s[24:27], s50 offen offset:3072 sc1
  buffer_load_dwordx4 a[196:199], v7, s[24:27], s51 offen offset:0 sc1
  buffer_load_dwordx4 a[200:203], v4, s[24:27], s50 offen offset:0 sc1
  buffer_load_dwordx4 a[204:207], v4, s[24:27], s50 offen offset:1024 sc1
  buffer_load_dwordx4 a[208:211], v4, s[24:27], s50 offen offset:2048 sc1
  buffer_load_dwordx4 a[212:215], v4, s[24:27], s50 offen offset:3072 sc1
  buffer_load_dwordx4 a[216:219], v4, s[24:27], s51 offen offset:0 sc1
  s_branch .rt7020
.rd7021:
  v_mfma_f32_16x16x32_bf16 v[64:67], a[40:43], a[140:143], v[84:87]
  v_mfma_f32_16x16x32_bf16 v[68:71], a[44:47], a[140:143], v[88:91]
  v_mfma_f32_16x16x32_bf16 v[72:75], a[48:51], a[140:143], v[92:95]
  v_mfma_f32_16x16x32_bf16 v[76:79], a[52:55], a[140:143], v[96:99]
  v_mfma_f32_16x16x32_bf16 v[80:83], a[56:59], a[140:143], v[100:103]
  v_mfma_f32_16x16x32_bf16 v[64:67], a[60:63], a[144:147], v[64:67]
  v_mfma_f32_16x16x32_bf16 v[68:71], a[64:67], a[144:147], v[68:71]
  v_mfma_f32_16x16x32_bf16 v[72:75], a[68:71], a[144:147], v[72:75]
  v_mfma_f32_16x16x32_bf16 v[76:79], a[72:75], a[144:147], v[76:79]
  v_mfma_f32_16x16x32_bf16 v[80:83], a[76:79], a[144:147], v[80:83]
  v_mfma_f32_16x16x32_bf16 v[64:67], a[80:83], a[148:151], v[64:67]
  v_mfma_f32_16x16x32_bf16 v[68:71], a[84:87], a[148:151], v[68:71]
  v_mfma_f32_16x16x32_bf16 v[72:75], a[88:91], a[148:151], v[72:75]
  v_mfma_f32_16x16x32_bf16 v[76:79], a[92:95], a[148:151], v[76:79]
  v_mfma_f32_16x16x32_bf16 v[80:83], a[96:99], a[148:151], v[80:83]
  v_mfma_f32_16x16x32_bf16 v[64:67], a[100:103], a[152:155], v[64:67]
  v_mfma_f32_16x16x32_bf16 v[68:71], a[104:107], a[152:155], v[68:71]
  v_mfma_f32_16x16x32_bf16 v[72:75], a[108:111], a[152:155], v[72:75]
  v_mfma_f32_16x16x32_bf16 v[76:79], a[112:115], a[152:155], v[76:79]
  v_mfma_f32_16x16x32_bf16 v[80:83], a[116:119], a[152:155], v[80:83]
  v_mfma_f32_16x16x32_bf16 v[64:67], a[120:123], a[156:159], v[64:67]
  v_mfma_f32_16x16x32_bf16 v[68:71], a[124:127], a[156:159], v[68:71]
  v_mfma_f32_16x16x32_bf16 v[72:75], a[128:131], a[156:159], v[72:75]
  v_mfma_f32_16x16x32_bf16 v[76:79], a[132:135], a[156:159], v[76:79]
  v_mfma_f32_16x16x32_bf16 v[80:83], a[136:139], a[156:159], v[80:83]
  s_nop 7
  s_nop 7
  s_branch .ocb19

.oc20:
  s_nop 7
  s_nop 7
  s_movk_i32 s100, 20000
.rt8022:
  s_waitcnt vmcnt(0)
  v_mov_b32 v124, 0
  v_accvgpr_read_b32 v125, a160
  v_accvgpr_read_b32 v126, a161
  s_nop 0
  v_max3_u32 v124, v124, v125, v126
  v_accvgpr_read_b32 v125, a162
  v_accvgpr_read_b32 v126, a163
  s_nop 0
  v_max3_u32 v124, v124, v125, v126
  v_accvgpr_read_b32 v125, a164
  v_accvgpr_read_b32 v126, a165
  s_nop 0
  v_max3_u32 v124, v124, v125, v126
  v_accvgpr_read_b32 v125, a166
  v_accvgpr_read_b32 v126, a167
  s_nop 0
  v_max3_u32 v124, v124, v125, v126
  v_accvgpr_read_b32 v125, a168
  v_accvgpr_read_b32 v126, a169
  s_nop 0
  v_max3_u32 v124, v124, v125, v126
  v_accvgpr_read_b32 v125, a170
  v_accvgpr_read_b32 v126, a171
  s_nop 0
  v_max3_u32 v124, v124, v125, v126
  v_accvgpr_read_b32 v125, a172
  v_accvgpr_read_b32 v126, a173
  s_nop 0
  v_max3_u32 v124, v124, v125, v126
  v_accvgpr_read_b32 v125, a174
  v_accvgpr_read_b32 v126, a175
  s_nop 0
  v_max3_u32 v124, v124, v125, v126
  v_accvgpr_read_b32 v125, a176
  v_accvgpr_read_b32 v126, a177
  s_nop 0
  v_max3_u32 v124, v124, v125, v126
  v_accvgpr_read_b32 v125, a178
  v_accvgpr_read_b32 v126, a179
  s_nop 0
  v_max3_u32 v124, v124, v125, v126
  v_cmp_eq_u32 vcc, -1, v124
  s_nop 0
  s_cbranch_vccz .rd8023
  s_sub_u32 s100, s100, 1
  s_cbranch_scc1 .rd8023
  buffer_load_dwordx4 a[160:163], v6, s[24:27], s50 offen offset:0 sc1
  buffer_load_dwordx4 a[164:167], v6, s[24:27], s50 offen offset:1024 sc1
  buffer_load_dwordx4 a[168:171], v6, s[24:27], s50 offen offset:2048 sc1
  buffer_load_dwordx4 a[172:175], v6, s[24:27], s50 offen offset:3072 sc1
  buffer_load_dwordx4 a[176:179], v6, s[24:27], s51 offen offset:0 sc1
  buffer_load_dwordx4 a[180:183], v7, s[24:27], s50 offen offset:0 sc1
  buffer_load_dwordx4 a[184:187], v7, s[24:27], s50 offen offset:1024 sc1
  buffer_load_dwordx4 a[188:191], v7, s[24:27], s50 offen offset:2048 sc1
  buffer_load_dwordx4 a[192:195], v7, s[24:27], s50 offen offset:3072 sc1
  buffer_load_dwordx4 a[196:199], v7, s[24:27], s51 offen offset:0 sc1
  buffer_load_dwordx4 a[200:203], v4, s[24:27], s50 offen offset:0 sc1
  buffer_load_dwordx4 a[204:207], v4, s[24:27], s50 offen offset:1024 sc1
  buffer_load_dwordx4 a[208:211], v4, s[24:27], s50 offen offset:2048 sc1
  buffer_load_dwordx4 a[212:215], v4, s[24:27], s50 offen offset:3072 sc1
  buffer_load_dwordx4 a[216:219], v4, s[24:27], s51 offen offset:0 sc1
  s_branch .rt8022
.rd8023:
  v_mfma_f32_16x16x32_bf16 v[128:131], a[40:43], a[160:163], v[104:107]
  v_mfma_f32_16x16x32_bf16 v[132:135], a[44:47], a[160:163], v[108:111]
  v_mfma_f32_16x16x32_bf16 v[136:139], a[48:51], a[160:163], v[112:115]
  v_mfma_f32_16x16x32_bf16 v[140:143], a[52:55], a[160:163], v[116:119]
  v_mfma_f32_16x16x32_bf16 v[160:163], a[56:59], a[160:163], v[120:123]
  v_mfma_f32_16x16x32_bf16 v[128:131], a[60:63], a[164:167], v[128:131]
  v_mfma_f32_16x16x32_bf16 v[132:135], a[64:67], a[164:167], v[132:135]
  v_mfma_f32_16x16x32_bf16 v[136:139], a[68:71], a[164:167], v[136:139]
  v_mfma_f32_16x16x32_bf16 v[140:143], a[72:75], a[164:167], v[140:143]
  v_mfma_f32_16x16x32_bf16 v[160:163], a[76:79], a[164:167], v[160:163]
  v_mfma_f32_16x16x32_bf16 v[128:131], a[80:83], a[168:171], v[128:131]
  v_mfma_f32_16x16x32_bf16 v[132:135], a[84:87], a[168:171], v[132:135]
  v_mfma_f32_16x16x32_bf16 v[136:139], a[88:91], a[168:171], v[136:139]
  v_mfma_f32_16x16x32_bf16 v[140:143], a[92:95], a[168:171], v[140:143]
  v_mfma_f32_16x16x32_bf16 v[160:163], a[96:99], a[168:171], v[160:163]
  v_mfma_f32_16x16x32_bf16 v[128:131], a[100:103], a[172:175], v[128:131]
  v_mfma_f32_16x16x32_bf16 v[132:135], a[104:107], a[172:175], v[132:135]
  v_mfma_f32_16x16x32_bf16 v[136:139], a[108:111], a[172:175], v[136:139]
  v_mfma_f32_16x16x32_bf16 v[140:143], a[112:115], a[172:175], v[140:143]
  v_mfma_f32_16x16x32_bf16 v[160:163], a[116:119], a[172:175], v[160:163]
  v_mfma_f32_16x16x32_bf16 v[128:131], a[120:123], a[176:179], v[128:131]
  v_mfma_f32_16x16x32_bf16 v[132:135], a[124:127], a[176:179], v[132:135]
  v_mfma_f32_16x16x32_bf16 v[136:139], a[128:131], a[176:179], v[136:139]
  v_mfma_f32_16x16x32_bf16 v[140:143], a[132:135], a[176:179], v[140:143]
  v_mfma_f32_16x16x32_bf16 v[160:163], a[136:139], a[176:179], v[160:163]
  s_nop 7
  s_nop 7
  s_branch .ocb21

.oc22:
  s_nop 7
  s_nop 7
  s_movk_i32 s100, 20000
.rt9024:
  s_waitcnt vmcnt(0)
  v_mov_b32 v124, 0
  v_accvgpr_read_b32 v125, a180
  v_accvgpr_read_b32 v126, a181
  s_nop 0
  v_max3_u32 v124, v124, v125, v126
  v_accvgpr_read_b32 v125, a182
  v_accvgpr_read_b32 v126, a183
  s_nop 0
  v_max3_u32 v124, v124, v125, v126
  v_accvgpr_read_b32 v125, a184
  v_accvgpr_read_b32 v126, a185
  s_nop 0
  v_max3_u32 v124, v124, v125, v126
  v_accvgpr_read_b32 v125, a186
  v_accvgpr_read_b32 v126, a187
  s_nop 0
  v_max3_u32 v124, v124, v125, v126
  v_accvgpr_read_b32 v125, a188
  v_accvgpr_read_b32 v126, a189
  s_nop 0
  v_max3_u32 v124, v124, v125, v126
  v_accvgpr_read_b32 v125, a190
  v_accvgpr_read_b32 v126, a191
  s_nop 0
  v_max3_u32 v124, v124, v125, v126
  v_accvgpr_read_b32 v125, a192
  v_accvgpr_read_b32 v126, a193
  s_nop 0
  v_max3_u32 v124, v124, v125, v126
  v_accvgpr_read_b32 v125, a194
  v_accvgpr_read_b32 v126, a195
  s_nop 0
  v_max3_u32 v124, v124, v125, v126
  v_accvgpr_read_b32 v125, a196
  v_accvgpr_read_b32 v126, a197
  s_nop 0
  v_max3_u32 v124, v124, v125, v126
  v_accvgpr_read_b32 v125, a198
  v_accvgpr_read_b32 v126, a199
  s_nop 0
  v_max3_u32 v124, v124, v125, v126
  v_cmp_eq_u32 vcc, -1, v124
  s_nop 0
  s_cbranch_vccz .rd9025
  s_sub_u32 s100, s100, 1
  s_cbranch_scc1 .rd9025
  buffer_load_dwordx4 a[180:183], v7, s[24:27], s50 offen offset:0 sc1
  buffer_load_dwordx4 a[184:187], v7, s[24:27], s50 offen offset:1024 sc1
  buffer_load_dwordx4 a[188:191], v7, s[24:27], s50 offen offset:2048 sc1
  buffer_load_dwordx4 a[192:195], v7, s[24:27], s50 offen offset:3072 sc1
  buffer_load_dwordx4 a[196:199], v7, s[24:27], s51 offen offset:0 sc1
  buffer_load_dwordx4 a[200:203], v4, s[24:27], s50 offen offset:0 sc1
  buffer_load_dwordx4 a[204:207], v4, s[24:27], s50 offen offset:1024 sc1
  buffer_load_dwordx4 a[208:211], v4, s[24:27], s50 offen offset:2048 sc1
  buffer_load_dwordx4 a[212:215], v4, s[24:27], s50 offen offset:3072 sc1
  buffer_load_dwordx4 a[216:219], v4, s[24:27], s51 offen offset:0 sc1
  s_branch .rt9024
.rd9025:
  v_mfma_f32_16x16x32_bf16 v[84:87], a[40:43], a[180:183], v[40:43]
  v_mfma_f32_16x16x32_bf16 v[88:91], a[44:47], a[180:183], v[44:47]
  v_mfma_f32_16x16x32_bf16 v[92:95], a[48:51], a[180:183], v[48:51]
  v_mfma_f32_16x16x32_bf16 v[96:99], a[52:55], a[180:183], v[52:55]
  v_mfma_f32_16x16x32_bf16 v[100:103], a[56:59], a[180:183], v[36:39]
  v_mfma_f32_16x16x32_bf16 v[84:87], a[60:63], a[184:187], v[84:87]
  v_mfma_f32_16x16x32_bf16 v[88:91], a[64:67], a[184:187], v[88:91]
  v_mfma_f32_16x16x32_bf16 v[92:95], a[68:71], a[184:187], v[92:95]
  v_mfma_f32_16x16x32_bf16 v[96:99], a[72:75], a[184:187], v[96:99]
  v_mfma_f32_16x16x32_bf16 v[100:103], a[76:79], a[184:187], v[100:103]
  v_mfma_f32_16x16x32_bf16 v[84:87], a[80:83], a[188:191], v[84:87]
  v_mfma_f32_16x16x32_bf16 v[88:91], a[84:87], a[188:191], v[88:91]
  v_mfma_f32_16x16x32_bf16 v[92:95], a[88:91], a[188:191], v[92:95]
  v_mfma_f32_16x16x32_bf16 v[96:99], a[92:95], a[188:191], v[96:99]
  v_mfma_f32_16x16x32_bf16 v[100:103], a[96:99], a[188:191], v[100:103]
  v_mfma_f32_16x16x32_bf16 v[84:87], a[100:103], a[192:195], v[84:87]
  v_mfma_f32_16x16x32_bf16 v[88:91], a[104:107], a[192:195], v[88:91]
  v_mfma_f32_16x16x32_bf16 v[92:95], a[108:111], a[192:195], v[92:95]
  v_mfma_f32_16x16x32_bf16 v[96:99], a[112:115], a[192:195], v[96:99]
  v_mfma_f32_16x16x32_bf16 v[100:103], a[116:119], a[192:195], v[100:103]
  v_mfma_f32_16x16x32_bf16 v[84:87], a[120:123], a[196:199], v[84:87]
  v_mfma_f32_16x16x32_bf16 v[88:91], a[124:127], a[196:199], v[88:91]
  v_mfma_f32_16x16x32_bf16 v[92:95], a[128:131], a[196:199], v[92:95]
  v_mfma_f32_16x16x32_bf16 v[96:99], a[132:135], a[196:199], v[96:99]
  v_mfma_f32_16x16x32_bf16 v[100:103], a[136:139], a[196:199], v[100:103]
  s_nop 7
  s_nop 7
  s_branch .ocb23

.oc24:
  s_nop 7
  s_nop 7
  s_movk_i32 s100, 20000
.rt10026:
  s_waitcnt vmcnt(0)
  v_mov_b32 v124, 0
  v_accvgpr_read_b32 v125, a200
  v_accvgpr_read_b32 v126, a201
  s_nop 0
  v_max3_u32 v124, v124, v125, v126
  v_accvgpr_read_b32 v125, a202
  v_accvgpr_read_b32 v126, a203
  s_nop 0
  v_max3_u32 v124, v124, v125, v126
  v_accvgpr_read_b32 v125, a204
  v_accvgpr_read_b32 v126, a205
  s_nop 0
  v_max3_u32 v124, v124, v125, v126
  v_accvgpr_read_b32 v125, a206
  v_accvgpr_read_b32 v126, a207
  s_nop 0
  v_max3_u32 v124, v124, v125, v126
  v_accvgpr_read_b32 v125, a208
  v_accvgpr_read_b32 v126, a209
  s_nop 0
  v_max3_u32 v124, v124, v125, v126
  v_accvgpr_read_b32 v125, a210
  v_accvgpr_read_b32 v126, a211
  s_nop 0
  v_max3_u32 v124, v124, v125, v126
  v_accvgpr_read_b32 v125, a212
  v_accvgpr_read_b32 v126, a213
  s_nop 0
  v_max3_u32 v124, v124, v125, v126
  v_accvgpr_read_b32 v125, a214
  v_accvgpr_read_b32 v126, a215
  s_nop 0
  v_max3_u32 v124, v124, v125, v126
  v_accvgpr_read_b32 v125, a216
  v_accvgpr_read_b32 v126, a217
  s_nop 0
  v_max3_u32 v124, v124, v125, v126
  v_accvgpr_read_b32 v125, a218
  v_accvgpr_read_b32 v126, a219
  s_nop 0
  v_max3_u32 v124, v124, v125, v126
  v_cmp_eq_u32 vcc, -1, v124
  s_nop 0
  s_cbranch_vccz .rd10027
  s_sub_u32 s100, s100, 1
  s_cbranch_scc1 .rd10027
  buffer_load_dwordx4 a[200:203], v4, s[24:27], s50 offen offset:0 sc1
  buffer_load_dwordx4 a[204:207], v4, s[24:27], s50 offen offset:1024 sc1
  buffer_load_dwordx4 a[208:211], v4, s[24:27], s50 offen offset:2048 sc1
  buffer_load_dwordx4 a[212:215], v4, s[24:27], s50 offen offset:3072 sc1
  buffer_load_dwordx4 a[216:219], v4, s[24:27], s51 offen offset:0 sc1
  s_branch .rt10026
.rd10027:
  v_mfma_f32_16x16x32_bf16 v[104:107], a[40:43], a[200:203], v[24:27]
  v_mfma_f32_16x16x32_bf16 v[108:111], a[44:47], a[200:203], v[28:31]
  v_mfma_f32_16x16x32_bf16 v[112:115], a[48:51], a[200:203], v[56:59]
  v_mfma_f32_16x16x32_bf16 v[116:119], a[52:55], a[200:203], v[60:63]
  v_mfma_f32_16x16x32_bf16 v[120:123], a[56:59], a[200:203], v[32:35]
  v_mfma_f32_16x16x32_bf16 v[104:107], a[60:63], a[204:207], v[104:107]
  v_mfma_f32_16x16x32_bf16 v[108:111], a[64:67], a[204:207], v[108:111]
  v_mfma_f32_16x16x32_bf16 v[112:115], a[68:71], a[204:207], v[112:115]
  v_mfma_f32_16x16x32_bf16 v[116:119], a[72:75], a[204:207], v[116:119]
  v_mfma_f32_16x16x32_bf16 v[120:123], a[76:79], a[204:207], v[120:123]
  v_mfma_f32_16x16x32_bf16 v[104:107], a[80:83], a[208:211], v[104:107]
  v_mfma_f32_16x16x32_bf16 v[108:111], a[84:87], a[208:211], v[108:111]
  v_mfma_f32_16x16x32_bf16 v[112:115], a[88:91], a[208:211], v[112:115]
  v_mfma_f32_16x16x32_bf16 v[116:119], a[92:95], a[208:211], v[116:119]
  v_mfma_f32_16x16x32_bf16 v[120:123], a[96:99], a[208:211], v[120:123]
  v_mfma_f32_16x16x32_bf16 v[104:107], a[100:103], a[212:215], v[104:107]
  v_mfma_f32_16x16x32_bf16 v[108:111], a[104:107], a[212:215], v[108:111]
  v_mfma_f32_16x16x32_bf16 v[112:115], a[108:111], a[212:215], v[112:115]
  v_mfma_f32_16x16x32_bf16 v[116:119], a[112:115], a[212:215], v[116:119]
  v_mfma_f32_16x16x32_bf16 v[120:123], a[116:119], a[212:215], v[120:123]
  v_mfma_f32_16x16x32_bf16 v[104:107], a[120:123], a[216:219], v[104:107]
  v_mfma_f32_16x16x32_bf16 v[108:111], a[124:127], a[216:219], v[108:111]
  v_mfma_f32_16x16x32_bf16 v[112:115], a[128:131], a[216:219], v[112:115]
  v_mfma_f32_16x16x32_bf16 v[116:119], a[132:135], a[216:219], v[116:119]
  v_mfma_f32_16x16x32_bf16 v[120:123], a[136:139], a[216:219], v[120:123]
  s_nop 7
  s_nop 7
  s_branch .ocb25

.slow26:
  s_mov_b32 s100, 40000
.spin28:
  buffer_load_dword v10, v37, s[52:55], 0 offen offset:0 sc1
  s_waitcnt vmcnt(0)
  v_cmp_eq_u32 vcc, 0, v10
  s_cbranch_vccz .back27
  s_sub_u32 s100, s100, 1
  s_cbranch_scc0 .spin28
  s_branch .back27
.slow29:
  s_mov_b32 s100, 40000
.spin31:
  buffer_load_dword v11, v93, s[24:27], s95 offen offset:0 sc1
  s_waitcnt vmcnt(0)
  v_cmp_eq_u32 vcc, 0, v11
  s_cbranch_vccz .back30
  s_sub_u32 s100, s100, 1
  s_cbranch_scc0 .spin31
  s_branch .back30
.slow32:
  s_mov_b32 s100, 40000
.spin34:
  buffer_load_dword v11, v10, s[24:27], s95 offen offset:1024 sc1
  s_waitcnt vmcnt(0)
  v_cmp_eq_u32 vcc, 0, v11
  s_cbranch_vccz .back33
  s_sub_u32 s100, s100, 1
  s_cbranch_scc0 .spin34
  s_branch .back33
.slow35:
  s_mov_b32 s100, 40000
.spin37:
  buffer_load_dword v188, v127, s[24:27], s95 offen offset:0 sc1
  s_waitcnt vmcnt(0)
  v_cmp_eq_u32 vcc, 0, v188
  s_cbranch_vccz .back36
  s_sub_u32 s100, s100, 1
  s_cbranch_scc0 .spin37
  s_branch .back36
.fb38:
  s_nop 7
  s_nop 7
  s_waitcnt lgkmcnt(0)
  v_mov_b32 v182, 0xff7fffff
  v_mov_b32 v192, 0
  v_mov_b32 v193, 0
  v_mov_b32 v194, 0
  v_mov_b32 v195, 0
  v_mov_b32 v196, 0
  v_mov_b32 v197, 0
  v_mov_b32 v198, 0
  v_mov_b32 v199, 0
  v_mov_b32 v200, 0
  v_mov_b32 v201, 0
  v_mov_b32 v202, 0
  v_mov_b32 v203, 0
  v_mov_b32 v204, 0
  v_mov_b32 v205, 0
  v_mov_b32 v206, 0
  v_mov_b32 v207, 0
  s_lshl_b32 s100, s3, 1
  s_sub_u32 s100, 8, s100
  s_cmp_lt_i32 s93, 0
  s_cselect_b32 s100, s100, 0
.fl15040:
  s_add_u32 s96, s100, 0
  s_mul_i32 s96, s96, 3072
  v_add_u32 v183, s96, v20
  v_add_u32 v184, s96, v21
  v_add_u32 v185, s96, v22
  ds_read_b128 v[176:179], v183
  ds_read_b64 v[180:181], v184
  ds_read_b128 v[224:227], v185
  ds_read_b128 v[228:231], v185 offset:768
  s_cmp_eq_u32 s100, 0
  s_cselect_b32 s96, 0xf149f2ca, 0
  s_and_b32 s97, s100, 7
  s_cselect_b32 s97, 0, -1
  v_xor_b32 v160, s96, v96
  v_and_b32 v160, s97, v160
  v_xor_b32 v161, s96, v97
  v_and_b32 v161, s97, v161
  v_xor_b32 v162, s96, v98
  v_and_b32 v162, s97, v162
  v_xor_b32 v163, s96, v99
  v_and_b32 v163, s97, v163
  v_xor_b32 v164, s96, v100
  v_and_b32 v164, s97, v164
  v_xor_b32 v165, s96, v101
  v_and_b32 v165, s97, v165
  v_xor_b32 v166, s96, v102
  v_and_b32 v166, s97, v166
  v_xor_b32 v167, s96, v103
  v_and_b32 v167, s97, v167
  v_xor_b32 v168, s96, v104
  v_and_b32 v168, s97, v168
  v_xor_b32 v169, s96, v105
  v_and_b32 v169, s97, v169
  v_xor_b32 v170, s96, v106
  v_and_b32 v170, s97, v170
  v_xor_b32 v171, s96, v107
  v_and_b32 v171, s97, v171
  v_xor_b32 v172, s96, v108
  v_and_b32 v172, s97, v172
  v_xor_b32 v173, s96, v109
  v_and_b32 v173, s97, v173
  v_xor_b32 v174, s96, v110
  v_and_b32 v174, s97, v174
  v_xor_b32 v175, s96, v111
  v_and_b32 v175, s97, v175
  s_waitcnt lgkmcnt(0)
  s_nop 0
  v_mfma_f32_32x32x16_bf16 v[128:143], v[176:179], v[112:115], v[160:175]
  v_mfma_f32_32x32x8_bf16 v[128:143], v[180:181], v[120:121], v[128:143]
  s_nop 7
  s_nop 3
  v_max_f32 v182, v182, v128
  v_max_f32 v182, v182, v129
  v_max_f32 v182, v182, v130
  v_max_f32 v182, v182, v131
  v_max_f32 v182, v182, v132
  v_max_f32 v182, v182, v133
  v_max_f32 v182, v182, v134
  v_max_f32 v182, v182, v135
  v_max_f32 v182, v182, v136
  v_max_f32 v182, v182, v137
  v_max_f32 v182, v182, v138
  v_max_f32 v182, v182, v139
  v_max_f32 v182, v182, v140
  v_max_f32 v182, v182, v141
  v_max_f32 v182, v182, v142
  v_max_f32 v182, v182, v143
  s_nop 7
  s_nop 7
  s_add_u32 s100, s100, 1
  s_cmp_lt_u32 s100, 9
  s_cbranch_scc1 .fl15040
  v_mov_b32 v186, v182
  s_nop 1
  v_permlane32_swap_b32 v182, v186
  v_max_f32 v182, v182, v186
  s_lshl_b32 s100, s3, 1
  s_sub_u32 s100, 8, s100
  s_cmp_lt_i32 s93, 0
  s_cselect_b32 s100, s100, 0
.fl15041:
  s_add_u32 s96, s100, 0
  s_mul_i32 s96, s96, 3072
  v_add_u32 v183, s96, v20
  v_add_u32 v184, s96, v21
  v_add_u32 v185, s96, v22
  ds_read_b128 v[176:179], v183
  ds_read_b64 v[180:181], v184
  ds_read_b128 v[224:227], v185
  ds_read_b128 v[228:231], v185 offset:768
  s_cmp_eq_u32 s100, 0
  s_cselect_b32 s96, 0xf149f2ca, 0
  s_and_b32 s97, s100, 7
  s_cselect_b32 s97, 0, -1
  v_xor_b32 v160, s96, v96
  v_and_b32 v160, s97, v160
  v_xor_b32 v161, s96, v97
  v_and_b32 v161, s97, v161
  v_xor_b32 v162, s96, v98
  v_and_b32 v162, s97, v162
  v_xor_b32 v163, s96, v99
  v_and_b32 v163, s97, v163
  v_xor_b32 v164, s96, v100
  v_and_b32 v164, s97, v164
  v_xor_b32 v165, s96, v101
  v_and_b32 v165, s97, v165
  v_xor_b32 v166, s96, v102
  v_and_b32 v166, s97, v166
  v_xor_b32 v167, s96, v103
  v_and_b32 v167, s97, v167
  v_xor_b32 v168, s96, v104
  v_and_b32 v168, s97, v168
  v_xor_b32 v169, s96, v105
  v_and_b32 v169, s97, v169
  v_xor_b32 v170, s96, v106
  v_and_b32 v170, s97, v170
  v_xor_b32 v171, s96, v107
  v_and_b32 v171, s97, v171
  v_xor_b32 v172, s96, v108
  v_and_b32 v172, s97, v172
  v_xor_b32 v173, s96, v109
  v_and_b32 v173, s97, v173
  v_xor_b32 v174, s96, v110
  v_and_b32 v174, s97, v174
  v_xor_b32 v175, s96, v111
  v_and_b32 v175, s97, v175
  s_waitcnt lgkmcnt(0)
  s_nop 0
  v_mfma_f32_32x32x16_bf16 v[128:143], v[176:179], v[112:115], v[160:175]
  v_mfma_f32_32x32x8_bf16 v[128:143], v[180:181], v[120:121], v[128:143]
  s_nop 7
  s_nop 3
  v_sub_f32 v128, v128, v182
  v_sub_f32 v129, v129, v182
  v_sub_f32 v130, v130, v182
  v_sub_f32 v131, v131, v182
  v_sub_f32 v132, v132, v182
  v_sub_f32 v133, v133, v182
  v_sub_f32 v134, v134, v182
  v_sub_f32 v135, v135, v182
  v_sub_f32 v136, v136, v182
  v_sub_f32 v137, v137, v182
  v_sub_f32 v138, v138, v182
  v_sub_f32 v139, v139, v182
  v_sub_f32 v140, v140, v182
  v_sub_f32 v141, v141, v182
  v_sub_f32 v142, v142, v182
  v_sub_f32 v143, v143, v182
  v_exp_f32 v128, v128
  v_exp_f32 v129, v129
  v_exp_f32 v130, v130
  v_exp_f32 v131, v131
  v_exp_f32 v132, v132
  v_exp_f32 v133, v133
  v_exp_f32 v134, v134
  v_exp_f32 v135, v135
  v_exp_f32 v136, v136
  v_exp_f32 v137, v137
  v_exp_f32 v138, v138
  v_exp_f32 v139, v139
  v_exp_f32 v140, v140
  v_exp_f32 v141, v141
  v_exp_f32 v142, v142
  v_exp_f32 v143, v143
  v_cvt_pk_bf16_f32 v232, v128, v129
  v_cvt_pk_bf16_f32 v233, v130, v131
  v_cvt_pk_bf16_f32 v234, v132, v133
  v_cvt_pk_bf16_f32 v235, v134, v135
  v_cvt_pk_bf16_f32 v236, v136, v137
  v_cvt_pk_bf16_f32 v237, v138, v139
  v_cvt_pk_bf16_f32 v238, v140, v141
  v_cvt_pk_bf16_f32 v239, v142, v143
  v_mfma_f32_32x32x16_bf16 v[192:207], v[224:227], v[232:235], v[192:207]
  s_nop 0
  v_mfma_f32_32x32x16_bf16 v[192:207], v[228:231], v[236:239], v[192:207]
  s_nop 7
  s_nop 7
  s_add_u32 s100, s100, 1
  s_cmp_lt_u32 s100, 9
  s_cbranch_scc1 .fl15041
  v_rcp_f32 v205, v204
  s_nop 0
  v_mul_f32 v192, v192, v205
  v_mul_f32 v193, v193, v205
  v_mul_f32 v194, v194, v205
  v_mul_f32 v195, v195, v205
  v_cvt_pk_bf16_f32 v192, v192, v193
  v_mul_f32 v196, v196, v205
  v_mul_f32 v197, v197, v205
  v_cvt_pk_bf16_f32 v193, v194, v195
  v_mul_f32 v198, v198, v205
  v_mul_f32 v199, v199, v205
  v_cvt_pk_bf16_f32 v194, v196, v197
  v_mul_f32 v200, v200, v205
  v_mul_f32 v201, v201, v205
  v_cvt_pk_bf16_f32 v195, v198, v199
  v_mul_f32 v202, v202, v205
  v_mul_f32 v203, v203, v205
  v_cvt_pk_bf16_f32 v196, v200, v201
  v_cvt_pk_bf16_f32 v197, v202, v203
  buffer_store_dwordx4 v[192:195], v13, s[24:27], s82 offen sc1
  s_mov_b32 exec_hi, 0
  buffer_store_dwordx2 v[196:197], v13, s[24:27], s83 offen sc1
  s_mov_b32 exec_hi, -1
  v_mov_b32 v182, 0xff7fffff
  v_mov_b32 v208, 0
  v_mov_b32 v209, 0
  v_mov_b32 v210, 0
  v_mov_b32 v211, 0
  v_mov_b32 v212, 0
  v_mov_b32 v213, 0
  v_mov_b32 v214, 0
  v_mov_b32 v215, 0
  v_mov_b32 v216, 0
  v_mov_b32 v217, 0
  v_mov_b32 v218, 0
  v_mov_b32 v219, 0
  v_mov_b32 v220, 0
  v_mov_b32 v221, 0
  v_mov_b32 v222, 0
  v_mov_b32 v223, 0
  s_lshl_b32 s100, s3, 1
  s_sub_u32 s100, 7, s100
  s_cmp_lt_i32 s93, 0
  s_cselect_b32 s100, s100, 0
.fl15042:
  s_add_u32 s96, s100, 1
  s_mul_i32 s96, s96, 3072
  v_add_u32 v183, s96, v20
  v_add_u32 v184, s96, v21
  v_add_u32 v185, s96, v22
  ds_read_b128 v[176:179], v183
  ds_read_b64 v[180:181], v184
  ds_read_b128 v[224:227], v185
  ds_read_b128 v[228:231], v185 offset:768
  s_cmp_eq_u32 s100, 0
  s_cselect_b32 s96, 0xf149f2ca, 0
  s_and_b32 s97, s100, 7
  s_cselect_b32 s97, 0, -1
  v_xor_b32 v160, s96, v96
  v_and_b32 v160, s97, v160
  v_xor_b32 v161, s96, v97
  v_and_b32 v161, s97, v161
  v_xor_b32 v162, s96, v98
  v_and_b32 v162, s97, v162
  v_xor_b32 v163, s96, v99
  v_and_b32 v163, s97, v163
  v_xor_b32 v164, s96, v100
  v_and_b32 v164, s97, v164
  v_xor_b32 v165, s96, v101
  v_and_b32 v165, s97, v165
  v_xor_b32 v166, s96, v102
  v_and_b32 v166, s97, v166
  v_xor_b32 v167, s96, v103
  v_and_b32 v167, s97, v167
  v_xor_b32 v168, s96, v104
  v_and_b32 v168, s97, v168
  v_xor_b32 v169, s96, v105
  v_and_b32 v169, s97, v169
  v_xor_b32 v170, s96, v106
  v_and_b32 v170, s97, v170
  v_xor_b32 v171, s96, v107
  v_and_b32 v171, s97, v171
  v_xor_b32 v172, s96, v108
  v_and_b32 v172, s97, v172
  v_xor_b32 v173, s96, v109
  v_and_b32 v173, s97, v173
  v_xor_b32 v174, s96, v110
  v_and_b32 v174, s97, v174
  v_xor_b32 v175, s96, v111
  v_and_b32 v175, s97, v175
  s_waitcnt lgkmcnt(0)
  s_nop 0
  v_mfma_f32_32x32x16_bf16 v[128:143], v[176:179], v[116:119], v[160:175]
  v_mfma_f32_32x32x8_bf16 v[128:143], v[180:181], v[122:123], v[128:143]
  s_nop 7
  s_nop 3
  v_max_f32 v182, v182, v128
  v_max_f32 v182, v182, v129
  v_max_f32 v182, v182, v130
  v_max_f32 v182, v182, v131
  v_max_f32 v182, v182, v132
  v_max_f32 v182, v182, v133
  v_max_f32 v182, v182, v134
  v_max_f32 v182, v182, v135
  v_max_f32 v182, v182, v136
  v_max_f32 v182, v182, v137
  v_max_f32 v182, v182, v138
  v_max_f32 v182, v182, v139
  v_max_f32 v182, v182, v140
  v_max_f32 v182, v182, v141
  v_max_f32 v182, v182, v142
  v_max_f32 v182, v182, v143
  s_nop 7
  s_nop 7
  s_add_u32 s100, s100, 1
  s_cmp_lt_u32 s100, 9
  s_cbranch_scc1 .fl15042
  v_mov_b32 v186, v182
  s_nop 1
  v_permlane32_swap_b32 v182, v186
  v_max_f32 v182, v182, v186
  s_lshl_b32 s100, s3, 1
  s_sub_u32 s100, 7, s100
  s_cmp_lt_i32 s93, 0
  s_cselect_b32 s100, s100, 0
.fl15043:
  s_add_u32 s96, s100, 1
  s_mul_i32 s96, s96, 3072
  v_add_u32 v183, s96, v20
  v_add_u32 v184, s96, v21
  v_add_u32 v185, s96, v22
  ds_read_b128 v[176:179], v183
  ds_read_b64 v[180:181], v184
  ds_read_b128 v[224:227], v185
  ds_read_b128 v[228:231], v185 offset:768
  s_cmp_eq_u32 s100, 0
  s_cselect_b32 s96, 0xf149f2ca, 0
  s_and_b32 s97, s100, 7
  s_cselect_b32 s97, 0, -1
  v_xor_b32 v160, s96, v96
  v_and_b32 v160, s97, v160
  v_xor_b32 v161, s96, v97
  v_and_b32 v161, s97, v161
  v_xor_b32 v162, s96, v98
  v_and_b32 v162, s97, v162
  v_xor_b32 v163, s96, v99
  v_and_b32 v163, s97, v163
  v_xor_b32 v164, s96, v100
  v_and_b32 v164, s97, v164
  v_xor_b32 v165, s96, v101
  v_and_b32 v165, s97, v165
  v_xor_b32 v166, s96, v102
  v_and_b32 v166, s97, v166
  v_xor_b32 v167, s96, v103
  v_and_b32 v167, s97, v167
  v_xor_b32 v168, s96, v104
  v_and_b32 v168, s97, v168
  v_xor_b32 v169, s96, v105
  v_and_b32 v169, s97, v169
  v_xor_b32 v170, s96, v106
  v_and_b32 v170, s97, v170
  v_xor_b32 v171, s96, v107
  v_and_b32 v171, s97, v171
  v_xor_b32 v172, s96, v108
  v_and_b32 v172, s97, v172
  v_xor_b32 v173, s96, v109
  v_and_b32 v173, s97, v173
  v_xor_b32 v174, s96, v110
  v_and_b32 v174, s97, v174
  v_xor_b32 v175, s96, v111
  v_and_b32 v175, s97, v175
  s_waitcnt lgkmcnt(0)
  s_nop 0
  v_mfma_f32_32x32x16_bf16 v[128:143], v[176:179], v[116:119], v[160:175]
  v_mfma_f32_32x32x8_bf16 v[128:143], v[180:181], v[122:123], v[128:143]
  s_nop 7
  s_nop 3
  v_sub_f32 v128, v128, v182
  v_sub_f32 v129, v129, v182
  v_sub_f32 v130, v130, v182
  v_sub_f32 v131, v131, v182
  v_sub_f32 v132, v132, v182
  v_sub_f32 v133, v133, v182
  v_sub_f32 v134, v134, v182
  v_sub_f32 v135, v135, v182
  v_sub_f32 v136, v136, v182
  v_sub_f32 v137, v137, v182
  v_sub_f32 v138, v138, v182
  v_sub_f32 v139, v139, v182
  v_sub_f32 v140, v140, v182
  v_sub_f32 v141, v141, v182
  v_sub_f32 v142, v142, v182
  v_sub_f32 v143, v143, v182
  v_exp_f32 v128, v128
  v_exp_f32 v129, v129
  v_exp_f32 v130, v130
  v_exp_f32 v131, v131
  v_exp_f32 v132, v132
  v_exp_f32 v133, v133
  v_exp_f32 v134, v134
  v_exp_f32 v135, v135
  v_exp_f32 v136, v136
  v_exp_f32 v137, v137
  v_exp_f32 v138, v138
  v_exp_f32 v139, v139
  v_exp_f32 v140, v140
  v_exp_f32 v141, v141
  v_exp_f32 v142, v142
  v_exp_f32 v143, v143
  v_cvt_pk_bf16_f32 v232, v128, v129
  v_cvt_pk_bf16_f32 v233, v130, v131
  v_cvt_pk_bf16_f32 v234, v132, v133
  v_cvt_pk_bf16_f32 v235, v134, v135
  v_cvt_pk_bf16_f32 v236, v136, v137
  v_cvt_pk_bf16_f32 v237, v138, v139
  v_cvt_pk_bf16_f32 v238, v140, v141
  v_cvt_pk_bf16_f32 v239, v142, v143
  v_mfma_f32_32x32x16_bf16 v[208:223], v[224:227], v[232:235], v[208:223]
  s_nop 0
  v_mfma_f32_32x32x16_bf16 v[208:223], v[228:231], v[236:239], v[208:223]
  s_nop 7
  s_nop 7
  s_add_u32 s100, s100, 1
  s_cmp_lt_u32 s100, 9
  s_cbranch_scc1 .fl15043
  v_rcp_f32 v221, v220
  s_waitcnt vmcnt(0)
  s_nop 7
  s_branch .fbb39

.slow40:
  s_mov_b32 s100, 40000
.spin42:
  buffer_load_dword v188, v23, s[24:27], s95 offen offset:0 sc1
  s_waitcnt vmcnt(0)
  v_cmp_eq_u32 vcc, 0, v188
  s_cbranch_vccz .back41
  s_sub_u32 s100, s100, 1
  s_cbranch_scc0 .spin42
  s_branch .back41
.oc43:
  s_nop 7
  s_nop 7
  s_movk_i32 s100, 20000
.rt17045:
  s_waitcnt vmcnt(0)
  v_mov_b32 v124, 0
  v_accvgpr_read_b32 v125, a140
  v_accvgpr_read_b32 v126, a141
  s_nop 0
  v_max3_u32 v124, v124, v125, v126
  v_accvgpr_read_b32 v125, a142
  v_accvgpr_read_b32 v126, a143
  s_nop 0
  v_max3_u32 v124, v124, v125, v126
  v_accvgpr_read_b32 v125, a144
  v_accvgpr_read_b32 v126, a145
  s_nop 0
  v_max3_u32 v124, v124, v125, v126
  v_accvgpr_read_b32 v125, a146
  v_accvgpr_read_b32 v126, a147
  s_nop 0
  v_max3_u32 v124, v124, v125, v126
  v_accvgpr_read_b32 v125, a148
  v_accvgpr_read_b32 v126, a149
  s_nop 0
  v_max3_u32 v124, v124, v125, v126
  v_accvgpr_read_b32 v125, a150
  v_accvgpr_read_b32 v126, a151
  s_nop 0
  v_max3_u32 v124, v124, v125, v126
  v_accvgpr_read_b32 v125, a152
  v_accvgpr_read_b32 v126, a153
  s_nop 0
  v_max3_u32 v124, v124, v125, v126
  v_accvgpr_read_b32 v125, a154
  v_accvgpr_read_b32 v126, a155
  s_nop 0
  v_max3_u32 v124, v124, v125, v126
  v_accvgpr_read_b32 v125, a156
  v_accvgpr_read_b32 v126, a157
  s_nop 0
  v_max3_u32 v124, v124, v125, v126
  v_accvgpr_read_b32 v125, a158
  v_accvgpr_read_b32 v126, a159
  s_nop 0
  v_max3_u32 v124, v124, v125, v126
  v_cmp_eq_u32 vcc, -1, v124
  s_nop 0
  s_cbranch_vccz .rd17046
  s_sub_u32 s100, s100, 1
  s_cbranch_scc1 .rd17046
  buffer_load_dwordx4 a[140:143], v5, s[24:27], s50 offen offset:0 sc1
  buffer_load_dwordx4 a[144:147], v5, s[24:27], s50 offen offset:1024 sc1
  buffer_load_dwordx4 a[148:151], v5, s[24:27], s50 offen offset:2048 sc1
  buffer_load_dwordx4 a[152:155], v5, s[24:27], s50 offen offset:3072 sc1
  buffer_load_dwordx4 a[156:159], v5, s[24:27], s51 offen offset:0 sc1
  buffer_load_dwordx4 a[160:163], v6, s[24:27], s50 offen offset:0 sc1
  buffer_load_dwordx4 a[164:167], v6, s[24:27], s50 offen offset:1024 sc1
  buffer_load_dwordx4 a[168:171], v6, s[24:27], s50 offen offset:2048 sc1
  buffer_load_dwordx4 a[172:175], v6, s[24:27], s50 offen offset:3072 sc1
  buffer_load_dwordx4 a[176:179], v6, s[24:27], s51 offen offset:0 sc1
  buffer_load_dwordx4 a[180:183], v7, s[24:27], s50 offen offset:0 sc1
  buffer_load_dwordx4 a[184:187], v7, s[24:27], s50 offen offset:1024 sc1
  buffer_load_dwordx4 a[188:191], v7, s[24:27], s50 offen offset:2048 sc1
  buffer_load_dwordx4 a[192:195], v7, s[24:27], s50 offen offset:3072 sc1
  buffer_load_dwordx4 a[196:199], v7, s[24:27], s51 offen offset:0 sc1
  buffer_load_dwordx4 a[200:203], v4, s[24:27], s50 offen offset:0 sc1
  buffer_load_dwordx4 a[204:207], v4, s[24:27], s50 offen offset:1024 sc1
  buffer_load_dwordx4 a[208:211], v4, s[24:27], s50 offen offset:2048 sc1
  buffer_load_dwordx4 a[212:215], v4, s[24:27], s50 offen offset:3072 sc1
  buffer_load_dwordx4 a[216:219], v4, s[24:27], s51 offen offset:0 sc1
  s_branch .rt17045
.rd17046:
  v_mfma_f32_16x16x32_bf16 v[64:67], a[40:43], a[140:143], v[84:87]
  v_mfma_f32_16x16x32_bf16 v[68:71], a[44:47], a[140:143], v[88:91]
  v_mfma_f32_16x16x32_bf16 v[72:75], a[48:51], a[140:143], v[92:95]
  v_mfma_f32_16x16x32_bf16 v[76:79], a[52:55], a[140:143], v[96:99]
  v_mfma_f32_16x16x32_bf16 v[80:83], a[56:59], a[140:143], v[100:103]
  v_mfma_f32_16x16x32_bf16 v[64:67], a[60:63], a[144:147], v[64:67]
  v_mfma_f32_16x16x32_bf16 v[68:71], a[64:67], a[144:147], v[68:71]
  v_mfma_f32_16x16x32_bf16 v[72:75], a[68:71], a[144:147], v[72:75]
  v_mfma_f32_16x16x32_bf16 v[76:79], a[72:75], a[144:147], v[76:79]
  v_mfma_f32_16x16x32_bf16 v[80:83], a[76:79], a[144:147], v[80:83]
  v_mfma_f32_16x16x32_bf16 v[64:67], a[80:83], a[148:151], v[64:67]
  v_mfma_f32_16x16x32_bf16 v[68:71], a[84:87], a[148:151], v[68:71]
  v_mfma_f32_16x16x32_bf16 v[72:75], a[88:91], a[148:151], v[72:75]
  v_mfma_f32_16x16x32_bf16 v[76:79], a[92:95], a[148:151], v[76:79]
  v_mfma_f32_16x16x32_bf16 v[80:83], a[96:99], a[148:151], v[80:83]
  v_mfma_f32_16x16x32_bf16 v[64:67], a[100:103], a[152:155], v[64:67]
  v_mfma_f32_16x16x32_bf16 v[68:71], a[104:107], a[152:155], v[68:71]
  v_mfma_f32_16x16x32_bf16 v[72:75], a[108:111], a[152:155], v[72:75]
  v_mfma_f32_16x16x32_bf16 v[76:79], a[112:115], a[152:155], v[76:79]
  v_mfma_f32_16x16x32_bf16 v[80:83], a[116:119], a[152:155], v[80:83]
  v_mfma_f32_16x16x32_bf16 v[64:67], a[120:123], a[156:159], v[64:67]
  v_mfma_f32_16x16x32_bf16 v[68:71], a[124:127], a[156:159], v[68:71]
  v_mfma_f32_16x16x32_bf16 v[72:75], a[128:131], a[156:159], v[72:75]
  v_mfma_f32_16x16x32_bf16 v[76:79], a[132:135], a[156:159], v[76:79]
  v_mfma_f32_16x16x32_bf16 v[80:83], a[136:139], a[156:159], v[80:83]
  s_nop 7
  s_nop 7
  s_branch .ocb44

.oc45:
  s_nop 7
  s_nop 7
  s_movk_i32 s100, 20000
.rt18047:
  s_waitcnt vmcnt(0)
  v_mov_b32 v124, 0
  v_accvgpr_read_b32 v125, a160
  v_accvgpr_read_b32 v126, a161
  s_nop 0
  v_max3_u32 v124, v124, v125, v126
  v_accvgpr_read_b32 v125, a162
  v_accvgpr_read_b32 v126, a163
  s_nop 0
  v_max3_u32 v124, v124, v125, v126
  v_accvgpr_read_b32 v125, a164
  v_accvgpr_read_b32 v126, a165
  s_nop 0
  v_max3_u32 v124, v124, v125, v126
  v_accvgpr_read_b32 v125, a166
  v_accvgpr_read_b32 v126, a167
  s_nop 0
  v_max3_u32 v124, v124, v125, v126
  v_accvgpr_read_b32 v125, a168
  v_accvgpr_read_b32 v126, a169
  s_nop 0
  v_max3_u32 v124, v124, v125, v126
  v_accvgpr_read_b32 v125, a170
  v_accvgpr_read_b32 v126, a171
  s_nop 0
  v_max3_u32 v124, v124, v125, v126
  v_accvgpr_read_b32 v125, a172
  v_accvgpr_read_b32 v126, a173
  s_nop 0
  v_max3_u32 v124, v124, v125, v126
  v_accvgpr_read_b32 v125, a174
  v_accvgpr_read_b32 v126, a175
  s_nop 0
  v_max3_u32 v124, v124, v125, v126
  v_accvgpr_read_b32 v125, a176
  v_accvgpr_read_b32 v126, a177
  s_nop 0
  v_max3_u32 v124, v124, v125, v126
  v_accvgpr_read_b32 v125, a178
  v_accvgpr_read_b32 v126, a179
  s_nop 0
  v_max3_u32 v124, v124, v125, v126
  v_cmp_eq_u32 vcc, -1, v124
  s_nop 0
  s_cbranch_vccz .rd18048
  s_sub_u32 s100, s100, 1
  s_cbranch_scc1 .rd18048
  buffer_load_dwordx4 a[160:163], v6, s[24:27], s50 offen offset:0 sc1
  buffer_load_dwordx4 a[164:167], v6, s[24:27], s50 offen offset:1024 sc1
  buffer_load_dwordx4 a[168:171], v6, s[24:27], s50 offen offset:2048 sc1
  buffer_load_dwordx4 a[172:175], v6, s[24:27], s50 offen offset:3072 sc1
  buffer_load_dwordx4 a[176:179], v6, s[24:27], s51 offen offset:0 sc1
  buffer_load_dwordx4 a[180:183], v7, s[24:27], s50 offen offset:0 sc1
  buffer_load_dwordx4 a[184:187], v7, s[24:27], s50 offen offset:1024 sc1
  buffer_load_dwordx4 a[188:191], v7, s[24:27], s50 offen offset:2048 sc1
  buffer_load_dwordx4 a[192:195], v7, s[24:27], s50 offen offset:3072 sc1
  buffer_load_dwordx4 a[196:199], v7, s[24:27], s51 offen offset:0 sc1
  buffer_load_dwordx4 a[200:203], v4, s[24:27], s50 offen offset:0 sc1
  buffer_load_dwordx4 a[204:207], v4, s[24:27], s50 offen offset:1024 sc1
  buffer_load_dwordx4 a[208:211], v4, s[24:27], s50 offen offset:2048 sc1
  buffer_load_dwordx4 a[212:215], v4, s[24:27], s50 offen offset:3072 sc1
  buffer_load_dwordx4 a[216:219], v4, s[24:27], s51 offen offset:0 sc1
  s_branch .rt18047
.rd18048:
  v_mfma_f32_16x16x32_bf16 v[128:131], a[40:43], a[160:163], v[104:107]
  v_mfma_f32_16x16x32_bf16 v[132:135], a[44:47], a[160:163], v[108:111]
  v_mfma_f32_16x16x32_bf16 v[136:139], a[48:51], a[160:163], v[112:115]
  v_mfma_f32_16x16x32_bf16 v[140:143], a[52:55], a[160:163], v[116:119]
  v_mfma_f32_16x16x32_bf16 v[160:163], a[56:59], a[160:163], v[120:123]
  v_mfma_f32_16x16x32_bf16 v[128:131], a[60:63], a[164:167], v[128:131]
  v_mfma_f32_16x16x32_bf16 v[132:135], a[64:67], a[164:167], v[132:135]
  v_mfma_f32_16x16x32_bf16 v[136:139], a[68:71], a[164:167], v[136:139]
  v_mfma_f32_16x16x32_bf16 v[140:143], a[72:75], a[164:167], v[140:143]
  v_mfma_f32_16x16x32_bf16 v[160:163], a[76:79], a[164:167], v[160:163]
  v_mfma_f32_16x16x32_bf16 v[128:131], a[80:83], a[168:171], v[128:131]
  v_mfma_f32_16x16x32_bf16 v[132:135], a[84:87], a[168:171], v[132:135]
  v_mfma_f32_16x16x32_bf16 v[136:139], a[88:91], a[168:171], v[136:139]
  v_mfma_f32_16x16x32_bf16 v[140:143], a[92:95], a[168:171], v[140:143]
  v_mfma_f32_16x16x32_bf16 v[160:163], a[96:99], a[168:171], v[160:163]
  v_mfma_f32_16x16x32_bf16 v[128:131], a[100:103], a[172:175], v[128:131]
  v_mfma_f32_16x16x32_bf16 v[132:135], a[104:107], a[172:175], v[132:135]
  v_mfma_f32_16x16x32_bf16 v[136:139], a[108:111], a[172:175], v[136:139]
  v_mfma_f32_16x16x32_bf16 v[140:143], a[112:115], a[172:175], v[140:143]
  v_mfma_f32_16x16x32_bf16 v[160:163], a[116:119], a[172:175], v[160:163]
  v_mfma_f32_16x16x32_bf16 v[128:131], a[120:123], a[176:179], v[128:131]
  v_mfma_f32_16x16x32_bf16 v[132:135], a[124:127], a[176:179], v[132:135]
  v_mfma_f32_16x16x32_bf16 v[136:139], a[128:131], a[176:179], v[136:139]
  v_mfma_f32_16x16x32_bf16 v[140:143], a[132:135], a[176:179], v[140:143]
  v_mfma_f32_16x16x32_bf16 v[160:163], a[136:139], a[176:179], v[160:163]
  s_nop 7
  s_nop 7
  s_branch .ocb46

.oc47:
  s_nop 7
  s_nop 7
  s_movk_i32 s100, 20000
.rt19049:
  s_waitcnt vmcnt(0)
  v_mov_b32 v124, 0
  v_accvgpr_read_b32 v125, a180
  v_accvgpr_read_b32 v126, a181
  s_nop 0
  v_max3_u32 v124, v124, v125, v126
  v_accvgpr_read_b32 v125, a182
  v_accvgpr_read_b32 v126, a183
  s_nop 0
  v_max3_u32 v124, v124, v125, v126
  v_accvgpr_read_b32 v125, a184
  v_accvgpr_read_b32 v126, a185
  s_nop 0
  v_max3_u32 v124, v124, v125, v126
  v_accvgpr_read_b32 v125, a186
  v_accvgpr_read_b32 v126, a187
  s_nop 0
  v_max3_u32 v124, v124, v125, v126
  v_accvgpr_read_b32 v125, a188
  v_accvgpr_read_b32 v126, a189
  s_nop 0
  v_max3_u32 v124, v124, v125, v126
  v_accvgpr_read_b32 v125, a190
  v_accvgpr_read_b32 v126, a191
  s_nop 0
  v_max3_u32 v124, v124, v125, v126
  v_accvgpr_read_b32 v125, a192
  v_accvgpr_read_b32 v126, a193
  s_nop 0
  v_max3_u32 v124, v124, v125, v126
  v_accvgpr_read_b32 v125, a194
  v_accvgpr_read_b32 v126, a195
  s_nop 0
  v_max3_u32 v124, v124, v125, v126
  v_accvgpr_read_b32 v125, a196
  v_accvgpr_read_b32 v126, a197
  s_nop 0
  v_max3_u32 v124, v124, v125, v126
  v_accvgpr_read_b32 v125, a198
  v_accvgpr_read_b32 v126, a199
  s_nop 0
  v_max3_u32 v124, v124, v125, v126
  v_cmp_eq_u32 vcc, -1, v124
  s_nop 0
  s_cbranch_vccz .rd19050
  s_sub_u32 s100, s100, 1
  s_cbranch_scc1 .rd19050
  buffer_load_dwordx4 a[180:183], v7, s[24:27], s50 offen offset:0 sc1
  buffer_load_dwordx4 a[184:187], v7, s[24:27], s50 offen offset:1024 sc1
  buffer_load_dwordx4 a[188:191], v7, s[24:27], s50 offen offset:2048 sc1
  buffer_load_dwordx4 a[192:195], v7, s[24:27], s50 offen offset:3072 sc1
  buffer_load_dwordx4 a[196:199], v7, s[24:27], s51 offen offset:0 sc1
  buffer_load_dwordx4 a[200:203], v4, s[24:27], s50 offen offset:0 sc1
  buffer_load_dwordx4 a[204:207], v4, s[24:27], s50 offen offset:1024 sc1
  buffer_load_dwordx4 a[208:211], v4, s[24:27], s50 offen offset:2048 sc1
  buffer_load_dwordx4 a[212:215], v4, s[24:27], s50 offen offset:3072 sc1
  buffer_load_dwordx4 a[216:219], v4, s[24:27], s51 offen offset:0 sc1
  s_branch .rt19049
.rd19050:
  v_mfma_f32_16x16x32_bf16 v[84:87], a[40:43], a[180:183], v[40:43]
  v_mfma_f32_16x16x32_bf16 v[88:91], a[44:47], a[180:183], v[44:47]
  v_mfma_f32_16x16x32_bf16 v[92:95], a[48:51], a[180:183], v[48:51]
  v_mfma_f32_16x16x32_bf16 v[96:99], a[52:55], a[180:183], v[52:55]
  v_mfma_f32_16x16x32_bf16 v[100:103], a[56:59], a[180:183], v[36:39]
  v_mfma_f32_16x16x32_bf16 v[84:87], a[60:63], a[184:187], v[84:87]
  v_mfma_f32_16x16x32_bf16 v[88:91], a[64:67], a[184:187], v[88:91]
  v_mfma_f32_16x16x32_bf16 v[92:95], a[68:71], a[184:187], v[92:95]
  v_mfma_f32_16x16x32_bf16 v[96:99], a[72:75], a[184:187], v[96:99]
  v_mfma_f32_16x16x32_bf16 v[100:103], a[76:79], a[184:187], v[100:103]
  v_mfma_f32_16x16x32_bf16 v[84:87], a[80:83], a[188:191], v[84:87]
  v_mfma_f32_16x16x32_bf16 v[88:91], a[84:87], a[188:191], v[88:91]
  v_mfma_f32_16x16x32_bf16 v[92:95], a[88:91], a[188:191], v[92:95]
  v_mfma_f32_16x16x32_bf16 v[96:99], a[92:95], a[188:191], v[96:99]
  v_mfma_f32_16x16x32_bf16 v[100:103], a[96:99], a[188:191], v[100:103]
  v_mfma_f32_16x16x32_bf16 v[84:87], a[100:103], a[192:195], v[84:87]
  v_mfma_f32_16x16x32_bf16 v[88:91], a[104:107], a[192:195], v[88:91]
  v_mfma_f32_16x16x32_bf16 v[92:95], a[108:111], a[192:195], v[92:95]
  v_mfma_f32_16x16x32_bf16 v[96:99], a[112:115], a[192:195], v[96:99]
  v_mfma_f32_16x16x32_bf16 v[100:103], a[116:119], a[192:195], v[100:103]
  v_mfma_f32_16x16x32_bf16 v[84:87], a[120:123], a[196:199], v[84:87]
  v_mfma_f32_16x16x32_bf16 v[88:91], a[124:127], a[196:199], v[88:91]
  v_mfma_f32_16x16x32_bf16 v[92:95], a[128:131], a[196:199], v[92:95]
  v_mfma_f32_16x16x32_bf16 v[96:99], a[132:135], a[196:199], v[96:99]
  v_mfma_f32_16x16x32_bf16 v[100:103], a[136:139], a[196:199], v[100:103]
  s_nop 7
  s_nop 7
  s_branch .ocb48

.oc49:
  s_nop 7
  s_nop 7
  s_movk_i32 s100, 20000
.rt20051:
  s_waitcnt vmcnt(0)
  v_mov_b32 v124, 0
  v_accvgpr_read_b32 v125, a200
  v_accvgpr_read_b32 v126, a201
  s_nop 0
  v_max3_u32 v124, v124, v125, v126
  v_accvgpr_read_b32 v125, a202
  v_accvgpr_read_b32 v126, a203
  s_nop 0
  v_max3_u32 v124, v124, v125, v126
  v_accvgpr_read_b32 v125, a204
  v_accvgpr_read_b32 v126, a205
  s_nop 0
  v_max3_u32 v124, v124, v125, v126
  v_accvgpr_read_b32 v125, a206
  v_accvgpr_read_b32 v126, a207
  s_nop 0
  v_max3_u32 v124, v124, v125, v126
  v_accvgpr_read_b32 v125, a208
  v_accvgpr_read_b32 v126, a209
  s_nop 0
  v_max3_u32 v124, v124, v125, v126
  v_accvgpr_read_b32 v125, a210
  v_accvgpr_read_b32 v126, a211
  s_nop 0
  v_max3_u32 v124, v124, v125, v126
  v_accvgpr_read_b32 v125, a212
  v_accvgpr_read_b32 v126, a213
  s_nop 0
  v_max3_u32 v124, v124, v125, v126
  v_accvgpr_read_b32 v125, a214
  v_accvgpr_read_b32 v126, a215
  s_nop 0
  v_max3_u32 v124, v124, v125, v126
  v_accvgpr_read_b32 v125, a216
  v_accvgpr_read_b32 v126, a217
  s_nop 0
  v_max3_u32 v124, v124, v125, v126
  v_accvgpr_read_b32 v125, a218
  v_accvgpr_read_b32 v126, a219
  s_nop 0
  v_max3_u32 v124, v124, v125, v126
  v_cmp_eq_u32 vcc, -1, v124
  s_nop 0
  s_cbranch_vccz .rd20052
  s_sub_u32 s100, s100, 1
  s_cbranch_scc1 .rd20052
  buffer_load_dwordx4 a[200:203], v4, s[24:27], s50 offen offset:0 sc1
  buffer_load_dwordx4 a[204:207], v4, s[24:27], s50 offen offset:1024 sc1
  buffer_load_dwordx4 a[208:211], v4, s[24:27], s50 offen offset:2048 sc1
  buffer_load_dwordx4 a[212:215], v4, s[24:27], s50 offen offset:3072 sc1
  buffer_load_dwordx4 a[216:219], v4, s[24:27], s51 offen offset:0 sc1
  s_branch .rt20051
.rd20052:
  v_mfma_f32_16x16x32_bf16 v[104:107], a[40:43], a[200:203], v[24:27]
  v_mfma_f32_16x16x32_bf16 v[108:111], a[44:47], a[200:203], v[28:31]
  v_mfma_f32_16x16x32_bf16 v[112:115], a[48:51], a[200:203], v[56:59]
  v_mfma_f32_16x16x32_bf16 v[116:119], a[52:55], a[200:203], v[60:63]
  v_mfma_f32_16x16x32_bf16 v[120:123], a[56:59], a[200:203], v[32:35]
  v_mfma_f32_16x16x32_bf16 v[104:107], a[60:63], a[204:207], v[104:107]
  v_mfma_f32_16x16x32_bf16 v[108:111], a[64:67], a[204:207], v[108:111]
  v_mfma_f32_16x16x32_bf16 v[112:115], a[68:71], a[204:207], v[112:115]
  v_mfma_f32_16x16x32_bf16 v[116:119], a[72:75], a[204:207], v[116:119]
  v_mfma_f32_16x16x32_bf16 v[120:123], a[76:79], a[204:207], v[120:123]
  v_mfma_f32_16x16x32_bf16 v[104:107], a[80:83], a[208:211], v[104:107]
  v_mfma_f32_16x16x32_bf16 v[108:111], a[84:87], a[208:211], v[108:111]
  v_mfma_f32_16x16x32_bf16 v[112:115], a[88:91], a[208:211], v[112:115]
  v_mfma_f32_16x16x32_bf16 v[116:119], a[92:95], a[208:211], v[116:119]
  v_mfma_f32_16x16x32_bf16 v[120:123], a[96:99], a[208:211], v[120:123]
  v_mfma_f32_16x16x32_bf16 v[104:107], a[100:103], a[212:215], v[104:107]
  v_mfma_f32_16x16x32_bf16 v[108:111], a[104:107], a[212:215], v[108:111]
  v_mfma_f32_16x16x32_bf16 v[112:115], a[108:111], a[212:215], v[112:115]
  v_mfma_f32_16x16x32_bf16 v[116:119], a[112:115], a[212:215], v[116:119]
  v_mfma_f32_16x16x32_bf16 v[120:123], a[116:119], a[212:215], v[120:123]
  v_mfma_f32_16x16x32_bf16 v[104:107], a[120:123], a[216:219], v[104:107]
  v_mfma_f32_16x16x32_bf16 v[108:111], a[124:127], a[216:219], v[108:111]
  v_mfma_f32_16x16x32_bf16 v[112:115], a[128:131], a[216:219], v[112:115]
  v_mfma_f32_16x16x32_bf16 v[116:119], a[132:135], a[216:219], v[116:119]
  v_mfma_f32_16x16x32_bf16 v[120:123], a[136:139], a[216:219], v[120:123]
  s_nop 7
  s_nop 7
  s_branch .ocb50

.slow51:
  s_mov_b32 s100, 40000
.spin53:
  buffer_load_dword v10, v37, s[52:55], 0 offen offset:0 sc1
  s_waitcnt vmcnt(0)
  v_cmp_eq_u32 vcc, 0, v10
  s_cbranch_vccz .back52
  s_sub_u32 s100, s100, 1
  s_cbranch_scc0 .spin53
  s_branch .back52
.slow54:
  s_mov_b32 s100, 40000
.spin56:
  buffer_load_dword v11, v93, s[24:27], s95 offen offset:0 sc1
  s_waitcnt vmcnt(0)
  v_cmp_eq_u32 vcc, 0, v11
  s_cbranch_vccz .back55
  s_sub_u32 s100, s100, 1
  s_cbranch_scc0 .spin56
  s_branch .back55
.slow57:
  s_mov_b32 s100, 40000
.spin59:
  buffer_load_dword v11, v10, s[24:27], s95 offen offset:1024 sc1
  s_waitcnt vmcnt(0)
  v_cmp_eq_u32 vcc, 0, v11
  s_cbranch_vccz .back58
  s_sub_u32 s100, s100, 1
  s_cbranch_scc0 .spin59
  s_branch .back58
.slow60:
  s_mov_b32 s100, 40000
.spin62:
  buffer_load_dword v188, v127, s[24:27], s95 offen offset:0 sc1
  s_waitcnt vmcnt(0)
  v_cmp_eq_u32 vcc, 0, v188
  s_cbranch_vccz .back61
  s_sub_u32 s100, s100, 1
  s_cbranch_scc0 .spin62
  s_branch .back61
.fb63:
  s_nop 7
  s_nop 7
  s_waitcnt lgkmcnt(0)
  v_mov_b32 v182, 0xff7fffff
  v_mov_b32 v192, 0
  v_mov_b32 v193, 0
  v_mov_b32 v194, 0
  v_mov_b32 v195, 0
  v_mov_b32 v196, 0
  v_mov_b32 v197, 0
  v_mov_b32 v198, 0
  v_mov_b32 v199, 0
  v_mov_b32 v200, 0
  v_mov_b32 v201, 0
  v_mov_b32 v202, 0
  v_mov_b32 v203, 0
  v_mov_b32 v204, 0
  v_mov_b32 v205, 0
  v_mov_b32 v206, 0
  v_mov_b32 v207, 0
  s_lshl_b32 s100, s3, 1
  s_sub_u32 s100, 8, s100
  s_cmp_lt_i32 s93, 0
  s_cselect_b32 s100, s100, 0
.fl25065:
  s_add_u32 s96, s100, 0
  s_mul_i32 s96, s96, 3072
  v_add_u32 v183, s96, v20
  v_add_u32 v184, s96, v21
  v_add_u32 v185, s96, v22
  ds_read_b128 v[176:179], v183
  ds_read_b64 v[180:181], v184
  ds_read_b128 v[224:227], v185
  ds_read_b128 v[228:231], v185 offset:768
  s_cmp_eq_u32 s100, 0
  s_cselect_b32 s96, 0xf149f2ca, 0
  s_and_b32 s97, s100, 7
  s_cselect_b32 s97, 0, -1
  v_xor_b32 v160, s96, v96
  v_and_b32 v160, s97, v160
  v_xor_b32 v161, s96, v97
  v_and_b32 v161, s97, v161
  v_xor_b32 v162, s96, v98
  v_and_b32 v162, s97, v162
  v_xor_b32 v163, s96, v99
  v_and_b32 v163, s97, v163
  v_xor_b32 v164, s96, v100
  v_and_b32 v164, s97, v164
  v_xor_b32 v165, s96, v101
  v_and_b32 v165, s97, v165
  v_xor_b32 v166, s96, v102
  v_and_b32 v166, s97, v166
  v_xor_b32 v167, s96, v103
  v_and_b32 v167, s97, v167
  v_xor_b32 v168, s96, v104
  v_and_b32 v168, s97, v168
  v_xor_b32 v169, s96, v105
  v_and_b32 v169, s97, v169
  v_xor_b32 v170, s96, v106
  v_and_b32 v170, s97, v170
  v_xor_b32 v171, s96, v107
  v_and_b32 v171, s97, v171
  v_xor_b32 v172, s96, v108
  v_and_b32 v172, s97, v172
  v_xor_b32 v173, s96, v109
  v_and_b32 v173, s97, v173
  v_xor_b32 v174, s96, v110
  v_and_b32 v174, s97, v174
  v_xor_b32 v175, s96, v111
  v_and_b32 v175, s97, v175
  s_waitcnt lgkmcnt(0)
  s_nop 0
  v_mfma_f32_32x32x16_bf16 v[128:143], v[176:179], v[112:115], v[160:175]
  v_mfma_f32_32x32x8_bf16 v[128:143], v[180:181], v[120:121], v[128:143]
  s_nop 7
  s_nop 3
  v_max_f32 v182, v182, v128
  v_max_f32 v182, v182, v129
  v_max_f32 v182, v182, v130
  v_max_f32 v182, v182, v131
  v_max_f32 v182, v182, v132
  v_max_f32 v182, v182, v133
  v_max_f32 v182, v182, v134
  v_max_f32 v182, v182, v135
  v_max_f32 v182, v182, v136
  v_max_f32 v182, v182, v137
  v_max_f32 v182, v182, v138
  v_max_f32 v182, v182, v139
  v_max_f32 v182, v182, v140
  v_max_f32 v182, v182, v141
  v_max_f32 v182, v182, v142
  v_max_f32 v182, v182, v143
  s_nop 7
  s_nop 7
  s_add_u32 s100, s100, 1
  s_cmp_lt_u32 s100, 9
  s_cbranch_scc1 .fl25065
  v_mov_b32 v186, v182
  s_nop 1
  v_permlane32_swap_b32 v182, v186
  v_max_f32 v182, v182, v186
  s_lshl_b32 s100, s3, 1
  s_sub_u32 s100, 8, s100
  s_cmp_lt_i32 s93, 0
  s_cselect_b32 s100, s100, 0
.fl25066:
  s_add_u32 s96, s100, 0
  s_mul_i32 s96, s96, 3072
  v_add_u32 v183, s96, v20
  v_add_u32 v184, s96, v21
  v_add_u32 v185, s96, v22
  ds_read_b128 v[176:179], v183
  ds_read_b64 v[180:181], v184
  ds_read_b128 v[224:227], v185
  ds_read_b128 v[228:231], v185 offset:768
  s_cmp_eq_u32 s100, 0
  s_cselect_b32 s96, 0xf149f2ca, 0
  s_and_b32 s97, s100, 7
  s_cselect_b32 s97, 0, -1
  v_xor_b32 v160, s96, v96
  v_and_b32 v160, s97, v160
  v_xor_b32 v161, s96, v97
  v_and_b32 v161, s97, v161
  v_xor_b32 v162, s96, v98
  v_and_b32 v162, s97, v162
  v_xor_b32 v163, s96, v99
  v_and_b32 v163, s97, v163
  v_xor_b32 v164, s96, v100
  v_and_b32 v164, s97, v164
  v_xor_b32 v165, s96, v101
  v_and_b32 v165, s97, v165
  v_xor_b32 v166, s96, v102
  v_and_b32 v166, s97, v166
  v_xor_b32 v167, s96, v103
  v_and_b32 v167, s97, v167
  v_xor_b32 v168, s96, v104
  v_and_b32 v168, s97, v168
  v_xor_b32 v169, s96, v105
  v_and_b32 v169, s97, v169
  v_xor_b32 v170, s96, v106
  v_and_b32 v170, s97, v170
  v_xor_b32 v171, s96, v107
  v_and_b32 v171, s97, v171
  v_xor_b32 v172, s96, v108
  v_and_b32 v172, s97, v172
  v_xor_b32 v173, s96, v109
  v_and_b32 v173, s97, v173
  v_xor_b32 v174, s96, v110
  v_and_b32 v174, s97, v174
  v_xor_b32 v175, s96, v111
  v_and_b32 v175, s97, v175
  s_waitcnt lgkmcnt(0)
  s_nop 0
  v_mfma_f32_32x32x16_bf16 v[128:143], v[176:179], v[112:115], v[160:175]
  v_mfma_f32_32x32x8_bf16 v[128:143], v[180:181], v[120:121], v[128:143]
  s_nop 7
  s_nop 3
  v_sub_f32 v128, v128, v182
  v_sub_f32 v129, v129, v182
  v_sub_f32 v130, v130, v182
  v_sub_f32 v131, v131, v182
  v_sub_f32 v132, v132, v182
  v_sub_f32 v133, v133, v182
  v_sub_f32 v134, v134, v182
  v_sub_f32 v135, v135, v182
  v_sub_f32 v136, v136, v182
  v_sub_f32 v137, v137, v182
  v_sub_f32 v138, v138, v182
  v_sub_f32 v139, v139, v182
  v_sub_f32 v140, v140, v182
  v_sub_f32 v141, v141, v182
  v_sub_f32 v142, v142, v182
  v_sub_f32 v143, v143, v182
  v_exp_f32 v128, v128
  v_exp_f32 v129, v129
  v_exp_f32 v130, v130
  v_exp_f32 v131, v131
  v_exp_f32 v132, v132
  v_exp_f32 v133, v133
  v_exp_f32 v134, v134
  v_exp_f32 v135, v135
  v_exp_f32 v136, v136
  v_exp_f32 v137, v137
  v_exp_f32 v138, v138
  v_exp_f32 v139, v139
  v_exp_f32 v140, v140
  v_exp_f32 v141, v141
  v_exp_f32 v142, v142
  v_exp_f32 v143, v143
  v_cvt_pk_bf16_f32 v232, v128, v129
  v_cvt_pk_bf16_f32 v233, v130, v131
  v_cvt_pk_bf16_f32 v234, v132, v133
  v_cvt_pk_bf16_f32 v235, v134, v135
  v_cvt_pk_bf16_f32 v236, v136, v137
  v_cvt_pk_bf16_f32 v237, v138, v139
  v_cvt_pk_bf16_f32 v238, v140, v141
  v_cvt_pk_bf16_f32 v239, v142, v143
  v_mfma_f32_32x32x16_bf16 v[192:207], v[224:227], v[232:235], v[192:207]
  s_nop 0
  v_mfma_f32_32x32x16_bf16 v[192:207], v[228:231], v[236:239], v[192:207]
  s_nop 7
  s_nop 7
  s_add_u32 s100, s100, 1
  s_cmp_lt_u32 s100, 9
  s_cbranch_scc1 .fl25066
  v_rcp_f32 v205, v204
  s_nop 0
  v_mul_f32 v192, v192, v205
  v_mul_f32 v193, v193, v205
  v_mul_f32 v194, v194, v205
  v_mul_f32 v195, v195, v205
  v_cvt_pk_bf16_f32 v192, v192, v193
  v_mul_f32 v196, v196, v205
  v_mul_f32 v197, v197, v205
  v_cvt_pk_bf16_f32 v193, v194, v195
  v_mul_f32 v198, v198, v205
  v_mul_f32 v199, v199, v205
  v_cvt_pk_bf16_f32 v194, v196, v197
  v_mul_f32 v200, v200, v205
  v_mul_f32 v201, v201, v205
  v_cvt_pk_bf16_f32 v195, v198, v199
  v_mul_f32 v202, v202, v205
  v_mul_f32 v203, v203, v205
  v_cvt_pk_bf16_f32 v196, v200, v201
  v_cvt_pk_bf16_f32 v197, v202, v203
  buffer_store_dwordx4 v[192:195], v13, s[24:27], s82 offen sc1
  s_mov_b32 exec_hi, 0
  buffer_store_dwordx2 v[196:197], v13, s[24:27], s83 offen sc1
  s_mov_b32 exec_hi, -1
  v_mov_b32 v182, 0xff7fffff
  v_mov_b32 v208, 0
  v_mov_b32 v209, 0
  v_mov_b32 v210, 0
  v_mov_b32 v211, 0
  v_mov_b32 v212, 0
  v_mov_b32 v213, 0
  v_mov_b32 v214, 0
  v_mov_b32 v215, 0
  v_mov_b32 v216, 0
  v_mov_b32 v217, 0
  v_mov_b32 v218, 0
  v_mov_b32 v219, 0
  v_mov_b32 v220, 0
  v_mov_b32 v221, 0
  v_mov_b32 v222, 0
  v_mov_b32 v223, 0
  s_lshl_b32 s100, s3, 1
  s_sub_u32 s100, 7, s100
  s_cmp_lt_i32 s93, 0
  s_cselect_b32 s100, s100, 0
.fl25067:
  s_add_u32 s96, s100, 1
  s_mul_i32 s96, s96, 3072
  v_add_u32 v183, s96, v20
  v_add_u32 v184, s96, v21
  v_add_u32 v185, s96, v22
  ds_read_b128 v[176:179], v183
  ds_read_b64 v[180:181], v184
  ds_read_b128 v[224:227], v185
  ds_read_b128 v[228:231], v185 offset:768
  s_cmp_eq_u32 s100, 0
  s_cselect_b32 s96, 0xf149f2ca, 0
  s_and_b32 s97, s100, 7
  s_cselect_b32 s97, 0, -1
  v_xor_b32 v160, s96, v96
  v_and_b32 v160, s97, v160
  v_xor_b32 v161, s96, v97
  v_and_b32 v161, s97, v161
  v_xor_b32 v162, s96, v98
  v_and_b32 v162, s97, v162
  v_xor_b32 v163, s96, v99
  v_and_b32 v163, s97, v163
  v_xor_b32 v164, s96, v100
  v_and_b32 v164, s97, v164
  v_xor_b32 v165, s96, v101
  v_and_b32 v165, s97, v165
  v_xor_b32 v166, s96, v102
  v_and_b32 v166, s97, v166
  v_xor_b32 v167, s96, v103
  v_and_b32 v167, s97, v167
  v_xor_b32 v168, s96, v104
  v_and_b32 v168, s97, v168
  v_xor_b32 v169, s96, v105
  v_and_b32 v169, s97, v169
  v_xor_b32 v170, s96, v106
  v_and_b32 v170, s97, v170
  v_xor_b32 v171, s96, v107
  v_and_b32 v171, s97, v171
  v_xor_b32 v172, s96, v108
  v_and_b32 v172, s97, v172
  v_xor_b32 v173, s96, v109
  v_and_b32 v173, s97, v173
  v_xor_b32 v174, s96, v110
  v_and_b32 v174, s97, v174
  v_xor_b32 v175, s96, v111
  v_and_b32 v175, s97, v175
  s_waitcnt lgkmcnt(0)
  s_nop 0
  v_mfma_f32_32x32x16_bf16 v[128:143], v[176:179], v[116:119], v[160:175]
  v_mfma_f32_32x32x8_bf16 v[128:143], v[180:181], v[122:123], v[128:143]
  s_nop 7
  s_nop 3
  v_max_f32 v182, v182, v128
  v_max_f32 v182, v182, v129
  v_max_f32 v182, v182, v130
  v_max_f32 v182, v182, v131
  v_max_f32 v182, v182, v132
  v_max_f32 v182, v182, v133
  v_max_f32 v182, v182, v134
  v_max_f32 v182, v182, v135
  v_max_f32 v182, v182, v136
  v_max_f32 v182, v182, v137
  v_max_f32 v182, v182, v138
  v_max_f32 v182, v182, v139
  v_max_f32 v182, v182, v140
  v_max_f32 v182, v182, v141
  v_max_f32 v182, v182, v142
  v_max_f32 v182, v182, v143
  s_nop 7
  s_nop 7
  s_add_u32 s100, s100, 1
  s_cmp_lt_u32 s100, 9
  s_cbranch_scc1 .fl25067
  v_mov_b32 v186, v182
  s_nop 1
  v_permlane32_swap_b32 v182, v186
  v_max_f32 v182, v182, v186
  s_lshl_b32 s100, s3, 1
  s_sub_u32 s100, 7, s100
  s_cmp_lt_i32 s93, 0
  s_cselect_b32 s100, s100, 0
.fl25068:
  s_add_u32 s96, s100, 1
  s_mul_i32 s96, s96, 3072
  v_add_u32 v183, s96, v20
  v_add_u32 v184, s96, v21
  v_add_u32 v185, s96, v22
  ds_read_b128 v[176:179], v183
  ds_read_b64 v[180:181], v184
  ds_read_b128 v[224:227], v185
  ds_read_b128 v[228:231], v185 offset:768
  s_cmp_eq_u32 s100, 0
  s_cselect_b32 s96, 0xf149f2ca, 0
  s_and_b32 s97, s100, 7
  s_cselect_b32 s97, 0, -1
  v_xor_b32 v160, s96, v96
  v_and_b32 v160, s97, v160
  v_xor_b32 v161, s96, v97
  v_and_b32 v161, s97, v161
  v_xor_b32 v162, s96, v98
  v_and_b32 v162, s97, v162
  v_xor_b32 v163, s96, v99
  v_and_b32 v163, s97, v163
  v_xor_b32 v164, s96, v100
  v_and_b32 v164, s97, v164
  v_xor_b32 v165, s96, v101
  v_and_b32 v165, s97, v165
  v_xor_b32 v166, s96, v102
  v_and_b32 v166, s97, v166
  v_xor_b32 v167, s96, v103
  v_and_b32 v167, s97, v167
  v_xor_b32 v168, s96, v104
  v_and_b32 v168, s97, v168
  v_xor_b32 v169, s96, v105
  v_and_b32 v169, s97, v169
  v_xor_b32 v170, s96, v106
  v_and_b32 v170, s97, v170
  v_xor_b32 v171, s96, v107
  v_and_b32 v171, s97, v171
  v_xor_b32 v172, s96, v108
  v_and_b32 v172, s97, v172
  v_xor_b32 v173, s96, v109
  v_and_b32 v173, s97, v173
  v_xor_b32 v174, s96, v110
  v_and_b32 v174, s97, v174
  v_xor_b32 v175, s96, v111
  v_and_b32 v175, s97, v175
  s_waitcnt lgkmcnt(0)
  s_nop 0
  v_mfma_f32_32x32x16_bf16 v[128:143], v[176:179], v[116:119], v[160:175]
  v_mfma_f32_32x32x8_bf16 v[128:143], v[180:181], v[122:123], v[128:143]
  s_nop 7
  s_nop 3
  v_sub_f32 v128, v128, v182
  v_sub_f32 v129, v129, v182
  v_sub_f32 v130, v130, v182
  v_sub_f32 v131, v131, v182
  v_sub_f32 v132, v132, v182
  v_sub_f32 v133, v133, v182
  v_sub_f32 v134, v134, v182
  v_sub_f32 v135, v135, v182
  v_sub_f32 v136, v136, v182
  v_sub_f32 v137, v137, v182
  v_sub_f32 v138, v138, v182
  v_sub_f32 v139, v139, v182
  v_sub_f32 v140, v140, v182
  v_sub_f32 v141, v141, v182
  v_sub_f32 v142, v142, v182
  v_sub_f32 v143, v143, v182
  v_exp_f32 v128, v128
  v_exp_f32 v129, v129
  v_exp_f32 v130, v130
  v_exp_f32 v131, v131
  v_exp_f32 v132, v132
  v_exp_f32 v133, v133
  v_exp_f32 v134, v134
  v_exp_f32 v135, v135
  v_exp_f32 v136, v136
  v_exp_f32 v137, v137
  v_exp_f32 v138, v138
  v_exp_f32 v139, v139
  v_exp_f32 v140, v140
  v_exp_f32 v141, v141
  v_exp_f32 v142, v142
  v_exp_f32 v143, v143
  v_cvt_pk_bf16_f32 v232, v128, v129
  v_cvt_pk_bf16_f32 v233, v130, v131
  v_cvt_pk_bf16_f32 v234, v132, v133
  v_cvt_pk_bf16_f32 v235, v134, v135
  v_cvt_pk_bf16_f32 v236, v136, v137
  v_cvt_pk_bf16_f32 v237, v138, v139
  v_cvt_pk_bf16_f32 v238, v140, v141
  v_cvt_pk_bf16_f32 v239, v142, v143
  v_mfma_f32_32x32x16_bf16 v[208:223], v[224:227], v[232:235], v[208:223]
  s_nop 0
  v_mfma_f32_32x32x16_bf16 v[208:223], v[228:231], v[236:239], v[208:223]
  s_nop 7
  s_nop 7
  s_add_u32 s100, s100, 1
  s_cmp_lt_u32 s100, 9
  s_cbranch_scc1 .fl25068
  v_rcp_f32 v221, v220
  s_waitcnt vmcnt(0)
  s_nop 7
  s_branch .fbb64

.slow65:
  s_mov_b32 s100, 40000
.spin67:
  buffer_load_dword v188, v23, s[24:27], s95 offen offset:0 sc1
  s_waitcnt vmcnt(0)
  v_cmp_eq_u32 vcc, 0, v188
  s_cbranch_vccz .back66
  s_sub_u32 s100, s100, 1
  s_cbranch_scc0 .spin67
  s_branch .back66
.oc68:
  s_nop 7
  s_nop 7
  s_movk_i32 s100, 20000
.rt27070:
  s_waitcnt vmcnt(0)
  v_mov_b32 v124, 0
  v_accvgpr_read_b32 v125, a140
  v_accvgpr_read_b32 v126, a141
  s_nop 0
  v_max3_u32 v124, v124, v125, v126
  v_accvgpr_read_b32 v125, a142
  v_accvgpr_read_b32 v126, a143
  s_nop 0
  v_max3_u32 v124, v124, v125, v126
  v_accvgpr_read_b32 v125, a144
  v_accvgpr_read_b32 v126, a145
  s_nop 0
  v_max3_u32 v124, v124, v125, v126
  v_accvgpr_read_b32 v125, a146
  v_accvgpr_read_b32 v126, a147
  s_nop 0
  v_max3_u32 v124, v124, v125, v126
  v_accvgpr_read_b32 v125, a148
  v_accvgpr_read_b32 v126, a149
  s_nop 0
  v_max3_u32 v124, v124, v125, v126
  v_accvgpr_read_b32 v125, a150
  v_accvgpr_read_b32 v126, a151
  s_nop 0
  v_max3_u32 v124, v124, v125, v126
  v_accvgpr_read_b32 v125, a152
  v_accvgpr_read_b32 v126, a153
  s_nop 0
  v_max3_u32 v124, v124, v125, v126
  v_accvgpr_read_b32 v125, a154
  v_accvgpr_read_b32 v126, a155
  s_nop 0
  v_max3_u32 v124, v124, v125, v126
  v_accvgpr_read_b32 v125, a156
  v_accvgpr_read_b32 v126, a157
  s_nop 0
  v_max3_u32 v124, v124, v125, v126
  v_accvgpr_read_b32 v125, a158
  v_accvgpr_read_b32 v126, a159
  s_nop 0
  v_max3_u32 v124, v124, v125, v126
  v_cmp_eq_u32 vcc, -1, v124
  s_nop 0
  s_cbranch_vccz .rd27071
  s_sub_u32 s100, s100, 1
  s_cbranch_scc1 .rd27071
  buffer_load_dwordx4 a[140:143], v5, s[24:27], s50 offen offset:0 sc1
  buffer_load_dwordx4 a[144:147], v5, s[24:27], s50 offen offset:1024 sc1
  buffer_load_dwordx4 a[148:151], v5, s[24:27], s50 offen offset:2048 sc1
  buffer_load_dwordx4 a[152:155], v5, s[24:27], s50 offen offset:3072 sc1
  buffer_load_dwordx4 a[156:159], v5, s[24:27], s51 offen offset:0 sc1
  buffer_load_dwordx4 a[160:163], v6, s[24:27], s50 offen offset:0 sc1
  buffer_load_dwordx4 a[164:167], v6, s[24:27], s50 offen offset:1024 sc1
  buffer_load_dwordx4 a[168:171], v6, s[24:27], s50 offen offset:2048 sc1
  buffer_load_dwordx4 a[172:175], v6, s[24:27], s50 offen offset:3072 sc1
  buffer_load_dwordx4 a[176:179], v6, s[24:27], s51 offen offset:0 sc1
  buffer_load_dwordx4 a[180:183], v7, s[24:27], s50 offen offset:0 sc1
  buffer_load_dwordx4 a[184:187], v7, s[24:27], s50 offen offset:1024 sc1
  buffer_load_dwordx4 a[188:191], v7, s[24:27], s50 offen offset:2048 sc1
  buffer_load_dwordx4 a[192:195], v7, s[24:27], s50 offen offset:3072 sc1
  buffer_load_dwordx4 a[196:199], v7, s[24:27], s51 offen offset:0 sc1
  buffer_load_dwordx4 a[200:203], v4, s[24:27], s50 offen offset:0 sc1
  buffer_load_dwordx4 a[204:207], v4, s[24:27], s50 offen offset:1024 sc1
  buffer_load_dwordx4 a[208:211], v4, s[24:27], s50 offen offset:2048 sc1
  buffer_load_dwordx4 a[212:215], v4, s[24:27], s50 offen offset:3072 sc1
  buffer_load_dwordx4 a[216:219], v4, s[24:27], s51 offen offset:0 sc1
  s_branch .rt27070
.rd27071:
  v_mfma_f32_16x16x32_bf16 v[64:67], a[40:43], a[140:143], v[84:87]
  v_mfma_f32_16x16x32_bf16 v[68:71], a[44:47], a[140:143], v[88:91]
  v_mfma_f32_16x16x32_bf16 v[72:75], a[48:51], a[140:143], v[92:95]
  v_mfma_f32_16x16x32_bf16 v[76:79], a[52:55], a[140:143], v[96:99]
  v_mfma_f32_16x16x32_bf16 v[80:83], a[56:59], a[140:143], v[100:103]
  v_mfma_f32_16x16x32_bf16 v[64:67], a[60:63], a[144:147], v[64:67]
  v_mfma_f32_16x16x32_bf16 v[68:71], a[64:67], a[144:147], v[68:71]
  v_mfma_f32_16x16x32_bf16 v[72:75], a[68:71], a[144:147], v[72:75]
  v_mfma_f32_16x16x32_bf16 v[76:79], a[72:75], a[144:147], v[76:79]
  v_mfma_f32_16x16x32_bf16 v[80:83], a[76:79], a[144:147], v[80:83]
  v_mfma_f32_16x16x32_bf16 v[64:67], a[80:83], a[148:151], v[64:67]
  v_mfma_f32_16x16x32_bf16 v[68:71], a[84:87], a[148:151], v[68:71]
  v_mfma_f32_16x16x32_bf16 v[72:75], a[88:91], a[148:151], v[72:75]
  v_mfma_f32_16x16x32_bf16 v[76:79], a[92:95], a[148:151], v[76:79]
  v_mfma_f32_16x16x32_bf16 v[80:83], a[96:99], a[148:151], v[80:83]
  v_mfma_f32_16x16x32_bf16 v[64:67], a[100:103], a[152:155], v[64:67]
  v_mfma_f32_16x16x32_bf16 v[68:71], a[104:107], a[152:155], v[68:71]
  v_mfma_f32_16x16x32_bf16 v[72:75], a[108:111], a[152:155], v[72:75]
  v_mfma_f32_16x16x32_bf16 v[76:79], a[112:115], a[152:155], v[76:79]
  v_mfma_f32_16x16x32_bf16 v[80:83], a[116:119], a[152:155], v[80:83]
  v_mfma_f32_16x16x32_bf16 v[64:67], a[120:123], a[156:159], v[64:67]
  v_mfma_f32_16x16x32_bf16 v[68:71], a[124:127], a[156:159], v[68:71]
  v_mfma_f32_16x16x32_bf16 v[72:75], a[128:131], a[156:159], v[72:75]
  v_mfma_f32_16x16x32_bf16 v[76:79], a[132:135], a[156:159], v[76:79]
  v_mfma_f32_16x16x32_bf16 v[80:83], a[136:139], a[156:159], v[80:83]
  s_nop 7
  s_nop 7
  s_branch .ocb69

.oc70:
  s_nop 7
  s_nop 7
  s_movk_i32 s100, 20000
.rt28072:
  s_waitcnt vmcnt(0)
  v_mov_b32 v124, 0
  v_accvgpr_read_b32 v125, a160
  v_accvgpr_read_b32 v126, a161
  s_nop 0
  v_max3_u32 v124, v124, v125, v126
  v_accvgpr_read_b32 v125, a162
  v_accvgpr_read_b32 v126, a163
  s_nop 0
  v_max3_u32 v124, v124, v125, v126
  v_accvgpr_read_b32 v125, a164
  v_accvgpr_read_b32 v126, a165
  s_nop 0
  v_max3_u32 v124, v124, v125, v126
  v_accvgpr_read_b32 v125, a166
  v_accvgpr_read_b32 v126, a167
  s_nop 0
  v_max3_u32 v124, v124, v125, v126
  v_accvgpr_read_b32 v125, a168
  v_accvgpr_read_b32 v126, a169
  s_nop 0
  v_max3_u32 v124, v124, v125, v126
  v_accvgpr_read_b32 v125, a170
  v_accvgpr_read_b32 v126, a171
  s_nop 0
  v_max3_u32 v124, v124, v125, v126
  v_accvgpr_read_b32 v125, a172
  v_accvgpr_read_b32 v126, a173
  s_nop 0
  v_max3_u32 v124, v124, v125, v126
  v_accvgpr_read_b32 v125, a174
  v_accvgpr_read_b32 v126, a175
  s_nop 0
  v_max3_u32 v124, v124, v125, v126
  v_accvgpr_read_b32 v125, a176
  v_accvgpr_read_b32 v126, a177
  s_nop 0
  v_max3_u32 v124, v124, v125, v126
  v_accvgpr_read_b32 v125, a178
  v_accvgpr_read_b32 v126, a179
  s_nop 0
  v_max3_u32 v124, v124, v125, v126
  v_cmp_eq_u32 vcc, -1, v124
  s_nop 0
  s_cbranch_vccz .rd28073
  s_sub_u32 s100, s100, 1
  s_cbranch_scc1 .rd28073
  buffer_load_dwordx4 a[160:163], v6, s[24:27], s50 offen offset:0 sc1
  buffer_load_dwordx4 a[164:167], v6, s[24:27], s50 offen offset:1024 sc1
  buffer_load_dwordx4 a[168:171], v6, s[24:27], s50 offen offset:2048 sc1
  buffer_load_dwordx4 a[172:175], v6, s[24:27], s50 offen offset:3072 sc1
  buffer_load_dwordx4 a[176:179], v6, s[24:27], s51 offen offset:0 sc1
  buffer_load_dwordx4 a[180:183], v7, s[24:27], s50 offen offset:0 sc1
  buffer_load_dwordx4 a[184:187], v7, s[24:27], s50 offen offset:1024 sc1
  buffer_load_dwordx4 a[188:191], v7, s[24:27], s50 offen offset:2048 sc1
  buffer_load_dwordx4 a[192:195], v7, s[24:27], s50 offen offset:3072 sc1
  buffer_load_dwordx4 a[196:199], v7, s[24:27], s51 offen offset:0 sc1
  buffer_load_dwordx4 a[200:203], v4, s[24:27], s50 offen offset:0 sc1
  buffer_load_dwordx4 a[204:207], v4, s[24:27], s50 offen offset:1024 sc1
  buffer_load_dwordx4 a[208:211], v4, s[24:27], s50 offen offset:2048 sc1
  buffer_load_dwordx4 a[212:215], v4, s[24:27], s50 offen offset:3072 sc1
  buffer_load_dwordx4 a[216:219], v4, s[24:27], s51 offen offset:0 sc1
  s_branch .rt28072
.rd28073:
  v_mfma_f32_16x16x32_bf16 v[128:131], a[40:43], a[160:163], v[104:107]
  v_mfma_f32_16x16x32_bf16 v[132:135], a[44:47], a[160:163], v[108:111]
  v_mfma_f32_16x16x32_bf16 v[136:139], a[48:51], a[160:163], v[112:115]
  v_mfma_f32_16x16x32_bf16 v[140:143], a[52:55], a[160:163], v[116:119]
  v_mfma_f32_16x16x32_bf16 v[160:163], a[56:59], a[160:163], v[120:123]
  v_mfma_f32_16x16x32_bf16 v[128:131], a[60:63], a[164:167], v[128:131]
  v_mfma_f32_16x16x32_bf16 v[132:135], a[64:67], a[164:167], v[132:135]
  v_mfma_f32_16x16x32_bf16 v[136:139], a[68:71], a[164:167], v[136:139]
  v_mfma_f32_16x16x32_bf16 v[140:143], a[72:75], a[164:167], v[140:143]
  v_mfma_f32_16x16x32_bf16 v[160:163], a[76:79], a[164:167], v[160:163]
  v_mfma_f32_16x16x32_bf16 v[128:131], a[80:83], a[168:171], v[128:131]
  v_mfma_f32_16x16x32_bf16 v[132:135], a[84:87], a[168:171], v[132:135]
  v_mfma_f32_16x16x32_bf16 v[136:139], a[88:91], a[168:171], v[136:139]
  v_mfma_f32_16x16x32_bf16 v[140:143], a[92:95], a[168:171], v[140:143]
  v_mfma_f32_16x16x32_bf16 v[160:163], a[96:99], a[168:171], v[160:163]
  v_mfma_f32_16x16x32_bf16 v[128:131], a[100:103], a[172:175], v[128:131]
  v_mfma_f32_16x16x32_bf16 v[132:135], a[104:107], a[172:175], v[132:135]
  v_mfma_f32_16x16x32_bf16 v[136:139], a[108:111], a[172:175], v[136:139]
  v_mfma_f32_16x16x32_bf16 v[140:143], a[112:115], a[172:175], v[140:143]
  v_mfma_f32_16x16x32_bf16 v[160:163], a[116:119], a[172:175], v[160:163]
  v_mfma_f32_16x16x32_bf16 v[128:131], a[120:123], a[176:179], v[128:131]
  v_mfma_f32_16x16x32_bf16 v[132:135], a[124:127], a[176:179], v[132:135]
  v_mfma_f32_16x16x32_bf16 v[136:139], a[128:131], a[176:179], v[136:139]
  v_mfma_f32_16x16x32_bf16 v[140:143], a[132:135], a[176:179], v[140:143]
  v_mfma_f32_16x16x32_bf16 v[160:163], a[136:139], a[176:179], v[160:163]
  s_nop 7
  s_nop 7
  s_branch .ocb71

.oc72:
  s_nop 7
  s_nop 7
  s_movk_i32 s100, 20000
.rt29074:
  s_waitcnt vmcnt(0)
  v_mov_b32 v124, 0
  v_accvgpr_read_b32 v125, a180
  v_accvgpr_read_b32 v126, a181
  s_nop 0
  v_max3_u32 v124, v124, v125, v126
  v_accvgpr_read_b32 v125, a182
  v_accvgpr_read_b32 v126, a183
  s_nop 0
  v_max3_u32 v124, v124, v125, v126
  v_accvgpr_read_b32 v125, a184
  v_accvgpr_read_b32 v126, a185
  s_nop 0
  v_max3_u32 v124, v124, v125, v126
  v_accvgpr_read_b32 v125, a186
  v_accvgpr_read_b32 v126, a187
  s_nop 0
  v_max3_u32 v124, v124, v125, v126
  v_accvgpr_read_b32 v125, a188
  v_accvgpr_read_b32 v126, a189
  s_nop 0
  v_max3_u32 v124, v124, v125, v126
  v_accvgpr_read_b32 v125, a190
  v_accvgpr_read_b32 v126, a191
  s_nop 0
  v_max3_u32 v124, v124, v125, v126
  v_accvgpr_read_b32 v125, a192
  v_accvgpr_read_b32 v126, a193
  s_nop 0
  v_max3_u32 v124, v124, v125, v126
  v_accvgpr_read_b32 v125, a194
  v_accvgpr_read_b32 v126, a195
  s_nop 0
  v_max3_u32 v124, v124, v125, v126
  v_accvgpr_read_b32 v125, a196
  v_accvgpr_read_b32 v126, a197
  s_nop 0
  v_max3_u32 v124, v124, v125, v126
  v_accvgpr_read_b32 v125, a198
  v_accvgpr_read_b32 v126, a199
  s_nop 0
  v_max3_u32 v124, v124, v125, v126
  v_cmp_eq_u32 vcc, -1, v124
  s_nop 0
  s_cbranch_vccz .rd29075
  s_sub_u32 s100, s100, 1
  s_cbranch_scc1 .rd29075
  buffer_load_dwordx4 a[180:183], v7, s[24:27], s50 offen offset:0 sc1
  buffer_load_dwordx4 a[184:187], v7, s[24:27], s50 offen offset:1024 sc1
  buffer_load_dwordx4 a[188:191], v7, s[24:27], s50 offen offset:2048 sc1
  buffer_load_dwordx4 a[192:195], v7, s[24:27], s50 offen offset:3072 sc1
  buffer_load_dwordx4 a[196:199], v7, s[24:27], s51 offen offset:0 sc1
  buffer_load_dwordx4 a[200:203], v4, s[24:27], s50 offen offset:0 sc1
  buffer_load_dwordx4 a[204:207], v4, s[24:27], s50 offen offset:1024 sc1
  buffer_load_dwordx4 a[208:211], v4, s[24:27], s50 offen offset:2048 sc1
  buffer_load_dwordx4 a[212:215], v4, s[24:27], s50 offen offset:3072 sc1
  buffer_load_dwordx4 a[216:219], v4, s[24:27], s51 offen offset:0 sc1
  s_branch .rt29074
.rd29075:
  v_mfma_f32_16x16x32_bf16 v[84:87], a[40:43], a[180:183], v[40:43]
  v_mfma_f32_16x16x32_bf16 v[88:91], a[44:47], a[180:183], v[44:47]
  v_mfma_f32_16x16x32_bf16 v[92:95], a[48:51], a[180:183], v[48:51]
  v_mfma_f32_16x16x32_bf16 v[96:99], a[52:55], a[180:183], v[52:55]
  v_mfma_f32_16x16x32_bf16 v[100:103], a[56:59], a[180:183], v[36:39]
  v_mfma_f32_16x16x32_bf16 v[84:87], a[60:63], a[184:187], v[84:87]
  v_mfma_f32_16x16x32_bf16 v[88:91], a[64:67], a[184:187], v[88:91]
  v_mfma_f32_16x16x32_bf16 v[92:95], a[68:71], a[184:187], v[92:95]
  v_mfma_f32_16x16x32_bf16 v[96:99], a[72:75], a[184:187], v[96:99]
  v_mfma_f32_16x16x32_bf16 v[100:103], a[76:79], a[184:187], v[100:103]
  v_mfma_f32_16x16x32_bf16 v[84:87], a[80:83], a[188:191], v[84:87]
  v_mfma_f32_16x16x32_bf16 v[88:91], a[84:87], a[188:191], v[88:91]
  v_mfma_f32_16x16x32_bf16 v[92:95], a[88:91], a[188:191], v[92:95]
  v_mfma_f32_16x16x32_bf16 v[96:99], a[92:95], a[188:191], v[96:99]
  v_mfma_f32_16x16x32_bf16 v[100:103], a[96:99], a[188:191], v[100:103]
  v_mfma_f32_16x16x32_bf16 v[84:87], a[100:103], a[192:195], v[84:87]
  v_mfma_f32_16x16x32_bf16 v[88:91], a[104:107], a[192:195], v[88:91]
  v_mfma_f32_16x16x32_bf16 v[92:95], a[108:111], a[192:195], v[92:95]
  v_mfma_f32_16x16x32_bf16 v[96:99], a[112:115], a[192:195], v[96:99]
  v_mfma_f32_16x16x32_bf16 v[100:103], a[116:119], a[192:195], v[100:103]
  v_mfma_f32_16x16x32_bf16 v[84:87], a[120:123], a[196:199], v[84:87]
  v_mfma_f32_16x16x32_bf16 v[88:91], a[124:127], a[196:199], v[88:91]
  v_mfma_f32_16x16x32_bf16 v[92:95], a[128:131], a[196:199], v[92:95]
  v_mfma_f32_16x16x32_bf16 v[96:99], a[132:135], a[196:199], v[96:99]
  v_mfma_f32_16x16x32_bf16 v[100:103], a[136:139], a[196:199], v[100:103]
  s_nop 7
  s_nop 7
  s_branch .ocb73

.oc74:
  s_nop 7
  s_nop 7
  s_movk_i32 s100, 20000
.rt30076:
  s_waitcnt vmcnt(0)
  v_mov_b32 v124, 0
  v_accvgpr_read_b32 v125, a200
  v_accvgpr_read_b32 v126, a201
  s_nop 0
  v_max3_u32 v124, v124, v125, v126
  v_accvgpr_read_b32 v125, a202
  v_accvgpr_read_b32 v126, a203
  s_nop 0
  v_max3_u32 v124, v124, v125, v126
  v_accvgpr_read_b32 v125, a204
  v_accvgpr_read_b32 v126, a205
  s_nop 0
  v_max3_u32 v124, v124, v125, v126
  v_accvgpr_read_b32 v125, a206
  v_accvgpr_read_b32 v126, a207
  s_nop 0
  v_max3_u32 v124, v124, v125, v126
  v_accvgpr_read_b32 v125, a208
  v_accvgpr_read_b32 v126, a209
  s_nop 0
  v_max3_u32 v124, v124, v125, v126
  v_accvgpr_read_b32 v125, a210
  v_accvgpr_read_b32 v126, a211
  s_nop 0
  v_max3_u32 v124, v124, v125, v126
  v_accvgpr_read_b32 v125, a212
  v_accvgpr_read_b32 v126, a213
  s_nop 0
  v_max3_u32 v124, v124, v125, v126
  v_accvgpr_read_b32 v125, a214
  v_accvgpr_read_b32 v126, a215
  s_nop 0
  v_max3_u32 v124, v124, v125, v126
  v_accvgpr_read_b32 v125, a216
  v_accvgpr_read_b32 v126, a217
  s_nop 0
  v_max3_u32 v124, v124, v125, v126
  v_accvgpr_read_b32 v125, a218
  v_accvgpr_read_b32 v126, a219
  s_nop 0
  v_max3_u32 v124, v124, v125, v126
  v_cmp_eq_u32 vcc, -1, v124
  s_nop 0
  s_cbranch_vccz .rd30077
  s_sub_u32 s100, s100, 1
  s_cbranch_scc1 .rd30077
  buffer_load_dwordx4 a[200:203], v4, s[24:27], s50 offen offset:0 sc1
  buffer_load_dwordx4 a[204:207], v4, s[24:27], s50 offen offset:1024 sc1
  buffer_load_dwordx4 a[208:211], v4, s[24:27], s50 offen offset:2048 sc1
  buffer_load_dwordx4 a[212:215], v4, s[24:27], s50 offen offset:3072 sc1
  buffer_load_dwordx4 a[216:219], v4, s[24:27], s51 offen offset:0 sc1
  s_branch .rt30076
.rd30077:
  v_mfma_f32_16x16x32_bf16 v[104:107], a[40:43], a[200:203], v[24:27]
  v_mfma_f32_16x16x32_bf16 v[108:111], a[44:47], a[200:203], v[28:31]
  v_mfma_f32_16x16x32_bf16 v[112:115], a[48:51], a[200:203], v[56:59]
  v_mfma_f32_16x16x32_bf16 v[116:119], a[52:55], a[200:203], v[60:63]
  v_mfma_f32_16x16x32_bf16 v[120:123], a[56:59], a[200:203], v[32:35]
  v_mfma_f32_16x16x32_bf16 v[104:107], a[60:63], a[204:207], v[104:107]
  v_mfma_f32_16x16x32_bf16 v[108:111], a[64:67], a[204:207], v[108:111]
  v_mfma_f32_16x16x32_bf16 v[112:115], a[68:71], a[204:207], v[112:115]
  v_mfma_f32_16x16x32_bf16 v[116:119], a[72:75], a[204:207], v[116:119]
  v_mfma_f32_16x16x32_bf16 v[120:123], a[76:79], a[204:207], v[120:123]
  v_mfma_f32_16x16x32_bf16 v[104:107], a[80:83], a[208:211], v[104:107]
  v_mfma_f32_16x16x32_bf16 v[108:111], a[84:87], a[208:211], v[108:111]
  v_mfma_f32_16x16x32_bf16 v[112:115], a[88:91], a[208:211], v[112:115]
  v_mfma_f32_16x16x32_bf16 v[116:119], a[92:95], a[208:211], v[116:119]
  v_mfma_f32_16x16x32_bf16 v[120:123], a[96:99], a[208:211], v[120:123]
  v_mfma_f32_16x16x32_bf16 v[104:107], a[100:103], a[212:215], v[104:107]
  v_mfma_f32_16x16x32_bf16 v[108:111], a[104:107], a[212:215], v[108:111]
  v_mfma_f32_16x16x32_bf16 v[112:115], a[108:111], a[212:215], v[112:115]
  v_mfma_f32_16x16x32_bf16 v[116:119], a[112:115], a[212:215], v[116:119]
  v_mfma_f32_16x16x32_bf16 v[120:123], a[116:119], a[212:215], v[120:123]
  v_mfma_f32_16x16x32_bf16 v[104:107], a[120:123], a[216:219], v[104:107]
  v_mfma_f32_16x16x32_bf16 v[108:111], a[124:127], a[216:219], v[108:111]
  v_mfma_f32_16x16x32_bf16 v[112:115], a[128:131], a[216:219], v[112:115]
  v_mfma_f32_16x16x32_bf16 v[116:119], a[132:135], a[216:219], v[116:119]
  v_mfma_f32_16x16x32_bf16 v[120:123], a[136:139], a[216:219], v[120:123]
  s_nop 7
  s_nop 7
  s_branch .ocb75

.Lend:
  s_endpgm
.if (.-.LV) < 65792
.fill (65792-(.-.LV))/4, 4, 0xbf810000
.endif
.section .rodata,"a"
.p2align 6
.amdhsa_kernel parallel_sum__sliding_block__glu_gated_reglu__prompt_kernel
  .amdhsa_next_free_vgpr 512
  .amdhsa_next_free_sgpr 102
  .amdhsa_accum_offset 256
  .amdhsa_group_segment_fixed_size 0
  .amdhsa_kernarg_size 80
  .amdhsa_user_sgpr_count 2
  .amdhsa_user_sgpr_kernarg_segment_ptr 1
  .amdhsa_system_sgpr_workgroup_id_x 1
.end_amdhsa_kernel
```
